```python
import torch

def _softmax(x, axis=-1):
    return torch.softmax(x, dim=axis)
def _gelu(x):
    return torch.nn.functional.gelu(x, approximate="tanh")
def _silu(x):
    return torch.nn.functional.silu(x)
def _sigmoid(x):
    return torch.sigmoid(x)
def _layernorm(x, axis=-1, eps=1e-5):
    m = x.mean(dim=axis, keepdim=True)
    v = x.var(dim=axis, keepdim=True, unbiased=False)
    return (x - m) / torch.sqrt(v + eps)
def _scatter_add(tgt, idx, src, axis=0):
    return tgt.clone().index_add_(axis, idx, src)
def _segment_sum(src, seg, n):
    out = torch.zeros((n,) + src.shape[1:], dtype=src.dtype)
    return out.index_add_(0, seg, src)
def _pad(x, pw):
    flat = tuple(v for pair in reversed(pw) for v in pair)
    return torch.nn.functional.pad(x, flat)

kernel_name = 'gated_mix__compressed_kv_cla__geglu_ffn__prompt'

def setup_inputs():

    _w = (lambda a: (lambda t: t.to(torch.bfloat16) if t.is_floating_point() else t)(torch.as_tensor(a)))
    def _A_setup():
        B, H, Sq, Sk, D, M = 1, 32, 2048, 2048, 128, 1024
        Dc = 4 * D
        return {
            "x": _w((lambda *s: torch.randn(*s, dtype=torch.bfloat16) * 0.05)(B, Sq, M)),
            "c_kv": _w((lambda *s: torch.randn(*s, dtype=torch.bfloat16) * 0.4)(B, Sk, Dc)),
            "w_q": _w((lambda *s: torch.randn(*s, dtype=torch.bfloat16) * 6.4)(M, H, D) * (M ** -0.5)),
            "w_uk": _w((lambda *s: torch.randn(*s, dtype=torch.bfloat16) * 6.4)(Dc, H, D) * (Dc ** -0.5)),
            "w_uv": _w((lambda *s: torch.randn(*s, dtype=torch.bfloat16) * 0.4)(Dc, H, D) * (Dc ** -0.5)),
            "w_o": _w((lambda *s: torch.randn(*s, dtype=torch.bfloat16) * 0.4)(H, D, M) * ((H * D) ** -0.5)),
        }
    _A_in = _A_setup()

    def _B_setup():
        B, S, D, F = 1, 2048, 1024, 3584
        return {
            "x": _w((lambda *s: torch.randn(*s, dtype=torch.bfloat16) * 0.05)(B, S, D)),
            "w_gate": _w((lambda *s: torch.randn(*s, dtype=torch.bfloat16) * 0.05)(D, F)),
            "w_up": _w((lambda *s: torch.randn(*s, dtype=torch.bfloat16) * 0.05)(D, F)),
            "w_down": _w((lambda *s: torch.randn(*s, dtype=torch.bfloat16) * 0.05)(F, D)),
        }
    _B_in = _B_setup()

    return {
        "A_x": _A_in["x"],
        "A_c_kv": _A_in["c_kv"],
        "A_w_q": _A_in["w_q"],
        "A_w_uk": _A_in["w_uk"],
        "A_w_uv": _A_in["w_uv"],
        "A_w_o": _A_in["w_o"],
        "B_x": _B_in["x"],
        "B_w_gate": _B_in["w_gate"],
        "B_w_up": _B_in["w_up"],
        "B_w_down": _B_in["w_down"],
        "gate_w": _w((lambda *s: torch.randn(*s, dtype=torch.bfloat16) * 0.05)(1024) * 16.0),
    }

def reference(A_x, A_c_kv, A_w_q, A_w_uk, A_w_uv, A_w_o, B_x, B_w_gate, B_w_up, B_w_down, gate_w):
    def _A_ref(x, c_kv, w_q, w_uk, w_uv, w_o):
        B, Sq, M = x.shape[0], x.shape[1], x.shape[2]
        Sk = c_kv.shape[1]
        H, D = w_q.shape[1], w_q.shape[2]
        q = torch.einsum("bqm,mhd->bhqd", x, w_q)
        k = torch.einsum("bkc,chd->bhkd", c_kv, w_uk)
        v = torch.einsum("bkc,chd->bhkd", c_kv, w_uv)
        scores = torch.einsum("bhqd,bhkd->bhqk", q, k) * (D ** -0.5)
        off = Sk - Sq
        qi = torch.arange(Sq)[:, None]
        kj = torch.arange(Sk)[None, :]
        cmask = kj <= (qi + off)
        scores = torch.where(cmask[None, None], scores, -1e9)
        p = _softmax(scores, axis=-1)
        ctx = torch.einsum("bhqk,bhkd->bhqd", p, v)
        return torch.einsum("bhqd,hdm->bqm", ctx, w_o)

    def _B_ref(x, w_gate, w_up, w_down):
        return (_gelu(x @ w_gate) * (x @ w_up)) @ w_down

    x = A_x
    g = _sigmoid((x * gate_w).sum(-1, keepdims=True))
    a = _A_ref(x, A_c_kv, A_w_q, A_w_uk, A_w_uv, A_w_o)
    b = _B_ref(x, B_w_gate, B_w_up, B_w_down)
    return g * a + (1 - g) * b
```

```asm
; @launch grid=(256,1,1) block=(256,1,1) lds=163840
.amdgcn_target "amdgcn-amd-amdhsa--gfx950"
.text
.globl gated_mix__compressed_kv_cla__geglu_ffn__prompt_kernel
.p2align 8
.type gated_mix__compressed_kv_cla__geglu_ffn__prompt_kernel,@function
gated_mix__compressed_kv_cla__geglu_ffn__prompt_kernel:
  s_cmp_ge_u32 s2, 256
  s_cbranch_scc1 mk_end
  s_load_dwordx16 s[16:31], s[0:1], 0
  s_load_dwordx8 s[32:39], s[0:1], 64
  s_load_dwordx4 s[40:43], s[0:1], 96
  v_lshrrev_b32 v27, 6, v0
  v_and_b32 v0, 63, v0
  v_readfirstlane_b32 s67, v27
  v_lshlrev_b32 v29, 2, v0
  s_and_b32 s76, s2, 7
  s_lshr_b32 s77, s2, 3
  s_and_b32 s78, s76, 1
  s_lshl_b32 s78, s78, 2
  s_and_b32 s79, s77, 3
  s_add_u32 s69, s78, s79
  s_lshr_b32 s76, s76, 1
  s_lshr_b32 s78, s77, 2
  s_lshl_b32 s79, s76, 3
  s_add_u32 s71, s79, s78
  s_and_b32 s78, s78, 3
  s_lshl_b32 s79, s76, 2
  s_add_u32 s70, s79, s78
  s_lshr_b32 s68, s77, 4
  s_mov_b32 s47, 0x20000
  s_mov_b32 s51, 0x20000
  s_mov_b32 s55, 0x20000
  s_mov_b32 s11, 0x20000
  s_mov_b32 s15, 0x20000
  s_mov_b32 s54, 268435456
  s_mov_b32 s10, 256
  s_mov_b32 s74, 8192
  s_mov_b32 s75, -16384
  s_mov_b32 s72, 0
  s_mul_i32 s62, s67, 24576
  s_add_u32 s62, s62, 65536
  s_add_u32 s63, s62, 24576
  s_mov_b32 s61, s62
  v_lshrrev_b32 v27, 3, v0
  s_lshl_b32 s76, s67, 6
  v_add_u32 v27, s76, v27
  v_and_b32 v28, 7, v0
  v_lshrrev_b32 v26, 4, v0
  v_xor_b32 v28, v28, v26
  v_xor_b32 v26, 4, v28
  s_movk_i32 s77, 11
  s_sub_u32 s77, s77, s68
  v_add_u32 v30, 0, v27
  v_lshlrev_b32 v31, s77, v30
  v_lshl_add_u32 v31, v28, 4, v31
  v_subrev_u32 v10, 0, v31
  v_add_u32 v30, 8, v27
  v_lshlrev_b32 v31, s77, v30
  v_lshl_add_u32 v31, v26, 4, v31
  v_subrev_u32 v11, 1024, v31
  v_add_u32 v30, 16, v27
  v_lshlrev_b32 v31, s77, v30
  v_lshl_add_u32 v31, v28, 4, v31
  v_subrev_u32 v12, 2048, v31
  v_add_u32 v30, 24, v27
  v_lshlrev_b32 v31, s77, v30
  v_lshl_add_u32 v31, v26, 4, v31
  v_subrev_u32 v13, 3072, v31
  v_lshrrev_b32 v27, 5, v0
  s_lshl_b32 s76, s67, 3
  v_bfe_u32 v28, v0, 2, 3
  v_and_b32 v26, 3, v0
  s_and_b32 s77, s67, 1
  s_lshl_b32 s77, s77, 1
  v_xor_b32 v26, s77, v26
  v_lshlrev_b32 v26, 4, v26
  v_add_u32 v30, 0, v27
  v_and_b32 v31, 3, v30
  v_xor_b32 v31, v31, v28
  v_add_u32 v30, s76, v30
  v_lshlrev_b32 v30, 13, v30
  v_lshl_add_u32 v30, v31, 6, v30
  v_add_u32 v30, v30, v26
  v_subrev_u32 v14, 0, v30
  v_add_u32 v30, 2, v27
  v_and_b32 v31, 3, v30
  v_xor_b32 v31, v31, v28
  v_add_u32 v30, s76, v30
  v_lshlrev_b32 v30, 13, v30
  v_lshl_add_u32 v30, v31, 6, v30
  v_add_u32 v30, v30, v26
  v_subrev_u32 v15, 1024, v30
  v_add_u32 v30, 4, v27
  v_and_b32 v31, 3, v30
  v_xor_b32 v31, v31, v28
  v_add_u32 v30, s76, v30
  v_lshlrev_b32 v30, 13, v30
  v_lshl_add_u32 v30, v31, 6, v30
  v_add_u32 v30, v30, v26
  v_subrev_u32 v16, 2048, v30
  v_add_u32 v30, 6, v27
  v_and_b32 v31, 3, v30
  v_xor_b32 v31, v31, v28
  v_add_u32 v30, s76, v30
  v_lshlrev_b32 v30, 13, v30
  v_lshl_add_u32 v30, v31, 6, v30
  v_add_u32 v30, v30, v26
  v_subrev_u32 v17, 3072, v30
  s_lshl_b32 s64, s67, 12
  s_mov_b32 s65, s64
  s_waitcnt lgkmcnt(0)
  s_mov_b32 s52, s42
  s_mov_b32 s53, s43
  s_mov_b32 s8, s40
  s_mov_b32 s9, s41
  s_cmp_eq_u32 s68, 0
  s_cselect_b32 s44, s16, s18
  s_cselect_b32 s45, s17, s19
  s_cselect_b32 s48, s20, s22
  s_cselect_b32 s49, s21, s23
  s_cselect_b32 s66, 8, 4
  s_lshr_b32 s46, 4194304, s68
  s_lshr_b32 s50, 8388608, s68
  s_lshl_b32 s56, s69, 19
  s_lshr_b32 s56, s56, s68
  s_lshr_b32 s60, 65536, s68
  s_lshl_b32 s58, s70, 9
  s_mov_b32 s59, 262144
  s_mov_b32 s12, s16
  s_mov_b32 s13, s17
  s_mov_b32 s14, 4194304
  s_lshl_b32 s76, s2, 3
  s_lshl_b32 s77, s67, 1
  s_add_u32 s76, s76, s77
  s_lshl_b32 s77, s76, 11
  v_lshlrev_b32 v27, 5, v0
  buffer_load_dwordx4 v[32:35], v27, s[12:15], s77 offen
  buffer_load_dwordx4 v[36:39], v27, s[12:15], s77 offen offset:16
  buffer_load_dwordx4 v[40:43], v27, s[12:15], s77 offen offset:2048
  buffer_load_dwordx4 v[44:47], v27, s[12:15], s77 offen offset:2064
  s_mov_b32 s12, s36
  s_mov_b32 s13, s37
  s_mov_b32 s14, 2048
  buffer_load_dwordx4 v[48:51], v27, s[12:15], 0 offen
  buffer_load_dwordx4 v[52:55], v27, s[12:15], 0 offen offset:16
  s_lshl_b32 s100, s76, 2
  s_add_u32 s100, s100, 83886080
  s_add_u32 m0, s64, 0
  s_nop 0
  buffer_load_dwordx4 v14, s[48:51], s58 offen offset:0 lds
  buffer_load_dwordx4 v15, s[48:51], s58 offen offset:1024 lds
  buffer_load_dwordx4 v16, s[48:51], s58 offen offset:2048 lds
  buffer_load_dwordx4 v17, s[48:51], s58 offen offset:3072 lds
  s_add_u32 s58, s58, s59
  s_mov_b32 m0, s61
  s_nop 0
  buffer_load_dwordx4 v10, s[44:47], s56 offen offset:0 lds
  buffer_load_dwordx4 v11, s[44:47], s56 offen offset:1024 lds
  buffer_load_dwordx4 v12, s[44:47], s56 offen offset:2048 lds
  buffer_load_dwordx4 v13, s[44:47], s56 offen offset:3072 lds
  s_add_u32 s57, s56, s60
  s_add_u32 s56, s56, 128
  s_add_u32 m0, s61, 4096
  s_nop 0
  buffer_load_dwordx4 v10, s[44:47], s57 offen offset:0 lds
  buffer_load_dwordx4 v11, s[44:47], s57 offen offset:1024 lds
  buffer_load_dwordx4 v12, s[44:47], s57 offen offset:2048 lds
  buffer_load_dwordx4 v13, s[44:47], s57 offen offset:3072 lds
  s_add_u32 s61, s61, 8192
  s_cmp_eq_u32 s61, s63
  s_cselect_b32 s61, s62, s61
  s_add_u32 m0, s64, 16384
  s_nop 0
  buffer_load_dwordx4 v14, s[48:51], s58 offen offset:0 lds
  buffer_load_dwordx4 v15, s[48:51], s58 offen offset:1024 lds
  buffer_load_dwordx4 v16, s[48:51], s58 offen offset:2048 lds
  buffer_load_dwordx4 v17, s[48:51], s58 offen offset:3072 lds
  s_add_u32 s58, s58, s59
  s_mov_b32 m0, s61
  s_nop 0
  buffer_load_dwordx4 v10, s[44:47], s56 offen offset:0 lds
  buffer_load_dwordx4 v11, s[44:47], s56 offen offset:1024 lds
  buffer_load_dwordx4 v12, s[44:47], s56 offen offset:2048 lds
  buffer_load_dwordx4 v13, s[44:47], s56 offen offset:3072 lds
  s_add_u32 s57, s56, s60
  s_add_u32 s56, s56, 128
  s_add_u32 m0, s64, 32768
  s_nop 0
  buffer_load_dwordx4 v14, s[48:51], s58 offen offset:0 lds
  buffer_load_dwordx4 v15, s[48:51], s58 offen offset:1024 lds
  buffer_load_dwordx4 v16, s[48:51], s58 offen offset:2048 lds
  buffer_load_dwordx4 v17, s[48:51], s58 offen offset:3072 lds
  s_add_u32 s58, s58, s59
  s_add_u32 m0, s61, 4096
  s_nop 0
  buffer_load_dwordx4 v10, s[44:47], s57 offen offset:0 lds
  buffer_load_dwordx4 v11, s[44:47], s57 offen offset:1024 lds
  buffer_load_dwordx4 v12, s[44:47], s57 offen offset:2048 lds
  buffer_load_dwordx4 v13, s[44:47], s57 offen offset:3072 lds
  s_add_u32 s61, s61, 8192
  s_cmp_eq_u32 s61, s63
  s_cselect_b32 s61, s62, s61
  v_and_b32 v27, 15, v0
  v_lshrrev_b32 v28, 4, v0
  v_lshrrev_b32 v26, 1, v27
  v_lshlrev_b32 v30, 7, v27
  v_add_u32 v30, s62, v30
  v_add_u32 v31, 0, v28
  v_xor_b32 v31, v31, v26
  v_lshl_add_u32 v1, v31, 4, v30
  v_add_u32 v31, 4, v28
  v_xor_b32 v31, v31, v26
  v_lshl_add_u32 v2, v31, 4, v30
  v_and_b32 v30, 3, v27
  v_bfe_u32 v31, v27, 2, 1
  v_lshl_add_u32 v30, v31, 3, v30
  v_bfe_u32 v31, v27, 3, 1
  v_lshl_add_u32 v30, v31, 2, v30
  v_lshrrev_b32 v26, 1, v30
  v_lshlrev_b32 v30, 7, v30
  v_add_u32 v30, s62, v30
  v_add_u32 v31, 0, v28
  v_xor_b32 v31, v31, v26
  v_lshl_add_u32 v31, v31, 4, v30
  v_sub_u32 v3, v31, v1
  v_add_u32 v31, 4, v28
  v_xor_b32 v31, v31, v26
  v_lshl_add_u32 v31, v31, 4, v30
  v_sub_u32 v4, v31, v2
  v_bfe_u32 v27, v0, 2, 2
  v_and_b32 v30, 3, v0
  v_lshl_add_u32 v31, v28, 3, v27
  v_lshlrev_b32 v30, 3, v30
  v_mul_u32_u24 v9, 224, v27
  v_mul_u32_u24 v26, 1920, v28
  v_add3_u32 v9, v9, v26, v30
  v_lshl_add_u32 v31, v31, 9, v30
  v_lshlrev_b32 v27, 1, v27
  v_and_b32 v26, 1, v28
  v_xor_b32 v27, v27, v26
  v_xor_b32 v30, 0, v27
  v_lshl_add_u32 v5, v30, 5, v31
  v_xor_b32 v30, 1, v27
  v_lshl_add_u32 v6, v30, 5, v31
  v_xor_b32 v30, 2, v27
  v_lshl_add_u32 v7, v30, 5, v31
  v_xor_b32 v30, 3, v27
  v_lshl_add_u32 v8, v30, 5, v31
  v_xor_b32 v30, 4, v27
  v_lshl_add_u32 v18, v30, 5, v31
  v_xor_b32 v30, 5, v27
  v_lshl_add_u32 v19, v30, 5, v31
  v_xor_b32 v30, 6, v27
  v_lshl_add_u32 v20, v30, 5, v31
  v_xor_b32 v30, 7, v27
  v_lshl_add_u32 v21, v30, 5, v31
  s_and_b32 s76, s67, 1
  s_lshl_b32 s77, s76, 8
  v_add_u32 v27, s77, v0
  v_add_u32 v28, 0, v27
  v_mul_u32_u24 v30, 547, v28
  v_lshrrev_b32 v30, 16, v30
  v_mul_u32_u24 v31, 120, v30
  v_sub_u32 v31, v28, v31
  v_mul_u32_u24 v26, 4682, v31
  v_lshrrev_b32 v26, 16, v26
  v_mul_u32_u24 v28, 14, v26
  v_sub_u32 v31, v31, v28
  v_lshl_add_u32 v28, v30, 3, v26
  v_mul_u32_u24 v28, 7168, v28
  v_lshl_add_u32 v28, v31, 4, v28
  v_subrev_u32 v28, 0, v28
  v_lshrrev_b32 v26, 3, v26
  v_lshrrev_b32 v30, 2, v30
  v_or_b32 v30, v30, v26
  v_lshl_or_b32 v22, v30, 30, v28
  v_add_u32 v28, 64, v27
  v_mul_u32_u24 v30, 547, v28
  v_lshrrev_b32 v30, 16, v30
  v_mul_u32_u24 v31, 120, v30
  v_sub_u32 v31, v28, v31
  v_mul_u32_u24 v26, 4682, v31
  v_lshrrev_b32 v26, 16, v26
  v_mul_u32_u24 v28, 14, v26
  v_sub_u32 v31, v31, v28
  v_lshl_add_u32 v28, v30, 3, v26
  v_mul_u32_u24 v28, 7168, v28
  v_lshl_add_u32 v28, v31, 4, v28
  v_subrev_u32 v28, 1024, v28
  v_lshrrev_b32 v26, 3, v26
  v_lshrrev_b32 v30, 2, v30
  v_or_b32 v30, v30, v26
  v_lshl_or_b32 v23, v30, 30, v28
  v_add_u32 v28, 128, v27
  v_mul_u32_u24 v30, 547, v28
  v_lshrrev_b32 v30, 16, v30
  v_mul_u32_u24 v31, 120, v30
  v_sub_u32 v31, v28, v31
  v_mul_u32_u24 v26, 4682, v31
  v_lshrrev_b32 v26, 16, v26
  v_mul_u32_u24 v28, 14, v26
  v_sub_u32 v31, v31, v28
  v_lshl_add_u32 v28, v30, 3, v26
  v_mul_u32_u24 v28, 7168, v28
  v_lshl_add_u32 v28, v31, 4, v28
  v_subrev_u32 v28, 2048, v28
  v_lshrrev_b32 v26, 3, v26
  v_lshrrev_b32 v30, 2, v30
  v_or_b32 v30, v30, v26
  v_lshl_or_b32 v24, v30, 30, v28
  v_add_u32 v28, 192, v27
  v_mul_u32_u24 v30, 547, v28
  v_lshrrev_b32 v30, 16, v30
  v_mul_u32_u24 v31, 120, v30
  v_sub_u32 v31, v28, v31
  v_mul_u32_u24 v26, 4682, v31
  v_lshrrev_b32 v26, 16, v26
  v_mul_u32_u24 v28, 14, v26
  v_sub_u32 v31, v31, v28
  v_lshl_add_u32 v28, v30, 3, v26
  v_mul_u32_u24 v28, 7168, v28
  v_lshl_add_u32 v28, v31, 4, v28
  v_subrev_u32 v28, 3072, v28
  v_lshrrev_b32 v26, 3, v26
  v_lshrrev_b32 v30, 2, v30
  v_or_b32 v30, v30, v26
  v_lshl_or_b32 v25, v30, 30, v28
  s_cmp_eq_u32 s68, 0
  s_cbranch_scc0 mk_nB
  s_mov_b32 s81, s16
  s_mov_b32 s82, s17
  s_mov_b32 s83, 4194304
  s_lshl_b32 s84, s69, 19
  s_mov_b32 s85, 65536
  s_cmp_lt_u32 s67, 2
  s_cselect_b32 s86, s30, s32
  s_cselect_b32 s87, s31, s33
  s_mov_b32 s88, 7340032
  s_mul_i32 s89, s71, 224
  s_mov_b32 s90, 229376
  s_mov_b32 s91, s64
  s_mov_b32 s92, s65
  s_branch mk_nC
mk_nB:
  s_mov_b32 s81, s18
  s_mov_b32 s82, s19
  s_mov_b32 s83, 2097152
  s_lshl_b32 s84, s69, 18
  s_mov_b32 s85, 32768
  s_mov_b32 s86, s24
  s_mov_b32 s87, s25
  s_mov_b32 s88, 4194304
  s_lshl_b32 s89, s70, 9
  s_mov_b32 s90, 262144
  s_mov_b32 s91, s64
  s_mov_b32 s92, s65
mk_nC:
  s_lshl_b32 s76, s67, 14
  v_lshlrev_b32 v26, 4, v0
  v_add_u32 v26, s76, v26
  s_mov_b32 s4, 0xf0f0f0f0
  s_mov_b32 s5, 0xf0f0f0f0
  s_cmp_eq_u32 s67, 1
  s_cselect_b32 s4, 0x27070442, s4
  s_cselect_b32 s5, 0xf0f05747, s5
  s_cmp_eq_u32 s67, 2
  s_cselect_b32 s4, 0xf0f0f0f0, s4
  s_cselect_b32 s5, 0xf0f0f0f0, s5
  s_cmp_eq_u32 s67, 3
  s_cselect_b32 s4, 0x28082462, s4
  s_cselect_b32 s5, 0xf0f05848, s5
  s_lshl_b32 s3, s2, 13
  v_lshlrev_b32 v27, 7, v0
  s_mov_b32 s6, 0
  s_mov_b32 s79, 0
  s_waitcnt vmcnt(28)
  v_mov_b32 v30, 0
  v_mov_b32 v31, 0
  v_dot2_f32_bf16 v30, v32, v48, v30
  v_dot2_f32_bf16 v31, v40, v48, v31
  v_dot2_f32_bf16 v30, v33, v49, v30
  v_dot2_f32_bf16 v31, v41, v49, v31
  v_dot2_f32_bf16 v30, v34, v50, v30
  v_dot2_f32_bf16 v31, v42, v50, v31
  v_dot2_f32_bf16 v30, v35, v51, v30
  v_dot2_f32_bf16 v31, v43, v51, v31
  v_dot2_f32_bf16 v30, v36, v52, v30
  v_dot2_f32_bf16 v31, v44, v52, v31
  v_dot2_f32_bf16 v30, v37, v53, v30
  v_dot2_f32_bf16 v31, v45, v53, v31
  v_dot2_f32_bf16 v30, v38, v54, v30
  v_dot2_f32_bf16 v31, v46, v54, v31
  v_dot2_f32_bf16 v30, v39, v55, v30
  v_dot2_f32_bf16 v31, v47, v55, v31
  s_nop 2
  v_add_f32_dpp v30, v30, v30 row_shr:1 row_mask:0xf bank_mask:0xf
  v_add_f32_dpp v31, v31, v31 row_shr:1 row_mask:0xf bank_mask:0xf
  s_nop 0
  v_add_f32_dpp v30, v30, v30 row_shr:2 row_mask:0xf bank_mask:0xf
  v_add_f32_dpp v31, v31, v31 row_shr:2 row_mask:0xf bank_mask:0xf
  s_nop 0
  v_add_f32_dpp v30, v30, v30 row_shr:4 row_mask:0xf bank_mask:0xf
  v_add_f32_dpp v31, v31, v31 row_shr:4 row_mask:0xf bank_mask:0xf
  s_nop 0
  v_add_f32_dpp v30, v30, v30 row_shr:8 row_mask:0xf bank_mask:0xf
  v_add_f32_dpp v31, v31, v31 row_shr:8 row_mask:0xf bank_mask:0xf
  s_nop 0
  v_add_f32_dpp v30, v30, v30 row_bcast:15 row_mask:0xa bank_mask:0xf
  v_add_f32_dpp v31, v31, v31 row_bcast:15 row_mask:0xa bank_mask:0xf
  s_nop 0
  v_add_f32_dpp v30, v30, v30 row_bcast:31 row_mask:0xc bank_mask:0xf
  v_add_f32_dpp v31, v31, v31 row_bcast:31 row_mask:0xc bank_mask:0xf
  s_nop 0
  v_mul_f32 v30, 0xbfb8aa3b, v30
  v_mul_f32 v31, 0xbfb8aa3b, v31
  v_exp_f32 v30, v30
  v_exp_f32 v31, v31
  s_nop 0
  v_add_f32 v30, 1.0, v30
  v_add_f32 v31, 1.0, v31
  v_rcp_f32 v30, v30
  v_rcp_f32 v31, v31
  s_mov_b32 exec_lo, 0
  s_brev_b32 exec_hi, 1
  buffer_store_dwordx2 v[30:31], off, s[52:55], s100 sc1
  s_and_b32 s76, s2, 7
  s_lshr_b32 s77, s2, 3
  s_lshl_b32 s78, s76, 2
  s_bfe_u32 s76, s77, 0x20002
  s_add_u32 s78, s78, s76
  s_and_b32 s79, s77, 3
  s_lshr_b32 s77, s77, 4
  s_lshl_b32 s77, s77, 2
  s_add_u32 s79, s79, s77
  s_lshr_b32 s34, s78, 1
  s_lshl_b32 s34, s34, 8
  s_add_u32 s34, s34, 83984384
  s_lshl_b32 s93, s68, 3
  s_add_u32 s93, s93, s69
  s_lshl_b32 s93, s93, 2
  s_lshl_b32 s76, s70, 8
  s_add_u32 s93, s93, s76
  s_add_u32 s93, s93, 83984384
  s_lshl_b32 s78, s78, 2
  s_sub_u32 s80, 15, s79
  s_cmp_eq_u32 s67, 1
  s_cselect_b32 s79, s79, s80
  s_lshl_b32 s79, s79, 7
  s_add_u32 s78, s78, s79
  s_add_u32 s78, s78, 83955712
  s_lshr_b32 s79, s2, 2
  s_lshl_b32 s79, s79, 7
  s_and_b32 s76, s2, 3
  s_lshl_b32 s76, s76, 2
  s_add_u32 s79, s79, s76
  s_add_u32 s79, s79, 83959808
  s_cmp_eq_u32 s67, 3
  s_cselect_b32 s78, s79, s78
  s_add_u32 s79, s2, 83951616
  v_mov_b32 v30, 0
  s_cmp_eq_u32 s67, 0
  s_cbranch_scc1 mk_z0
  buffer_store_dword v30, off, s[52:55], s78 sc1
  s_branch mk_z1
mk_z0:
  buffer_store_byte v30, off, s[52:55], s79 sc1
  buffer_store_dword v30, off, s[52:55], s93 sc1
mk_z1:
  s_lshl_b32 s76, s2, 2
  s_add_u32 s76, s76, s67
  s_lshl_b32 s76, s76, 7
  s_add_u32 s76, s76, 84017152
  buffer_store_dword v30, off, s[52:55], s76 sc1
  s_mov_b64 exec, -1
  s_mov_b32 s79, 0
  s_mov_b32 s14, 0
  buffer_load_dword v28, v27, s[12:15], s79 offen
  s_waitcnt vmcnt(16) lgkmcnt(0)
  s_barrier
  ds_read_b128 a[32:35], v1 offset:0
  ds_read_b128 a[36:39], v1 offset:2048
  ds_read_b128 a[40:43], v1 offset:4096
  ds_read_b128 a[44:47], v1 offset:6144
  ds_read_b64_tr_b16 a[64:65], v5 offset:0
  ds_read_b64_tr_b16 a[66:67], v5 offset:2048
  ds_read_b64_tr_b16 a[68:69], v6 offset:0
  ds_read_b64_tr_b16 a[70:71], v6 offset:2048
  ds_read_b64_tr_b16 a[72:73], v7 offset:0
  ds_read_b64_tr_b16 a[74:75], v7 offset:2048
  ds_read_b64_tr_b16 a[76:77], v8 offset:0
  ds_read_b64_tr_b16 a[78:79], v8 offset:2048
  ds_read_b64_tr_b16 a[80:81], v18 offset:0
  ds_read_b64_tr_b16 a[82:83], v18 offset:2048
  ds_read_b64_tr_b16 a[84:85], v19 offset:0
  ds_read_b64_tr_b16 a[86:87], v19 offset:2048
  ds_read_b64_tr_b16 a[88:89], v20 offset:0
  ds_read_b64_tr_b16 a[90:91], v20 offset:2048
  ds_read_b64_tr_b16 a[92:93], v21 offset:0
  ds_read_b64_tr_b16 a[94:95], v21 offset:2048
  s_add_u32 m0, s64, 49152
  s_nop 0
  buffer_load_dwordx4 v14, s[48:51], s58 offen offset:0 lds
  buffer_load_dwordx4 v15, s[48:51], s58 offen offset:1024 lds
  buffer_load_dwordx4 v16, s[48:51], s58 offen offset:2048 lds
  buffer_load_dwordx4 v17, s[48:51], s58 offen offset:3072 lds
  s_add_u32 s58, s58, s59
  s_waitcnt lgkmcnt(0)
  v_mfma_f32_16x16x32_bf16 v[32:35], a[64:67], a[32:35], 0
  ds_read_b64_tr_b16 a[96:97], v5 offset:256
  v_mfma_f32_16x16x32_bf16 v[36:39], a[64:67], a[36:39], 0
  ds_read_b64_tr_b16 a[98:99], v5 offset:2304
  v_mfma_f32_16x16x32_bf16 v[40:43], a[64:67], a[40:43], 0
  ds_read_b64_tr_b16 a[100:101], v6 offset:256
  v_mfma_f32_16x16x32_bf16 v[44:47], a[64:67], a[44:47], 0
  ds_read_b64_tr_b16 a[102:103], v6 offset:2304
  v_mfma_f32_16x16x32_bf16 v[48:51], a[68:71], a[32:35], 0
  ds_read_b64_tr_b16 a[104:105], v7 offset:256
  v_mfma_f32_16x16x32_bf16 v[52:55], a[68:71], a[36:39], 0
  ds_read_b64_tr_b16 a[106:107], v7 offset:2304
  v_mfma_f32_16x16x32_bf16 v[56:59], a[68:71], a[40:43], 0
  ds_read_b64_tr_b16 a[108:109], v8 offset:256
  v_mfma_f32_16x16x32_bf16 v[60:63], a[68:71], a[44:47], 0
  ds_read_b64_tr_b16 a[110:111], v8 offset:2304
  v_mfma_f32_16x16x32_bf16 v[64:67], a[72:75], a[32:35], 0
  ds_read_b64_tr_b16 a[112:113], v18 offset:256
  v_mfma_f32_16x16x32_bf16 v[68:71], a[72:75], a[36:39], 0
  ds_read_b64_tr_b16 a[114:115], v18 offset:2304
  v_mfma_f32_16x16x32_bf16 v[72:75], a[72:75], a[40:43], 0
  ds_read_b64_tr_b16 a[116:117], v19 offset:256
  v_mfma_f32_16x16x32_bf16 v[76:79], a[72:75], a[44:47], 0
  ds_read_b64_tr_b16 a[118:119], v19 offset:2304
  s_mov_b32 m0, s61
  v_mfma_f32_16x16x32_bf16 v[80:83], a[76:79], a[32:35], 0
  ds_read_b64_tr_b16 a[120:121], v20 offset:256
  buffer_load_dwordx4 v10, s[44:47], s56 offen offset:0 lds
  v_mfma_f32_16x16x32_bf16 v[84:87], a[76:79], a[36:39], 0
  ds_read_b64_tr_b16 a[122:123], v20 offset:2304
  v_mfma_f32_16x16x32_bf16 v[88:91], a[76:79], a[40:43], 0
  ds_read_b64_tr_b16 a[124:125], v21 offset:256
  v_mfma_f32_16x16x32_bf16 v[92:95], a[76:79], a[44:47], 0
  ds_read_b64_tr_b16 a[126:127], v21 offset:2304
  v_mfma_f32_16x16x32_bf16 v[96:99], a[80:83], a[32:35], 0
  buffer_load_dwordx4 v11, s[44:47], s56 offen offset:1024 lds
  v_mfma_f32_16x16x32_bf16 v[100:103], a[80:83], a[36:39], 0
  v_mfma_f32_16x16x32_bf16 v[104:107], a[80:83], a[40:43], 0
  v_mfma_f32_16x16x32_bf16 v[108:111], a[80:83], a[44:47], 0
  v_mfma_f32_16x16x32_bf16 v[112:115], a[84:87], a[32:35], 0
  buffer_load_dwordx4 v12, s[44:47], s56 offen offset:2048 lds
  v_mfma_f32_16x16x32_bf16 v[116:119], a[84:87], a[36:39], 0
  v_mfma_f32_16x16x32_bf16 v[120:123], a[84:87], a[40:43], 0
  s_cmp_eq_u32 s67, 0
  s_cselect_b32 s14, s6, 0
  v_mfma_f32_16x16x32_bf16 v[124:127], a[84:87], a[44:47], 0
  v_mfma_f32_16x16x32_bf16 v[128:131], a[88:91], a[32:35], 0
  buffer_load_dwordx4 v13, s[44:47], s56 offen offset:3072 lds
  v_mfma_f32_16x16x32_bf16 v[132:135], a[88:91], a[36:39], 0
  s_add_u32 s57, s56, s60
  s_add_u32 s56, s56, 128
  v_mfma_f32_16x16x32_bf16 v[136:139], a[88:91], a[40:43], 0
  v_mfma_f32_16x16x32_bf16 v[140:143], a[88:91], a[44:47], 0
  v_mfma_f32_16x16x32_bf16 v[144:147], a[92:95], a[32:35], 0
  v_mfma_f32_16x16x32_bf16 v[148:151], a[92:95], a[36:39], 0
  buffer_load_dword v28, v27, s[12:15], s79 offen
  v_mfma_f32_16x16x32_bf16 v[152:155], a[92:95], a[40:43], 0
  v_mfma_f32_16x16x32_bf16 v[156:159], a[92:95], a[44:47], 0
  s_waitcnt vmcnt(19) lgkmcnt(0)
  s_barrier
  v_mfma_f32_16x16x32_bf16 v[160:163], a[96:99], a[32:35], 0
  ds_read_b128 a[48:51], v2 offset:0
  v_mfma_f32_16x16x32_bf16 v[164:167], a[96:99], a[36:39], 0
  ds_read_b128 a[52:55], v2 offset:2048
  v_mfma_f32_16x16x32_bf16 v[168:171], a[96:99], a[40:43], 0
  ds_read_b128 a[56:59], v2 offset:4096
  v_mfma_f32_16x16x32_bf16 v[172:175], a[96:99], a[44:47], 0
  ds_read_b128 a[60:63], v2 offset:6144
  v_mfma_f32_16x16x32_bf16 v[176:179], a[100:103], a[32:35], 0
  ds_read_b64_tr_b16 a[64:65], v5 offset:16384
  v_mfma_f32_16x16x32_bf16 v[180:183], a[100:103], a[36:39], 0
  ds_read_b64_tr_b16 a[66:67], v5 offset:18432
  v_mfma_f32_16x16x32_bf16 v[184:187], a[100:103], a[40:43], 0
  ds_read_b64_tr_b16 a[68:69], v6 offset:16384
  v_mfma_f32_16x16x32_bf16 v[188:191], a[100:103], a[44:47], 0
  ds_read_b64_tr_b16 a[70:71], v6 offset:18432
  v_mfma_f32_16x16x32_bf16 v[192:195], a[104:107], a[32:35], 0
  ds_read_b64_tr_b16 a[72:73], v7 offset:16384
  v_mfma_f32_16x16x32_bf16 v[196:199], a[104:107], a[36:39], 0
  ds_read_b64_tr_b16 a[74:75], v7 offset:18432
  v_mfma_f32_16x16x32_bf16 v[200:203], a[104:107], a[40:43], 0
  ds_read_b64_tr_b16 a[76:77], v8 offset:16384
  v_mfma_f32_16x16x32_bf16 v[204:207], a[104:107], a[44:47], 0
  ds_read_b64_tr_b16 a[78:79], v8 offset:18432
  s_add_u32 m0, s64, 0
  v_mfma_f32_16x16x32_bf16 v[208:211], a[108:111], a[32:35], 0
  ds_read_b64_tr_b16 a[80:81], v18 offset:16384
  buffer_load_dwordx4 v14, s[48:51], s58 offen offset:0 lds
  v_mfma_f32_16x16x32_bf16 v[212:215], a[108:111], a[36:39], 0
  ds_read_b64_tr_b16 a[82:83], v18 offset:18432
  v_mfma_f32_16x16x32_bf16 v[216:219], a[108:111], a[40:43], 0
  ds_read_b64_tr_b16 a[84:85], v19 offset:16384
  v_mfma_f32_16x16x32_bf16 v[220:223], a[108:111], a[44:47], 0
  ds_read_b64_tr_b16 a[86:87], v19 offset:18432
  v_mfma_f32_16x16x32_bf16 v[224:227], a[112:115], a[32:35], 0
  ds_read_b64_tr_b16 a[88:89], v20 offset:16384
  buffer_load_dwordx4 v15, s[48:51], s58 offen offset:1024 lds
  v_mfma_f32_16x16x32_bf16 v[228:231], a[112:115], a[36:39], 0
  ds_read_b64_tr_b16 a[90:91], v20 offset:18432
  v_mfma_f32_16x16x32_bf16 v[232:235], a[112:115], a[40:43], 0
  ds_read_b64_tr_b16 a[92:93], v21 offset:16384
  v_mfma_f32_16x16x32_bf16 v[236:239], a[112:115], a[44:47], 0
  ds_read_b64_tr_b16 a[94:95], v21 offset:18432
  v_mfma_f32_16x16x32_bf16 v[240:243], a[116:119], a[32:35], 0
  buffer_load_dwordx4 v16, s[48:51], s58 offen offset:2048 lds
  v_mfma_f32_16x16x32_bf16 v[244:247], a[116:119], a[36:39], 0
  s_add_u32 s72, s72, 1
  v_mfma_f32_16x16x32_bf16 v[248:251], a[116:119], a[40:43], 0
  s_cmp_eq_u32 s72, 3
  s_cselect_b32 s73, s75, s74
  s_cselect_b32 s72, 0, s72
  v_mfma_f32_16x16x32_bf16 v[252:255], a[116:119], a[44:47], 0
  v_mfma_f32_16x16x32_bf16 a[0:3], a[120:123], a[32:35], 0
  buffer_load_dwordx4 v17, s[48:51], s58 offen offset:3072 lds
  v_mfma_f32_16x16x32_bf16 a[4:7], a[120:123], a[36:39], 0
  s_add_u32 s58, s58, s59
  s_and_b32 s78, s4, 15
  s_lshl_b32 s78, s78, 3
  v_mfma_f32_16x16x32_bf16 a[8:11], a[120:123], a[40:43], 0
  s_load_dwordx2 s[12:13], s[0:1], s78
  s_bfe_u32 s79, s4, 0x40004
  v_mfma_f32_16x16x32_bf16 a[12:15], a[120:123], a[44:47], 0
  s_cmp_eq_u32 s79, 15
  s_cselect_b32 s6, 0, -1
  v_mfma_f32_16x16x32_bf16 a[16:19], a[124:127], a[32:35], 0
  v_add_u32 v1, s73, v1
  v_add_u32 v2, s73, v2
  v_mfma_f32_16x16x32_bf16 a[20:23], a[124:127], a[36:39], 0
  s_lshl_b32 s79, s79, 20
  s_add_u32 s79, s79, s3
  v_mfma_f32_16x16x32_bf16 a[24:27], a[124:127], a[40:43], 0
  s_lshr_b64 s[4:5], s[4:5], 8
  s_or_b32 s5, s5, 0xf0000000
  v_mfma_f32_16x16x32_bf16 a[28:31], a[124:127], a[44:47], 0
  s_branch mk_k_entry
.p2align 6
mk_k_top:
  s_waitcnt vmcnt(19) lgkmcnt(0)
  s_barrier
  v_mfma_f32_16x16x32_bf16 v[160:163], a[96:99], a[48:51], v[160:163]
  ds_read_b128 a[32:35], v1 offset:0
  v_mfma_f32_16x16x32_bf16 v[164:167], a[96:99], a[52:55], v[164:167]
  ds_read_b128 a[36:39], v1 offset:2048
  v_mfma_f32_16x16x32_bf16 v[168:171], a[96:99], a[56:59], v[168:171]
  ds_read_b128 a[40:43], v1 offset:4096
  v_mfma_f32_16x16x32_bf16 v[172:175], a[96:99], a[60:63], v[172:175]
  ds_read_b128 a[44:47], v1 offset:6144
  v_mfma_f32_16x16x32_bf16 v[176:179], a[100:103], a[48:51], v[176:179]
  ds_read_b64_tr_b16 a[64:65], v5 offset:0
  v_mfma_f32_16x16x32_bf16 v[180:183], a[100:103], a[52:55], v[180:183]
  ds_read_b64_tr_b16 a[66:67], v5 offset:2048
  v_mfma_f32_16x16x32_bf16 v[184:187], a[100:103], a[56:59], v[184:187]
  ds_read_b64_tr_b16 a[68:69], v6 offset:0
  v_mfma_f32_16x16x32_bf16 v[188:191], a[100:103], a[60:63], v[188:191]
  ds_read_b64_tr_b16 a[70:71], v6 offset:2048
  v_mfma_f32_16x16x32_bf16 v[192:195], a[104:107], a[48:51], v[192:195]
  ds_read_b64_tr_b16 a[72:73], v7 offset:0
  v_mfma_f32_16x16x32_bf16 v[196:199], a[104:107], a[52:55], v[196:199]
  ds_read_b64_tr_b16 a[74:75], v7 offset:2048
  v_mfma_f32_16x16x32_bf16 v[200:203], a[104:107], a[56:59], v[200:203]
  ds_read_b64_tr_b16 a[76:77], v8 offset:0
  v_mfma_f32_16x16x32_bf16 v[204:207], a[104:107], a[60:63], v[204:207]
  ds_read_b64_tr_b16 a[78:79], v8 offset:2048
  s_add_u32 m0, s64, 49152
  v_mfma_f32_16x16x32_bf16 v[208:211], a[108:111], a[48:51], v[208:211]
  ds_read_b64_tr_b16 a[80:81], v18 offset:0
  buffer_load_dwordx4 v14, s[48:51], s58 offen offset:0 lds
  v_mfma_f32_16x16x32_bf16 v[212:215], a[108:111], a[52:55], v[212:215]
  ds_read_b64_tr_b16 a[82:83], v18 offset:2048
  v_mfma_f32_16x16x32_bf16 v[216:219], a[108:111], a[56:59], v[216:219]
  ds_read_b64_tr_b16 a[84:85], v19 offset:0
  v_mfma_f32_16x16x32_bf16 v[220:223], a[108:111], a[60:63], v[220:223]
  ds_read_b64_tr_b16 a[86:87], v19 offset:2048
  v_mfma_f32_16x16x32_bf16 v[224:227], a[112:115], a[48:51], v[224:227]
  ds_read_b64_tr_b16 a[88:89], v20 offset:0
  buffer_load_dwordx4 v15, s[48:51], s58 offen offset:1024 lds
  v_mfma_f32_16x16x32_bf16 v[228:231], a[112:115], a[52:55], v[228:231]
  ds_read_b64_tr_b16 a[90:91], v20 offset:2048
  v_mfma_f32_16x16x32_bf16 v[232:235], a[112:115], a[56:59], v[232:235]
  ds_read_b64_tr_b16 a[92:93], v21 offset:0
  v_mfma_f32_16x16x32_bf16 v[236:239], a[112:115], a[60:63], v[236:239]
  ds_read_b64_tr_b16 a[94:95], v21 offset:2048
  v_mfma_f32_16x16x32_bf16 v[240:243], a[116:119], a[48:51], v[240:243]
  buffer_load_dwordx4 v16, s[48:51], s58 offen offset:2048 lds
  v_mfma_f32_16x16x32_bf16 v[244:247], a[116:119], a[52:55], v[244:247]
  v_mfma_f32_16x16x32_bf16 v[248:251], a[116:119], a[56:59], v[248:251]
  v_mfma_f32_16x16x32_bf16 v[252:255], a[116:119], a[60:63], v[252:255]
  v_mfma_f32_16x16x32_bf16 a[0:3], a[120:123], a[48:51], a[0:3]
  buffer_load_dwordx4 v17, s[48:51], s58 offen offset:3072 lds
  v_mfma_f32_16x16x32_bf16 a[4:7], a[120:123], a[52:55], a[4:7]
  s_add_u32 s58, s58, s59
  v_mfma_f32_16x16x32_bf16 a[8:11], a[120:123], a[56:59], a[8:11]
  v_mfma_f32_16x16x32_bf16 a[12:15], a[120:123], a[60:63], a[12:15]
  v_mfma_f32_16x16x32_bf16 a[16:19], a[124:127], a[48:51], a[16:19]
  v_mfma_f32_16x16x32_bf16 a[20:23], a[124:127], a[52:55], a[20:23]
  v_mfma_f32_16x16x32_bf16 a[24:27], a[124:127], a[56:59], a[24:27]
  v_mfma_f32_16x16x32_bf16 a[28:31], a[124:127], a[60:63], a[28:31]
  s_cmp_lg_u32 s66, 3
  s_cbranch_scc1 hk_1
  s_cmp_lg_u32 s67, 0
  s_cbranch_scc1 fs_2
  v_mov_b32 v30, 1
  s_mov_b64 exec, 1
  buffer_store_byte v30, off, s[8:11], s2 sc1
  s_mov_b64 exec, -1
fs_2:
hk_1:
  s_cmp_lg_u32 s66, 1
  s_cbranch_scc1 mk_k_nsx
  s_mov_b32 s44, s81
  s_mov_b32 s45, s82
  s_mov_b32 s46, s83
  s_mov_b32 s56, s84
  s_mov_b32 s60, s85
mk_k_nsx:
  s_waitcnt lgkmcnt(0)
  v_mfma_f32_16x16x32_bf16 v[32:35], a[64:67], a[32:35], v[32:35]
  ds_read_b64_tr_b16 a[96:97], v5 offset:256
  v_mfma_f32_16x16x32_bf16 v[36:39], a[64:67], a[36:39], v[36:39]
  ds_read_b64_tr_b16 a[98:99], v5 offset:2304
  v_mfma_f32_16x16x32_bf16 v[40:43], a[64:67], a[40:43], v[40:43]
  ds_read_b64_tr_b16 a[100:101], v6 offset:256
  v_mfma_f32_16x16x32_bf16 v[44:47], a[64:67], a[44:47], v[44:47]
  ds_read_b64_tr_b16 a[102:103], v6 offset:2304
  v_mfma_f32_16x16x32_bf16 v[48:51], a[68:71], a[32:35], v[48:51]
  ds_read_b64_tr_b16 a[104:105], v7 offset:256
  v_mfma_f32_16x16x32_bf16 v[52:55], a[68:71], a[36:39], v[52:55]
  ds_read_b64_tr_b16 a[106:107], v7 offset:2304
  v_mfma_f32_16x16x32_bf16 v[56:59], a[68:71], a[40:43], v[56:59]
  ds_read_b64_tr_b16 a[108:109], v8 offset:256
  v_mfma_f32_16x16x32_bf16 v[60:63], a[68:71], a[44:47], v[60:63]
  ds_read_b64_tr_b16 a[110:111], v8 offset:2304
  v_mfma_f32_16x16x32_bf16 v[64:67], a[72:75], a[32:35], v[64:67]
  ds_read_b64_tr_b16 a[112:113], v18 offset:256
  v_mfma_f32_16x16x32_bf16 v[68:71], a[72:75], a[36:39], v[68:71]
  ds_read_b64_tr_b16 a[114:115], v18 offset:2304
  v_mfma_f32_16x16x32_bf16 v[72:75], a[72:75], a[40:43], v[72:75]
  ds_read_b64_tr_b16 a[116:117], v19 offset:256
  v_mfma_f32_16x16x32_bf16 v[76:79], a[72:75], a[44:47], v[76:79]
  ds_read_b64_tr_b16 a[118:119], v19 offset:2304
  s_mov_b32 m0, s61
  v_mfma_f32_16x16x32_bf16 v[80:83], a[76:79], a[32:35], v[80:83]
  ds_read_b64_tr_b16 a[120:121], v20 offset:256
  buffer_load_dwordx4 v10, s[44:47], s56 offen offset:0 lds
  v_mfma_f32_16x16x32_bf16 v[84:87], a[76:79], a[36:39], v[84:87]
  ds_read_b64_tr_b16 a[122:123], v20 offset:2304
  v_mfma_f32_16x16x32_bf16 v[88:91], a[76:79], a[40:43], v[88:91]
  ds_read_b64_tr_b16 a[124:125], v21 offset:256
  v_mfma_f32_16x16x32_bf16 v[92:95], a[76:79], a[44:47], v[92:95]
  ds_read_b64_tr_b16 a[126:127], v21 offset:2304
  v_mfma_f32_16x16x32_bf16 v[96:99], a[80:83], a[32:35], v[96:99]
  buffer_load_dwordx4 v11, s[44:47], s56 offen offset:1024 lds
  v_mfma_f32_16x16x32_bf16 v[100:103], a[80:83], a[36:39], v[100:103]
  v_mfma_f32_16x16x32_bf16 v[104:107], a[80:83], a[40:43], v[104:107]
  v_mfma_f32_16x16x32_bf16 v[108:111], a[80:83], a[44:47], v[108:111]
  v_mfma_f32_16x16x32_bf16 v[112:115], a[84:87], a[32:35], v[112:115]
  buffer_load_dwordx4 v12, s[44:47], s56 offen offset:2048 lds
  v_mfma_f32_16x16x32_bf16 v[116:119], a[84:87], a[36:39], v[116:119]
  v_mfma_f32_16x16x32_bf16 v[120:123], a[84:87], a[40:43], v[120:123]
  s_cmp_eq_u32 s67, 0
  s_cselect_b32 s14, s6, 0
  v_mfma_f32_16x16x32_bf16 v[124:127], a[84:87], a[44:47], v[124:127]
  v_mfma_f32_16x16x32_bf16 v[128:131], a[88:91], a[32:35], v[128:131]
  buffer_load_dwordx4 v13, s[44:47], s56 offen offset:3072 lds
  v_mfma_f32_16x16x32_bf16 v[132:135], a[88:91], a[36:39], v[132:135]
  s_add_u32 s57, s56, s60
  s_add_u32 s56, s56, 128
  v_mfma_f32_16x16x32_bf16 v[136:139], a[88:91], a[40:43], v[136:139]
  v_mfma_f32_16x16x32_bf16 v[140:143], a[88:91], a[44:47], v[140:143]
  v_mfma_f32_16x16x32_bf16 v[144:147], a[92:95], a[32:35], v[144:147]
  v_mfma_f32_16x16x32_bf16 v[148:151], a[92:95], a[36:39], v[148:151]
  buffer_load_dword v28, v27, s[12:15], s79 offen
  v_mfma_f32_16x16x32_bf16 v[152:155], a[92:95], a[40:43], v[152:155]
  v_mfma_f32_16x16x32_bf16 v[156:159], a[92:95], a[44:47], v[156:159]
  s_cmp_lg_u32 s66, 1
  s_cbranch_scc1 mk_k_nsw
  s_mov_b32 s48, s86
  s_mov_b32 s49, s87
  s_mov_b32 s50, s88
  s_mov_b32 s58, s89
  s_mov_b32 s59, s90
  s_mov_b32 s64, s91
  s_mov_b32 s65, s92
  s_cmp_lg_u32 s68, 0
  s_cbranch_scc1 vsw_3
  v_mov_b32 v14, v22
  v_mov_b32 v15, v23
  v_mov_b32 v16, v24
  v_mov_b32 v17, v25
vsw_3:
mk_k_nsw:
  s_waitcnt vmcnt(19) lgkmcnt(0)
  s_barrier
  v_mfma_f32_16x16x32_bf16 v[160:163], a[96:99], a[32:35], v[160:163]
  ds_read_b128 a[48:51], v2 offset:0
  v_mfma_f32_16x16x32_bf16 v[164:167], a[96:99], a[36:39], v[164:167]
  ds_read_b128 a[52:55], v2 offset:2048
  v_mfma_f32_16x16x32_bf16 v[168:171], a[96:99], a[40:43], v[168:171]
  ds_read_b128 a[56:59], v2 offset:4096
  v_mfma_f32_16x16x32_bf16 v[172:175], a[96:99], a[44:47], v[172:175]
  ds_read_b128 a[60:63], v2 offset:6144
  v_mfma_f32_16x16x32_bf16 v[176:179], a[100:103], a[32:35], v[176:179]
  ds_read_b64_tr_b16 a[64:65], v5 offset:16384
  v_mfma_f32_16x16x32_bf16 v[180:183], a[100:103], a[36:39], v[180:183]
  ds_read_b64_tr_b16 a[66:67], v5 offset:18432
  v_mfma_f32_16x16x32_bf16 v[184:187], a[100:103], a[40:43], v[184:187]
  ds_read_b64_tr_b16 a[68:69], v6 offset:16384
  v_mfma_f32_16x16x32_bf16 v[188:191], a[100:103], a[44:47], v[188:191]
  ds_read_b64_tr_b16 a[70:71], v6 offset:18432
  v_mfma_f32_16x16x32_bf16 v[192:195], a[104:107], a[32:35], v[192:195]
  ds_read_b64_tr_b16 a[72:73], v7 offset:16384
  v_mfma_f32_16x16x32_bf16 v[196:199], a[104:107], a[36:39], v[196:199]
  ds_read_b64_tr_b16 a[74:75], v7 offset:18432
  v_mfma_f32_16x16x32_bf16 v[200:203], a[104:107], a[40:43], v[200:203]
  ds_read_b64_tr_b16 a[76:77], v8 offset:16384
  v_mfma_f32_16x16x32_bf16 v[204:207], a[104:107], a[44:47], v[204:207]
  ds_read_b64_tr_b16 a[78:79], v8 offset:18432
  s_add_u32 m0, s64, 0
  v_mfma_f32_16x16x32_bf16 v[208:211], a[108:111], a[32:35], v[208:211]
  ds_read_b64_tr_b16 a[80:81], v18 offset:16384
  buffer_load_dwordx4 v14, s[48:51], s58 offen offset:0 lds
  v_mfma_f32_16x16x32_bf16 v[212:215], a[108:111], a[36:39], v[212:215]
  ds_read_b64_tr_b16 a[82:83], v18 offset:18432
  v_mfma_f32_16x16x32_bf16 v[216:219], a[108:111], a[40:43], v[216:219]
  ds_read_b64_tr_b16 a[84:85], v19 offset:16384
  v_mfma_f32_16x16x32_bf16 v[220:223], a[108:111], a[44:47], v[220:223]
  ds_read_b64_tr_b16 a[86:87], v19 offset:18432
  v_mfma_f32_16x16x32_bf16 v[224:227], a[112:115], a[32:35], v[224:227]
  ds_read_b64_tr_b16 a[88:89], v20 offset:16384
  buffer_load_dwordx4 v15, s[48:51], s58 offen offset:1024 lds
  v_mfma_f32_16x16x32_bf16 v[228:231], a[112:115], a[36:39], v[228:231]
  ds_read_b64_tr_b16 a[90:91], v20 offset:18432
  v_mfma_f32_16x16x32_bf16 v[232:235], a[112:115], a[40:43], v[232:235]
  ds_read_b64_tr_b16 a[92:93], v21 offset:16384
  v_mfma_f32_16x16x32_bf16 v[236:239], a[112:115], a[44:47], v[236:239]
  ds_read_b64_tr_b16 a[94:95], v21 offset:18432
  v_mfma_f32_16x16x32_bf16 v[240:243], a[116:119], a[32:35], v[240:243]
  buffer_load_dwordx4 v16, s[48:51], s58 offen offset:2048 lds
  v_mfma_f32_16x16x32_bf16 v[244:247], a[116:119], a[36:39], v[244:247]
  s_add_u32 s72, s72, 1
  v_mfma_f32_16x16x32_bf16 v[248:251], a[116:119], a[40:43], v[248:251]
  s_cmp_eq_u32 s72, 3
  s_cselect_b32 s73, s75, s74
  s_cselect_b32 s72, 0, s72
  v_mfma_f32_16x16x32_bf16 v[252:255], a[116:119], a[44:47], v[252:255]
  v_mfma_f32_16x16x32_bf16 a[0:3], a[120:123], a[32:35], a[0:3]
  buffer_load_dwordx4 v17, s[48:51], s58 offen offset:3072 lds
  v_mfma_f32_16x16x32_bf16 a[4:7], a[120:123], a[36:39], a[4:7]
  s_add_u32 s58, s58, s59
  s_and_b32 s78, s4, 15
  s_lshl_b32 s78, s78, 3
  v_mfma_f32_16x16x32_bf16 a[8:11], a[120:123], a[40:43], a[8:11]
  s_load_dwordx2 s[12:13], s[0:1], s78
  s_bfe_u32 s79, s4, 0x40004
  v_mfma_f32_16x16x32_bf16 a[12:15], a[120:123], a[44:47], a[12:15]
  s_cmp_eq_u32 s79, 15
  s_cselect_b32 s6, 0, -1
  v_mfma_f32_16x16x32_bf16 a[16:19], a[124:127], a[32:35], a[16:19]
  v_add_u32 v1, s73, v1
  v_add_u32 v2, s73, v2
  v_mfma_f32_16x16x32_bf16 a[20:23], a[124:127], a[36:39], a[20:23]
  s_lshl_b32 s79, s79, 20
  s_add_u32 s79, s79, s3
  v_mfma_f32_16x16x32_bf16 a[24:27], a[124:127], a[40:43], a[24:27]
  s_lshr_b64 s[4:5], s[4:5], 8
  s_or_b32 s5, s5, 0xf0000000
  v_mfma_f32_16x16x32_bf16 a[28:31], a[124:127], a[44:47], a[28:31]
mk_k_entry:
  s_waitcnt lgkmcnt(0)
  v_mfma_f32_16x16x32_bf16 v[32:35], a[64:67], a[48:51], v[32:35]
  ds_read_b64_tr_b16 a[96:97], v5 offset:16640
  v_mfma_f32_16x16x32_bf16 v[36:39], a[64:67], a[52:55], v[36:39]
  ds_read_b64_tr_b16 a[98:99], v5 offset:18688
  v_mfma_f32_16x16x32_bf16 v[40:43], a[64:67], a[56:59], v[40:43]
  ds_read_b64_tr_b16 a[100:101], v6 offset:16640
  v_mfma_f32_16x16x32_bf16 v[44:47], a[64:67], a[60:63], v[44:47]
  ds_read_b64_tr_b16 a[102:103], v6 offset:18688
  v_mfma_f32_16x16x32_bf16 v[48:51], a[68:71], a[48:51], v[48:51]
  ds_read_b64_tr_b16 a[104:105], v7 offset:16640
  v_mfma_f32_16x16x32_bf16 v[52:55], a[68:71], a[52:55], v[52:55]
  ds_read_b64_tr_b16 a[106:107], v7 offset:18688
  v_mfma_f32_16x16x32_bf16 v[56:59], a[68:71], a[56:59], v[56:59]
  ds_read_b64_tr_b16 a[108:109], v8 offset:16640
  v_mfma_f32_16x16x32_bf16 v[60:63], a[68:71], a[60:63], v[60:63]
  ds_read_b64_tr_b16 a[110:111], v8 offset:18688
  v_mfma_f32_16x16x32_bf16 v[64:67], a[72:75], a[48:51], v[64:67]
  ds_read_b64_tr_b16 a[112:113], v18 offset:16640
  v_mfma_f32_16x16x32_bf16 v[68:71], a[72:75], a[52:55], v[68:71]
  ds_read_b64_tr_b16 a[114:115], v18 offset:18688
  v_mfma_f32_16x16x32_bf16 v[72:75], a[72:75], a[56:59], v[72:75]
  ds_read_b64_tr_b16 a[116:117], v19 offset:16640
  v_mfma_f32_16x16x32_bf16 v[76:79], a[72:75], a[60:63], v[76:79]
  ds_read_b64_tr_b16 a[118:119], v19 offset:18688
  s_add_u32 m0, s61, 4096
  v_mfma_f32_16x16x32_bf16 v[80:83], a[76:79], a[48:51], v[80:83]
  ds_read_b64_tr_b16 a[120:121], v20 offset:16640
  buffer_load_dwordx4 v10, s[44:47], s57 offen offset:0 lds
  v_mfma_f32_16x16x32_bf16 v[84:87], a[76:79], a[52:55], v[84:87]
  ds_read_b64_tr_b16 a[122:123], v20 offset:18688
  v_mfma_f32_16x16x32_bf16 v[88:91], a[76:79], a[56:59], v[88:91]
  ds_read_b64_tr_b16 a[124:125], v21 offset:16640
  v_mfma_f32_16x16x32_bf16 v[92:95], a[76:79], a[60:63], v[92:95]
  ds_read_b64_tr_b16 a[126:127], v21 offset:18688
  v_mfma_f32_16x16x32_bf16 v[96:99], a[80:83], a[48:51], v[96:99]
  buffer_load_dwordx4 v11, s[44:47], s57 offen offset:1024 lds
  v_mfma_f32_16x16x32_bf16 v[100:103], a[80:83], a[52:55], v[100:103]
  v_mfma_f32_16x16x32_bf16 v[104:107], a[80:83], a[56:59], v[104:107]
  v_mfma_f32_16x16x32_bf16 v[108:111], a[80:83], a[60:63], v[108:111]
  v_mfma_f32_16x16x32_bf16 v[112:115], a[84:87], a[48:51], v[112:115]
  buffer_load_dwordx4 v12, s[44:47], s57 offen offset:2048 lds
  v_mfma_f32_16x16x32_bf16 v[116:119], a[84:87], a[52:55], v[116:119]
  v_mfma_f32_16x16x32_bf16 v[120:123], a[84:87], a[56:59], v[120:123]
  s_cmp_eq_u32 s67, 1
  s_cselect_b32 s14, s6, 0
  v_mfma_f32_16x16x32_bf16 v[124:127], a[84:87], a[60:63], v[124:127]
  v_mfma_f32_16x16x32_bf16 v[128:131], a[88:91], a[48:51], v[128:131]
  buffer_load_dwordx4 v13, s[44:47], s57 offen offset:3072 lds
  v_mfma_f32_16x16x32_bf16 v[132:135], a[88:91], a[52:55], v[132:135]
  s_add_u32 s61, s61, 8192
  s_cmp_eq_u32 s61, s63
  s_cselect_b32 s61, s62, s61
  v_mfma_f32_16x16x32_bf16 v[136:139], a[88:91], a[56:59], v[136:139]
  v_mfma_f32_16x16x32_bf16 v[140:143], a[88:91], a[60:63], v[140:143]
  v_mfma_f32_16x16x32_bf16 v[144:147], a[92:95], a[48:51], v[144:147]
  v_mfma_f32_16x16x32_bf16 v[148:151], a[92:95], a[52:55], v[148:151]
  buffer_load_dword v28, v27, s[12:15], s79 offen
  v_mfma_f32_16x16x32_bf16 v[152:155], a[92:95], a[56:59], v[152:155]
  v_mfma_f32_16x16x32_bf16 v[156:159], a[92:95], a[60:63], v[156:159]
  s_waitcnt vmcnt(19) lgkmcnt(0)
  s_barrier
  v_mfma_f32_16x16x32_bf16 v[160:163], a[96:99], a[48:51], v[160:163]
  ds_read_b128 a[32:35], v1 offset:0
  v_mfma_f32_16x16x32_bf16 v[164:167], a[96:99], a[52:55], v[164:167]
  ds_read_b128 a[36:39], v1 offset:2048
  v_mfma_f32_16x16x32_bf16 v[168:171], a[96:99], a[56:59], v[168:171]
  ds_read_b128 a[40:43], v1 offset:4096
  v_mfma_f32_16x16x32_bf16 v[172:175], a[96:99], a[60:63], v[172:175]
  ds_read_b128 a[44:47], v1 offset:6144
  v_mfma_f32_16x16x32_bf16 v[176:179], a[100:103], a[48:51], v[176:179]
  ds_read_b64_tr_b16 a[64:65], v5 offset:32768
  v_mfma_f32_16x16x32_bf16 v[180:183], a[100:103], a[52:55], v[180:183]
  ds_read_b64_tr_b16 a[66:67], v5 offset:34816
  v_mfma_f32_16x16x32_bf16 v[184:187], a[100:103], a[56:59], v[184:187]
  ds_read_b64_tr_b16 a[68:69], v6 offset:32768
  v_mfma_f32_16x16x32_bf16 v[188:191], a[100:103], a[60:63], v[188:191]
  ds_read_b64_tr_b16 a[70:71], v6 offset:34816
  v_mfma_f32_16x16x32_bf16 v[192:195], a[104:107], a[48:51], v[192:195]
  ds_read_b64_tr_b16 a[72:73], v7 offset:32768
  v_mfma_f32_16x16x32_bf16 v[196:199], a[104:107], a[52:55], v[196:199]
  ds_read_b64_tr_b16 a[74:75], v7 offset:34816
  v_mfma_f32_16x16x32_bf16 v[200:203], a[104:107], a[56:59], v[200:203]
  ds_read_b64_tr_b16 a[76:77], v8 offset:32768
  v_mfma_f32_16x16x32_bf16 v[204:207], a[104:107], a[60:63], v[204:207]
  ds_read_b64_tr_b16 a[78:79], v8 offset:34816
  s_add_u32 m0, s64, 16384
  v_mfma_f32_16x16x32_bf16 v[208:211], a[108:111], a[48:51], v[208:211]
  ds_read_b64_tr_b16 a[80:81], v18 offset:32768
  buffer_load_dwordx4 v14, s[48:51], s58 offen offset:0 lds
  v_mfma_f32_16x16x32_bf16 v[212:215], a[108:111], a[52:55], v[212:215]
  ds_read_b64_tr_b16 a[82:83], v18 offset:34816
  v_mfma_f32_16x16x32_bf16 v[216:219], a[108:111], a[56:59], v[216:219]
  ds_read_b64_tr_b16 a[84:85], v19 offset:32768
  v_mfma_f32_16x16x32_bf16 v[220:223], a[108:111], a[60:63], v[220:223]
  ds_read_b64_tr_b16 a[86:87], v19 offset:34816
  v_mfma_f32_16x16x32_bf16 v[224:227], a[112:115], a[48:51], v[224:227]
  ds_read_b64_tr_b16 a[88:89], v20 offset:32768
  buffer_load_dwordx4 v15, s[48:51], s58 offen offset:1024 lds
  v_mfma_f32_16x16x32_bf16 v[228:231], a[112:115], a[52:55], v[228:231]
  ds_read_b64_tr_b16 a[90:91], v20 offset:34816
  v_mfma_f32_16x16x32_bf16 v[232:235], a[112:115], a[56:59], v[232:235]
  ds_read_b64_tr_b16 a[92:93], v21 offset:32768
  v_mfma_f32_16x16x32_bf16 v[236:239], a[112:115], a[60:63], v[236:239]
  ds_read_b64_tr_b16 a[94:95], v21 offset:34816
  v_mfma_f32_16x16x32_bf16 v[240:243], a[116:119], a[48:51], v[240:243]
  buffer_load_dwordx4 v16, s[48:51], s58 offen offset:2048 lds
  v_mfma_f32_16x16x32_bf16 v[244:247], a[116:119], a[52:55], v[244:247]
  v_mfma_f32_16x16x32_bf16 v[248:251], a[116:119], a[56:59], v[248:251]
  v_mfma_f32_16x16x32_bf16 v[252:255], a[116:119], a[60:63], v[252:255]
  v_mfma_f32_16x16x32_bf16 a[0:3], a[120:123], a[48:51], a[0:3]
  buffer_load_dwordx4 v17, s[48:51], s58 offen offset:3072 lds
  v_mfma_f32_16x16x32_bf16 a[4:7], a[120:123], a[52:55], a[4:7]
  s_add_u32 s58, s58, s59
  v_mfma_f32_16x16x32_bf16 a[8:11], a[120:123], a[56:59], a[8:11]
  v_mfma_f32_16x16x32_bf16 a[12:15], a[120:123], a[60:63], a[12:15]
  v_mfma_f32_16x16x32_bf16 a[16:19], a[124:127], a[48:51], a[16:19]
  v_mfma_f32_16x16x32_bf16 a[20:23], a[124:127], a[52:55], a[20:23]
  v_mfma_f32_16x16x32_bf16 a[24:27], a[124:127], a[56:59], a[24:27]
  v_mfma_f32_16x16x32_bf16 a[28:31], a[124:127], a[60:63], a[28:31]
  s_waitcnt lgkmcnt(0)
  v_mfma_f32_16x16x32_bf16 v[32:35], a[64:67], a[32:35], v[32:35]
  ds_read_b64_tr_b16 a[96:97], v5 offset:33024
  v_mfma_f32_16x16x32_bf16 v[36:39], a[64:67], a[36:39], v[36:39]
  ds_read_b64_tr_b16 a[98:99], v5 offset:35072
  v_mfma_f32_16x16x32_bf16 v[40:43], a[64:67], a[40:43], v[40:43]
  ds_read_b64_tr_b16 a[100:101], v6 offset:33024
  v_mfma_f32_16x16x32_bf16 v[44:47], a[64:67], a[44:47], v[44:47]
  ds_read_b64_tr_b16 a[102:103], v6 offset:35072
  v_mfma_f32_16x16x32_bf16 v[48:51], a[68:71], a[32:35], v[48:51]
  ds_read_b64_tr_b16 a[104:105], v7 offset:33024
  v_mfma_f32_16x16x32_bf16 v[52:55], a[68:71], a[36:39], v[52:55]
  ds_read_b64_tr_b16 a[106:107], v7 offset:35072
  v_mfma_f32_16x16x32_bf16 v[56:59], a[68:71], a[40:43], v[56:59]
  ds_read_b64_tr_b16 a[108:109], v8 offset:33024
  v_mfma_f32_16x16x32_bf16 v[60:63], a[68:71], a[44:47], v[60:63]
  ds_read_b64_tr_b16 a[110:111], v8 offset:35072
  v_mfma_f32_16x16x32_bf16 v[64:67], a[72:75], a[32:35], v[64:67]
  ds_read_b64_tr_b16 a[112:113], v18 offset:33024
  v_mfma_f32_16x16x32_bf16 v[68:71], a[72:75], a[36:39], v[68:71]
  ds_read_b64_tr_b16 a[114:115], v18 offset:35072
  v_mfma_f32_16x16x32_bf16 v[72:75], a[72:75], a[40:43], v[72:75]
  ds_read_b64_tr_b16 a[116:117], v19 offset:33024
  v_mfma_f32_16x16x32_bf16 v[76:79], a[72:75], a[44:47], v[76:79]
  ds_read_b64_tr_b16 a[118:119], v19 offset:35072
  s_mov_b32 m0, s61
  v_mfma_f32_16x16x32_bf16 v[80:83], a[76:79], a[32:35], v[80:83]
  ds_read_b64_tr_b16 a[120:121], v20 offset:33024
  buffer_load_dwordx4 v10, s[44:47], s56 offen offset:0 lds
  v_mfma_f32_16x16x32_bf16 v[84:87], a[76:79], a[36:39], v[84:87]
  ds_read_b64_tr_b16 a[122:123], v20 offset:35072
  v_mfma_f32_16x16x32_bf16 v[88:91], a[76:79], a[40:43], v[88:91]
  ds_read_b64_tr_b16 a[124:125], v21 offset:33024
  v_mfma_f32_16x16x32_bf16 v[92:95], a[76:79], a[44:47], v[92:95]
  ds_read_b64_tr_b16 a[126:127], v21 offset:35072
  v_mfma_f32_16x16x32_bf16 v[96:99], a[80:83], a[32:35], v[96:99]
  buffer_load_dwordx4 v11, s[44:47], s56 offen offset:1024 lds
  v_mfma_f32_16x16x32_bf16 v[100:103], a[80:83], a[36:39], v[100:103]
  v_mfma_f32_16x16x32_bf16 v[104:107], a[80:83], a[40:43], v[104:107]
  v_mfma_f32_16x16x32_bf16 v[108:111], a[80:83], a[44:47], v[108:111]
  v_mfma_f32_16x16x32_bf16 v[112:115], a[84:87], a[32:35], v[112:115]
  buffer_load_dwordx4 v12, s[44:47], s56 offen offset:2048 lds
  v_mfma_f32_16x16x32_bf16 v[116:119], a[84:87], a[36:39], v[116:119]
  v_mfma_f32_16x16x32_bf16 v[120:123], a[84:87], a[40:43], v[120:123]
  s_cmp_eq_u32 s67, 2
  s_cselect_b32 s14, s6, 0
  v_mfma_f32_16x16x32_bf16 v[124:127], a[84:87], a[44:47], v[124:127]
  v_mfma_f32_16x16x32_bf16 v[128:131], a[88:91], a[32:35], v[128:131]
  buffer_load_dwordx4 v13, s[44:47], s56 offen offset:3072 lds
  v_mfma_f32_16x16x32_bf16 v[132:135], a[88:91], a[36:39], v[132:135]
  s_add_u32 s57, s56, s60
  s_add_u32 s56, s56, 128
  v_mfma_f32_16x16x32_bf16 v[136:139], a[88:91], a[40:43], v[136:139]
  v_mfma_f32_16x16x32_bf16 v[140:143], a[88:91], a[44:47], v[140:143]
  v_mfma_f32_16x16x32_bf16 v[144:147], a[92:95], a[32:35], v[144:147]
  v_mfma_f32_16x16x32_bf16 v[148:151], a[92:95], a[36:39], v[148:151]
  buffer_load_dword v28, v27, s[12:15], s79 offen
  v_mfma_f32_16x16x32_bf16 v[152:155], a[92:95], a[40:43], v[152:155]
  v_mfma_f32_16x16x32_bf16 v[156:159], a[92:95], a[44:47], v[156:159]
  s_waitcnt vmcnt(19) lgkmcnt(0)
  s_barrier
  v_mfma_f32_16x16x32_bf16 v[160:163], a[96:99], a[32:35], v[160:163]
  ds_read_b128 a[48:51], v2 offset:0
  v_mfma_f32_16x16x32_bf16 v[164:167], a[96:99], a[36:39], v[164:167]
  ds_read_b128 a[52:55], v2 offset:2048
  v_mfma_f32_16x16x32_bf16 v[168:171], a[96:99], a[40:43], v[168:171]
  ds_read_b128 a[56:59], v2 offset:4096
  v_mfma_f32_16x16x32_bf16 v[172:175], a[96:99], a[44:47], v[172:175]
  ds_read_b128 a[60:63], v2 offset:6144
  v_mfma_f32_16x16x32_bf16 v[176:179], a[100:103], a[32:35], v[176:179]
  ds_read_b64_tr_b16 a[64:65], v5 offset:49152
  v_mfma_f32_16x16x32_bf16 v[180:183], a[100:103], a[36:39], v[180:183]
  ds_read_b64_tr_b16 a[66:67], v5 offset:51200
  v_mfma_f32_16x16x32_bf16 v[184:187], a[100:103], a[40:43], v[184:187]
  ds_read_b64_tr_b16 a[68:69], v6 offset:49152
  v_mfma_f32_16x16x32_bf16 v[188:191], a[100:103], a[44:47], v[188:191]
  ds_read_b64_tr_b16 a[70:71], v6 offset:51200
  v_mfma_f32_16x16x32_bf16 v[192:195], a[104:107], a[32:35], v[192:195]
  ds_read_b64_tr_b16 a[72:73], v7 offset:49152
  v_mfma_f32_16x16x32_bf16 v[196:199], a[104:107], a[36:39], v[196:199]
  ds_read_b64_tr_b16 a[74:75], v7 offset:51200
  v_mfma_f32_16x16x32_bf16 v[200:203], a[104:107], a[40:43], v[200:203]
  ds_read_b64_tr_b16 a[76:77], v8 offset:49152
  v_mfma_f32_16x16x32_bf16 v[204:207], a[104:107], a[44:47], v[204:207]
  ds_read_b64_tr_b16 a[78:79], v8 offset:51200
  s_add_u32 m0, s64, 32768
  v_mfma_f32_16x16x32_bf16 v[208:211], a[108:111], a[32:35], v[208:211]
  ds_read_b64_tr_b16 a[80:81], v18 offset:49152
  buffer_load_dwordx4 v14, s[48:51], s58 offen offset:0 lds
  v_mfma_f32_16x16x32_bf16 v[212:215], a[108:111], a[36:39], v[212:215]
  ds_read_b64_tr_b16 a[82:83], v18 offset:51200
  v_mfma_f32_16x16x32_bf16 v[216:219], a[108:111], a[40:43], v[216:219]
  ds_read_b64_tr_b16 a[84:85], v19 offset:49152
  v_mfma_f32_16x16x32_bf16 v[220:223], a[108:111], a[44:47], v[220:223]
  ds_read_b64_tr_b16 a[86:87], v19 offset:51200
  v_mfma_f32_16x16x32_bf16 v[224:227], a[112:115], a[32:35], v[224:227]
  ds_read_b64_tr_b16 a[88:89], v20 offset:49152
  buffer_load_dwordx4 v15, s[48:51], s58 offen offset:1024 lds
  v_mfma_f32_16x16x32_bf16 v[228:231], a[112:115], a[36:39], v[228:231]
  ds_read_b64_tr_b16 a[90:91], v20 offset:51200
  v_mfma_f32_16x16x32_bf16 v[232:235], a[112:115], a[40:43], v[232:235]
  ds_read_b64_tr_b16 a[92:93], v21 offset:49152
  v_mfma_f32_16x16x32_bf16 v[236:239], a[112:115], a[44:47], v[236:239]
  ds_read_b64_tr_b16 a[94:95], v21 offset:51200
  v_mfma_f32_16x16x32_bf16 v[240:243], a[116:119], a[32:35], v[240:243]
  buffer_load_dwordx4 v16, s[48:51], s58 offen offset:2048 lds
  v_mfma_f32_16x16x32_bf16 v[244:247], a[116:119], a[36:39], v[244:247]
  s_add_u32 s72, s72, 1
  v_mfma_f32_16x16x32_bf16 v[248:251], a[116:119], a[40:43], v[248:251]
  s_cmp_eq_u32 s72, 3
  s_cselect_b32 s73, s75, s74
  s_cselect_b32 s72, 0, s72
  v_mfma_f32_16x16x32_bf16 v[252:255], a[116:119], a[44:47], v[252:255]
  v_mfma_f32_16x16x32_bf16 a[0:3], a[120:123], a[32:35], a[0:3]
  buffer_load_dwordx4 v17, s[48:51], s58 offen offset:3072 lds
  v_mfma_f32_16x16x32_bf16 a[4:7], a[120:123], a[36:39], a[4:7]
  s_add_u32 s58, s58, s59
  v_mfma_f32_16x16x32_bf16 a[8:11], a[120:123], a[40:43], a[8:11]
  v_mfma_f32_16x16x32_bf16 a[12:15], a[120:123], a[44:47], a[12:15]
  v_mfma_f32_16x16x32_bf16 a[16:19], a[124:127], a[32:35], a[16:19]
  v_add_u32 v1, s73, v1
  v_add_u32 v2, s73, v2
  v_mfma_f32_16x16x32_bf16 a[20:23], a[124:127], a[36:39], a[20:23]
  v_mfma_f32_16x16x32_bf16 a[24:27], a[124:127], a[40:43], a[24:27]
  v_mfma_f32_16x16x32_bf16 a[28:31], a[124:127], a[44:47], a[28:31]
  s_waitcnt lgkmcnt(0)
  v_mfma_f32_16x16x32_bf16 v[32:35], a[64:67], a[48:51], v[32:35]
  ds_read_b64_tr_b16 a[96:97], v5 offset:49408
  v_mfma_f32_16x16x32_bf16 v[36:39], a[64:67], a[52:55], v[36:39]
  ds_read_b64_tr_b16 a[98:99], v5 offset:51456
  v_mfma_f32_16x16x32_bf16 v[40:43], a[64:67], a[56:59], v[40:43]
  ds_read_b64_tr_b16 a[100:101], v6 offset:49408
  v_mfma_f32_16x16x32_bf16 v[44:47], a[64:67], a[60:63], v[44:47]
  ds_read_b64_tr_b16 a[102:103], v6 offset:51456
  v_mfma_f32_16x16x32_bf16 v[48:51], a[68:71], a[48:51], v[48:51]
  ds_read_b64_tr_b16 a[104:105], v7 offset:49408
  v_mfma_f32_16x16x32_bf16 v[52:55], a[68:71], a[52:55], v[52:55]
  ds_read_b64_tr_b16 a[106:107], v7 offset:51456
  v_mfma_f32_16x16x32_bf16 v[56:59], a[68:71], a[56:59], v[56:59]
  ds_read_b64_tr_b16 a[108:109], v8 offset:49408
  v_mfma_f32_16x16x32_bf16 v[60:63], a[68:71], a[60:63], v[60:63]
  ds_read_b64_tr_b16 a[110:111], v8 offset:51456
  v_mfma_f32_16x16x32_bf16 v[64:67], a[72:75], a[48:51], v[64:67]
  ds_read_b64_tr_b16 a[112:113], v18 offset:49408
  v_mfma_f32_16x16x32_bf16 v[68:71], a[72:75], a[52:55], v[68:71]
  ds_read_b64_tr_b16 a[114:115], v18 offset:51456
  v_mfma_f32_16x16x32_bf16 v[72:75], a[72:75], a[56:59], v[72:75]
  ds_read_b64_tr_b16 a[116:117], v19 offset:49408
  v_mfma_f32_16x16x32_bf16 v[76:79], a[72:75], a[60:63], v[76:79]
  ds_read_b64_tr_b16 a[118:119], v19 offset:51456
  s_add_u32 m0, s61, 4096
  v_mfma_f32_16x16x32_bf16 v[80:83], a[76:79], a[48:51], v[80:83]
  ds_read_b64_tr_b16 a[120:121], v20 offset:49408
  buffer_load_dwordx4 v10, s[44:47], s57 offen offset:0 lds
  v_mfma_f32_16x16x32_bf16 v[84:87], a[76:79], a[52:55], v[84:87]
  ds_read_b64_tr_b16 a[122:123], v20 offset:51456
  v_mfma_f32_16x16x32_bf16 v[88:91], a[76:79], a[56:59], v[88:91]
  ds_read_b64_tr_b16 a[124:125], v21 offset:49408
  v_mfma_f32_16x16x32_bf16 v[92:95], a[76:79], a[60:63], v[92:95]
  ds_read_b64_tr_b16 a[126:127], v21 offset:51456
  v_mfma_f32_16x16x32_bf16 v[96:99], a[80:83], a[48:51], v[96:99]
  buffer_load_dwordx4 v11, s[44:47], s57 offen offset:1024 lds
  v_mfma_f32_16x16x32_bf16 v[100:103], a[80:83], a[52:55], v[100:103]
  v_mfma_f32_16x16x32_bf16 v[104:107], a[80:83], a[56:59], v[104:107]
  v_mfma_f32_16x16x32_bf16 v[108:111], a[80:83], a[60:63], v[108:111]
  v_mfma_f32_16x16x32_bf16 v[112:115], a[84:87], a[48:51], v[112:115]
  buffer_load_dwordx4 v12, s[44:47], s57 offen offset:2048 lds
  v_mfma_f32_16x16x32_bf16 v[116:119], a[84:87], a[52:55], v[116:119]
  v_mfma_f32_16x16x32_bf16 v[120:123], a[84:87], a[56:59], v[120:123]
  s_cmp_eq_u32 s67, 3
  s_cselect_b32 s14, s6, 0
  v_mfma_f32_16x16x32_bf16 v[124:127], a[84:87], a[60:63], v[124:127]
  v_mfma_f32_16x16x32_bf16 v[128:131], a[88:91], a[48:51], v[128:131]
  buffer_load_dwordx4 v13, s[44:47], s57 offen offset:3072 lds
  v_mfma_f32_16x16x32_bf16 v[132:135], a[88:91], a[52:55], v[132:135]
  s_add_u32 s61, s61, 8192
  s_cmp_eq_u32 s61, s63
  s_cselect_b32 s61, s62, s61
  v_mfma_f32_16x16x32_bf16 v[136:139], a[88:91], a[56:59], v[136:139]
  v_mfma_f32_16x16x32_bf16 v[140:143], a[88:91], a[60:63], v[140:143]
  v_mfma_f32_16x16x32_bf16 v[144:147], a[92:95], a[48:51], v[144:147]
  v_mfma_f32_16x16x32_bf16 v[148:151], a[92:95], a[52:55], v[148:151]
  buffer_load_dword v28, v27, s[12:15], s79 offen
  v_mfma_f32_16x16x32_bf16 v[152:155], a[92:95], a[56:59], v[152:155]
  v_mfma_f32_16x16x32_bf16 v[156:159], a[92:95], a[60:63], v[156:159]
  s_sub_u32 s66, s66, 1
  s_cmp_lg_u32 s66, 0
  s_cbranch_scc1 mk_k_top
  s_cmp_lg_u32 s68, 0
  s_cbranch_scc1 mk_k2v
  s_waitcnt vmcnt(19) lgkmcnt(0)
  s_barrier
  v_mfma_f32_16x16x32_bf16 v[160:163], a[96:99], a[48:51], v[160:163]
  ds_read_b128 a[32:35], v1 offset:0
  v_mfma_f32_16x16x32_bf16 v[164:167], a[96:99], a[52:55], v[164:167]
  ds_read_b128 a[36:39], v1 offset:2048
  v_mfma_f32_16x16x32_bf16 v[168:171], a[96:99], a[56:59], v[168:171]
  ds_read_b128 a[40:43], v1 offset:4096
  v_mfma_f32_16x16x32_bf16 v[172:175], a[96:99], a[60:63], v[172:175]
  ds_read_b128 a[44:47], v1 offset:6144
  v_mfma_f32_16x16x32_bf16 v[176:179], a[100:103], a[48:51], v[176:179]
  ds_read_b64_tr_b16 a[64:65], v9 offset:0
  v_mfma_f32_16x16x32_bf16 v[180:183], a[100:103], a[52:55], v[180:183]
  ds_read_b64_tr_b16 a[66:67], v9 offset:896
  v_mfma_f32_16x16x32_bf16 v[184:187], a[100:103], a[56:59], v[184:187]
  ds_read_b64_tr_b16 a[68:69], v9 offset:32
  v_mfma_f32_16x16x32_bf16 v[188:191], a[100:103], a[60:63], v[188:191]
  ds_read_b64_tr_b16 a[70:71], v9 offset:928
  v_mfma_f32_16x16x32_bf16 v[192:195], a[104:107], a[48:51], v[192:195]
  ds_read_b64_tr_b16 a[72:73], v9 offset:64
  v_mfma_f32_16x16x32_bf16 v[196:199], a[104:107], a[52:55], v[196:199]
  ds_read_b64_tr_b16 a[74:75], v9 offset:960
  v_mfma_f32_16x16x32_bf16 v[200:203], a[104:107], a[56:59], v[200:203]
  ds_read_b64_tr_b16 a[76:77], v9 offset:96
  v_mfma_f32_16x16x32_bf16 v[204:207], a[104:107], a[60:63], v[204:207]
  ds_read_b64_tr_b16 a[78:79], v9 offset:992
  s_add_u32 m0, s64, 49152
  v_mfma_f32_16x16x32_bf16 v[208:211], a[108:111], a[48:51], v[208:211]
  ds_read_b64_tr_b16 a[80:81], v9 offset:128
  buffer_load_dwordx4 v14, s[48:51], s58 offen offset:0 lds
  v_mfma_f32_16x16x32_bf16 v[212:215], a[108:111], a[52:55], v[212:215]
  ds_read_b64_tr_b16 a[82:83], v9 offset:1024
  v_mfma_f32_16x16x32_bf16 v[216:219], a[108:111], a[56:59], v[216:219]
  ds_read_b64_tr_b16 a[84:85], v9 offset:160
  v_mfma_f32_16x16x32_bf16 v[220:223], a[108:111], a[60:63], v[220:223]
  ds_read_b64_tr_b16 a[86:87], v9 offset:1056
  v_mfma_f32_16x16x32_bf16 v[224:227], a[112:115], a[48:51], v[224:227]
  ds_read_b64_tr_b16 a[88:89], v9 offset:192
  buffer_load_dwordx4 v15, s[48:51], s58 offen offset:1024 lds
  v_mfma_f32_16x16x32_bf16 v[228:231], a[112:115], a[52:55], v[228:231]
  ds_read_b64_tr_b16 a[90:91], v9 offset:1088
  v_mfma_f32_16x16x32_bf16 v[232:235], a[112:115], a[56:59], v[232:235]
  v_mfma_f32_16x16x32_bf16 v[236:239], a[112:115], a[60:63], v[236:239]
  v_mfma_f32_16x16x32_bf16 v[240:243], a[116:119], a[48:51], v[240:243]
  buffer_load_dwordx4 v16, s[48:51], s58 offen offset:2048 lds
  v_mfma_f32_16x16x32_bf16 v[244:247], a[116:119], a[52:55], v[244:247]
  v_mfma_f32_16x16x32_bf16 v[248:251], a[116:119], a[56:59], v[248:251]
  v_mfma_f32_16x16x32_bf16 v[252:255], a[116:119], a[60:63], v[252:255]
  v_mfma_f32_16x16x32_bf16 a[0:3], a[120:123], a[48:51], a[0:3]
  buffer_load_dwordx4 v17, s[48:51], s58 offen offset:3072 lds
  v_mfma_f32_16x16x32_bf16 a[4:7], a[120:123], a[52:55], a[4:7]
  s_add_u32 s58, s58, s59
  v_mfma_f32_16x16x32_bf16 a[8:11], a[120:123], a[56:59], a[8:11]
  v_mfma_f32_16x16x32_bf16 a[12:15], a[120:123], a[60:63], a[12:15]
  v_mfma_f32_16x16x32_bf16 a[16:19], a[124:127], a[48:51], a[16:19]
  v_mfma_f32_16x16x32_bf16 a[20:23], a[124:127], a[52:55], a[20:23]
  v_mfma_f32_16x16x32_bf16 a[24:27], a[124:127], a[56:59], a[24:27]
  v_mfma_f32_16x16x32_bf16 a[28:31], a[124:127], a[60:63], a[28:31]
  s_mov_b32 s94, 0x3e0293ee
  s_mov_b32 s95, 0x3e0293ee
  s_lshl_b32 s80, s70, 20
  s_lshl_b32 s76, s69, 16
  s_add_u32 s80, s80, s76
  s_mov_b32 s26, s80
  s_add_u32 s27, s80, 4096
  s_mov_b32 s28, 8192
  s_mov_b32 s14, 0
  buffer_load_dword v28, v27, s[12:15], s79 offen
  buffer_load_dword v28, v27, s[12:15], s79 offen
  buffer_load_dword v28, v27, s[12:15], s79 offen
  buffer_load_dword v28, v27, s[12:15], s79 offen
  v_pk_mul_f32 v[32:33], v[32:33], s[94:95]
  v_pk_mul_f32 v[34:35], v[34:35], s[94:95]
  v_pk_mul_f32 v[36:37], v[36:37], s[94:95]
  v_pk_mul_f32 v[38:39], v[38:39], s[94:95]
  v_cvt_pk_bf16_f32 v32, v32, v33
  v_cvt_pk_bf16_f32 v33, v34, v35
  v_cvt_pk_bf16_f32 v36, v36, v37
  v_cvt_pk_bf16_f32 v37, v38, v39
  v_pk_mul_f32 v[40:41], v[40:41], s[94:95]
  v_pk_mul_f32 v[42:43], v[42:43], s[94:95]
  v_pk_mul_f32 v[44:45], v[44:45], s[94:95]
  v_pk_mul_f32 v[46:47], v[46:47], s[94:95]
  v_cvt_pk_bf16_f32 v40, v40, v41
  v_cvt_pk_bf16_f32 v41, v42, v43
  v_cvt_pk_bf16_f32 v44, v44, v45
  v_cvt_pk_bf16_f32 v45, v46, v47
  v_permlane16_swap_b32 v32, v36
  v_permlane16_swap_b32 v33, v37
  v_accvgpr_write_b32 a128, v32
  v_accvgpr_write_b32 a129, v33
  v_accvgpr_write_b32 a130, v36
  v_accvgpr_write_b32 a131, v37
  v_pk_mul_f32 v[48:49], v[48:49], s[94:95]
  v_pk_mul_f32 v[50:51], v[50:51], s[94:95]
  v_pk_mul_f32 v[52:53], v[52:53], s[94:95]
  v_pk_mul_f32 v[54:55], v[54:55], s[94:95]
  v_cvt_pk_bf16_f32 v48, v48, v49
  v_cvt_pk_bf16_f32 v49, v50, v51
  v_cvt_pk_bf16_f32 v52, v52, v53
  v_cvt_pk_bf16_f32 v53, v54, v55
  v_permlane16_swap_b32 v40, v44
  v_permlane16_swap_b32 v41, v45
  v_accvgpr_write_b32 a160, v40
  v_accvgpr_write_b32 a161, v41
  v_accvgpr_write_b32 a162, v44
  v_accvgpr_write_b32 a163, v45
  v_pk_mul_f32 v[56:57], v[56:57], s[94:95]
  v_pk_mul_f32 v[58:59], v[58:59], s[94:95]
  v_pk_mul_f32 v[60:61], v[60:61], s[94:95]
  v_pk_mul_f32 v[62:63], v[62:63], s[94:95]
  v_cvt_pk_bf16_f32 v56, v56, v57
  v_cvt_pk_bf16_f32 v57, v58, v59
  v_cvt_pk_bf16_f32 v60, v60, v61
  v_cvt_pk_bf16_f32 v61, v62, v63
  v_permlane16_swap_b32 v48, v52
  v_permlane16_swap_b32 v49, v53
  v_accvgpr_write_b32 a132, v48
  v_accvgpr_write_b32 a133, v49
  v_accvgpr_write_b32 a134, v52
  v_accvgpr_write_b32 a135, v53
  v_pk_mul_f32 v[64:65], v[64:65], s[94:95]
  v_pk_mul_f32 v[66:67], v[66:67], s[94:95]
  v_pk_mul_f32 v[68:69], v[68:69], s[94:95]
  v_pk_mul_f32 v[70:71], v[70:71], s[94:95]
  v_cvt_pk_bf16_f32 v64, v64, v65
  v_cvt_pk_bf16_f32 v65, v66, v67
  v_cvt_pk_bf16_f32 v68, v68, v69
  v_cvt_pk_bf16_f32 v69, v70, v71
  v_permlane16_swap_b32 v56, v60
  v_permlane16_swap_b32 v57, v61
  v_accvgpr_write_b32 a164, v56
  v_accvgpr_write_b32 a165, v57
  v_accvgpr_write_b32 a166, v60
  v_accvgpr_write_b32 a167, v61
  v_pk_mul_f32 v[72:73], v[72:73], s[94:95]
  v_pk_mul_f32 v[74:75], v[74:75], s[94:95]
  v_pk_mul_f32 v[76:77], v[76:77], s[94:95]
  v_pk_mul_f32 v[78:79], v[78:79], s[94:95]
  v_cvt_pk_bf16_f32 v72, v72, v73
  v_cvt_pk_bf16_f32 v73, v74, v75
  v_cvt_pk_bf16_f32 v76, v76, v77
  v_cvt_pk_bf16_f32 v77, v78, v79
  v_permlane16_swap_b32 v64, v68
  v_permlane16_swap_b32 v65, v69
  v_accvgpr_write_b32 a136, v64
  v_accvgpr_write_b32 a137, v65
  v_accvgpr_write_b32 a138, v68
  v_accvgpr_write_b32 a139, v69
  v_pk_mul_f32 v[80:81], v[80:81], s[94:95]
  v_pk_mul_f32 v[82:83], v[82:83], s[94:95]
  v_pk_mul_f32 v[84:85], v[84:85], s[94:95]
  v_pk_mul_f32 v[86:87], v[86:87], s[94:95]
  v_cvt_pk_bf16_f32 v80, v80, v81
  v_cvt_pk_bf16_f32 v81, v82, v83
  v_cvt_pk_bf16_f32 v84, v84, v85
  v_cvt_pk_bf16_f32 v85, v86, v87
  v_permlane16_swap_b32 v72, v76
  v_permlane16_swap_b32 v73, v77
  v_accvgpr_write_b32 a168, v72
  v_accvgpr_write_b32 a169, v73
  v_accvgpr_write_b32 a170, v76
  v_accvgpr_write_b32 a171, v77
  v_pk_mul_f32 v[88:89], v[88:89], s[94:95]
  v_pk_mul_f32 v[90:91], v[90:91], s[94:95]
  v_pk_mul_f32 v[92:93], v[92:93], s[94:95]
  v_pk_mul_f32 v[94:95], v[94:95], s[94:95]
  v_cvt_pk_bf16_f32 v88, v88, v89
  v_cvt_pk_bf16_f32 v89, v90, v91
  v_cvt_pk_bf16_f32 v92, v92, v93
  v_cvt_pk_bf16_f32 v93, v94, v95
  v_permlane16_swap_b32 v80, v84
  v_permlane16_swap_b32 v81, v85
  v_accvgpr_write_b32 a140, v80
  v_accvgpr_write_b32 a141, v81
  v_accvgpr_write_b32 a142, v84
  v_accvgpr_write_b32 a143, v85
  v_pk_mul_f32 v[96:97], v[96:97], s[94:95]
  v_pk_mul_f32 v[98:99], v[98:99], s[94:95]
  v_pk_mul_f32 v[100:101], v[100:101], s[94:95]
  v_pk_mul_f32 v[102:103], v[102:103], s[94:95]
  v_cvt_pk_bf16_f32 v96, v96, v97
  v_cvt_pk_bf16_f32 v97, v98, v99
  v_cvt_pk_bf16_f32 v100, v100, v101
  v_cvt_pk_bf16_f32 v101, v102, v103
  v_permlane16_swap_b32 v88, v92
  v_permlane16_swap_b32 v89, v93
  v_accvgpr_write_b32 a172, v88
  v_accvgpr_write_b32 a173, v89
  v_accvgpr_write_b32 a174, v92
  v_accvgpr_write_b32 a175, v93
  v_pk_mul_f32 v[104:105], v[104:105], s[94:95]
  v_pk_mul_f32 v[106:107], v[106:107], s[94:95]
  v_pk_mul_f32 v[108:109], v[108:109], s[94:95]
  v_pk_mul_f32 v[110:111], v[110:111], s[94:95]
  v_cvt_pk_bf16_f32 v104, v104, v105
  v_cvt_pk_bf16_f32 v105, v106, v107
  v_cvt_pk_bf16_f32 v108, v108, v109
  v_cvt_pk_bf16_f32 v109, v110, v111
  v_permlane16_swap_b32 v96, v100
  v_permlane16_swap_b32 v97, v101
  v_accvgpr_write_b32 a144, v96
  v_accvgpr_write_b32 a145, v97
  v_accvgpr_write_b32 a146, v100
  v_accvgpr_write_b32 a147, v101
  v_pk_mul_f32 v[112:113], v[112:113], s[94:95]
  v_pk_mul_f32 v[114:115], v[114:115], s[94:95]
  v_pk_mul_f32 v[116:117], v[116:117], s[94:95]
  v_pk_mul_f32 v[118:119], v[118:119], s[94:95]
  v_cvt_pk_bf16_f32 v112, v112, v113
  v_cvt_pk_bf16_f32 v113, v114, v115
  v_cvt_pk_bf16_f32 v116, v116, v117
  v_cvt_pk_bf16_f32 v117, v118, v119
  v_permlane16_swap_b32 v104, v108
  v_permlane16_swap_b32 v105, v109
  v_accvgpr_write_b32 a176, v104
  v_accvgpr_write_b32 a177, v105
  v_accvgpr_write_b32 a178, v108
  v_accvgpr_write_b32 a179, v109
  v_pk_mul_f32 v[120:121], v[120:121], s[94:95]
  v_pk_mul_f32 v[122:123], v[122:123], s[94:95]
  v_pk_mul_f32 v[124:125], v[124:125], s[94:95]
  v_pk_mul_f32 v[126:127], v[126:127], s[94:95]
  v_cvt_pk_bf16_f32 v120, v120, v121
  v_cvt_pk_bf16_f32 v121, v122, v123
  v_cvt_pk_bf16_f32 v124, v124, v125
  v_cvt_pk_bf16_f32 v125, v126, v127
  v_permlane16_swap_b32 v112, v116
  v_permlane16_swap_b32 v113, v117
  v_accvgpr_write_b32 a148, v112
  v_accvgpr_write_b32 a149, v113
  v_accvgpr_write_b32 a150, v116
  v_accvgpr_write_b32 a151, v117
  v_pk_mul_f32 v[128:129], v[128:129], s[94:95]
  v_pk_mul_f32 v[130:131], v[130:131], s[94:95]
  v_pk_mul_f32 v[132:133], v[132:133], s[94:95]
  v_pk_mul_f32 v[134:135], v[134:135], s[94:95]
  v_cvt_pk_bf16_f32 v128, v128, v129
  v_cvt_pk_bf16_f32 v129, v130, v131
  v_cvt_pk_bf16_f32 v132, v132, v133
  v_cvt_pk_bf16_f32 v133, v134, v135
  v_permlane16_swap_b32 v120, v124
  v_permlane16_swap_b32 v121, v125
  v_accvgpr_write_b32 a180, v120
  v_accvgpr_write_b32 a181, v121
  v_accvgpr_write_b32 a182, v124
  v_accvgpr_write_b32 a183, v125
  v_pk_mul_f32 v[136:137], v[136:137], s[94:95]
  v_pk_mul_f32 v[138:139], v[138:139], s[94:95]
  v_pk_mul_f32 v[140:141], v[140:141], s[94:95]
  v_pk_mul_f32 v[142:143], v[142:143], s[94:95]
  v_cvt_pk_bf16_f32 v136, v136, v137
  v_cvt_pk_bf16_f32 v137, v138, v139
  v_cvt_pk_bf16_f32 v140, v140, v141
  v_cvt_pk_bf16_f32 v141, v142, v143
  v_permlane16_swap_b32 v128, v132
  v_permlane16_swap_b32 v129, v133
  v_accvgpr_write_b32 a152, v128
  v_accvgpr_write_b32 a153, v129
  v_accvgpr_write_b32 a154, v132
  v_accvgpr_write_b32 a155, v133
  v_pk_mul_f32 v[144:145], v[144:145], s[94:95]
  v_pk_mul_f32 v[146:147], v[146:147], s[94:95]
  v_pk_mul_f32 v[148:149], v[148:149], s[94:95]
  v_pk_mul_f32 v[150:151], v[150:151], s[94:95]
  v_cvt_pk_bf16_f32 v144, v144, v145
  v_cvt_pk_bf16_f32 v145, v146, v147
  v_cvt_pk_bf16_f32 v148, v148, v149
  v_cvt_pk_bf16_f32 v149, v150, v151
  v_permlane16_swap_b32 v136, v140
  v_permlane16_swap_b32 v137, v141
  v_accvgpr_write_b32 a184, v136
  v_accvgpr_write_b32 a185, v137
  v_accvgpr_write_b32 a186, v140
  v_accvgpr_write_b32 a187, v141
  v_pk_mul_f32 v[152:153], v[152:153], s[94:95]
  v_pk_mul_f32 v[154:155], v[154:155], s[94:95]
  v_pk_mul_f32 v[156:157], v[156:157], s[94:95]
  v_pk_mul_f32 v[158:159], v[158:159], s[94:95]
  v_cvt_pk_bf16_f32 v152, v152, v153
  v_cvt_pk_bf16_f32 v153, v154, v155
  v_cvt_pk_bf16_f32 v156, v156, v157
  v_cvt_pk_bf16_f32 v157, v158, v159
  v_permlane16_swap_b32 v144, v148
  v_permlane16_swap_b32 v145, v149
  v_accvgpr_write_b32 a156, v144
  v_accvgpr_write_b32 a157, v145
  v_accvgpr_write_b32 a158, v148
  v_accvgpr_write_b32 a159, v149
  v_pk_mul_f32 v[160:161], v[160:161], s[94:95]
  v_pk_mul_f32 v[162:163], v[162:163], s[94:95]
  v_pk_mul_f32 v[164:165], v[164:165], s[94:95]
  v_pk_mul_f32 v[166:167], v[166:167], s[94:95]
  v_cvt_pk_bf16_f32 v160, v160, v161
  v_cvt_pk_bf16_f32 v161, v162, v163
  v_cvt_pk_bf16_f32 v164, v164, v165
  v_cvt_pk_bf16_f32 v165, v166, v167
  v_permlane16_swap_b32 v152, v156
  v_permlane16_swap_b32 v153, v157
  v_accvgpr_write_b32 a188, v152
  v_accvgpr_write_b32 a189, v153
  v_accvgpr_write_b32 a190, v156
  v_accvgpr_write_b32 a191, v157
  v_pk_mul_f32 v[168:169], v[168:169], s[94:95]
  v_pk_mul_f32 v[170:171], v[170:171], s[94:95]
  v_pk_mul_f32 v[172:173], v[172:173], s[94:95]
  v_pk_mul_f32 v[174:175], v[174:175], s[94:95]
  v_cvt_pk_bf16_f32 v168, v168, v169
  v_cvt_pk_bf16_f32 v169, v170, v171
  v_cvt_pk_bf16_f32 v172, v172, v173
  v_cvt_pk_bf16_f32 v173, v174, v175
  v_permlane16_swap_b32 v160, v164
  v_permlane16_swap_b32 v161, v165
  v_accvgpr_write_b32 a192, v160
  v_accvgpr_write_b32 a193, v161
  v_accvgpr_write_b32 a194, v164
  v_accvgpr_write_b32 a195, v165
  v_pk_mul_f32 v[176:177], v[176:177], s[94:95]
  v_pk_mul_f32 v[178:179], v[178:179], s[94:95]
  v_pk_mul_f32 v[180:181], v[180:181], s[94:95]
  v_pk_mul_f32 v[182:183], v[182:183], s[94:95]
  v_cvt_pk_bf16_f32 v176, v176, v177
  v_cvt_pk_bf16_f32 v177, v178, v179
  v_cvt_pk_bf16_f32 v180, v180, v181
  v_cvt_pk_bf16_f32 v181, v182, v183
  v_permlane16_swap_b32 v168, v172
  v_permlane16_swap_b32 v169, v173
  v_accvgpr_write_b32 a224, v168
  v_accvgpr_write_b32 a225, v169
  v_accvgpr_write_b32 a226, v172
  v_accvgpr_write_b32 a227, v173
  v_pk_mul_f32 v[184:185], v[184:185], s[94:95]
  v_pk_mul_f32 v[186:187], v[186:187], s[94:95]
  v_pk_mul_f32 v[188:189], v[188:189], s[94:95]
  v_pk_mul_f32 v[190:191], v[190:191], s[94:95]
  v_cvt_pk_bf16_f32 v184, v184, v185
  v_cvt_pk_bf16_f32 v185, v186, v187
  v_cvt_pk_bf16_f32 v188, v188, v189
  v_cvt_pk_bf16_f32 v189, v190, v191
  v_permlane16_swap_b32 v176, v180
  v_permlane16_swap_b32 v177, v181
  v_accvgpr_write_b32 a196, v176
  v_accvgpr_write_b32 a197, v177
  v_accvgpr_write_b32 a198, v180
  v_accvgpr_write_b32 a199, v181
  v_pk_mul_f32 v[192:193], v[192:193], s[94:95]
  v_pk_mul_f32 v[194:195], v[194:195], s[94:95]
  v_pk_mul_f32 v[196:197], v[196:197], s[94:95]
  v_pk_mul_f32 v[198:199], v[198:199], s[94:95]
  v_cvt_pk_bf16_f32 v192, v192, v193
  v_cvt_pk_bf16_f32 v193, v194, v195
  v_cvt_pk_bf16_f32 v196, v196, v197
  v_cvt_pk_bf16_f32 v197, v198, v199
  v_permlane16_swap_b32 v184, v188
  v_permlane16_swap_b32 v185, v189
  v_accvgpr_write_b32 a228, v184
  v_accvgpr_write_b32 a229, v185
  v_accvgpr_write_b32 a230, v188
  v_accvgpr_write_b32 a231, v189
  v_pk_mul_f32 v[200:201], v[200:201], s[94:95]
  v_pk_mul_f32 v[202:203], v[202:203], s[94:95]
  v_pk_mul_f32 v[204:205], v[204:205], s[94:95]
  v_pk_mul_f32 v[206:207], v[206:207], s[94:95]
  v_cvt_pk_bf16_f32 v200, v200, v201
  v_cvt_pk_bf16_f32 v201, v202, v203
  v_cvt_pk_bf16_f32 v204, v204, v205
  v_cvt_pk_bf16_f32 v205, v206, v207
  v_permlane16_swap_b32 v192, v196
  v_permlane16_swap_b32 v193, v197
  v_accvgpr_write_b32 a200, v192
  v_accvgpr_write_b32 a201, v193
  v_accvgpr_write_b32 a202, v196
  v_accvgpr_write_b32 a203, v197
  v_pk_mul_f32 v[208:209], v[208:209], s[94:95]
  v_pk_mul_f32 v[210:211], v[210:211], s[94:95]
  v_pk_mul_f32 v[212:213], v[212:213], s[94:95]
  v_pk_mul_f32 v[214:215], v[214:215], s[94:95]
  v_cvt_pk_bf16_f32 v208, v208, v209
  v_cvt_pk_bf16_f32 v209, v210, v211
  v_cvt_pk_bf16_f32 v212, v212, v213
  v_cvt_pk_bf16_f32 v213, v214, v215
  v_permlane16_swap_b32 v200, v204
  v_permlane16_swap_b32 v201, v205
  v_accvgpr_write_b32 a232, v200
  v_accvgpr_write_b32 a233, v201
  v_accvgpr_write_b32 a234, v204
  v_accvgpr_write_b32 a235, v205
  v_pk_mul_f32 v[216:217], v[216:217], s[94:95]
  v_pk_mul_f32 v[218:219], v[218:219], s[94:95]
  v_pk_mul_f32 v[220:221], v[220:221], s[94:95]
  v_pk_mul_f32 v[222:223], v[222:223], s[94:95]
  v_cvt_pk_bf16_f32 v216, v216, v217
  v_cvt_pk_bf16_f32 v217, v218, v219
  v_cvt_pk_bf16_f32 v220, v220, v221
  v_cvt_pk_bf16_f32 v221, v222, v223
  v_permlane16_swap_b32 v208, v212
  v_permlane16_swap_b32 v209, v213
  v_accvgpr_write_b32 a204, v208
  v_accvgpr_write_b32 a205, v209
  v_accvgpr_write_b32 a206, v212
  v_accvgpr_write_b32 a207, v213
  v_pk_mul_f32 v[224:225], v[224:225], s[94:95]
  v_pk_mul_f32 v[226:227], v[226:227], s[94:95]
  v_pk_mul_f32 v[228:229], v[228:229], s[94:95]
  v_pk_mul_f32 v[230:231], v[230:231], s[94:95]
  v_cvt_pk_bf16_f32 v224, v224, v225
  v_cvt_pk_bf16_f32 v225, v226, v227
  v_cvt_pk_bf16_f32 v228, v228, v229
  v_cvt_pk_bf16_f32 v229, v230, v231
  v_permlane16_swap_b32 v216, v220
  v_permlane16_swap_b32 v217, v221
  v_accvgpr_write_b32 a236, v216
  v_accvgpr_write_b32 a237, v217
  v_accvgpr_write_b32 a238, v220
  v_accvgpr_write_b32 a239, v221
  v_pk_mul_f32 v[232:233], v[232:233], s[94:95]
  v_pk_mul_f32 v[234:235], v[234:235], s[94:95]
  v_pk_mul_f32 v[236:237], v[236:237], s[94:95]
  v_pk_mul_f32 v[238:239], v[238:239], s[94:95]
  v_cvt_pk_bf16_f32 v232, v232, v233
  v_cvt_pk_bf16_f32 v233, v234, v235
  v_cvt_pk_bf16_f32 v236, v236, v237
  v_cvt_pk_bf16_f32 v237, v238, v239
  v_permlane16_swap_b32 v224, v228
  v_permlane16_swap_b32 v225, v229
  v_accvgpr_write_b32 a208, v224
  v_accvgpr_write_b32 a209, v225
  v_accvgpr_write_b32 a210, v228
  v_accvgpr_write_b32 a211, v229
  v_pk_mul_f32 v[240:241], v[240:241], s[94:95]
  v_pk_mul_f32 v[242:243], v[242:243], s[94:95]
  v_pk_mul_f32 v[244:245], v[244:245], s[94:95]
  v_pk_mul_f32 v[246:247], v[246:247], s[94:95]
  v_cvt_pk_bf16_f32 v240, v240, v241
  v_cvt_pk_bf16_f32 v241, v242, v243
  v_cvt_pk_bf16_f32 v244, v244, v245
  v_cvt_pk_bf16_f32 v245, v246, v247
  v_permlane16_swap_b32 v232, v236
  v_permlane16_swap_b32 v233, v237
  v_accvgpr_write_b32 a240, v232
  v_accvgpr_write_b32 a241, v233
  v_accvgpr_write_b32 a242, v236
  v_accvgpr_write_b32 a243, v237
  v_pk_mul_f32 v[248:249], v[248:249], s[94:95]
  v_pk_mul_f32 v[250:251], v[250:251], s[94:95]
  v_pk_mul_f32 v[252:253], v[252:253], s[94:95]
  v_pk_mul_f32 v[254:255], v[254:255], s[94:95]
  v_cvt_pk_bf16_f32 v248, v248, v249
  v_cvt_pk_bf16_f32 v249, v250, v251
  v_cvt_pk_bf16_f32 v252, v252, v253
  v_cvt_pk_bf16_f32 v253, v254, v255
  v_permlane16_swap_b32 v240, v244
  v_permlane16_swap_b32 v241, v245
  v_accvgpr_write_b32 a212, v240
  v_accvgpr_write_b32 a213, v241
  v_accvgpr_write_b32 a214, v244
  v_accvgpr_write_b32 a215, v245
  v_accvgpr_read_b32 v32, a0
  v_accvgpr_read_b32 v33, a1
  v_accvgpr_read_b32 v34, a2
  v_accvgpr_read_b32 v35, a3
  v_accvgpr_read_b32 v36, a4
  v_accvgpr_read_b32 v37, a5
  v_accvgpr_read_b32 v38, a6
  v_accvgpr_read_b32 v39, a7
  v_pk_mul_f32 v[32:33], v[32:33], s[94:95]
  v_pk_mul_f32 v[34:35], v[34:35], s[94:95]
  v_pk_mul_f32 v[36:37], v[36:37], s[94:95]
  v_pk_mul_f32 v[38:39], v[38:39], s[94:95]
  v_cvt_pk_bf16_f32 v32, v32, v33
  v_cvt_pk_bf16_f32 v33, v34, v35
  v_cvt_pk_bf16_f32 v36, v36, v37
  v_cvt_pk_bf16_f32 v37, v38, v39
  v_permlane16_swap_b32 v248, v252
  v_permlane16_swap_b32 v249, v253
  v_accvgpr_write_b32 a244, v248
  v_accvgpr_write_b32 a245, v249
  v_accvgpr_write_b32 a246, v252
  v_accvgpr_write_b32 a247, v253
  v_accvgpr_read_b32 v40, a8
  v_accvgpr_read_b32 v41, a9
  v_accvgpr_read_b32 v42, a10
  v_accvgpr_read_b32 v43, a11
  v_accvgpr_read_b32 v44, a12
  v_accvgpr_read_b32 v45, a13
  v_accvgpr_read_b32 v46, a14
  v_accvgpr_read_b32 v47, a15
  v_pk_mul_f32 v[40:41], v[40:41], s[94:95]
  v_pk_mul_f32 v[42:43], v[42:43], s[94:95]
  v_pk_mul_f32 v[44:45], v[44:45], s[94:95]
  v_pk_mul_f32 v[46:47], v[46:47], s[94:95]
  v_cvt_pk_bf16_f32 v40, v40, v41
  v_cvt_pk_bf16_f32 v41, v42, v43
  v_cvt_pk_bf16_f32 v44, v44, v45
  v_cvt_pk_bf16_f32 v45, v46, v47
  v_permlane16_swap_b32 v32, v36
  v_permlane16_swap_b32 v33, v37
  v_accvgpr_write_b32 a216, v32
  v_accvgpr_write_b32 a217, v33
  v_accvgpr_write_b32 a218, v36
  v_accvgpr_write_b32 a219, v37
  v_accvgpr_read_b32 v48, a16
  v_accvgpr_read_b32 v49, a17
  v_accvgpr_read_b32 v50, a18
  v_accvgpr_read_b32 v51, a19
  v_accvgpr_read_b32 v52, a20
  v_accvgpr_read_b32 v53, a21
  v_accvgpr_read_b32 v54, a22
  v_accvgpr_read_b32 v55, a23
  v_pk_mul_f32 v[48:49], v[48:49], s[94:95]
  v_pk_mul_f32 v[50:51], v[50:51], s[94:95]
  v_pk_mul_f32 v[52:53], v[52:53], s[94:95]
  v_pk_mul_f32 v[54:55], v[54:55], s[94:95]
  v_cvt_pk_bf16_f32 v48, v48, v49
  v_cvt_pk_bf16_f32 v49, v50, v51
  v_cvt_pk_bf16_f32 v52, v52, v53
  v_cvt_pk_bf16_f32 v53, v54, v55
  v_permlane16_swap_b32 v40, v44
  v_permlane16_swap_b32 v41, v45
  v_accvgpr_write_b32 a248, v40
  v_accvgpr_write_b32 a249, v41
  v_accvgpr_write_b32 a250, v44
  v_accvgpr_write_b32 a251, v45
  v_accvgpr_read_b32 v56, a24
  v_accvgpr_read_b32 v57, a25
  v_accvgpr_read_b32 v58, a26
  v_accvgpr_read_b32 v59, a27
  v_accvgpr_read_b32 v60, a28
  v_accvgpr_read_b32 v61, a29
  v_accvgpr_read_b32 v62, a30
  v_accvgpr_read_b32 v63, a31
  v_pk_mul_f32 v[56:57], v[56:57], s[94:95]
  v_pk_mul_f32 v[58:59], v[58:59], s[94:95]
  v_pk_mul_f32 v[60:61], v[60:61], s[94:95]
  v_pk_mul_f32 v[62:63], v[62:63], s[94:95]
  v_cvt_pk_bf16_f32 v56, v56, v57
  v_cvt_pk_bf16_f32 v57, v58, v59
  v_cvt_pk_bf16_f32 v60, v60, v61
  v_cvt_pk_bf16_f32 v61, v62, v63
  v_permlane16_swap_b32 v48, v52
  v_permlane16_swap_b32 v49, v53
  v_accvgpr_write_b32 a220, v48
  v_accvgpr_write_b32 a221, v49
  v_accvgpr_write_b32 a222, v52
  v_accvgpr_write_b32 a223, v53
  s_nop 1
  v_permlane16_swap_b32 v56, v60
  v_permlane16_swap_b32 v57, v61
  v_accvgpr_write_b32 a252, v56
  v_accvgpr_write_b32 a253, v57
  v_accvgpr_write_b32 a254, v60
  v_accvgpr_write_b32 a255, v61
  s_branch mk_gu_start
mk_k2v:
  s_waitcnt vmcnt(19) lgkmcnt(0)
  s_barrier
  v_add_u32 v1, v1, v3
  v_add_u32 v2, v2, v4
  v_mfma_f32_16x16x32_bf16 v[160:163], a[96:99], a[48:51], v[160:163]
  ds_read_b128 a[32:35], v1 offset:0
  v_mfma_f32_16x16x32_bf16 v[164:167], a[96:99], a[52:55], v[164:167]
  ds_read_b128 a[36:39], v1 offset:2048
  v_mfma_f32_16x16x32_bf16 v[168:171], a[96:99], a[56:59], v[168:171]
  ds_read_b128 a[40:43], v1 offset:4096
  v_mfma_f32_16x16x32_bf16 v[172:175], a[96:99], a[60:63], v[172:175]
  ds_read_b128 a[44:47], v1 offset:6144
  v_mfma_f32_16x16x32_bf16 v[176:179], a[100:103], a[48:51], v[176:179]
  ds_read_b64_tr_b16 a[64:65], v5 offset:0
  v_mfma_f32_16x16x32_bf16 v[180:183], a[100:103], a[52:55], v[180:183]
  ds_read_b64_tr_b16 a[66:67], v5 offset:2048
  v_mfma_f32_16x16x32_bf16 v[184:187], a[100:103], a[56:59], v[184:187]
  ds_read_b64_tr_b16 a[68:69], v6 offset:0
  v_mfma_f32_16x16x32_bf16 v[188:191], a[100:103], a[60:63], v[188:191]
  ds_read_b64_tr_b16 a[70:71], v6 offset:2048
  v_mfma_f32_16x16x32_bf16 v[192:195], a[104:107], a[48:51], v[192:195]
  ds_read_b64_tr_b16 a[72:73], v7 offset:0
  v_mfma_f32_16x16x32_bf16 v[196:199], a[104:107], a[52:55], v[196:199]
  ds_read_b64_tr_b16 a[74:75], v7 offset:2048
  v_mfma_f32_16x16x32_bf16 v[200:203], a[104:107], a[56:59], v[200:203]
  ds_read_b64_tr_b16 a[76:77], v8 offset:0
  v_mfma_f32_16x16x32_bf16 v[204:207], a[104:107], a[60:63], v[204:207]
  ds_read_b64_tr_b16 a[78:79], v8 offset:2048
  s_add_u32 m0, s64, 49152
  v_mfma_f32_16x16x32_bf16 v[208:211], a[108:111], a[48:51], v[208:211]
  ds_read_b64_tr_b16 a[80:81], v18 offset:0
  buffer_load_dwordx4 v14, s[48:51], s58 offen offset:0 lds
  v_mfma_f32_16x16x32_bf16 v[212:215], a[108:111], a[52:55], v[212:215]
  ds_read_b64_tr_b16 a[82:83], v18 offset:2048
  v_mfma_f32_16x16x32_bf16 v[216:219], a[108:111], a[56:59], v[216:219]
  ds_read_b64_tr_b16 a[84:85], v19 offset:0
  v_mfma_f32_16x16x32_bf16 v[220:223], a[108:111], a[60:63], v[220:223]
  ds_read_b64_tr_b16 a[86:87], v19 offset:2048
  v_mfma_f32_16x16x32_bf16 v[224:227], a[112:115], a[48:51], v[224:227]
  ds_read_b64_tr_b16 a[88:89], v20 offset:0
  buffer_load_dwordx4 v15, s[48:51], s58 offen offset:1024 lds
  v_mfma_f32_16x16x32_bf16 v[228:231], a[112:115], a[52:55], v[228:231]
  ds_read_b64_tr_b16 a[90:91], v20 offset:2048
  v_mfma_f32_16x16x32_bf16 v[232:235], a[112:115], a[56:59], v[232:235]
  ds_read_b64_tr_b16 a[92:93], v21 offset:0
  v_mfma_f32_16x16x32_bf16 v[236:239], a[112:115], a[60:63], v[236:239]
  ds_read_b64_tr_b16 a[94:95], v21 offset:2048
  v_mfma_f32_16x16x32_bf16 v[240:243], a[116:119], a[48:51], v[240:243]
  buffer_load_dwordx4 v16, s[48:51], s58 offen offset:2048 lds
  v_mfma_f32_16x16x32_bf16 v[244:247], a[116:119], a[52:55], v[244:247]
  v_mfma_f32_16x16x32_bf16 v[248:251], a[116:119], a[56:59], v[248:251]
  v_mfma_f32_16x16x32_bf16 v[252:255], a[116:119], a[60:63], v[252:255]
  v_mfma_f32_16x16x32_bf16 a[0:3], a[120:123], a[48:51], a[0:3]
  buffer_load_dwordx4 v17, s[48:51], s58 offen offset:3072 lds
  v_mfma_f32_16x16x32_bf16 a[4:7], a[120:123], a[52:55], a[4:7]
  s_add_u32 s58, s58, s59
  v_mfma_f32_16x16x32_bf16 a[8:11], a[120:123], a[56:59], a[8:11]
  v_mfma_f32_16x16x32_bf16 a[12:15], a[120:123], a[60:63], a[12:15]
  v_mfma_f32_16x16x32_bf16 a[16:19], a[124:127], a[48:51], a[16:19]
  v_mfma_f32_16x16x32_bf16 a[20:23], a[124:127], a[52:55], a[20:23]
  v_mfma_f32_16x16x32_bf16 a[24:27], a[124:127], a[56:59], a[24:27]
  v_mfma_f32_16x16x32_bf16 a[28:31], a[124:127], a[60:63], a[28:31]
  s_lshl_b32 s80, s70, 20
  s_lshl_b32 s76, s69, 16
  s_add_u32 s80, s80, s76
  s_add_u32 s80, s80, 16777216
  s_mov_b32 s26, s80
  s_add_u32 s27, s80, 4096
  s_mov_b32 s28, 8192
  s_mov_b32 s14, 0
  buffer_load_dword v28, v27, s[12:15], s79 offen
  buffer_load_dword v28, v27, s[12:15], s79 offen
  buffer_load_dword v28, v27, s[12:15], s79 offen
  buffer_load_dword v28, v27, s[12:15], s79 offen
  v_cvt_pk_bf16_f32 v32, v32, v33
  v_cvt_pk_bf16_f32 v33, v34, v35
  v_cvt_pk_bf16_f32 v36, v36, v37
  v_cvt_pk_bf16_f32 v37, v38, v39
  v_cvt_pk_bf16_f32 v40, v40, v41
  v_cvt_pk_bf16_f32 v41, v42, v43
  v_cvt_pk_bf16_f32 v44, v44, v45
  v_cvt_pk_bf16_f32 v45, v46, v47
  v_permlane16_swap_b32 v32, v36
  v_permlane16_swap_b32 v33, v37
  v_accvgpr_write_b32 a128, v32
  v_accvgpr_write_b32 a129, v33
  v_accvgpr_write_b32 a130, v36
  v_accvgpr_write_b32 a131, v37
  v_cvt_pk_bf16_f32 v48, v48, v49
  v_cvt_pk_bf16_f32 v49, v50, v51
  v_cvt_pk_bf16_f32 v52, v52, v53
  v_cvt_pk_bf16_f32 v53, v54, v55
  v_permlane16_swap_b32 v40, v44
  v_permlane16_swap_b32 v41, v45
  v_accvgpr_write_b32 a160, v40
  v_accvgpr_write_b32 a161, v41
  v_accvgpr_write_b32 a162, v44
  v_accvgpr_write_b32 a163, v45
  v_cvt_pk_bf16_f32 v56, v56, v57
  v_cvt_pk_bf16_f32 v57, v58, v59
  v_cvt_pk_bf16_f32 v60, v60, v61
  v_cvt_pk_bf16_f32 v61, v62, v63
  v_permlane16_swap_b32 v48, v52
  v_permlane16_swap_b32 v49, v53
  v_accvgpr_write_b32 a132, v48
  v_accvgpr_write_b32 a133, v49
  v_accvgpr_write_b32 a134, v52
  v_accvgpr_write_b32 a135, v53
  v_cvt_pk_bf16_f32 v64, v64, v65
  v_cvt_pk_bf16_f32 v65, v66, v67
  v_cvt_pk_bf16_f32 v68, v68, v69
  v_cvt_pk_bf16_f32 v69, v70, v71
  v_permlane16_swap_b32 v56, v60
  v_permlane16_swap_b32 v57, v61
  v_accvgpr_write_b32 a164, v56
  v_accvgpr_write_b32 a165, v57
  v_accvgpr_write_b32 a166, v60
  v_accvgpr_write_b32 a167, v61
  v_cvt_pk_bf16_f32 v72, v72, v73
  v_cvt_pk_bf16_f32 v73, v74, v75
  v_cvt_pk_bf16_f32 v76, v76, v77
  v_cvt_pk_bf16_f32 v77, v78, v79
  v_permlane16_swap_b32 v64, v68
  v_permlane16_swap_b32 v65, v69
  v_accvgpr_write_b32 a136, v64
  v_accvgpr_write_b32 a137, v65
  v_accvgpr_write_b32 a138, v68
  v_accvgpr_write_b32 a139, v69
  v_cvt_pk_bf16_f32 v80, v80, v81
  v_cvt_pk_bf16_f32 v81, v82, v83
  v_cvt_pk_bf16_f32 v84, v84, v85
  v_cvt_pk_bf16_f32 v85, v86, v87
  v_permlane16_swap_b32 v72, v76
  v_permlane16_swap_b32 v73, v77
  v_accvgpr_write_b32 a168, v72
  v_accvgpr_write_b32 a169, v73
  v_accvgpr_write_b32 a170, v76
  v_accvgpr_write_b32 a171, v77
  v_cvt_pk_bf16_f32 v88, v88, v89
  v_cvt_pk_bf16_f32 v89, v90, v91
  v_cvt_pk_bf16_f32 v92, v92, v93
  v_cvt_pk_bf16_f32 v93, v94, v95
  v_permlane16_swap_b32 v80, v84
  v_permlane16_swap_b32 v81, v85
  v_accvgpr_write_b32 a140, v80
  v_accvgpr_write_b32 a141, v81
  v_accvgpr_write_b32 a142, v84
  v_accvgpr_write_b32 a143, v85
  v_cvt_pk_bf16_f32 v96, v96, v97
  v_cvt_pk_bf16_f32 v97, v98, v99
  v_cvt_pk_bf16_f32 v100, v100, v101
  v_cvt_pk_bf16_f32 v101, v102, v103
  v_permlane16_swap_b32 v88, v92
  v_permlane16_swap_b32 v89, v93
  v_accvgpr_write_b32 a172, v88
  v_accvgpr_write_b32 a173, v89
  v_accvgpr_write_b32 a174, v92
  v_accvgpr_write_b32 a175, v93
  v_cvt_pk_bf16_f32 v104, v104, v105
  v_cvt_pk_bf16_f32 v105, v106, v107
  v_cvt_pk_bf16_f32 v108, v108, v109
  v_cvt_pk_bf16_f32 v109, v110, v111
  v_permlane16_swap_b32 v96, v100
  v_permlane16_swap_b32 v97, v101
  v_accvgpr_write_b32 a144, v96
  v_accvgpr_write_b32 a145, v97
  v_accvgpr_write_b32 a146, v100
  v_accvgpr_write_b32 a147, v101
  v_cvt_pk_bf16_f32 v112, v112, v113
  v_cvt_pk_bf16_f32 v113, v114, v115
  v_cvt_pk_bf16_f32 v116, v116, v117
  v_cvt_pk_bf16_f32 v117, v118, v119
  v_permlane16_swap_b32 v104, v108
  v_permlane16_swap_b32 v105, v109
  v_accvgpr_write_b32 a176, v104
  v_accvgpr_write_b32 a177, v105
  v_accvgpr_write_b32 a178, v108
  v_accvgpr_write_b32 a179, v109
  v_cvt_pk_bf16_f32 v120, v120, v121
  v_cvt_pk_bf16_f32 v121, v122, v123
  v_cvt_pk_bf16_f32 v124, v124, v125
  v_cvt_pk_bf16_f32 v125, v126, v127
  v_permlane16_swap_b32 v112, v116
  v_permlane16_swap_b32 v113, v117
  v_accvgpr_write_b32 a148, v112
  v_accvgpr_write_b32 a149, v113
  v_accvgpr_write_b32 a150, v116
  v_accvgpr_write_b32 a151, v117
  v_cvt_pk_bf16_f32 v128, v128, v129
  v_cvt_pk_bf16_f32 v129, v130, v131
  v_cvt_pk_bf16_f32 v132, v132, v133
  v_cvt_pk_bf16_f32 v133, v134, v135
  v_permlane16_swap_b32 v120, v124
  v_permlane16_swap_b32 v121, v125
  v_accvgpr_write_b32 a180, v120
  v_accvgpr_write_b32 a181, v121
  v_accvgpr_write_b32 a182, v124
  v_accvgpr_write_b32 a183, v125
  v_cvt_pk_bf16_f32 v136, v136, v137
  v_cvt_pk_bf16_f32 v137, v138, v139
  v_cvt_pk_bf16_f32 v140, v140, v141
  v_cvt_pk_bf16_f32 v141, v142, v143
  v_permlane16_swap_b32 v128, v132
  v_permlane16_swap_b32 v129, v133
  v_accvgpr_write_b32 a152, v128
  v_accvgpr_write_b32 a153, v129
  v_accvgpr_write_b32 a154, v132
  v_accvgpr_write_b32 a155, v133
  v_cvt_pk_bf16_f32 v144, v144, v145
  v_cvt_pk_bf16_f32 v145, v146, v147
  v_cvt_pk_bf16_f32 v148, v148, v149
  v_cvt_pk_bf16_f32 v149, v150, v151
  v_permlane16_swap_b32 v136, v140
  v_permlane16_swap_b32 v137, v141
  v_accvgpr_write_b32 a184, v136
  v_accvgpr_write_b32 a185, v137
  v_accvgpr_write_b32 a186, v140
  v_accvgpr_write_b32 a187, v141
  v_cvt_pk_bf16_f32 v152, v152, v153
  v_cvt_pk_bf16_f32 v153, v154, v155
  v_cvt_pk_bf16_f32 v156, v156, v157
  v_cvt_pk_bf16_f32 v157, v158, v159
  v_permlane16_swap_b32 v144, v148
  v_permlane16_swap_b32 v145, v149
  v_accvgpr_write_b32 a156, v144
  v_accvgpr_write_b32 a157, v145
  v_accvgpr_write_b32 a158, v148
  v_accvgpr_write_b32 a159, v149
  v_cvt_pk_bf16_f32 v160, v160, v161
  v_cvt_pk_bf16_f32 v161, v162, v163
  v_cvt_pk_bf16_f32 v164, v164, v165
  v_cvt_pk_bf16_f32 v165, v166, v167
  v_permlane16_swap_b32 v152, v156
  v_permlane16_swap_b32 v153, v157
  v_accvgpr_write_b32 a188, v152
  v_accvgpr_write_b32 a189, v153
  v_accvgpr_write_b32 a190, v156
  v_accvgpr_write_b32 a191, v157
  v_cvt_pk_bf16_f32 v168, v168, v169
  v_cvt_pk_bf16_f32 v169, v170, v171
  v_cvt_pk_bf16_f32 v172, v172, v173
  v_cvt_pk_bf16_f32 v173, v174, v175
  v_permlane16_swap_b32 v160, v164
  v_permlane16_swap_b32 v161, v165
  v_accvgpr_write_b32 a192, v160
  v_accvgpr_write_b32 a193, v161
  v_accvgpr_write_b32 a194, v164
  v_accvgpr_write_b32 a195, v165
  v_cvt_pk_bf16_f32 v176, v176, v177
  v_cvt_pk_bf16_f32 v177, v178, v179
  v_cvt_pk_bf16_f32 v180, v180, v181
  v_cvt_pk_bf16_f32 v181, v182, v183
  v_permlane16_swap_b32 v168, v172
  v_permlane16_swap_b32 v169, v173
  v_accvgpr_write_b32 a224, v168
  v_accvgpr_write_b32 a225, v169
  v_accvgpr_write_b32 a226, v172
  v_accvgpr_write_b32 a227, v173
  v_cvt_pk_bf16_f32 v184, v184, v185
  v_cvt_pk_bf16_f32 v185, v186, v187
  v_cvt_pk_bf16_f32 v188, v188, v189
  v_cvt_pk_bf16_f32 v189, v190, v191
  v_permlane16_swap_b32 v176, v180
  v_permlane16_swap_b32 v177, v181
  v_accvgpr_write_b32 a196, v176
  v_accvgpr_write_b32 a197, v177
  v_accvgpr_write_b32 a198, v180
  v_accvgpr_write_b32 a199, v181
  v_cvt_pk_bf16_f32 v192, v192, v193
  v_cvt_pk_bf16_f32 v193, v194, v195
  v_cvt_pk_bf16_f32 v196, v196, v197
  v_cvt_pk_bf16_f32 v197, v198, v199
  v_permlane16_swap_b32 v184, v188
  v_permlane16_swap_b32 v185, v189
  v_accvgpr_write_b32 a228, v184
  v_accvgpr_write_b32 a229, v185
  v_accvgpr_write_b32 a230, v188
  v_accvgpr_write_b32 a231, v189
  v_cvt_pk_bf16_f32 v200, v200, v201
  v_cvt_pk_bf16_f32 v201, v202, v203
  v_cvt_pk_bf16_f32 v204, v204, v205
  v_cvt_pk_bf16_f32 v205, v206, v207
  v_permlane16_swap_b32 v192, v196
  v_permlane16_swap_b32 v193, v197
  v_accvgpr_write_b32 a200, v192
  v_accvgpr_write_b32 a201, v193
  v_accvgpr_write_b32 a202, v196
  v_accvgpr_write_b32 a203, v197
  v_cvt_pk_bf16_f32 v208, v208, v209
  v_cvt_pk_bf16_f32 v209, v210, v211
  v_cvt_pk_bf16_f32 v212, v212, v213
  v_cvt_pk_bf16_f32 v213, v214, v215
  v_permlane16_swap_b32 v200, v204
  v_permlane16_swap_b32 v201, v205
  v_accvgpr_write_b32 a232, v200
  v_accvgpr_write_b32 a233, v201
  v_accvgpr_write_b32 a234, v204
  v_accvgpr_write_b32 a235, v205
  v_cvt_pk_bf16_f32 v216, v216, v217
  v_cvt_pk_bf16_f32 v217, v218, v219
  v_cvt_pk_bf16_f32 v220, v220, v221
  v_cvt_pk_bf16_f32 v221, v222, v223
  v_permlane16_swap_b32 v208, v212
  v_permlane16_swap_b32 v209, v213
  v_accvgpr_write_b32 a204, v208
  v_accvgpr_write_b32 a205, v209
  v_accvgpr_write_b32 a206, v212
  v_accvgpr_write_b32 a207, v213
  v_cvt_pk_bf16_f32 v224, v224, v225
  v_cvt_pk_bf16_f32 v225, v226, v227
  v_cvt_pk_bf16_f32 v228, v228, v229
  v_cvt_pk_bf16_f32 v229, v230, v231
  v_permlane16_swap_b32 v216, v220
  v_permlane16_swap_b32 v217, v221
  v_accvgpr_write_b32 a236, v216
  v_accvgpr_write_b32 a237, v217
  v_accvgpr_write_b32 a238, v220
  v_accvgpr_write_b32 a239, v221
  v_cvt_pk_bf16_f32 v232, v232, v233
  v_cvt_pk_bf16_f32 v233, v234, v235
  v_cvt_pk_bf16_f32 v236, v236, v237
  v_cvt_pk_bf16_f32 v237, v238, v239
  v_permlane16_swap_b32 v224, v228
  v_permlane16_swap_b32 v225, v229
  v_accvgpr_write_b32 a208, v224
  v_accvgpr_write_b32 a209, v225
  v_accvgpr_write_b32 a210, v228
  v_accvgpr_write_b32 a211, v229
  v_cvt_pk_bf16_f32 v240, v240, v241
  v_cvt_pk_bf16_f32 v241, v242, v243
  v_cvt_pk_bf16_f32 v244, v244, v245
  v_cvt_pk_bf16_f32 v245, v246, v247
  v_permlane16_swap_b32 v232, v236
  v_permlane16_swap_b32 v233, v237
  v_accvgpr_write_b32 a240, v232
  v_accvgpr_write_b32 a241, v233
  v_accvgpr_write_b32 a242, v236
  v_accvgpr_write_b32 a243, v237
  v_cvt_pk_bf16_f32 v248, v248, v249
  v_cvt_pk_bf16_f32 v249, v250, v251
  v_cvt_pk_bf16_f32 v252, v252, v253
  v_cvt_pk_bf16_f32 v253, v254, v255
  v_permlane16_swap_b32 v240, v244
  v_permlane16_swap_b32 v241, v245
  v_accvgpr_write_b32 a212, v240
  v_accvgpr_write_b32 a213, v241
  v_accvgpr_write_b32 a214, v244
  v_accvgpr_write_b32 a215, v245
  v_accvgpr_read_b32 v32, a0
  v_accvgpr_read_b32 v33, a1
  v_accvgpr_read_b32 v34, a2
  v_accvgpr_read_b32 v35, a3
  v_accvgpr_read_b32 v36, a4
  v_accvgpr_read_b32 v37, a5
  v_accvgpr_read_b32 v38, a6
  v_accvgpr_read_b32 v39, a7
  v_cvt_pk_bf16_f32 v32, v32, v33
  v_cvt_pk_bf16_f32 v33, v34, v35
  v_cvt_pk_bf16_f32 v36, v36, v37
  v_cvt_pk_bf16_f32 v37, v38, v39
  v_permlane16_swap_b32 v248, v252
  v_permlane16_swap_b32 v249, v253
  v_accvgpr_write_b32 a244, v248
  v_accvgpr_write_b32 a245, v249
  v_accvgpr_write_b32 a246, v252
  v_accvgpr_write_b32 a247, v253
  v_accvgpr_read_b32 v40, a8
  v_accvgpr_read_b32 v41, a9
  v_accvgpr_read_b32 v42, a10
  v_accvgpr_read_b32 v43, a11
  v_accvgpr_read_b32 v44, a12
  v_accvgpr_read_b32 v45, a13
  v_accvgpr_read_b32 v46, a14
  v_accvgpr_read_b32 v47, a15
  v_cvt_pk_bf16_f32 v40, v40, v41
  v_cvt_pk_bf16_f32 v41, v42, v43
  v_cvt_pk_bf16_f32 v44, v44, v45
  v_cvt_pk_bf16_f32 v45, v46, v47
  v_permlane16_swap_b32 v32, v36
  v_permlane16_swap_b32 v33, v37
  v_accvgpr_write_b32 a216, v32
  v_accvgpr_write_b32 a217, v33
  v_accvgpr_write_b32 a218, v36
  v_accvgpr_write_b32 a219, v37
  v_accvgpr_read_b32 v48, a16
  v_accvgpr_read_b32 v49, a17
  v_accvgpr_read_b32 v50, a18
  v_accvgpr_read_b32 v51, a19
  v_accvgpr_read_b32 v52, a20
  v_accvgpr_read_b32 v53, a21
  v_accvgpr_read_b32 v54, a22
  v_accvgpr_read_b32 v55, a23
  v_cvt_pk_bf16_f32 v48, v48, v49
  v_cvt_pk_bf16_f32 v49, v50, v51
  v_cvt_pk_bf16_f32 v52, v52, v53
  v_cvt_pk_bf16_f32 v53, v54, v55
  v_permlane16_swap_b32 v40, v44
  v_permlane16_swap_b32 v41, v45
  v_accvgpr_write_b32 a248, v40
  v_accvgpr_write_b32 a249, v41
  v_accvgpr_write_b32 a250, v44
  v_accvgpr_write_b32 a251, v45
  v_accvgpr_read_b32 v56, a24
  v_accvgpr_read_b32 v57, a25
  v_accvgpr_read_b32 v58, a26
  v_accvgpr_read_b32 v59, a27
  v_accvgpr_read_b32 v60, a28
  v_accvgpr_read_b32 v61, a29
  v_accvgpr_read_b32 v62, a30
  v_accvgpr_read_b32 v63, a31
  v_cvt_pk_bf16_f32 v56, v56, v57
  v_cvt_pk_bf16_f32 v57, v58, v59
  v_cvt_pk_bf16_f32 v60, v60, v61
  v_cvt_pk_bf16_f32 v61, v62, v63
  v_permlane16_swap_b32 v48, v52
  v_permlane16_swap_b32 v49, v53
  v_accvgpr_write_b32 a220, v48
  v_accvgpr_write_b32 a221, v49
  v_accvgpr_write_b32 a222, v52
  v_accvgpr_write_b32 a223, v53
  s_nop 1
  v_permlane16_swap_b32 v56, v60
  v_permlane16_swap_b32 v57, v61
  v_accvgpr_write_b32 a252, v56
  v_accvgpr_write_b32 a253, v57
  v_accvgpr_write_b32 a254, v60
  v_accvgpr_write_b32 a255, v61
  s_mov_b32 s81, s16
  s_mov_b32 s82, s17
  s_mov_b32 s83, 4194304
  s_lshl_b32 s84, s69, 19
  s_mov_b32 s85, 65536
  s_cmp_lt_u32 s67, 2
  s_cselect_b32 s86, s30, s32
  s_cselect_b32 s87, s31, s33
  s_mov_b32 s88, 7340032
  s_mul_i32 s89, s71, 224
  s_mov_b32 s90, 229376
  s_mov_b32 s91, s64
  s_mov_b32 s92, s65
  s_mov_b32 s66, 4
  s_waitcnt lgkmcnt(0)
  v_mfma_f32_16x16x32_bf16 v[32:35], a[32:35], a[64:67], 0
  ds_read_b64_tr_b16 a[96:97], v5 offset:256
  v_mfma_f32_16x16x32_bf16 v[36:39], a[36:39], a[64:67], 0
  ds_read_b64_tr_b16 a[98:99], v5 offset:2304
  v_mfma_f32_16x16x32_bf16 v[40:43], a[40:43], a[64:67], 0
  ds_read_b64_tr_b16 a[100:101], v6 offset:256
  v_mfma_f32_16x16x32_bf16 v[44:47], a[44:47], a[64:67], 0
  ds_read_b64_tr_b16 a[102:103], v6 offset:2304
  v_mfma_f32_16x16x32_bf16 v[48:51], a[32:35], a[68:71], 0
  ds_read_b64_tr_b16 a[104:105], v7 offset:256
  v_mfma_f32_16x16x32_bf16 v[52:55], a[36:39], a[68:71], 0
  ds_read_b64_tr_b16 a[106:107], v7 offset:2304
  v_mfma_f32_16x16x32_bf16 v[56:59], a[40:43], a[68:71], 0
  ds_read_b64_tr_b16 a[108:109], v8 offset:256
  v_mfma_f32_16x16x32_bf16 v[60:63], a[44:47], a[68:71], 0
  ds_read_b64_tr_b16 a[110:111], v8 offset:2304
  v_mfma_f32_16x16x32_bf16 v[64:67], a[32:35], a[72:75], 0
  ds_read_b64_tr_b16 a[112:113], v18 offset:256
  v_mfma_f32_16x16x32_bf16 v[68:71], a[36:39], a[72:75], 0
  ds_read_b64_tr_b16 a[114:115], v18 offset:2304
  v_mfma_f32_16x16x32_bf16 v[72:75], a[40:43], a[72:75], 0
  ds_read_b64_tr_b16 a[116:117], v19 offset:256
  v_mfma_f32_16x16x32_bf16 v[76:79], a[44:47], a[72:75], 0
  ds_read_b64_tr_b16 a[118:119], v19 offset:2304
  s_mov_b32 m0, s61
  v_mfma_f32_16x16x32_bf16 v[80:83], a[32:35], a[76:79], 0
  ds_read_b64_tr_b16 a[120:121], v20 offset:256
  buffer_load_dwordx4 v10, s[44:47], s56 offen offset:0 lds
  v_mfma_f32_16x16x32_bf16 v[84:87], a[36:39], a[76:79], 0
  ds_read_b64_tr_b16 a[122:123], v20 offset:2304
  v_mfma_f32_16x16x32_bf16 v[88:91], a[40:43], a[76:79], 0
  ds_read_b64_tr_b16 a[124:125], v21 offset:256
  v_mfma_f32_16x16x32_bf16 v[92:95], a[44:47], a[76:79], 0
  ds_read_b64_tr_b16 a[126:127], v21 offset:2304
  v_mfma_f32_16x16x32_bf16 v[96:99], a[32:35], a[80:83], 0
  buffer_load_dwordx4 v11, s[44:47], s56 offen offset:1024 lds
  v_mfma_f32_16x16x32_bf16 v[100:103], a[36:39], a[80:83], 0
  v_mfma_f32_16x16x32_bf16 v[104:107], a[40:43], a[80:83], 0
  v_mfma_f32_16x16x32_bf16 v[108:111], a[44:47], a[80:83], 0
  v_mfma_f32_16x16x32_bf16 v[112:115], a[32:35], a[84:87], 0
  buffer_load_dwordx4 v12, s[44:47], s56 offen offset:2048 lds
  v_mfma_f32_16x16x32_bf16 v[116:119], a[36:39], a[84:87], 0
  v_mfma_f32_16x16x32_bf16 v[120:123], a[40:43], a[84:87], 0
  s_cmp_eq_u32 s67, 0
  s_cselect_b32 s14, s6, 0
  v_mfma_f32_16x16x32_bf16 v[124:127], a[44:47], a[84:87], 0
  v_mfma_f32_16x16x32_bf16 v[128:131], a[32:35], a[88:91], 0
  buffer_load_dwordx4 v13, s[44:47], s56 offen offset:3072 lds
  v_mfma_f32_16x16x32_bf16 v[132:135], a[36:39], a[88:91], 0
  s_add_u32 s57, s56, s60
  s_add_u32 s56, s56, 128
  v_mfma_f32_16x16x32_bf16 v[136:139], a[40:43], a[88:91], 0
  buffer_store_dwordx4 a[128:131], v26, s[52:55], s26 offen offset:0 sc1
  v_mfma_f32_16x16x32_bf16 v[140:143], a[44:47], a[88:91], 0
  v_mfma_f32_16x16x32_bf16 v[144:147], a[32:35], a[92:95], 0
  buffer_store_dwordx4 a[132:135], v26, s[52:55], s26 offen offset:1024 sc1
  v_mfma_f32_16x16x32_bf16 v[148:151], a[36:39], a[92:95], 0
  buffer_load_dword v28, v27, s[12:15], s79 offen
  v_mfma_f32_16x16x32_bf16 v[152:155], a[40:43], a[92:95], 0
  v_mfma_f32_16x16x32_bf16 v[156:159], a[44:47], a[92:95], 0
  s_waitcnt vmcnt(19) lgkmcnt(0)
  s_barrier
  v_mfma_f32_16x16x32_bf16 v[160:163], a[32:35], a[96:99], 0
  ds_read_b128 a[48:51], v2 offset:0
  v_accvgpr_mov_b32 a128, a160
  v_mfma_f32_16x16x32_bf16 v[164:167], a[36:39], a[96:99], 0
  ds_read_b128 a[52:55], v2 offset:2048
  v_accvgpr_mov_b32 a129, a161
  v_mfma_f32_16x16x32_bf16 v[168:171], a[40:43], a[96:99], 0
  ds_read_b128 a[56:59], v2 offset:4096
  v_accvgpr_mov_b32 a130, a162
  v_mfma_f32_16x16x32_bf16 v[172:175], a[44:47], a[96:99], 0
  ds_read_b128 a[60:63], v2 offset:6144
  v_accvgpr_mov_b32 a131, a163
  v_mfma_f32_16x16x32_bf16 v[176:179], a[32:35], a[100:103], 0
  ds_read_b64_tr_b16 a[64:65], v5 offset:16384
  v_accvgpr_mov_b32 a132, a164
  v_mfma_f32_16x16x32_bf16 v[180:183], a[36:39], a[100:103], 0
  ds_read_b64_tr_b16 a[66:67], v5 offset:18432
  v_accvgpr_mov_b32 a133, a165
  v_mfma_f32_16x16x32_bf16 v[184:187], a[40:43], a[100:103], 0
  ds_read_b64_tr_b16 a[68:69], v6 offset:16384
  v_accvgpr_mov_b32 a134, a166
  v_mfma_f32_16x16x32_bf16 v[188:191], a[44:47], a[100:103], 0
  ds_read_b64_tr_b16 a[70:71], v6 offset:18432
  v_mfma_f32_16x16x32_bf16 v[192:195], a[32:35], a[104:107], 0
  ds_read_b64_tr_b16 a[72:73], v7 offset:16384
  v_mfma_f32_16x16x32_bf16 v[196:199], a[36:39], a[104:107], 0
  ds_read_b64_tr_b16 a[74:75], v7 offset:18432
  v_mfma_f32_16x16x32_bf16 v[200:203], a[40:43], a[104:107], 0
  ds_read_b64_tr_b16 a[76:77], v8 offset:16384
  v_mfma_f32_16x16x32_bf16 v[204:207], a[44:47], a[104:107], 0
  ds_read_b64_tr_b16 a[78:79], v8 offset:18432
  s_add_u32 m0, s64, 0
  v_mfma_f32_16x16x32_bf16 v[208:211], a[32:35], a[108:111], 0
  ds_read_b64_tr_b16 a[80:81], v18 offset:16384
  buffer_load_dwordx4 v14, s[48:51], s58 offen offset:0 lds
  v_mfma_f32_16x16x32_bf16 v[212:215], a[36:39], a[108:111], 0
  ds_read_b64_tr_b16 a[82:83], v18 offset:18432
  v_mfma_f32_16x16x32_bf16 v[216:219], a[40:43], a[108:111], 0
  ds_read_b64_tr_b16 a[84:85], v19 offset:16384
  v_mfma_f32_16x16x32_bf16 v[220:223], a[44:47], a[108:111], 0
  ds_read_b64_tr_b16 a[86:87], v19 offset:18432
  v_mfma_f32_16x16x32_bf16 v[224:227], a[32:35], a[112:115], 0
  ds_read_b64_tr_b16 a[88:89], v20 offset:16384
  buffer_load_dwordx4 v15, s[48:51], s58 offen offset:1024 lds
  v_mfma_f32_16x16x32_bf16 v[228:231], a[36:39], a[112:115], 0
  ds_read_b64_tr_b16 a[90:91], v20 offset:18432
  v_mfma_f32_16x16x32_bf16 v[232:235], a[40:43], a[112:115], 0
  ds_read_b64_tr_b16 a[92:93], v21 offset:16384
  v_mfma_f32_16x16x32_bf16 v[236:239], a[44:47], a[112:115], 0
  ds_read_b64_tr_b16 a[94:95], v21 offset:18432
  v_mfma_f32_16x16x32_bf16 v[240:243], a[32:35], a[116:119], 0
  buffer_load_dwordx4 v16, s[48:51], s58 offen offset:2048 lds
  v_mfma_f32_16x16x32_bf16 v[244:247], a[36:39], a[116:119], 0
  s_add_u32 s72, s72, 1
  v_mfma_f32_16x16x32_bf16 v[248:251], a[40:43], a[116:119], 0
  s_cmp_eq_u32 s72, 3
  s_cselect_b32 s73, s75, s74
  s_cselect_b32 s72, 0, s72
  v_mfma_f32_16x16x32_bf16 v[252:255], a[44:47], a[116:119], 0
  v_accvgpr_mov_b32 a135, a167
  v_mfma_f32_16x16x32_bf16 a[0:3], a[32:35], a[120:123], 0
  buffer_load_dwordx4 v17, s[48:51], s58 offen offset:3072 lds
  v_mfma_f32_16x16x32_bf16 a[4:7], a[36:39], a[120:123], 0
  s_add_u32 s58, s58, s59
  s_and_b32 s78, s4, 15
  s_lshl_b32 s78, s78, 3
  v_mfma_f32_16x16x32_bf16 a[8:11], a[40:43], a[120:123], 0
  s_load_dwordx2 s[12:13], s[0:1], s78
  s_bfe_u32 s79, s4, 0x40004
  v_mfma_f32_16x16x32_bf16 a[12:15], a[44:47], a[120:123], 0
  s_cmp_eq_u32 s79, 15
  s_cselect_b32 s6, 0, -1
  v_mfma_f32_16x16x32_bf16 a[16:19], a[32:35], a[124:127], 0
  v_add_u32 v1, s73, v1
  v_add_u32 v2, s73, v2
  v_mfma_f32_16x16x32_bf16 a[20:23], a[36:39], a[124:127], 0
  s_lshl_b32 s79, s79, 20
  s_add_u32 s79, s79, s3
  v_mfma_f32_16x16x32_bf16 a[24:27], a[40:43], a[124:127], 0
  s_lshr_b64 s[4:5], s[4:5], 8
  s_or_b32 s5, s5, 0xf0000000
  v_mfma_f32_16x16x32_bf16 a[28:31], a[44:47], a[124:127], 0
  s_branch mk_v_entry
.p2align 6
mk_v_top:
  s_waitcnt vmcnt(25) lgkmcnt(0)
  s_barrier
  v_mfma_f32_16x16x32_bf16 v[160:163], a[48:51], a[96:99], v[160:163]
  ds_read_b128 a[32:35], v1 offset:0
  v_accvgpr_mov_b32 a152, a184
  v_mfma_f32_16x16x32_bf16 v[164:167], a[52:55], a[96:99], v[164:167]
  ds_read_b128 a[36:39], v1 offset:2048
  v_mfma_f32_16x16x32_bf16 v[168:171], a[56:59], a[96:99], v[168:171]
  ds_read_b128 a[40:43], v1 offset:4096
  v_mfma_f32_16x16x32_bf16 v[172:175], a[60:63], a[96:99], v[172:175]
  ds_read_b128 a[44:47], v1 offset:6144
  v_mfma_f32_16x16x32_bf16 v[176:179], a[48:51], a[100:103], v[176:179]
  ds_read_b64_tr_b16 a[64:65], v5 offset:0
  v_mfma_f32_16x16x32_bf16 v[180:183], a[52:55], a[100:103], v[180:183]
  ds_read_b64_tr_b16 a[66:67], v5 offset:2048
  v_mfma_f32_16x16x32_bf16 v[184:187], a[56:59], a[100:103], v[184:187]
  ds_read_b64_tr_b16 a[68:69], v6 offset:0
  v_mfma_f32_16x16x32_bf16 v[188:191], a[60:63], a[100:103], v[188:191]
  ds_read_b64_tr_b16 a[70:71], v6 offset:2048
  v_mfma_f32_16x16x32_bf16 v[192:195], a[48:51], a[104:107], v[192:195]
  ds_read_b64_tr_b16 a[72:73], v7 offset:0
  v_mfma_f32_16x16x32_bf16 v[196:199], a[52:55], a[104:107], v[196:199]
  ds_read_b64_tr_b16 a[74:75], v7 offset:2048
  v_mfma_f32_16x16x32_bf16 v[200:203], a[56:59], a[104:107], v[200:203]
  ds_read_b64_tr_b16 a[76:77], v8 offset:0
  v_mfma_f32_16x16x32_bf16 v[204:207], a[60:63], a[104:107], v[204:207]
  ds_read_b64_tr_b16 a[78:79], v8 offset:2048
  s_add_u32 m0, s64, 49152
  v_mfma_f32_16x16x32_bf16 v[208:211], a[48:51], a[108:111], v[208:211]
  ds_read_b64_tr_b16 a[80:81], v18 offset:0
  buffer_load_dwordx4 v14, s[48:51], s58 offen offset:0 lds
  v_mfma_f32_16x16x32_bf16 v[212:215], a[52:55], a[108:111], v[212:215]
  ds_read_b64_tr_b16 a[82:83], v18 offset:2048
  v_mfma_f32_16x16x32_bf16 v[216:219], a[56:59], a[108:111], v[216:219]
  ds_read_b64_tr_b16 a[84:85], v19 offset:0
  v_mfma_f32_16x16x32_bf16 v[220:223], a[60:63], a[108:111], v[220:223]
  ds_read_b64_tr_b16 a[86:87], v19 offset:2048
  v_mfma_f32_16x16x32_bf16 v[224:227], a[48:51], a[112:115], v[224:227]
  ds_read_b64_tr_b16 a[88:89], v20 offset:0
  buffer_load_dwordx4 v15, s[48:51], s58 offen offset:1024 lds
  v_mfma_f32_16x16x32_bf16 v[228:231], a[52:55], a[112:115], v[228:231]
  ds_read_b64_tr_b16 a[90:91], v20 offset:2048
  v_mfma_f32_16x16x32_bf16 v[232:235], a[56:59], a[112:115], v[232:235]
  ds_read_b64_tr_b16 a[92:93], v21 offset:0
  v_mfma_f32_16x16x32_bf16 v[236:239], a[60:63], a[112:115], v[236:239]
  ds_read_b64_tr_b16 a[94:95], v21 offset:2048
  v_mfma_f32_16x16x32_bf16 v[240:243], a[48:51], a[116:119], v[240:243]
  buffer_load_dwordx4 v16, s[48:51], s58 offen offset:2048 lds
  v_mfma_f32_16x16x32_bf16 v[244:247], a[52:55], a[116:119], v[244:247]
  v_accvgpr_mov_b32 a153, a185
  v_mfma_f32_16x16x32_bf16 v[248:251], a[56:59], a[116:119], v[248:251]
  v_accvgpr_mov_b32 a154, a186
  v_mfma_f32_16x16x32_bf16 v[252:255], a[60:63], a[116:119], v[252:255]
  v_accvgpr_mov_b32 a155, a187
  v_mfma_f32_16x16x32_bf16 a[0:3], a[48:51], a[120:123], a[0:3]
  buffer_load_dwordx4 v17, s[48:51], s58 offen offset:3072 lds
  v_mfma_f32_16x16x32_bf16 a[4:7], a[52:55], a[120:123], a[4:7]
  s_add_u32 s58, s58, s59
  s_add_u32 s26, s26, s28
  s_add_u32 s27, s26, 4096
  v_mfma_f32_16x16x32_bf16 a[8:11], a[56:59], a[120:123], a[8:11]
  s_xor_b32 s28, s28, 507904
  v_mfma_f32_16x16x32_bf16 a[12:15], a[60:63], a[120:123], a[12:15]
  v_accvgpr_mov_b32 a156, a188
  v_mfma_f32_16x16x32_bf16 a[16:19], a[48:51], a[124:127], a[16:19]
  v_accvgpr_mov_b32 a157, a189
  v_mfma_f32_16x16x32_bf16 a[20:23], a[52:55], a[124:127], a[20:23]
  v_accvgpr_mov_b32 a158, a190
  v_mfma_f32_16x16x32_bf16 a[24:27], a[56:59], a[124:127], a[24:27]
  v_accvgpr_mov_b32 a159, a191
  v_mfma_f32_16x16x32_bf16 a[28:31], a[60:63], a[124:127], a[28:31]
  s_cmp_lg_u32 s66, 1
  s_cbranch_scc1 mk_v_nsx
  s_mov_b32 s44, s81
  s_mov_b32 s45, s82
  s_mov_b32 s46, s83
  s_mov_b32 s56, s84
  s_mov_b32 s60, s85
  v_add_u32 v30, 0, v10
  v_and_b32 v30, 0xfffffc00, v30
  v_add_u32 v10, v10, v30
  v_add_u32 v30, 1024, v11
  v_and_b32 v30, 0xfffffc00, v30
  v_add_u32 v11, v11, v30
  v_add_u32 v30, 2048, v12
  v_and_b32 v30, 0xfffffc00, v30
  v_add_u32 v12, v12, v30
  v_add_u32 v30, 3072, v13
  v_and_b32 v30, 0xfffffc00, v30
  v_add_u32 v13, v13, v30
mk_v_nsx:
  s_waitcnt lgkmcnt(0)
  v_mfma_f32_16x16x32_bf16 v[32:35], a[32:35], a[64:67], v[32:35]
  ds_read_b64_tr_b16 a[96:97], v5 offset:256
  v_accvgpr_mov_b32 a184, a216
  v_mfma_f32_16x16x32_bf16 v[36:39], a[36:39], a[64:67], v[36:39]
  ds_read_b64_tr_b16 a[98:99], v5 offset:2304
  v_accvgpr_mov_b32 a185, a217
  v_mfma_f32_16x16x32_bf16 v[40:43], a[40:43], a[64:67], v[40:43]
  ds_read_b64_tr_b16 a[100:101], v6 offset:256
  v_accvgpr_mov_b32 a186, a218
  v_mfma_f32_16x16x32_bf16 v[44:47], a[44:47], a[64:67], v[44:47]
  ds_read_b64_tr_b16 a[102:103], v6 offset:2304
  v_accvgpr_mov_b32 a187, a219
  v_mfma_f32_16x16x32_bf16 v[48:51], a[32:35], a[68:71], v[48:51]
  ds_read_b64_tr_b16 a[104:105], v7 offset:256
  v_accvgpr_mov_b32 a188, a220
  v_mfma_f32_16x16x32_bf16 v[52:55], a[36:39], a[68:71], v[52:55]
  ds_read_b64_tr_b16 a[106:107], v7 offset:2304
  v_accvgpr_mov_b32 a189, a221
  v_mfma_f32_16x16x32_bf16 v[56:59], a[40:43], a[68:71], v[56:59]
  ds_read_b64_tr_b16 a[108:109], v8 offset:256
  v_accvgpr_mov_b32 a190, a222
  v_mfma_f32_16x16x32_bf16 v[60:63], a[44:47], a[68:71], v[60:63]
  ds_read_b64_tr_b16 a[110:111], v8 offset:2304
  v_accvgpr_mov_b32 a191, a223
  v_mfma_f32_16x16x32_bf16 v[64:67], a[32:35], a[72:75], v[64:67]
  ds_read_b64_tr_b16 a[112:113], v18 offset:256
  v_accvgpr_mov_b32 a216, a248
  v_mfma_f32_16x16x32_bf16 v[68:71], a[36:39], a[72:75], v[68:71]
  ds_read_b64_tr_b16 a[114:115], v18 offset:2304
  v_mfma_f32_16x16x32_bf16 v[72:75], a[40:43], a[72:75], v[72:75]
  ds_read_b64_tr_b16 a[116:117], v19 offset:256
  v_mfma_f32_16x16x32_bf16 v[76:79], a[44:47], a[72:75], v[76:79]
  ds_read_b64_tr_b16 a[118:119], v19 offset:2304
  s_mov_b32 m0, s61
  v_mfma_f32_16x16x32_bf16 v[80:83], a[32:35], a[76:79], v[80:83]
  ds_read_b64_tr_b16 a[120:121], v20 offset:256
  buffer_load_dwordx4 v10, s[44:47], s56 offen offset:0 lds
  v_mfma_f32_16x16x32_bf16 v[84:87], a[36:39], a[76:79], v[84:87]
  ds_read_b64_tr_b16 a[122:123], v20 offset:2304
  v_mfma_f32_16x16x32_bf16 v[88:91], a[40:43], a[76:79], v[88:91]
  ds_read_b64_tr_b16 a[124:125], v21 offset:256
  v_mfma_f32_16x16x32_bf16 v[92:95], a[44:47], a[76:79], v[92:95]
  ds_read_b64_tr_b16 a[126:127], v21 offset:2304
  v_mfma_f32_16x16x32_bf16 v[96:99], a[32:35], a[80:83], v[96:99]
  buffer_load_dwordx4 v11, s[44:47], s56 offen offset:1024 lds
  v_mfma_f32_16x16x32_bf16 v[100:103], a[36:39], a[80:83], v[100:103]
  v_accvgpr_mov_b32 a217, a249
  v_mfma_f32_16x16x32_bf16 v[104:107], a[40:43], a[80:83], v[104:107]
  v_accvgpr_mov_b32 a218, a250
  v_mfma_f32_16x16x32_bf16 v[108:111], a[44:47], a[80:83], v[108:111]
  v_accvgpr_mov_b32 a219, a251
  v_mfma_f32_16x16x32_bf16 v[112:115], a[32:35], a[84:87], v[112:115]
  buffer_load_dwordx4 v12, s[44:47], s56 offen offset:2048 lds
  v_mfma_f32_16x16x32_bf16 v[116:119], a[36:39], a[84:87], v[116:119]
  v_accvgpr_mov_b32 a220, a252
  v_mfma_f32_16x16x32_bf16 v[120:123], a[40:43], a[84:87], v[120:123]
  s_cmp_eq_u32 s67, 0
  s_cselect_b32 s14, s6, 0
  v_mfma_f32_16x16x32_bf16 v[124:127], a[44:47], a[84:87], v[124:127]
  v_accvgpr_mov_b32 a221, a253
  v_mfma_f32_16x16x32_bf16 v[128:131], a[32:35], a[88:91], v[128:131]
  buffer_load_dwordx4 v13, s[44:47], s56 offen offset:3072 lds
  v_mfma_f32_16x16x32_bf16 v[132:135], a[36:39], a[88:91], v[132:135]
  s_add_u32 s57, s56, s60
  s_add_u32 s56, s56, 128
  v_mfma_f32_16x16x32_bf16 v[136:139], a[40:43], a[88:91], v[136:139]
  buffer_store_dwordx4 a[128:131], v26, s[52:55], s26 offen offset:0 sc1
  v_mfma_f32_16x16x32_bf16 v[140:143], a[44:47], a[88:91], v[140:143]
  v_accvgpr_mov_b32 a222, a254
  v_mfma_f32_16x16x32_bf16 v[144:147], a[32:35], a[92:95], v[144:147]
  buffer_store_dwordx4 a[132:135], v26, s[52:55], s26 offen offset:1024 sc1
  v_mfma_f32_16x16x32_bf16 v[148:151], a[36:39], a[92:95], v[148:151]
  buffer_load_dword v28, v27, s[12:15], s79 offen
  v_mfma_f32_16x16x32_bf16 v[152:155], a[40:43], a[92:95], v[152:155]
  v_accvgpr_mov_b32 a223, a255
  v_mfma_f32_16x16x32_bf16 v[156:159], a[44:47], a[92:95], v[156:159]
  s_cmp_lg_u32 s66, 1
  s_cbranch_scc1 mk_v_nsw
  s_mov_b32 s48, s86
  s_mov_b32 s49, s87
  s_mov_b32 s50, s88
  s_mov_b32 s58, s89
  s_mov_b32 s59, s90
  s_mov_b32 s64, s91
  s_mov_b32 s65, s92
  v_mov_b32 v14, v22
  v_mov_b32 v15, v23
  v_mov_b32 v16, v24
  v_mov_b32 v17, v25
mk_v_nsw:
  s_waitcnt vmcnt(25) lgkmcnt(0)
  s_barrier
  v_mfma_f32_16x16x32_bf16 v[160:163], a[32:35], a[96:99], v[160:163]
  ds_read_b128 a[48:51], v2 offset:0
  v_accvgpr_mov_b32 a128, a160
  v_mfma_f32_16x16x32_bf16 v[164:167], a[36:39], a[96:99], v[164:167]
  ds_read_b128 a[52:55], v2 offset:2048
  v_accvgpr_mov_b32 a129, a161
  v_mfma_f32_16x16x32_bf16 v[168:171], a[40:43], a[96:99], v[168:171]
  ds_read_b128 a[56:59], v2 offset:4096
  v_accvgpr_mov_b32 a130, a162
  v_mfma_f32_16x16x32_bf16 v[172:175], a[44:47], a[96:99], v[172:175]
  ds_read_b128 a[60:63], v2 offset:6144
  v_accvgpr_mov_b32 a131, a163
  v_mfma_f32_16x16x32_bf16 v[176:179], a[32:35], a[100:103], v[176:179]
  ds_read_b64_tr_b16 a[64:65], v5 offset:16384
  v_accvgpr_mov_b32 a132, a164
  v_mfma_f32_16x16x32_bf16 v[180:183], a[36:39], a[100:103], v[180:183]
  ds_read_b64_tr_b16 a[66:67], v5 offset:18432
  v_accvgpr_mov_b32 a133, a165
  v_mfma_f32_16x16x32_bf16 v[184:187], a[40:43], a[100:103], v[184:187]
  ds_read_b64_tr_b16 a[68:69], v6 offset:16384
  v_accvgpr_mov_b32 a134, a166
  v_mfma_f32_16x16x32_bf16 v[188:191], a[44:47], a[100:103], v[188:191]
  ds_read_b64_tr_b16 a[70:71], v6 offset:18432
  v_mfma_f32_16x16x32_bf16 v[192:195], a[32:35], a[104:107], v[192:195]
  ds_read_b64_tr_b16 a[72:73], v7 offset:16384
  v_mfma_f32_16x16x32_bf16 v[196:199], a[36:39], a[104:107], v[196:199]
  ds_read_b64_tr_b16 a[74:75], v7 offset:18432
  v_mfma_f32_16x16x32_bf16 v[200:203], a[40:43], a[104:107], v[200:203]
  ds_read_b64_tr_b16 a[76:77], v8 offset:16384
  v_mfma_f32_16x16x32_bf16 v[204:207], a[44:47], a[104:107], v[204:207]
  ds_read_b64_tr_b16 a[78:79], v8 offset:18432
  s_add_u32 m0, s64, 0
  v_mfma_f32_16x16x32_bf16 v[208:211], a[32:35], a[108:111], v[208:211]
  ds_read_b64_tr_b16 a[80:81], v18 offset:16384
  buffer_load_dwordx4 v14, s[48:51], s58 offen offset:0 lds
  v_mfma_f32_16x16x32_bf16 v[212:215], a[36:39], a[108:111], v[212:215]
  ds_read_b64_tr_b16 a[82:83], v18 offset:18432
  v_mfma_f32_16x16x32_bf16 v[216:219], a[40:43], a[108:111], v[216:219]
  ds_read_b64_tr_b16 a[84:85], v19 offset:16384
  v_mfma_f32_16x16x32_bf16 v[220:223], a[44:47], a[108:111], v[220:223]
  ds_read_b64_tr_b16 a[86:87], v19 offset:18432
  v_mfma_f32_16x16x32_bf16 v[224:227], a[32:35], a[112:115], v[224:227]
  ds_read_b64_tr_b16 a[88:89], v20 offset:16384
  buffer_load_dwordx4 v15, s[48:51], s58 offen offset:1024 lds
  v_mfma_f32_16x16x32_bf16 v[228:231], a[36:39], a[112:115], v[228:231]
  ds_read_b64_tr_b16 a[90:91], v20 offset:18432
  v_mfma_f32_16x16x32_bf16 v[232:235], a[40:43], a[112:115], v[232:235]
  ds_read_b64_tr_b16 a[92:93], v21 offset:16384
  v_mfma_f32_16x16x32_bf16 v[236:239], a[44:47], a[112:115], v[236:239]
  ds_read_b64_tr_b16 a[94:95], v21 offset:18432
  v_mfma_f32_16x16x32_bf16 v[240:243], a[32:35], a[116:119], v[240:243]
  buffer_load_dwordx4 v16, s[48:51], s58 offen offset:2048 lds
  v_mfma_f32_16x16x32_bf16 v[244:247], a[36:39], a[116:119], v[244:247]
  s_add_u32 s72, s72, 1
  v_mfma_f32_16x16x32_bf16 v[248:251], a[40:43], a[116:119], v[248:251]
  s_cmp_eq_u32 s72, 3
  s_cselect_b32 s73, s75, s74
  s_cselect_b32 s72, 0, s72
  v_mfma_f32_16x16x32_bf16 v[252:255], a[44:47], a[116:119], v[252:255]
  v_accvgpr_mov_b32 a135, a167
  v_mfma_f32_16x16x32_bf16 a[0:3], a[32:35], a[120:123], a[0:3]
  buffer_load_dwordx4 v17, s[48:51], s58 offen offset:3072 lds
  v_mfma_f32_16x16x32_bf16 a[4:7], a[36:39], a[120:123], a[4:7]
  s_add_u32 s58, s58, s59
  s_and_b32 s78, s4, 15
  s_lshl_b32 s78, s78, 3
  v_mfma_f32_16x16x32_bf16 a[8:11], a[40:43], a[120:123], a[8:11]
  s_load_dwordx2 s[12:13], s[0:1], s78
  s_bfe_u32 s79, s4, 0x40004
  v_mfma_f32_16x16x32_bf16 a[12:15], a[44:47], a[120:123], a[12:15]
  s_cmp_eq_u32 s79, 15
  s_cselect_b32 s6, 0, -1
  v_mfma_f32_16x16x32_bf16 a[16:19], a[32:35], a[124:127], a[16:19]
  v_add_u32 v1, s73, v1
  v_add_u32 v2, s73, v2
  v_mfma_f32_16x16x32_bf16 a[20:23], a[36:39], a[124:127], a[20:23]
  s_lshl_b32 s79, s79, 20
  s_add_u32 s79, s79, s3
  v_mfma_f32_16x16x32_bf16 a[24:27], a[40:43], a[124:127], a[24:27]
  s_lshr_b64 s[4:5], s[4:5], 8
  s_or_b32 s5, s5, 0xf0000000
  v_mfma_f32_16x16x32_bf16 a[28:31], a[44:47], a[124:127], a[28:31]
mk_v_entry:
  s_waitcnt lgkmcnt(0)
  v_mfma_f32_16x16x32_bf16 v[32:35], a[48:51], a[64:67], v[32:35]
  ds_read_b64_tr_b16 a[96:97], v5 offset:16640
  v_accvgpr_mov_b32 a160, a192
  v_mfma_f32_16x16x32_bf16 v[36:39], a[52:55], a[64:67], v[36:39]
  ds_read_b64_tr_b16 a[98:99], v5 offset:18688
  v_accvgpr_mov_b32 a161, a193
  v_mfma_f32_16x16x32_bf16 v[40:43], a[56:59], a[64:67], v[40:43]
  ds_read_b64_tr_b16 a[100:101], v6 offset:16640
  v_accvgpr_mov_b32 a162, a194
  v_mfma_f32_16x16x32_bf16 v[44:47], a[60:63], a[64:67], v[44:47]
  ds_read_b64_tr_b16 a[102:103], v6 offset:18688
  v_accvgpr_mov_b32 a163, a195
  v_mfma_f32_16x16x32_bf16 v[48:51], a[48:51], a[68:71], v[48:51]
  ds_read_b64_tr_b16 a[104:105], v7 offset:16640
  v_accvgpr_mov_b32 a164, a196
  v_mfma_f32_16x16x32_bf16 v[52:55], a[52:55], a[68:71], v[52:55]
  ds_read_b64_tr_b16 a[106:107], v7 offset:18688
  v_accvgpr_mov_b32 a165, a197
  v_mfma_f32_16x16x32_bf16 v[56:59], a[56:59], a[68:71], v[56:59]
  ds_read_b64_tr_b16 a[108:109], v8 offset:16640
  v_accvgpr_mov_b32 a166, a198
  v_mfma_f32_16x16x32_bf16 v[60:63], a[60:63], a[68:71], v[60:63]
  ds_read_b64_tr_b16 a[110:111], v8 offset:18688
  v_accvgpr_mov_b32 a167, a199
  v_mfma_f32_16x16x32_bf16 v[64:67], a[48:51], a[72:75], v[64:67]
  ds_read_b64_tr_b16 a[112:113], v18 offset:16640
  v_accvgpr_mov_b32 a192, a224
  v_mfma_f32_16x16x32_bf16 v[68:71], a[52:55], a[72:75], v[68:71]
  ds_read_b64_tr_b16 a[114:115], v18 offset:18688
  v_mfma_f32_16x16x32_bf16 v[72:75], a[56:59], a[72:75], v[72:75]
  ds_read_b64_tr_b16 a[116:117], v19 offset:16640
  v_mfma_f32_16x16x32_bf16 v[76:79], a[60:63], a[72:75], v[76:79]
  ds_read_b64_tr_b16 a[118:119], v19 offset:18688
  s_add_u32 m0, s61, 4096
  v_mfma_f32_16x16x32_bf16 v[80:83], a[48:51], a[76:79], v[80:83]
  ds_read_b64_tr_b16 a[120:121], v20 offset:16640
  buffer_load_dwordx4 v10, s[44:47], s57 offen offset:0 lds
  v_mfma_f32_16x16x32_bf16 v[84:87], a[52:55], a[76:79], v[84:87]
  ds_read_b64_tr_b16 a[122:123], v20 offset:18688
  v_mfma_f32_16x16x32_bf16 v[88:91], a[56:59], a[76:79], v[88:91]
  ds_read_b64_tr_b16 a[124:125], v21 offset:16640
  v_mfma_f32_16x16x32_bf16 v[92:95], a[60:63], a[76:79], v[92:95]
  ds_read_b64_tr_b16 a[126:127], v21 offset:18688
  v_mfma_f32_16x16x32_bf16 v[96:99], a[48:51], a[80:83], v[96:99]
  buffer_load_dwordx4 v11, s[44:47], s57 offen offset:1024 lds
  v_mfma_f32_16x16x32_bf16 v[100:103], a[52:55], a[80:83], v[100:103]
  v_accvgpr_mov_b32 a193, a225
  v_mfma_f32_16x16x32_bf16 v[104:107], a[56:59], a[80:83], v[104:107]
  v_accvgpr_mov_b32 a194, a226
  v_mfma_f32_16x16x32_bf16 v[108:111], a[60:63], a[80:83], v[108:111]
  v_accvgpr_mov_b32 a195, a227
  v_mfma_f32_16x16x32_bf16 v[112:115], a[48:51], a[84:87], v[112:115]
  buffer_load_dwordx4 v12, s[44:47], s57 offen offset:2048 lds
  v_mfma_f32_16x16x32_bf16 v[116:119], a[52:55], a[84:87], v[116:119]
  v_accvgpr_mov_b32 a196, a228
  v_mfma_f32_16x16x32_bf16 v[120:123], a[56:59], a[84:87], v[120:123]
  s_cmp_eq_u32 s67, 1
  s_cselect_b32 s14, s6, 0
  v_mfma_f32_16x16x32_bf16 v[124:127], a[60:63], a[84:87], v[124:127]
  v_accvgpr_mov_b32 a197, a229
  v_mfma_f32_16x16x32_bf16 v[128:131], a[48:51], a[88:91], v[128:131]
  buffer_load_dwordx4 v13, s[44:47], s57 offen offset:3072 lds
  v_mfma_f32_16x16x32_bf16 v[132:135], a[52:55], a[88:91], v[132:135]
  s_add_u32 s61, s61, 8192
  s_cmp_eq_u32 s61, s63
  s_cselect_b32 s61, s62, s61
  v_mfma_f32_16x16x32_bf16 v[136:139], a[56:59], a[88:91], v[136:139]
  buffer_store_dwordx4 a[136:139], v26, s[52:55], s26 offen offset:2048 sc1
  v_mfma_f32_16x16x32_bf16 v[140:143], a[60:63], a[88:91], v[140:143]
  v_accvgpr_mov_b32 a198, a230
  v_mfma_f32_16x16x32_bf16 v[144:147], a[48:51], a[92:95], v[144:147]
  buffer_store_dwordx4 a[140:143], v26, s[52:55], s26 offen offset:3072 sc1
  v_mfma_f32_16x16x32_bf16 v[148:151], a[52:55], a[92:95], v[148:151]
  buffer_load_dword v28, v27, s[12:15], s79 offen
  v_mfma_f32_16x16x32_bf16 v[152:155], a[56:59], a[92:95], v[152:155]
  v_accvgpr_mov_b32 a199, a231
  v_mfma_f32_16x16x32_bf16 v[156:159], a[60:63], a[92:95], v[156:159]
  s_waitcnt vmcnt(25) lgkmcnt(0)
  s_barrier
  v_mfma_f32_16x16x32_bf16 v[160:163], a[48:51], a[96:99], v[160:163]
  ds_read_b128 a[32:35], v1 offset:0
  v_mfma_f32_16x16x32_bf16 v[164:167], a[52:55], a[96:99], v[164:167]
  ds_read_b128 a[36:39], v1 offset:2048
  v_mfma_f32_16x16x32_bf16 v[168:171], a[56:59], a[96:99], v[168:171]
  ds_read_b128 a[40:43], v1 offset:4096
  v_mfma_f32_16x16x32_bf16 v[172:175], a[60:63], a[96:99], v[172:175]
  ds_read_b128 a[44:47], v1 offset:6144
  v_mfma_f32_16x16x32_bf16 v[176:179], a[48:51], a[100:103], v[176:179]
  ds_read_b64_tr_b16 a[64:65], v5 offset:32768
  v_mfma_f32_16x16x32_bf16 v[180:183], a[52:55], a[100:103], v[180:183]
  ds_read_b64_tr_b16 a[66:67], v5 offset:34816
  v_mfma_f32_16x16x32_bf16 v[184:187], a[56:59], a[100:103], v[184:187]
  ds_read_b64_tr_b16 a[68:69], v6 offset:32768
  v_mfma_f32_16x16x32_bf16 v[188:191], a[60:63], a[100:103], v[188:191]
  ds_read_b64_tr_b16 a[70:71], v6 offset:34816
  v_mfma_f32_16x16x32_bf16 v[192:195], a[48:51], a[104:107], v[192:195]
  ds_read_b64_tr_b16 a[72:73], v7 offset:32768
  v_mfma_f32_16x16x32_bf16 v[196:199], a[52:55], a[104:107], v[196:199]
  ds_read_b64_tr_b16 a[74:75], v7 offset:34816
  v_mfma_f32_16x16x32_bf16 v[200:203], a[56:59], a[104:107], v[200:203]
  ds_read_b64_tr_b16 a[76:77], v8 offset:32768
  v_mfma_f32_16x16x32_bf16 v[204:207], a[60:63], a[104:107], v[204:207]
  ds_read_b64_tr_b16 a[78:79], v8 offset:34816
  s_add_u32 m0, s64, 16384
  v_mfma_f32_16x16x32_bf16 v[208:211], a[48:51], a[108:111], v[208:211]
  ds_read_b64_tr_b16 a[80:81], v18 offset:32768
  buffer_load_dwordx4 v14, s[48:51], s58 offen offset:0 lds
  v_mfma_f32_16x16x32_bf16 v[212:215], a[52:55], a[108:111], v[212:215]
  ds_read_b64_tr_b16 a[82:83], v18 offset:34816
  v_mfma_f32_16x16x32_bf16 v[216:219], a[56:59], a[108:111], v[216:219]
  ds_read_b64_tr_b16 a[84:85], v19 offset:32768
  v_mfma_f32_16x16x32_bf16 v[220:223], a[60:63], a[108:111], v[220:223]
  ds_read_b64_tr_b16 a[86:87], v19 offset:34816
  v_mfma_f32_16x16x32_bf16 v[224:227], a[48:51], a[112:115], v[224:227]
  ds_read_b64_tr_b16 a[88:89], v20 offset:32768
  buffer_load_dwordx4 v15, s[48:51], s58 offen offset:1024 lds
  v_mfma_f32_16x16x32_bf16 v[228:231], a[52:55], a[112:115], v[228:231]
  ds_read_b64_tr_b16 a[90:91], v20 offset:34816
  v_mfma_f32_16x16x32_bf16 v[232:235], a[56:59], a[112:115], v[232:235]
  ds_read_b64_tr_b16 a[92:93], v21 offset:32768
  v_mfma_f32_16x16x32_bf16 v[236:239], a[60:63], a[112:115], v[236:239]
  ds_read_b64_tr_b16 a[94:95], v21 offset:34816
  v_mfma_f32_16x16x32_bf16 v[240:243], a[48:51], a[116:119], v[240:243]
  buffer_load_dwordx4 v16, s[48:51], s58 offen offset:2048 lds
  v_mfma_f32_16x16x32_bf16 v[244:247], a[52:55], a[116:119], v[244:247]
  v_accvgpr_mov_b32 a136, a168
  v_mfma_f32_16x16x32_bf16 v[248:251], a[56:59], a[116:119], v[248:251]
  v_accvgpr_mov_b32 a137, a169
  v_mfma_f32_16x16x32_bf16 v[252:255], a[60:63], a[116:119], v[252:255]
  v_accvgpr_mov_b32 a138, a170
  v_mfma_f32_16x16x32_bf16 a[0:3], a[48:51], a[120:123], a[0:3]
  buffer_load_dwordx4 v17, s[48:51], s58 offen offset:3072 lds
  v_mfma_f32_16x16x32_bf16 a[4:7], a[52:55], a[120:123], a[4:7]
  s_add_u32 s58, s58, s59
  v_mfma_f32_16x16x32_bf16 a[8:11], a[56:59], a[120:123], a[8:11]
  v_accvgpr_mov_b32 a139, a171
  v_mfma_f32_16x16x32_bf16 a[12:15], a[60:63], a[120:123], a[12:15]
  v_accvgpr_mov_b32 a140, a172
  v_mfma_f32_16x16x32_bf16 a[16:19], a[48:51], a[124:127], a[16:19]
  v_accvgpr_mov_b32 a141, a173
  v_mfma_f32_16x16x32_bf16 a[20:23], a[52:55], a[124:127], a[20:23]
  v_accvgpr_mov_b32 a142, a174
  v_mfma_f32_16x16x32_bf16 a[24:27], a[56:59], a[124:127], a[24:27]
  v_accvgpr_mov_b32 a143, a175
  v_mfma_f32_16x16x32_bf16 a[28:31], a[60:63], a[124:127], a[28:31]
  s_waitcnt lgkmcnt(0)
  v_mfma_f32_16x16x32_bf16 v[32:35], a[32:35], a[64:67], v[32:35]
  ds_read_b64_tr_b16 a[96:97], v5 offset:33024
  v_accvgpr_mov_b32 a168, a200
  v_mfma_f32_16x16x32_bf16 v[36:39], a[36:39], a[64:67], v[36:39]
  ds_read_b64_tr_b16 a[98:99], v5 offset:35072
  v_accvgpr_mov_b32 a169, a201
  v_mfma_f32_16x16x32_bf16 v[40:43], a[40:43], a[64:67], v[40:43]
  ds_read_b64_tr_b16 a[100:101], v6 offset:33024
  v_accvgpr_mov_b32 a170, a202
  v_mfma_f32_16x16x32_bf16 v[44:47], a[44:47], a[64:67], v[44:47]
  ds_read_b64_tr_b16 a[102:103], v6 offset:35072
  v_accvgpr_mov_b32 a171, a203
  v_mfma_f32_16x16x32_bf16 v[48:51], a[32:35], a[68:71], v[48:51]
  ds_read_b64_tr_b16 a[104:105], v7 offset:33024
  v_accvgpr_mov_b32 a172, a204
  v_mfma_f32_16x16x32_bf16 v[52:55], a[36:39], a[68:71], v[52:55]
  ds_read_b64_tr_b16 a[106:107], v7 offset:35072
  v_accvgpr_mov_b32 a173, a205
  v_mfma_f32_16x16x32_bf16 v[56:59], a[40:43], a[68:71], v[56:59]
  ds_read_b64_tr_b16 a[108:109], v8 offset:33024
  v_accvgpr_mov_b32 a174, a206
  v_mfma_f32_16x16x32_bf16 v[60:63], a[44:47], a[68:71], v[60:63]
  ds_read_b64_tr_b16 a[110:111], v8 offset:35072
  v_accvgpr_mov_b32 a175, a207
  v_mfma_f32_16x16x32_bf16 v[64:67], a[32:35], a[72:75], v[64:67]
  ds_read_b64_tr_b16 a[112:113], v18 offset:33024
  v_accvgpr_mov_b32 a200, a232
  v_mfma_f32_16x16x32_bf16 v[68:71], a[36:39], a[72:75], v[68:71]
  ds_read_b64_tr_b16 a[114:115], v18 offset:35072
  v_mfma_f32_16x16x32_bf16 v[72:75], a[40:43], a[72:75], v[72:75]
  ds_read_b64_tr_b16 a[116:117], v19 offset:33024
  v_mfma_f32_16x16x32_bf16 v[76:79], a[44:47], a[72:75], v[76:79]
  ds_read_b64_tr_b16 a[118:119], v19 offset:35072
  s_mov_b32 m0, s61
  v_mfma_f32_16x16x32_bf16 v[80:83], a[32:35], a[76:79], v[80:83]
  ds_read_b64_tr_b16 a[120:121], v20 offset:33024
  buffer_load_dwordx4 v10, s[44:47], s56 offen offset:0 lds
  v_mfma_f32_16x16x32_bf16 v[84:87], a[36:39], a[76:79], v[84:87]
  ds_read_b64_tr_b16 a[122:123], v20 offset:35072
  v_mfma_f32_16x16x32_bf16 v[88:91], a[40:43], a[76:79], v[88:91]
  ds_read_b64_tr_b16 a[124:125], v21 offset:33024
  v_mfma_f32_16x16x32_bf16 v[92:95], a[44:47], a[76:79], v[92:95]
  ds_read_b64_tr_b16 a[126:127], v21 offset:35072
  v_mfma_f32_16x16x32_bf16 v[96:99], a[32:35], a[80:83], v[96:99]
  buffer_load_dwordx4 v11, s[44:47], s56 offen offset:1024 lds
  v_mfma_f32_16x16x32_bf16 v[100:103], a[36:39], a[80:83], v[100:103]
  v_accvgpr_mov_b32 a201, a233
  v_mfma_f32_16x16x32_bf16 v[104:107], a[40:43], a[80:83], v[104:107]
  v_accvgpr_mov_b32 a202, a234
  v_mfma_f32_16x16x32_bf16 v[108:111], a[44:47], a[80:83], v[108:111]
  v_accvgpr_mov_b32 a203, a235
  v_mfma_f32_16x16x32_bf16 v[112:115], a[32:35], a[84:87], v[112:115]
  buffer_load_dwordx4 v12, s[44:47], s56 offen offset:2048 lds
  v_mfma_f32_16x16x32_bf16 v[116:119], a[36:39], a[84:87], v[116:119]
  v_accvgpr_mov_b32 a204, a236
  v_mfma_f32_16x16x32_bf16 v[120:123], a[40:43], a[84:87], v[120:123]
  s_cmp_eq_u32 s67, 2
  s_cselect_b32 s14, s6, 0
  v_mfma_f32_16x16x32_bf16 v[124:127], a[44:47], a[84:87], v[124:127]
  v_accvgpr_mov_b32 a205, a237
  v_mfma_f32_16x16x32_bf16 v[128:131], a[32:35], a[88:91], v[128:131]
  buffer_load_dwordx4 v13, s[44:47], s56 offen offset:3072 lds
  v_mfma_f32_16x16x32_bf16 v[132:135], a[36:39], a[88:91], v[132:135]
  s_add_u32 s57, s56, s60
  s_add_u32 s56, s56, 128
  v_mfma_f32_16x16x32_bf16 v[136:139], a[40:43], a[88:91], v[136:139]
  buffer_store_dwordx4 a[144:147], v26, s[52:55], s27 offen offset:0 sc1
  v_mfma_f32_16x16x32_bf16 v[140:143], a[44:47], a[88:91], v[140:143]
  v_accvgpr_mov_b32 a206, a238
  v_mfma_f32_16x16x32_bf16 v[144:147], a[32:35], a[92:95], v[144:147]
  buffer_store_dwordx4 a[148:151], v26, s[52:55], s27 offen offset:1024 sc1
  v_mfma_f32_16x16x32_bf16 v[148:151], a[36:39], a[92:95], v[148:151]
  buffer_load_dword v28, v27, s[12:15], s79 offen
  v_mfma_f32_16x16x32_bf16 v[152:155], a[40:43], a[92:95], v[152:155]
  v_accvgpr_mov_b32 a207, a239
  v_mfma_f32_16x16x32_bf16 v[156:159], a[44:47], a[92:95], v[156:159]
  s_waitcnt vmcnt(25) lgkmcnt(0)
  s_barrier
  v_mfma_f32_16x16x32_bf16 v[160:163], a[32:35], a[96:99], v[160:163]
  ds_read_b128 a[48:51], v2 offset:0
  v_accvgpr_mov_b32 a144, a176
  v_mfma_f32_16x16x32_bf16 v[164:167], a[36:39], a[96:99], v[164:167]
  ds_read_b128 a[52:55], v2 offset:2048
  v_accvgpr_mov_b32 a145, a177
  v_mfma_f32_16x16x32_bf16 v[168:171], a[40:43], a[96:99], v[168:171]
  ds_read_b128 a[56:59], v2 offset:4096
  v_accvgpr_mov_b32 a146, a178
  v_mfma_f32_16x16x32_bf16 v[172:175], a[44:47], a[96:99], v[172:175]
  ds_read_b128 a[60:63], v2 offset:6144
  v_mfma_f32_16x16x32_bf16 v[176:179], a[32:35], a[100:103], v[176:179]
  ds_read_b64_tr_b16 a[64:65], v5 offset:49152
  v_mfma_f32_16x16x32_bf16 v[180:183], a[36:39], a[100:103], v[180:183]
  ds_read_b64_tr_b16 a[66:67], v5 offset:51200
  v_mfma_f32_16x16x32_bf16 v[184:187], a[40:43], a[100:103], v[184:187]
  ds_read_b64_tr_b16 a[68:69], v6 offset:49152
  v_mfma_f32_16x16x32_bf16 v[188:191], a[44:47], a[100:103], v[188:191]
  ds_read_b64_tr_b16 a[70:71], v6 offset:51200
  v_mfma_f32_16x16x32_bf16 v[192:195], a[32:35], a[104:107], v[192:195]
  ds_read_b64_tr_b16 a[72:73], v7 offset:49152
  v_mfma_f32_16x16x32_bf16 v[196:199], a[36:39], a[104:107], v[196:199]
  ds_read_b64_tr_b16 a[74:75], v7 offset:51200
  v_mfma_f32_16x16x32_bf16 v[200:203], a[40:43], a[104:107], v[200:203]
  ds_read_b64_tr_b16 a[76:77], v8 offset:49152
  v_mfma_f32_16x16x32_bf16 v[204:207], a[44:47], a[104:107], v[204:207]
  ds_read_b64_tr_b16 a[78:79], v8 offset:51200
  s_add_u32 m0, s64, 32768
  v_mfma_f32_16x16x32_bf16 v[208:211], a[32:35], a[108:111], v[208:211]
  ds_read_b64_tr_b16 a[80:81], v18 offset:49152
  buffer_load_dwordx4 v14, s[48:51], s58 offen offset:0 lds
  v_mfma_f32_16x16x32_bf16 v[212:215], a[36:39], a[108:111], v[212:215]
  ds_read_b64_tr_b16 a[82:83], v18 offset:51200
  v_mfma_f32_16x16x32_bf16 v[216:219], a[40:43], a[108:111], v[216:219]
  ds_read_b64_tr_b16 a[84:85], v19 offset:49152
  v_mfma_f32_16x16x32_bf16 v[220:223], a[44:47], a[108:111], v[220:223]
  ds_read_b64_tr_b16 a[86:87], v19 offset:51200
  v_mfma_f32_16x16x32_bf16 v[224:227], a[32:35], a[112:115], v[224:227]
  ds_read_b64_tr_b16 a[88:89], v20 offset:49152
  buffer_load_dwordx4 v15, s[48:51], s58 offen offset:1024 lds
  v_mfma_f32_16x16x32_bf16 v[228:231], a[36:39], a[112:115], v[228:231]
  ds_read_b64_tr_b16 a[90:91], v20 offset:51200
  v_mfma_f32_16x16x32_bf16 v[232:235], a[40:43], a[112:115], v[232:235]
  ds_read_b64_tr_b16 a[92:93], v21 offset:49152
  v_mfma_f32_16x16x32_bf16 v[236:239], a[44:47], a[112:115], v[236:239]
  ds_read_b64_tr_b16 a[94:95], v21 offset:51200
  v_mfma_f32_16x16x32_bf16 v[240:243], a[32:35], a[116:119], v[240:243]
  buffer_load_dwordx4 v16, s[48:51], s58 offen offset:2048 lds
  v_mfma_f32_16x16x32_bf16 v[244:247], a[36:39], a[116:119], v[244:247]
  s_add_u32 s72, s72, 1
  v_mfma_f32_16x16x32_bf16 v[248:251], a[40:43], a[116:119], v[248:251]
  s_cmp_eq_u32 s72, 3
  s_cselect_b32 s73, s75, s74
  s_cselect_b32 s72, 0, s72
  v_mfma_f32_16x16x32_bf16 v[252:255], a[44:47], a[116:119], v[252:255]
  v_accvgpr_mov_b32 a147, a179
  v_mfma_f32_16x16x32_bf16 a[0:3], a[32:35], a[120:123], a[0:3]
  buffer_load_dwordx4 v17, s[48:51], s58 offen offset:3072 lds
  v_mfma_f32_16x16x32_bf16 a[4:7], a[36:39], a[120:123], a[4:7]
  s_add_u32 s58, s58, s59
  v_mfma_f32_16x16x32_bf16 a[8:11], a[40:43], a[120:123], a[8:11]
  v_accvgpr_mov_b32 a148, a180
  v_mfma_f32_16x16x32_bf16 a[12:15], a[44:47], a[120:123], a[12:15]
  v_accvgpr_mov_b32 a149, a181
  v_mfma_f32_16x16x32_bf16 a[16:19], a[32:35], a[124:127], a[16:19]
  v_add_u32 v1, s73, v1
  v_add_u32 v2, s73, v2
  v_mfma_f32_16x16x32_bf16 a[20:23], a[36:39], a[124:127], a[20:23]
  v_accvgpr_mov_b32 a150, a182
  v_mfma_f32_16x16x32_bf16 a[24:27], a[40:43], a[124:127], a[24:27]
  v_accvgpr_mov_b32 a151, a183
  v_mfma_f32_16x16x32_bf16 a[28:31], a[44:47], a[124:127], a[28:31]
  s_waitcnt lgkmcnt(0)
  v_mfma_f32_16x16x32_bf16 v[32:35], a[48:51], a[64:67], v[32:35]
  ds_read_b64_tr_b16 a[96:97], v5 offset:49408
  v_accvgpr_mov_b32 a176, a208
  v_mfma_f32_16x16x32_bf16 v[36:39], a[52:55], a[64:67], v[36:39]
  ds_read_b64_tr_b16 a[98:99], v5 offset:51456
  v_accvgpr_mov_b32 a177, a209
  v_mfma_f32_16x16x32_bf16 v[40:43], a[56:59], a[64:67], v[40:43]
  ds_read_b64_tr_b16 a[100:101], v6 offset:49408
  v_accvgpr_mov_b32 a178, a210
  v_mfma_f32_16x16x32_bf16 v[44:47], a[60:63], a[64:67], v[44:47]
  ds_read_b64_tr_b16 a[102:103], v6 offset:51456
  v_accvgpr_mov_b32 a179, a211
  v_mfma_f32_16x16x32_bf16 v[48:51], a[48:51], a[68:71], v[48:51]
  ds_read_b64_tr_b16 a[104:105], v7 offset:49408
  v_accvgpr_mov_b32 a180, a212
  v_mfma_f32_16x16x32_bf16 v[52:55], a[52:55], a[68:71], v[52:55]
  ds_read_b64_tr_b16 a[106:107], v7 offset:51456
  v_accvgpr_mov_b32 a181, a213
  v_mfma_f32_16x16x32_bf16 v[56:59], a[56:59], a[68:71], v[56:59]
  ds_read_b64_tr_b16 a[108:109], v8 offset:49408
  v_accvgpr_mov_b32 a182, a214
  v_mfma_f32_16x16x32_bf16 v[60:63], a[60:63], a[68:71], v[60:63]
  ds_read_b64_tr_b16 a[110:111], v8 offset:51456
  v_accvgpr_mov_b32 a183, a215
  v_mfma_f32_16x16x32_bf16 v[64:67], a[48:51], a[72:75], v[64:67]
  ds_read_b64_tr_b16 a[112:113], v18 offset:49408
  v_accvgpr_mov_b32 a208, a240
  v_mfma_f32_16x16x32_bf16 v[68:71], a[52:55], a[72:75], v[68:71]
  ds_read_b64_tr_b16 a[114:115], v18 offset:51456
  v_mfma_f32_16x16x32_bf16 v[72:75], a[56:59], a[72:75], v[72:75]
  ds_read_b64_tr_b16 a[116:117], v19 offset:49408
  v_mfma_f32_16x16x32_bf16 v[76:79], a[60:63], a[72:75], v[76:79]
  ds_read_b64_tr_b16 a[118:119], v19 offset:51456
  s_add_u32 m0, s61, 4096
  v_mfma_f32_16x16x32_bf16 v[80:83], a[48:51], a[76:79], v[80:83]
  ds_read_b64_tr_b16 a[120:121], v20 offset:49408
  buffer_load_dwordx4 v10, s[44:47], s57 offen offset:0 lds
  v_mfma_f32_16x16x32_bf16 v[84:87], a[52:55], a[76:79], v[84:87]
  ds_read_b64_tr_b16 a[122:123], v20 offset:51456
  v_mfma_f32_16x16x32_bf16 v[88:91], a[56:59], a[76:79], v[88:91]
  ds_read_b64_tr_b16 a[124:125], v21 offset:49408
  v_mfma_f32_16x16x32_bf16 v[92:95], a[60:63], a[76:79], v[92:95]
  ds_read_b64_tr_b16 a[126:127], v21 offset:51456
  v_mfma_f32_16x16x32_bf16 v[96:99], a[48:51], a[80:83], v[96:99]
  buffer_load_dwordx4 v11, s[44:47], s57 offen offset:1024 lds
  v_mfma_f32_16x16x32_bf16 v[100:103], a[52:55], a[80:83], v[100:103]
  v_accvgpr_mov_b32 a209, a241
  v_mfma_f32_16x16x32_bf16 v[104:107], a[56:59], a[80:83], v[104:107]
  v_accvgpr_mov_b32 a210, a242
  v_mfma_f32_16x16x32_bf16 v[108:111], a[60:63], a[80:83], v[108:111]
  v_accvgpr_mov_b32 a211, a243
  v_mfma_f32_16x16x32_bf16 v[112:115], a[48:51], a[84:87], v[112:115]
  buffer_load_dwordx4 v12, s[44:47], s57 offen offset:2048 lds
  v_mfma_f32_16x16x32_bf16 v[116:119], a[52:55], a[84:87], v[116:119]
  v_accvgpr_mov_b32 a212, a244
  v_mfma_f32_16x16x32_bf16 v[120:123], a[56:59], a[84:87], v[120:123]
  s_cmp_eq_u32 s67, 3
  s_cselect_b32 s14, s6, 0
  v_mfma_f32_16x16x32_bf16 v[124:127], a[60:63], a[84:87], v[124:127]
  v_accvgpr_mov_b32 a213, a245
  v_mfma_f32_16x16x32_bf16 v[128:131], a[48:51], a[88:91], v[128:131]
  buffer_load_dwordx4 v13, s[44:47], s57 offen offset:3072 lds
  v_mfma_f32_16x16x32_bf16 v[132:135], a[52:55], a[88:91], v[132:135]
  s_add_u32 s61, s61, 8192
  s_cmp_eq_u32 s61, s63
  s_cselect_b32 s61, s62, s61
  v_mfma_f32_16x16x32_bf16 v[136:139], a[56:59], a[88:91], v[136:139]
  buffer_store_dwordx4 a[152:155], v26, s[52:55], s27 offen offset:2048 sc1
  v_mfma_f32_16x16x32_bf16 v[140:143], a[60:63], a[88:91], v[140:143]
  v_accvgpr_mov_b32 a214, a246
  v_mfma_f32_16x16x32_bf16 v[144:147], a[48:51], a[92:95], v[144:147]
  buffer_store_dwordx4 a[156:159], v26, s[52:55], s27 offen offset:3072 sc1
  v_mfma_f32_16x16x32_bf16 v[148:151], a[52:55], a[92:95], v[148:151]
  buffer_load_dword v28, v27, s[12:15], s79 offen
  v_mfma_f32_16x16x32_bf16 v[152:155], a[56:59], a[92:95], v[152:155]
  v_accvgpr_mov_b32 a215, a247
  v_mfma_f32_16x16x32_bf16 v[156:159], a[60:63], a[92:95], v[156:159]
  s_sub_u32 s66, s66, 1
  s_cmp_lg_u32 s66, 0
  s_cbranch_scc1 mk_v_top
  s_waitcnt vmcnt(25) lgkmcnt(0)
  s_barrier
  v_sub_u32 v1, v1, v3
  v_sub_u32 v2, v2, v4
  v_mfma_f32_16x16x32_bf16 v[160:163], a[48:51], a[96:99], v[160:163]
  ds_read_b128 a[32:35], v1 offset:0
  v_mfma_f32_16x16x32_bf16 v[164:167], a[52:55], a[96:99], v[164:167]
  ds_read_b128 a[36:39], v1 offset:2048
  v_mfma_f32_16x16x32_bf16 v[168:171], a[56:59], a[96:99], v[168:171]
  ds_read_b128 a[40:43], v1 offset:4096
  v_mfma_f32_16x16x32_bf16 v[172:175], a[60:63], a[96:99], v[172:175]
  ds_read_b128 a[44:47], v1 offset:6144
  v_mfma_f32_16x16x32_bf16 v[176:179], a[48:51], a[100:103], v[176:179]
  ds_read_b64_tr_b16 a[64:65], v9 offset:0
  v_mfma_f32_16x16x32_bf16 v[180:183], a[52:55], a[100:103], v[180:183]
  ds_read_b64_tr_b16 a[66:67], v9 offset:896
  v_mfma_f32_16x16x32_bf16 v[184:187], a[56:59], a[100:103], v[184:187]
  ds_read_b64_tr_b16 a[68:69], v9 offset:32
  v_mfma_f32_16x16x32_bf16 v[188:191], a[60:63], a[100:103], v[188:191]
  ds_read_b64_tr_b16 a[70:71], v9 offset:928
  v_mfma_f32_16x16x32_bf16 v[192:195], a[48:51], a[104:107], v[192:195]
  ds_read_b64_tr_b16 a[72:73], v9 offset:64
  v_mfma_f32_16x16x32_bf16 v[196:199], a[52:55], a[104:107], v[196:199]
  ds_read_b64_tr_b16 a[74:75], v9 offset:960
  v_mfma_f32_16x16x32_bf16 v[200:203], a[56:59], a[104:107], v[200:203]
  ds_read_b64_tr_b16 a[76:77], v9 offset:96
  v_mfma_f32_16x16x32_bf16 v[204:207], a[60:63], a[104:107], v[204:207]
  ds_read_b64_tr_b16 a[78:79], v9 offset:992
  s_add_u32 m0, s64, 49152
  v_mfma_f32_16x16x32_bf16 v[208:211], a[48:51], a[108:111], v[208:211]
  ds_read_b64_tr_b16 a[80:81], v9 offset:128
  buffer_load_dwordx4 v14, s[48:51], s58 offen offset:0 lds
  v_mfma_f32_16x16x32_bf16 v[212:215], a[52:55], a[108:111], v[212:215]
  ds_read_b64_tr_b16 a[82:83], v9 offset:1024
  v_mfma_f32_16x16x32_bf16 v[216:219], a[56:59], a[108:111], v[216:219]
  ds_read_b64_tr_b16 a[84:85], v9 offset:160
  v_mfma_f32_16x16x32_bf16 v[220:223], a[60:63], a[108:111], v[220:223]
  ds_read_b64_tr_b16 a[86:87], v9 offset:1056
  v_mfma_f32_16x16x32_bf16 v[224:227], a[48:51], a[112:115], v[224:227]
  ds_read_b64_tr_b16 a[88:89], v9 offset:192
  buffer_load_dwordx4 v15, s[48:51], s58 offen offset:1024 lds
  v_mfma_f32_16x16x32_bf16 v[228:231], a[52:55], a[112:115], v[228:231]
  ds_read_b64_tr_b16 a[90:91], v9 offset:1088
  v_mfma_f32_16x16x32_bf16 v[232:235], a[56:59], a[112:115], v[232:235]
  v_mfma_f32_16x16x32_bf16 v[236:239], a[60:63], a[112:115], v[236:239]
  v_mfma_f32_16x16x32_bf16 v[240:243], a[48:51], a[116:119], v[240:243]
  buffer_load_dwordx4 v16, s[48:51], s58 offen offset:2048 lds
  v_mfma_f32_16x16x32_bf16 v[244:247], a[52:55], a[116:119], v[244:247]
  v_mfma_f32_16x16x32_bf16 v[248:251], a[56:59], a[116:119], v[248:251]
  v_mfma_f32_16x16x32_bf16 v[252:255], a[60:63], a[116:119], v[252:255]
  v_mfma_f32_16x16x32_bf16 a[0:3], a[48:51], a[120:123], a[0:3]
  buffer_load_dwordx4 v17, s[48:51], s58 offen offset:3072 lds
  v_mfma_f32_16x16x32_bf16 a[4:7], a[52:55], a[120:123], a[4:7]
  s_add_u32 s58, s58, s59
  v_mfma_f32_16x16x32_bf16 a[8:11], a[56:59], a[120:123], a[8:11]
  v_mfma_f32_16x16x32_bf16 a[12:15], a[60:63], a[120:123], a[12:15]
  v_mfma_f32_16x16x32_bf16 a[16:19], a[48:51], a[124:127], a[16:19]
  v_mfma_f32_16x16x32_bf16 a[20:23], a[52:55], a[124:127], a[20:23]
  v_mfma_f32_16x16x32_bf16 a[24:27], a[56:59], a[124:127], a[24:27]
  v_mfma_f32_16x16x32_bf16 a[28:31], a[60:63], a[124:127], a[28:31]
  s_add_u32 s80, s80, 16777216
  s_mov_b32 s26, s80
  s_add_u32 s27, s80, 4096
  s_mov_b32 s28, 8192
  s_mov_b32 s14, 0
  buffer_load_dword v28, v27, s[12:15], s79 offen
  buffer_load_dword v28, v27, s[12:15], s79 offen
  buffer_load_dword v28, v27, s[12:15], s79 offen
  buffer_load_dword v28, v27, s[12:15], s79 offen
  v_cvt_pk_bf16_f32 v32, v32, v33
  v_cvt_pk_bf16_f32 v33, v34, v35
  v_cvt_pk_bf16_f32 v48, v48, v49
  v_cvt_pk_bf16_f32 v49, v50, v51
  v_cvt_pk_bf16_f32 v36, v36, v37
  v_cvt_pk_bf16_f32 v37, v38, v39
  v_cvt_pk_bf16_f32 v52, v52, v53
  v_cvt_pk_bf16_f32 v53, v54, v55
  v_permlane16_swap_b32 v32, v48
  v_permlane16_swap_b32 v33, v49
  v_accvgpr_write_b32 a128, v32
  v_accvgpr_write_b32 a129, v33
  v_accvgpr_write_b32 a130, v48
  v_accvgpr_write_b32 a131, v49
  v_cvt_pk_bf16_f32 v40, v40, v41
  v_cvt_pk_bf16_f32 v41, v42, v43
  v_cvt_pk_bf16_f32 v56, v56, v57
  v_cvt_pk_bf16_f32 v57, v58, v59
  v_permlane16_swap_b32 v36, v52
  v_permlane16_swap_b32 v37, v53
  v_accvgpr_write_b32 a144, v36
  v_accvgpr_write_b32 a145, v37
  v_accvgpr_write_b32 a146, v52
  v_accvgpr_write_b32 a147, v53
  v_cvt_pk_bf16_f32 v44, v44, v45
  v_cvt_pk_bf16_f32 v45, v46, v47
  v_cvt_pk_bf16_f32 v60, v60, v61
  v_cvt_pk_bf16_f32 v61, v62, v63
  v_permlane16_swap_b32 v40, v56
  v_permlane16_swap_b32 v41, v57
  v_accvgpr_write_b32 a160, v40
  v_accvgpr_write_b32 a161, v41
  v_accvgpr_write_b32 a162, v56
  v_accvgpr_write_b32 a163, v57
  v_cvt_pk_bf16_f32 v64, v64, v65
  v_cvt_pk_bf16_f32 v65, v66, v67
  v_cvt_pk_bf16_f32 v80, v80, v81
  v_cvt_pk_bf16_f32 v81, v82, v83
  v_permlane16_swap_b32 v44, v60
  v_permlane16_swap_b32 v45, v61
  v_accvgpr_write_b32 a176, v44
  v_accvgpr_write_b32 a177, v45
  v_accvgpr_write_b32 a178, v60
  v_accvgpr_write_b32 a179, v61
  v_cvt_pk_bf16_f32 v68, v68, v69
  v_cvt_pk_bf16_f32 v69, v70, v71
  v_cvt_pk_bf16_f32 v84, v84, v85
  v_cvt_pk_bf16_f32 v85, v86, v87
  v_permlane16_swap_b32 v64, v80
  v_permlane16_swap_b32 v65, v81
  v_accvgpr_write_b32 a132, v64
  v_accvgpr_write_b32 a133, v65
  v_accvgpr_write_b32 a134, v80
  v_accvgpr_write_b32 a135, v81
  v_cvt_pk_bf16_f32 v72, v72, v73
  v_cvt_pk_bf16_f32 v73, v74, v75
  v_cvt_pk_bf16_f32 v88, v88, v89
  v_cvt_pk_bf16_f32 v89, v90, v91
  v_permlane16_swap_b32 v68, v84
  v_permlane16_swap_b32 v69, v85
  v_accvgpr_write_b32 a148, v68
  v_accvgpr_write_b32 a149, v69
  v_accvgpr_write_b32 a150, v84
  v_accvgpr_write_b32 a151, v85
  v_cvt_pk_bf16_f32 v76, v76, v77
  v_cvt_pk_bf16_f32 v77, v78, v79
  v_cvt_pk_bf16_f32 v92, v92, v93
  v_cvt_pk_bf16_f32 v93, v94, v95
  v_permlane16_swap_b32 v72, v88
  v_permlane16_swap_b32 v73, v89
  v_accvgpr_write_b32 a164, v72
  v_accvgpr_write_b32 a165, v73
  v_accvgpr_write_b32 a166, v88
  v_accvgpr_write_b32 a167, v89
  v_cvt_pk_bf16_f32 v96, v96, v97
  v_cvt_pk_bf16_f32 v97, v98, v99
  v_cvt_pk_bf16_f32 v112, v112, v113
  v_cvt_pk_bf16_f32 v113, v114, v115
  v_permlane16_swap_b32 v76, v92
  v_permlane16_swap_b32 v77, v93
  v_accvgpr_write_b32 a180, v76
  v_accvgpr_write_b32 a181, v77
  v_accvgpr_write_b32 a182, v92
  v_accvgpr_write_b32 a183, v93
  v_cvt_pk_bf16_f32 v100, v100, v101
  v_cvt_pk_bf16_f32 v101, v102, v103
  v_cvt_pk_bf16_f32 v116, v116, v117
  v_cvt_pk_bf16_f32 v117, v118, v119
  v_permlane16_swap_b32 v96, v112
  v_permlane16_swap_b32 v97, v113
  v_accvgpr_write_b32 a136, v96
  v_accvgpr_write_b32 a137, v97
  v_accvgpr_write_b32 a138, v112
  v_accvgpr_write_b32 a139, v113
  v_cvt_pk_bf16_f32 v104, v104, v105
  v_cvt_pk_bf16_f32 v105, v106, v107
  v_cvt_pk_bf16_f32 v120, v120, v121
  v_cvt_pk_bf16_f32 v121, v122, v123
  v_permlane16_swap_b32 v100, v116
  v_permlane16_swap_b32 v101, v117
  v_accvgpr_write_b32 a152, v100
  v_accvgpr_write_b32 a153, v101
  v_accvgpr_write_b32 a154, v116
  v_accvgpr_write_b32 a155, v117
  v_cvt_pk_bf16_f32 v108, v108, v109
  v_cvt_pk_bf16_f32 v109, v110, v111
  v_cvt_pk_bf16_f32 v124, v124, v125
  v_cvt_pk_bf16_f32 v125, v126, v127
  v_permlane16_swap_b32 v104, v120
  v_permlane16_swap_b32 v105, v121
  v_accvgpr_write_b32 a168, v104
  v_accvgpr_write_b32 a169, v105
  v_accvgpr_write_b32 a170, v120
  v_accvgpr_write_b32 a171, v121
  v_cvt_pk_bf16_f32 v128, v128, v129
  v_cvt_pk_bf16_f32 v129, v130, v131
  v_cvt_pk_bf16_f32 v144, v144, v145
  v_cvt_pk_bf16_f32 v145, v146, v147
  v_permlane16_swap_b32 v108, v124
  v_permlane16_swap_b32 v109, v125
  v_accvgpr_write_b32 a184, v108
  v_accvgpr_write_b32 a185, v109
  v_accvgpr_write_b32 a186, v124
  v_accvgpr_write_b32 a187, v125
  v_cvt_pk_bf16_f32 v132, v132, v133
  v_cvt_pk_bf16_f32 v133, v134, v135
  v_cvt_pk_bf16_f32 v148, v148, v149
  v_cvt_pk_bf16_f32 v149, v150, v151
  v_permlane16_swap_b32 v128, v144
  v_permlane16_swap_b32 v129, v145
  v_accvgpr_write_b32 a140, v128
  v_accvgpr_write_b32 a141, v129
  v_accvgpr_write_b32 a142, v144
  v_accvgpr_write_b32 a143, v145
  v_cvt_pk_bf16_f32 v136, v136, v137
  v_cvt_pk_bf16_f32 v137, v138, v139
  v_cvt_pk_bf16_f32 v152, v152, v153
  v_cvt_pk_bf16_f32 v153, v154, v155
  v_permlane16_swap_b32 v132, v148
  v_permlane16_swap_b32 v133, v149
  v_accvgpr_write_b32 a156, v132
  v_accvgpr_write_b32 a157, v133
  v_accvgpr_write_b32 a158, v148
  v_accvgpr_write_b32 a159, v149
  v_cvt_pk_bf16_f32 v140, v140, v141
  v_cvt_pk_bf16_f32 v141, v142, v143
  v_cvt_pk_bf16_f32 v156, v156, v157
  v_cvt_pk_bf16_f32 v157, v158, v159
  v_permlane16_swap_b32 v136, v152
  v_permlane16_swap_b32 v137, v153
  v_accvgpr_write_b32 a172, v136
  v_accvgpr_write_b32 a173, v137
  v_accvgpr_write_b32 a174, v152
  v_accvgpr_write_b32 a175, v153
  v_cvt_pk_bf16_f32 v160, v160, v161
  v_cvt_pk_bf16_f32 v161, v162, v163
  v_cvt_pk_bf16_f32 v176, v176, v177
  v_cvt_pk_bf16_f32 v177, v178, v179
  v_permlane16_swap_b32 v140, v156
  v_permlane16_swap_b32 v141, v157
  v_accvgpr_write_b32 a188, v140
  v_accvgpr_write_b32 a189, v141
  v_accvgpr_write_b32 a190, v156
  v_accvgpr_write_b32 a191, v157
  v_cvt_pk_bf16_f32 v164, v164, v165
  v_cvt_pk_bf16_f32 v165, v166, v167
  v_cvt_pk_bf16_f32 v180, v180, v181
  v_cvt_pk_bf16_f32 v181, v182, v183
  v_permlane16_swap_b32 v160, v176
  v_permlane16_swap_b32 v161, v177
  v_accvgpr_write_b32 a192, v160
  v_accvgpr_write_b32 a193, v161
  v_accvgpr_write_b32 a194, v176
  v_accvgpr_write_b32 a195, v177
  v_cvt_pk_bf16_f32 v168, v168, v169
  v_cvt_pk_bf16_f32 v169, v170, v171
  v_cvt_pk_bf16_f32 v184, v184, v185
  v_cvt_pk_bf16_f32 v185, v186, v187
  v_permlane16_swap_b32 v164, v180
  v_permlane16_swap_b32 v165, v181
  v_accvgpr_write_b32 a208, v164
  v_accvgpr_write_b32 a209, v165
  v_accvgpr_write_b32 a210, v180
  v_accvgpr_write_b32 a211, v181
  v_cvt_pk_bf16_f32 v172, v172, v173
  v_cvt_pk_bf16_f32 v173, v174, v175
  v_cvt_pk_bf16_f32 v188, v188, v189
  v_cvt_pk_bf16_f32 v189, v190, v191
  v_permlane16_swap_b32 v168, v184
  v_permlane16_swap_b32 v169, v185
  v_accvgpr_write_b32 a224, v168
  v_accvgpr_write_b32 a225, v169
  v_accvgpr_write_b32 a226, v184
  v_accvgpr_write_b32 a227, v185
  v_cvt_pk_bf16_f32 v192, v192, v193
  v_cvt_pk_bf16_f32 v193, v194, v195
  v_cvt_pk_bf16_f32 v208, v208, v209
  v_cvt_pk_bf16_f32 v209, v210, v211
  v_permlane16_swap_b32 v172, v188
  v_permlane16_swap_b32 v173, v189
  v_accvgpr_write_b32 a240, v172
  v_accvgpr_write_b32 a241, v173
  v_accvgpr_write_b32 a242, v188
  v_accvgpr_write_b32 a243, v189
  v_cvt_pk_bf16_f32 v196, v196, v197
  v_cvt_pk_bf16_f32 v197, v198, v199
  v_cvt_pk_bf16_f32 v212, v212, v213
  v_cvt_pk_bf16_f32 v213, v214, v215
  v_permlane16_swap_b32 v192, v208
  v_permlane16_swap_b32 v193, v209
  v_accvgpr_write_b32 a196, v192
  v_accvgpr_write_b32 a197, v193
  v_accvgpr_write_b32 a198, v208
  v_accvgpr_write_b32 a199, v209
  v_cvt_pk_bf16_f32 v200, v200, v201
  v_cvt_pk_bf16_f32 v201, v202, v203
  v_cvt_pk_bf16_f32 v216, v216, v217
  v_cvt_pk_bf16_f32 v217, v218, v219
  v_permlane16_swap_b32 v196, v212
  v_permlane16_swap_b32 v197, v213
  v_accvgpr_write_b32 a212, v196
  v_accvgpr_write_b32 a213, v197
  v_accvgpr_write_b32 a214, v212
  v_accvgpr_write_b32 a215, v213
  v_cvt_pk_bf16_f32 v204, v204, v205
  v_cvt_pk_bf16_f32 v205, v206, v207
  v_cvt_pk_bf16_f32 v220, v220, v221
  v_cvt_pk_bf16_f32 v221, v222, v223
  v_permlane16_swap_b32 v200, v216
  v_permlane16_swap_b32 v201, v217
  v_accvgpr_write_b32 a228, v200
  v_accvgpr_write_b32 a229, v201
  v_accvgpr_write_b32 a230, v216
  v_accvgpr_write_b32 a231, v217
  v_cvt_pk_bf16_f32 v224, v224, v225
  v_cvt_pk_bf16_f32 v225, v226, v227
  v_cvt_pk_bf16_f32 v240, v240, v241
  v_cvt_pk_bf16_f32 v241, v242, v243
  v_permlane16_swap_b32 v204, v220
  v_permlane16_swap_b32 v205, v221
  v_accvgpr_write_b32 a244, v204
  v_accvgpr_write_b32 a245, v205
  v_accvgpr_write_b32 a246, v220
  v_accvgpr_write_b32 a247, v221
  v_cvt_pk_bf16_f32 v228, v228, v229
  v_cvt_pk_bf16_f32 v229, v230, v231
  v_cvt_pk_bf16_f32 v244, v244, v245
  v_cvt_pk_bf16_f32 v245, v246, v247
  v_permlane16_swap_b32 v224, v240
  v_permlane16_swap_b32 v225, v241
  v_accvgpr_write_b32 a200, v224
  v_accvgpr_write_b32 a201, v225
  v_accvgpr_write_b32 a202, v240
  v_accvgpr_write_b32 a203, v241
  v_cvt_pk_bf16_f32 v232, v232, v233
  v_cvt_pk_bf16_f32 v233, v234, v235
  v_cvt_pk_bf16_f32 v248, v248, v249
  v_cvt_pk_bf16_f32 v249, v250, v251
  v_permlane16_swap_b32 v228, v244
  v_permlane16_swap_b32 v229, v245
  v_accvgpr_write_b32 a216, v228
  v_accvgpr_write_b32 a217, v229
  v_accvgpr_write_b32 a218, v244
  v_accvgpr_write_b32 a219, v245
  v_cvt_pk_bf16_f32 v236, v236, v237
  v_cvt_pk_bf16_f32 v237, v238, v239
  v_cvt_pk_bf16_f32 v252, v252, v253
  v_cvt_pk_bf16_f32 v253, v254, v255
  v_permlane16_swap_b32 v232, v248
  v_permlane16_swap_b32 v233, v249
  v_accvgpr_write_b32 a232, v232
  v_accvgpr_write_b32 a233, v233
  v_accvgpr_write_b32 a234, v248
  v_accvgpr_write_b32 a235, v249
  v_accvgpr_read_b32 v32, a0
  v_accvgpr_read_b32 v33, a1
  v_accvgpr_read_b32 v34, a2
  v_accvgpr_read_b32 v35, a3
  v_accvgpr_read_b32 v48, a16
  v_accvgpr_read_b32 v49, a17
  v_accvgpr_read_b32 v50, a18
  v_accvgpr_read_b32 v51, a19
  v_cvt_pk_bf16_f32 v32, v32, v33
  v_cvt_pk_bf16_f32 v33, v34, v35
  v_cvt_pk_bf16_f32 v48, v48, v49
  v_cvt_pk_bf16_f32 v49, v50, v51
  v_permlane16_swap_b32 v236, v252
  v_permlane16_swap_b32 v237, v253
  v_accvgpr_write_b32 a248, v236
  v_accvgpr_write_b32 a249, v237
  v_accvgpr_write_b32 a250, v252
  v_accvgpr_write_b32 a251, v253
  v_accvgpr_read_b32 v36, a4
  v_accvgpr_read_b32 v37, a5
  v_accvgpr_read_b32 v38, a6
  v_accvgpr_read_b32 v39, a7
  v_accvgpr_read_b32 v52, a20
  v_accvgpr_read_b32 v53, a21
  v_accvgpr_read_b32 v54, a22
  v_accvgpr_read_b32 v55, a23
  v_cvt_pk_bf16_f32 v36, v36, v37
  v_cvt_pk_bf16_f32 v37, v38, v39
  v_cvt_pk_bf16_f32 v52, v52, v53
  v_cvt_pk_bf16_f32 v53, v54, v55
  v_permlane16_swap_b32 v32, v48
  v_permlane16_swap_b32 v33, v49
  v_accvgpr_write_b32 a204, v32
  v_accvgpr_write_b32 a205, v33
  v_accvgpr_write_b32 a206, v48
  v_accvgpr_write_b32 a207, v49
  v_accvgpr_read_b32 v40, a8
  v_accvgpr_read_b32 v41, a9
  v_accvgpr_read_b32 v42, a10
  v_accvgpr_read_b32 v43, a11
  v_accvgpr_read_b32 v56, a24
  v_accvgpr_read_b32 v57, a25
  v_accvgpr_read_b32 v58, a26
  v_accvgpr_read_b32 v59, a27
  v_cvt_pk_bf16_f32 v40, v40, v41
  v_cvt_pk_bf16_f32 v41, v42, v43
  v_cvt_pk_bf16_f32 v56, v56, v57
  v_cvt_pk_bf16_f32 v57, v58, v59
  v_permlane16_swap_b32 v36, v52
  v_permlane16_swap_b32 v37, v53
  v_accvgpr_write_b32 a220, v36
  v_accvgpr_write_b32 a221, v37
  v_accvgpr_write_b32 a222, v52
  v_accvgpr_write_b32 a223, v53
  v_accvgpr_read_b32 v44, a12
  v_accvgpr_read_b32 v45, a13
  v_accvgpr_read_b32 v46, a14
  v_accvgpr_read_b32 v47, a15
  v_accvgpr_read_b32 v60, a28
  v_accvgpr_read_b32 v61, a29
  v_accvgpr_read_b32 v62, a30
  v_accvgpr_read_b32 v63, a31
  v_cvt_pk_bf16_f32 v44, v44, v45
  v_cvt_pk_bf16_f32 v45, v46, v47
  v_cvt_pk_bf16_f32 v60, v60, v61
  v_cvt_pk_bf16_f32 v61, v62, v63
  v_permlane16_swap_b32 v40, v56
  v_permlane16_swap_b32 v41, v57
  v_accvgpr_write_b32 a236, v40
  v_accvgpr_write_b32 a237, v41
  v_accvgpr_write_b32 a238, v56
  v_accvgpr_write_b32 a239, v57
  s_nop 1
  v_permlane16_swap_b32 v44, v60
  v_permlane16_swap_b32 v45, v61
  v_accvgpr_write_b32 a252, v44
  v_accvgpr_write_b32 a253, v45
  v_accvgpr_write_b32 a254, v60
  v_accvgpr_write_b32 a255, v61
mk_gu_start:
  s_mov_b32 s83, 0
  s_mov_b32 s88, 0
  s_mov_b32 s66, 8
  s_waitcnt lgkmcnt(0)
  v_mfma_f32_16x16x32_bf16 v[32:35], a[64:67], a[32:35], 0
  ds_read_b64_tr_b16 a[96:97], v9 offset:8192
  v_mfma_f32_16x16x32_bf16 v[36:39], a[64:67], a[36:39], 0
  ds_read_b64_tr_b16 a[98:99], v9 offset:9088
  v_mfma_f32_16x16x32_bf16 v[40:43], a[64:67], a[40:43], 0
  ds_read_b64_tr_b16 a[100:101], v9 offset:8224
  v_mfma_f32_16x16x32_bf16 v[44:47], a[64:67], a[44:47], 0
  ds_read_b64_tr_b16 a[102:103], v9 offset:9120
  v_mfma_f32_16x16x32_bf16 v[48:51], a[68:71], a[32:35], 0
  ds_read_b64_tr_b16 a[104:105], v9 offset:8256
  v_mfma_f32_16x16x32_bf16 v[52:55], a[68:71], a[36:39], 0
  ds_read_b64_tr_b16 a[106:107], v9 offset:9152
  v_mfma_f32_16x16x32_bf16 v[56:59], a[68:71], a[40:43], 0
  ds_read_b64_tr_b16 a[108:109], v9 offset:8288
  v_mfma_f32_16x16x32_bf16 v[60:63], a[68:71], a[44:47], 0
  ds_read_b64_tr_b16 a[110:111], v9 offset:9184
  s_mov_b32 m0, s61
  v_mfma_f32_16x16x32_bf16 v[64:67], a[72:75], a[32:35], 0
  ds_read_b64_tr_b16 a[112:113], v9 offset:8320
  buffer_load_dwordx4 v10, s[44:47], s56 offen offset:0 lds
  v_mfma_f32_16x16x32_bf16 v[68:71], a[72:75], a[36:39], 0
  ds_read_b64_tr_b16 a[114:115], v9 offset:9216
  v_mfma_f32_16x16x32_bf16 v[72:75], a[72:75], a[40:43], 0
  ds_read_b64_tr_b16 a[116:117], v9 offset:8352
  v_mfma_f32_16x16x32_bf16 v[76:79], a[72:75], a[44:47], 0
  ds_read_b64_tr_b16 a[118:119], v9 offset:9248
  v_mfma_f32_16x16x32_bf16 v[80:83], a[76:79], a[32:35], 0
  ds_read_b64_tr_b16 a[120:121], v9 offset:8384
  buffer_load_dwordx4 v11, s[44:47], s56 offen offset:1024 lds
  v_mfma_f32_16x16x32_bf16 v[84:87], a[76:79], a[36:39], 0
  ds_read_b64_tr_b16 a[122:123], v9 offset:9280
  v_mfma_f32_16x16x32_bf16 v[88:91], a[76:79], a[40:43], 0
  v_mfma_f32_16x16x32_bf16 v[92:95], a[76:79], a[44:47], 0
  v_mfma_f32_16x16x32_bf16 v[96:99], a[80:83], a[32:35], 0
  buffer_load_dwordx4 v12, s[44:47], s56 offen offset:2048 lds
  v_mfma_f32_16x16x32_bf16 v[100:103], a[80:83], a[36:39], 0
  v_mfma_f32_16x16x32_bf16 v[104:107], a[80:83], a[40:43], 0
  v_mfma_f32_16x16x32_bf16 v[108:111], a[80:83], a[44:47], 0
  v_mfma_f32_16x16x32_bf16 v[112:115], a[84:87], a[32:35], 0
  buffer_load_dwordx4 v13, s[44:47], s56 offen offset:3072 lds
  v_mfma_f32_16x16x32_bf16 v[116:119], a[84:87], a[36:39], 0
  s_add_u32 s57, s56, s60
  s_add_u32 s56, s56, 128
  v_mfma_f32_16x16x32_bf16 v[120:123], a[84:87], a[40:43], 0
  buffer_store_dwordx4 a[128:131], v26, s[52:55], s26 offen offset:0 sc1
  v_mfma_f32_16x16x32_bf16 v[124:127], a[84:87], a[44:47], 0
  v_mfma_f32_16x16x32_bf16 v[128:131], a[88:91], a[32:35], 0
  buffer_store_dwordx4 a[132:135], v26, s[52:55], s26 offen offset:1024 sc1
  v_mfma_f32_16x16x32_bf16 v[132:135], a[88:91], a[36:39], 0
  v_mfma_f32_16x16x32_bf16 v[136:139], a[88:91], a[40:43], 0
  v_mfma_f32_16x16x32_bf16 v[140:143], a[88:91], a[44:47], 0
  s_waitcnt vmcnt(19) lgkmcnt(0)
  s_barrier
  v_mfma_f32_16x16x32_bf16 v[144:147], a[96:99], a[32:35], 0
  ds_read_b128 a[48:51], v2 offset:0
  v_accvgpr_mov_b32 a128, a160
  v_mfma_f32_16x16x32_bf16 v[148:151], a[96:99], a[36:39], 0
  ds_read_b128 a[52:55], v2 offset:2048
  v_accvgpr_mov_b32 a129, a161
  v_mfma_f32_16x16x32_bf16 v[152:155], a[96:99], a[40:43], 0
  ds_read_b128 a[56:59], v2 offset:4096
  v_accvgpr_mov_b32 a130, a162
  v_mfma_f32_16x16x32_bf16 v[156:159], a[96:99], a[44:47], 0
  ds_read_b128 a[60:63], v2 offset:6144
  v_mfma_f32_16x16x32_bf16 v[160:163], a[100:103], a[32:35], 0
  ds_read_b64_tr_b16 a[64:65], v9 offset:16384
  v_mfma_f32_16x16x32_bf16 v[164:167], a[100:103], a[36:39], 0
  ds_read_b64_tr_b16 a[66:67], v9 offset:17280
  v_mfma_f32_16x16x32_bf16 v[168:171], a[100:103], a[40:43], 0
  ds_read_b64_tr_b16 a[68:69], v9 offset:16416
  v_mfma_f32_16x16x32_bf16 v[172:175], a[100:103], a[44:47], 0
  ds_read_b64_tr_b16 a[70:71], v9 offset:17312
  s_add_u32 m0, s64, 0
  v_mfma_f32_16x16x32_bf16 v[176:179], a[104:107], a[32:35], 0
  ds_read_b64_tr_b16 a[72:73], v9 offset:16448
  buffer_load_dwordx4 v14, s[48:51], s58 offen offset:0 lds
  v_mfma_f32_16x16x32_bf16 v[180:183], a[104:107], a[36:39], 0
  ds_read_b64_tr_b16 a[74:75], v9 offset:17344
  v_mfma_f32_16x16x32_bf16 v[184:187], a[104:107], a[40:43], 0
  ds_read_b64_tr_b16 a[76:77], v9 offset:16480
  v_mfma_f32_16x16x32_bf16 v[188:191], a[104:107], a[44:47], 0
  ds_read_b64_tr_b16 a[78:79], v9 offset:17376
  v_mfma_f32_16x16x32_bf16 v[192:195], a[108:111], a[32:35], 0
  ds_read_b64_tr_b16 a[80:81], v9 offset:16512
  buffer_load_dwordx4 v15, s[48:51], s58 offen offset:1024 lds
  v_mfma_f32_16x16x32_bf16 v[196:199], a[108:111], a[36:39], 0
  ds_read_b64_tr_b16 a[82:83], v9 offset:17408
  v_mfma_f32_16x16x32_bf16 v[200:203], a[108:111], a[40:43], 0
  ds_read_b64_tr_b16 a[84:85], v9 offset:16544
  v_mfma_f32_16x16x32_bf16 v[204:207], a[108:111], a[44:47], 0
  ds_read_b64_tr_b16 a[86:87], v9 offset:17440
  v_mfma_f32_16x16x32_bf16 v[208:211], a[112:115], a[32:35], 0
  ds_read_b64_tr_b16 a[88:89], v9 offset:16576
  buffer_load_dwordx4 v16, s[48:51], s58 offen offset:2048 lds
  v_mfma_f32_16x16x32_bf16 v[212:215], a[112:115], a[36:39], 0
  ds_read_b64_tr_b16 a[90:91], v9 offset:17472
  s_add_u32 s72, s72, 1
  v_mfma_f32_16x16x32_bf16 v[216:219], a[112:115], a[40:43], 0
  s_cmp_eq_u32 s72, 3
  s_cselect_b32 s73, s75, s74
  s_cselect_b32 s72, 0, s72
  v_mfma_f32_16x16x32_bf16 v[220:223], a[112:115], a[44:47], 0
  v_accvgpr_mov_b32 a131, a163
  v_mfma_f32_16x16x32_bf16 v[224:227], a[116:119], a[32:35], 0
  buffer_load_dwordx4 v17, s[48:51], s58 offen offset:3072 lds
  v_mfma_f32_16x16x32_bf16 v[228:231], a[116:119], a[36:39], 0
  s_add_u32 s58, s58, s59
  v_mfma_f32_16x16x32_bf16 v[232:235], a[116:119], a[40:43], 0
  v_accvgpr_mov_b32 a132, a164
  v_mfma_f32_16x16x32_bf16 v[236:239], a[116:119], a[44:47], 0
  v_accvgpr_mov_b32 a133, a165
  v_mfma_f32_16x16x32_bf16 v[240:243], a[120:123], a[32:35], 0
  v_add_u32 v1, s73, v1
  v_add_u32 v2, s73, v2
  v_mfma_f32_16x16x32_bf16 v[244:247], a[120:123], a[36:39], 0
  v_accvgpr_mov_b32 a134, a166
  v_mfma_f32_16x16x32_bf16 v[248:251], a[120:123], a[40:43], 0
  v_accvgpr_mov_b32 a135, a167
  v_mfma_f32_16x16x32_bf16 v[252:255], a[120:123], a[44:47], 0
  s_branch mk_ga_entry
.p2align 6
mk_ga_top:
  s_waitcnt vmcnt(22) lgkmcnt(0)
  s_barrier
  v_mfma_f32_16x16x32_bf16 v[144:147], a[96:99], a[48:51], v[144:147]
  ds_read_b128 a[32:35], v1 offset:0
  v_accvgpr_mov_b32 a152, a184
  v_mfma_f32_16x16x32_bf16 v[148:151], a[96:99], a[52:55], v[148:151]
  ds_read_b128 a[36:39], v1 offset:2048
  v_accvgpr_mov_b32 a153, a185
  v_mfma_f32_16x16x32_bf16 v[152:155], a[96:99], a[56:59], v[152:155]
  ds_read_b128 a[40:43], v1 offset:4096
  v_mfma_f32_16x16x32_bf16 v[156:159], a[96:99], a[60:63], v[156:159]
  ds_read_b128 a[44:47], v1 offset:6144
  v_mfma_f32_16x16x32_bf16 v[160:163], a[100:103], a[48:51], v[160:163]
  ds_read_b64_tr_b16 a[64:65], v9 offset:0
  v_mfma_f32_16x16x32_bf16 v[164:167], a[100:103], a[52:55], v[164:167]
  ds_read_b64_tr_b16 a[66:67], v9 offset:896
  v_mfma_f32_16x16x32_bf16 v[168:171], a[100:103], a[56:59], v[168:171]
  ds_read_b64_tr_b16 a[68:69], v9 offset:32
  v_mfma_f32_16x16x32_bf16 v[172:175], a[100:103], a[60:63], v[172:175]
  ds_read_b64_tr_b16 a[70:71], v9 offset:928
  s_add_u32 m0, s64, 49152
  v_mfma_f32_16x16x32_bf16 v[176:179], a[104:107], a[48:51], v[176:179]
  ds_read_b64_tr_b16 a[72:73], v9 offset:64
  buffer_load_dwordx4 v14, s[48:51], s58 offen offset:0 lds
  v_mfma_f32_16x16x32_bf16 v[180:183], a[104:107], a[52:55], v[180:183]
  ds_read_b64_tr_b16 a[74:75], v9 offset:960
  v_mfma_f32_16x16x32_bf16 v[184:187], a[104:107], a[56:59], v[184:187]
  ds_read_b64_tr_b16 a[76:77], v9 offset:96
  v_mfma_f32_16x16x32_bf16 v[188:191], a[104:107], a[60:63], v[188:191]
  ds_read_b64_tr_b16 a[78:79], v9 offset:992
  v_mfma_f32_16x16x32_bf16 v[192:195], a[108:111], a[48:51], v[192:195]
  ds_read_b64_tr_b16 a[80:81], v9 offset:128
  buffer_load_dwordx4 v15, s[48:51], s58 offen offset:1024 lds
  v_mfma_f32_16x16x32_bf16 v[196:199], a[108:111], a[52:55], v[196:199]
  ds_read_b64_tr_b16 a[82:83], v9 offset:1024
  v_mfma_f32_16x16x32_bf16 v[200:203], a[108:111], a[56:59], v[200:203]
  ds_read_b64_tr_b16 a[84:85], v9 offset:160
  v_mfma_f32_16x16x32_bf16 v[204:207], a[108:111], a[60:63], v[204:207]
  ds_read_b64_tr_b16 a[86:87], v9 offset:1056
  v_mfma_f32_16x16x32_bf16 v[208:211], a[112:115], a[48:51], v[208:211]
  ds_read_b64_tr_b16 a[88:89], v9 offset:192
  buffer_load_dwordx4 v16, s[48:51], s58 offen offset:2048 lds
  v_mfma_f32_16x16x32_bf16 v[212:215], a[112:115], a[52:55], v[212:215]
  ds_read_b64_tr_b16 a[90:91], v9 offset:1088
  v_mfma_f32_16x16x32_bf16 v[216:219], a[112:115], a[56:59], v[216:219]
  v_accvgpr_mov_b32 a154, a186
  v_mfma_f32_16x16x32_bf16 v[220:223], a[112:115], a[60:63], v[220:223]
  v_accvgpr_mov_b32 a155, a187
  v_mfma_f32_16x16x32_bf16 v[224:227], a[116:119], a[48:51], v[224:227]
  buffer_load_dwordx4 v17, s[48:51], s58 offen offset:3072 lds
  v_mfma_f32_16x16x32_bf16 v[228:231], a[116:119], a[52:55], v[228:231]
  s_add_u32 s58, s58, s59
  s_add_u32 s26, s26, s28
  s_add_u32 s27, s26, 4096
  v_mfma_f32_16x16x32_bf16 v[232:235], a[116:119], a[56:59], v[232:235]
  s_xor_b32 s28, s28, 507904
  v_mfma_f32_16x16x32_bf16 v[236:239], a[116:119], a[60:63], v[236:239]
  v_accvgpr_mov_b32 a156, a188
  v_mfma_f32_16x16x32_bf16 v[240:243], a[120:123], a[48:51], v[240:243]
  v_accvgpr_mov_b32 a157, a189
  v_mfma_f32_16x16x32_bf16 v[244:247], a[120:123], a[52:55], v[244:247]
  v_accvgpr_mov_b32 a158, a190
  v_mfma_f32_16x16x32_bf16 v[248:251], a[120:123], a[56:59], v[248:251]
  v_accvgpr_mov_b32 a159, a191
  v_mfma_f32_16x16x32_bf16 v[252:255], a[120:123], a[60:63], v[252:255]
  s_waitcnt lgkmcnt(0)
  v_mfma_f32_16x16x32_bf16 v[32:35], a[64:67], a[32:35], v[32:35]
  ds_read_b64_tr_b16 a[96:97], v9 offset:8192
  v_accvgpr_mov_b32 a184, a216
  v_mfma_f32_16x16x32_bf16 v[36:39], a[64:67], a[36:39], v[36:39]
  ds_read_b64_tr_b16 a[98:99], v9 offset:9088
  v_accvgpr_mov_b32 a185, a217
  v_mfma_f32_16x16x32_bf16 v[40:43], a[64:67], a[40:43], v[40:43]
  ds_read_b64_tr_b16 a[100:101], v9 offset:8224
  v_accvgpr_mov_b32 a186, a218
  v_mfma_f32_16x16x32_bf16 v[44:47], a[64:67], a[44:47], v[44:47]
  ds_read_b64_tr_b16 a[102:103], v9 offset:9120
  v_accvgpr_mov_b32 a187, a219
  v_mfma_f32_16x16x32_bf16 v[48:51], a[68:71], a[32:35], v[48:51]
  ds_read_b64_tr_b16 a[104:105], v9 offset:8256
  v_accvgpr_mov_b32 a188, a220
  v_mfma_f32_16x16x32_bf16 v[52:55], a[68:71], a[36:39], v[52:55]
  ds_read_b64_tr_b16 a[106:107], v9 offset:9152
  v_accvgpr_mov_b32 a189, a221
  v_mfma_f32_16x16x32_bf16 v[56:59], a[68:71], a[40:43], v[56:59]
  ds_read_b64_tr_b16 a[108:109], v9 offset:8288
  v_accvgpr_mov_b32 a190, a222
  v_mfma_f32_16x16x32_bf16 v[60:63], a[68:71], a[44:47], v[60:63]
  ds_read_b64_tr_b16 a[110:111], v9 offset:9184
  s_mov_b32 m0, s61
  v_mfma_f32_16x16x32_bf16 v[64:67], a[72:75], a[32:35], v[64:67]
  ds_read_b64_tr_b16 a[112:113], v9 offset:8320
  buffer_load_dwordx4 v10, s[44:47], s56 offen offset:0 lds
  v_mfma_f32_16x16x32_bf16 v[68:71], a[72:75], a[36:39], v[68:71]
  ds_read_b64_tr_b16 a[114:115], v9 offset:9216
  v_accvgpr_mov_b32 a191, a223
  v_mfma_f32_16x16x32_bf16 v[72:75], a[72:75], a[40:43], v[72:75]
  ds_read_b64_tr_b16 a[116:117], v9 offset:8352
  v_mfma_f32_16x16x32_bf16 v[76:79], a[72:75], a[44:47], v[76:79]
  ds_read_b64_tr_b16 a[118:119], v9 offset:9248
  v_mfma_f32_16x16x32_bf16 v[80:83], a[76:79], a[32:35], v[80:83]
  ds_read_b64_tr_b16 a[120:121], v9 offset:8384
  buffer_load_dwordx4 v11, s[44:47], s56 offen offset:1024 lds
  v_mfma_f32_16x16x32_bf16 v[84:87], a[76:79], a[36:39], v[84:87]
  ds_read_b64_tr_b16 a[122:123], v9 offset:9280
  v_mfma_f32_16x16x32_bf16 v[88:91], a[76:79], a[40:43], v[88:91]
  v_accvgpr_mov_b32 a216, a248
  v_mfma_f32_16x16x32_bf16 v[92:95], a[76:79], a[44:47], v[92:95]
  v_accvgpr_mov_b32 a217, a249
  v_mfma_f32_16x16x32_bf16 v[96:99], a[80:83], a[32:35], v[96:99]
  buffer_load_dwordx4 v12, s[44:47], s56 offen offset:2048 lds
  v_mfma_f32_16x16x32_bf16 v[100:103], a[80:83], a[36:39], v[100:103]
  v_accvgpr_mov_b32 a218, a250
  v_mfma_f32_16x16x32_bf16 v[104:107], a[80:83], a[40:43], v[104:107]
  v_accvgpr_mov_b32 a219, a251
  v_mfma_f32_16x16x32_bf16 v[108:111], a[80:83], a[44:47], v[108:111]
  v_accvgpr_mov_b32 a220, a252
  v_mfma_f32_16x16x32_bf16 v[112:115], a[84:87], a[32:35], v[112:115]
  buffer_load_dwordx4 v13, s[44:47], s56 offen offset:3072 lds
  v_mfma_f32_16x16x32_bf16 v[116:119], a[84:87], a[36:39], v[116:119]
  s_add_u32 s57, s56, s60
  s_add_u32 s56, s56, 128
  v_mfma_f32_16x16x32_bf16 v[120:123], a[84:87], a[40:43], v[120:123]
  buffer_store_dwordx4 a[128:131], v26, s[52:55], s26 offen offset:0 sc1
  v_mfma_f32_16x16x32_bf16 v[124:127], a[84:87], a[44:47], v[124:127]
  v_accvgpr_mov_b32 a221, a253
  v_mfma_f32_16x16x32_bf16 v[128:131], a[88:91], a[32:35], v[128:131]
  buffer_store_dwordx4 a[132:135], v26, s[52:55], s26 offen offset:1024 sc1
  v_mfma_f32_16x16x32_bf16 v[132:135], a[88:91], a[36:39], v[132:135]
  v_accvgpr_mov_b32 a222, a254
  v_mfma_f32_16x16x32_bf16 v[136:139], a[88:91], a[40:43], v[136:139]
  v_accvgpr_mov_b32 a223, a255
  v_mfma_f32_16x16x32_bf16 v[140:143], a[88:91], a[44:47], v[140:143]
  s_waitcnt vmcnt(22) lgkmcnt(0)
  s_barrier
  v_mfma_f32_16x16x32_bf16 v[144:147], a[96:99], a[32:35], v[144:147]
  ds_read_b128 a[48:51], v2 offset:0
  v_accvgpr_mov_b32 a128, a160
  v_mfma_f32_16x16x32_bf16 v[148:151], a[96:99], a[36:39], v[148:151]
  ds_read_b128 a[52:55], v2 offset:2048
  v_accvgpr_mov_b32 a129, a161
  v_mfma_f32_16x16x32_bf16 v[152:155], a[96:99], a[40:43], v[152:155]
  ds_read_b128 a[56:59], v2 offset:4096
  v_accvgpr_mov_b32 a130, a162
  v_mfma_f32_16x16x32_bf16 v[156:159], a[96:99], a[44:47], v[156:159]
  ds_read_b128 a[60:63], v2 offset:6144
  v_mfma_f32_16x16x32_bf16 v[160:163], a[100:103], a[32:35], v[160:163]
  ds_read_b64_tr_b16 a[64:65], v9 offset:16384
  v_mfma_f32_16x16x32_bf16 v[164:167], a[100:103], a[36:39], v[164:167]
  ds_read_b64_tr_b16 a[66:67], v9 offset:17280
  v_mfma_f32_16x16x32_bf16 v[168:171], a[100:103], a[40:43], v[168:171]
  ds_read_b64_tr_b16 a[68:69], v9 offset:16416
  v_mfma_f32_16x16x32_bf16 v[172:175], a[100:103], a[44:47], v[172:175]
  ds_read_b64_tr_b16 a[70:71], v9 offset:17312
  s_add_u32 m0, s64, 0
  v_mfma_f32_16x16x32_bf16 v[176:179], a[104:107], a[32:35], v[176:179]
  ds_read_b64_tr_b16 a[72:73], v9 offset:16448
  buffer_load_dwordx4 v14, s[48:51], s58 offen offset:0 lds
  v_mfma_f32_16x16x32_bf16 v[180:183], a[104:107], a[36:39], v[180:183]
  ds_read_b64_tr_b16 a[74:75], v9 offset:17344
  v_mfma_f32_16x16x32_bf16 v[184:187], a[104:107], a[40:43], v[184:187]
  ds_read_b64_tr_b16 a[76:77], v9 offset:16480
  v_mfma_f32_16x16x32_bf16 v[188:191], a[104:107], a[44:47], v[188:191]
  ds_read_b64_tr_b16 a[78:79], v9 offset:17376
  v_mfma_f32_16x16x32_bf16 v[192:195], a[108:111], a[32:35], v[192:195]
  ds_read_b64_tr_b16 a[80:81], v9 offset:16512
  buffer_load_dwordx4 v15, s[48:51], s58 offen offset:1024 lds
  v_mfma_f32_16x16x32_bf16 v[196:199], a[108:111], a[36:39], v[196:199]
  ds_read_b64_tr_b16 a[82:83], v9 offset:17408
  v_mfma_f32_16x16x32_bf16 v[200:203], a[108:111], a[40:43], v[200:203]
  ds_read_b64_tr_b16 a[84:85], v9 offset:16544
  v_mfma_f32_16x16x32_bf16 v[204:207], a[108:111], a[44:47], v[204:207]
  ds_read_b64_tr_b16 a[86:87], v9 offset:17440
  v_mfma_f32_16x16x32_bf16 v[208:211], a[112:115], a[32:35], v[208:211]
  ds_read_b64_tr_b16 a[88:89], v9 offset:16576
  buffer_load_dwordx4 v16, s[48:51], s58 offen offset:2048 lds
  v_mfma_f32_16x16x32_bf16 v[212:215], a[112:115], a[36:39], v[212:215]
  ds_read_b64_tr_b16 a[90:91], v9 offset:17472
  s_add_u32 s72, s72, 1
  v_mfma_f32_16x16x32_bf16 v[216:219], a[112:115], a[40:43], v[216:219]
  s_cmp_eq_u32 s72, 3
  s_cselect_b32 s73, s75, s74
  s_cselect_b32 s72, 0, s72
  v_mfma_f32_16x16x32_bf16 v[220:223], a[112:115], a[44:47], v[220:223]
  v_accvgpr_mov_b32 a131, a163
  v_mfma_f32_16x16x32_bf16 v[224:227], a[116:119], a[32:35], v[224:227]
  buffer_load_dwordx4 v17, s[48:51], s58 offen offset:3072 lds
  v_mfma_f32_16x16x32_bf16 v[228:231], a[116:119], a[36:39], v[228:231]
  s_add_u32 s58, s58, s59
  v_mfma_f32_16x16x32_bf16 v[232:235], a[116:119], a[40:43], v[232:235]
  v_accvgpr_mov_b32 a132, a164
  v_mfma_f32_16x16x32_bf16 v[236:239], a[116:119], a[44:47], v[236:239]
  v_accvgpr_mov_b32 a133, a165
  v_mfma_f32_16x16x32_bf16 v[240:243], a[120:123], a[32:35], v[240:243]
  v_add_u32 v1, s73, v1
  v_add_u32 v2, s73, v2
  v_mfma_f32_16x16x32_bf16 v[244:247], a[120:123], a[36:39], v[244:247]
  v_accvgpr_mov_b32 a134, a166
  v_mfma_f32_16x16x32_bf16 v[248:251], a[120:123], a[40:43], v[248:251]
  v_accvgpr_mov_b32 a135, a167
  v_mfma_f32_16x16x32_bf16 v[252:255], a[120:123], a[44:47], v[252:255]
mk_ga_entry:
  s_waitcnt lgkmcnt(0)
  v_mfma_f32_16x16x32_bf16 v[32:35], a[64:67], a[48:51], v[32:35]
  ds_read_b64_tr_b16 a[96:97], v9 offset:24576
  v_accvgpr_mov_b32 a160, a192
  v_mfma_f32_16x16x32_bf16 v[36:39], a[64:67], a[52:55], v[36:39]
  ds_read_b64_tr_b16 a[98:99], v9 offset:25472
  v_accvgpr_mov_b32 a161, a193
  v_mfma_f32_16x16x32_bf16 v[40:43], a[64:67], a[56:59], v[40:43]
  ds_read_b64_tr_b16 a[100:101], v9 offset:24608
  v_accvgpr_mov_b32 a162, a194
  v_mfma_f32_16x16x32_bf16 v[44:47], a[64:67], a[60:63], v[44:47]
  ds_read_b64_tr_b16 a[102:103], v9 offset:25504
  v_accvgpr_mov_b32 a163, a195
  v_mfma_f32_16x16x32_bf16 v[48:51], a[68:71], a[48:51], v[48:51]
  ds_read_b64_tr_b16 a[104:105], v9 offset:24640
  v_accvgpr_mov_b32 a164, a196
  v_mfma_f32_16x16x32_bf16 v[52:55], a[68:71], a[52:55], v[52:55]
  ds_read_b64_tr_b16 a[106:107], v9 offset:25536
  v_accvgpr_mov_b32 a165, a197
  v_mfma_f32_16x16x32_bf16 v[56:59], a[68:71], a[56:59], v[56:59]
  ds_read_b64_tr_b16 a[108:109], v9 offset:24672
  v_accvgpr_mov_b32 a166, a198
  v_mfma_f32_16x16x32_bf16 v[60:63], a[68:71], a[60:63], v[60:63]
  ds_read_b64_tr_b16 a[110:111], v9 offset:25568
  s_add_u32 m0, s61, 4096
  v_mfma_f32_16x16x32_bf16 v[64:67], a[72:75], a[48:51], v[64:67]
  ds_read_b64_tr_b16 a[112:113], v9 offset:24704
  buffer_load_dwordx4 v10, s[44:47], s57 offen offset:0 lds
  v_mfma_f32_16x16x32_bf16 v[68:71], a[72:75], a[52:55], v[68:71]
  ds_read_b64_tr_b16 a[114:115], v9 offset:25600
  v_accvgpr_mov_b32 a167, a199
  v_mfma_f32_16x16x32_bf16 v[72:75], a[72:75], a[56:59], v[72:75]
  ds_read_b64_tr_b16 a[116:117], v9 offset:24736
  v_mfma_f32_16x16x32_bf16 v[76:79], a[72:75], a[60:63], v[76:79]
  ds_read_b64_tr_b16 a[118:119], v9 offset:25632
  v_mfma_f32_16x16x32_bf16 v[80:83], a[76:79], a[48:51], v[80:83]
  ds_read_b64_tr_b16 a[120:121], v9 offset:24768
  buffer_load_dwordx4 v11, s[44:47], s57 offen offset:1024 lds
  v_mfma_f32_16x16x32_bf16 v[84:87], a[76:79], a[52:55], v[84:87]
  ds_read_b64_tr_b16 a[122:123], v9 offset:25664
  v_mfma_f32_16x16x32_bf16 v[88:91], a[76:79], a[56:59], v[88:91]
  v_accvgpr_mov_b32 a192, a224
  v_mfma_f32_16x16x32_bf16 v[92:95], a[76:79], a[60:63], v[92:95]
  v_accvgpr_mov_b32 a193, a225
  v_mfma_f32_16x16x32_bf16 v[96:99], a[80:83], a[48:51], v[96:99]
  buffer_load_dwordx4 v12, s[44:47], s57 offen offset:2048 lds
  v_mfma_f32_16x16x32_bf16 v[100:103], a[80:83], a[52:55], v[100:103]
  v_accvgpr_mov_b32 a194, a226
  v_mfma_f32_16x16x32_bf16 v[104:107], a[80:83], a[56:59], v[104:107]
  v_accvgpr_mov_b32 a195, a227
  v_mfma_f32_16x16x32_bf16 v[108:111], a[80:83], a[60:63], v[108:111]
  v_accvgpr_mov_b32 a196, a228
  v_mfma_f32_16x16x32_bf16 v[112:115], a[84:87], a[48:51], v[112:115]
  buffer_load_dwordx4 v13, s[44:47], s57 offen offset:3072 lds
  v_mfma_f32_16x16x32_bf16 v[116:119], a[84:87], a[52:55], v[116:119]
  s_add_u32 s61, s61, 8192
  s_cmp_eq_u32 s61, s63
  s_cselect_b32 s61, s62, s61
  v_mfma_f32_16x16x32_bf16 v[120:123], a[84:87], a[56:59], v[120:123]
  buffer_store_dwordx4 a[136:139], v26, s[52:55], s26 offen offset:2048 sc1
  v_mfma_f32_16x16x32_bf16 v[124:127], a[84:87], a[60:63], v[124:127]
  v_accvgpr_mov_b32 a197, a229
  v_mfma_f32_16x16x32_bf16 v[128:131], a[88:91], a[48:51], v[128:131]
  buffer_store_dwordx4 a[140:143], v26, s[52:55], s26 offen offset:3072 sc1
  v_mfma_f32_16x16x32_bf16 v[132:135], a[88:91], a[52:55], v[132:135]
  v_accvgpr_mov_b32 a198, a230
  v_mfma_f32_16x16x32_bf16 v[136:139], a[88:91], a[56:59], v[136:139]
  v_accvgpr_mov_b32 a199, a231
  v_mfma_f32_16x16x32_bf16 v[140:143], a[88:91], a[60:63], v[140:143]
  s_waitcnt vmcnt(22) lgkmcnt(0)
  s_barrier
  v_mfma_f32_16x16x32_bf16 v[144:147], a[96:99], a[48:51], v[144:147]
  ds_read_b128 a[32:35], v1 offset:0
  v_accvgpr_mov_b32 a136, a168
  v_mfma_f32_16x16x32_bf16 v[148:151], a[96:99], a[52:55], v[148:151]
  ds_read_b128 a[36:39], v1 offset:2048
  v_mfma_f32_16x16x32_bf16 v[152:155], a[96:99], a[56:59], v[152:155]
  ds_read_b128 a[40:43], v1 offset:4096
  v_mfma_f32_16x16x32_bf16 v[156:159], a[96:99], a[60:63], v[156:159]
  ds_read_b128 a[44:47], v1 offset:6144
  v_mfma_f32_16x16x32_bf16 v[160:163], a[100:103], a[48:51], v[160:163]
  ds_read_b64_tr_b16 a[64:65], v9 offset:32768
  v_mfma_f32_16x16x32_bf16 v[164:167], a[100:103], a[52:55], v[164:167]
  ds_read_b64_tr_b16 a[66:67], v9 offset:33664
  v_mfma_f32_16x16x32_bf16 v[168:171], a[100:103], a[56:59], v[168:171]
  ds_read_b64_tr_b16 a[68:69], v9 offset:32800
  v_mfma_f32_16x16x32_bf16 v[172:175], a[100:103], a[60:63], v[172:175]
  ds_read_b64_tr_b16 a[70:71], v9 offset:33696
  s_add_u32 m0, s64, 16384
  v_mfma_f32_16x16x32_bf16 v[176:179], a[104:107], a[48:51], v[176:179]
  ds_read_b64_tr_b16 a[72:73], v9 offset:32832
  buffer_load_dwordx4 v14, s[48:51], s58 offen offset:0 lds
  v_mfma_f32_16x16x32_bf16 v[180:183], a[104:107], a[52:55], v[180:183]
  ds_read_b64_tr_b16 a[74:75], v9 offset:33728
  v_mfma_f32_16x16x32_bf16 v[184:187], a[104:107], a[56:59], v[184:187]
  ds_read_b64_tr_b16 a[76:77], v9 offset:32864
  v_mfma_f32_16x16x32_bf16 v[188:191], a[104:107], a[60:63], v[188:191]
  ds_read_b64_tr_b16 a[78:79], v9 offset:33760
  v_mfma_f32_16x16x32_bf16 v[192:195], a[108:111], a[48:51], v[192:195]
  ds_read_b64_tr_b16 a[80:81], v9 offset:32896
  buffer_load_dwordx4 v15, s[48:51], s58 offen offset:1024 lds
  v_mfma_f32_16x16x32_bf16 v[196:199], a[108:111], a[52:55], v[196:199]
  ds_read_b64_tr_b16 a[82:83], v9 offset:33792
  v_mfma_f32_16x16x32_bf16 v[200:203], a[108:111], a[56:59], v[200:203]
  ds_read_b64_tr_b16 a[84:85], v9 offset:32928
  v_mfma_f32_16x16x32_bf16 v[204:207], a[108:111], a[60:63], v[204:207]
  ds_read_b64_tr_b16 a[86:87], v9 offset:33824
  v_mfma_f32_16x16x32_bf16 v[208:211], a[112:115], a[48:51], v[208:211]
  ds_read_b64_tr_b16 a[88:89], v9 offset:32960
  buffer_load_dwordx4 v16, s[48:51], s58 offen offset:2048 lds
  v_mfma_f32_16x16x32_bf16 v[212:215], a[112:115], a[52:55], v[212:215]
  ds_read_b64_tr_b16 a[90:91], v9 offset:33856
  v_mfma_f32_16x16x32_bf16 v[216:219], a[112:115], a[56:59], v[216:219]
  v_accvgpr_mov_b32 a137, a169
  v_mfma_f32_16x16x32_bf16 v[220:223], a[112:115], a[60:63], v[220:223]
  v_accvgpr_mov_b32 a138, a170
  v_mfma_f32_16x16x32_bf16 v[224:227], a[116:119], a[48:51], v[224:227]
  buffer_load_dwordx4 v17, s[48:51], s58 offen offset:3072 lds
  v_mfma_f32_16x16x32_bf16 v[228:231], a[116:119], a[52:55], v[228:231]
  s_add_u32 s58, s58, s59
  v_mfma_f32_16x16x32_bf16 v[232:235], a[116:119], a[56:59], v[232:235]
  v_accvgpr_mov_b32 a139, a171
  v_mfma_f32_16x16x32_bf16 v[236:239], a[116:119], a[60:63], v[236:239]
  v_accvgpr_mov_b32 a140, a172
  v_mfma_f32_16x16x32_bf16 v[240:243], a[120:123], a[48:51], v[240:243]
  v_accvgpr_mov_b32 a141, a173
  v_mfma_f32_16x16x32_bf16 v[244:247], a[120:123], a[52:55], v[244:247]
  v_accvgpr_mov_b32 a142, a174
  v_mfma_f32_16x16x32_bf16 v[248:251], a[120:123], a[56:59], v[248:251]
  v_accvgpr_mov_b32 a143, a175
  v_mfma_f32_16x16x32_bf16 v[252:255], a[120:123], a[60:63], v[252:255]
  s_waitcnt lgkmcnt(0)
  v_mfma_f32_16x16x32_bf16 v[32:35], a[64:67], a[32:35], v[32:35]
  ds_read_b64_tr_b16 a[96:97], v9 offset:40960
  v_accvgpr_mov_b32 a168, a200
  v_mfma_f32_16x16x32_bf16 v[36:39], a[64:67], a[36:39], v[36:39]
  ds_read_b64_tr_b16 a[98:99], v9 offset:41856
  v_accvgpr_mov_b32 a169, a201
  v_mfma_f32_16x16x32_bf16 v[40:43], a[64:67], a[40:43], v[40:43]
  ds_read_b64_tr_b16 a[100:101], v9 offset:40992
  v_accvgpr_mov_b32 a170, a202
  v_mfma_f32_16x16x32_bf16 v[44:47], a[64:67], a[44:47], v[44:47]
  ds_read_b64_tr_b16 a[102:103], v9 offset:41888
  v_accvgpr_mov_b32 a171, a203
  v_mfma_f32_16x16x32_bf16 v[48:51], a[68:71], a[32:35], v[48:51]
  ds_read_b64_tr_b16 a[104:105], v9 offset:41024
  v_accvgpr_mov_b32 a172, a204
  v_mfma_f32_16x16x32_bf16 v[52:55], a[68:71], a[36:39], v[52:55]
  ds_read_b64_tr_b16 a[106:107], v9 offset:41920
  v_accvgpr_mov_b32 a173, a205
  v_mfma_f32_16x16x32_bf16 v[56:59], a[68:71], a[40:43], v[56:59]
  ds_read_b64_tr_b16 a[108:109], v9 offset:41056
  v_accvgpr_mov_b32 a174, a206
  v_mfma_f32_16x16x32_bf16 v[60:63], a[68:71], a[44:47], v[60:63]
  ds_read_b64_tr_b16 a[110:111], v9 offset:41952
  s_mov_b32 m0, s61
  v_mfma_f32_16x16x32_bf16 v[64:67], a[72:75], a[32:35], v[64:67]
  ds_read_b64_tr_b16 a[112:113], v9 offset:41088
  buffer_load_dwordx4 v10, s[44:47], s56 offen offset:0 lds
  v_mfma_f32_16x16x32_bf16 v[68:71], a[72:75], a[36:39], v[68:71]
  ds_read_b64_tr_b16 a[114:115], v9 offset:41984
  v_accvgpr_mov_b32 a175, a207
  v_mfma_f32_16x16x32_bf16 v[72:75], a[72:75], a[40:43], v[72:75]
  ds_read_b64_tr_b16 a[116:117], v9 offset:41120
  v_mfma_f32_16x16x32_bf16 v[76:79], a[72:75], a[44:47], v[76:79]
  ds_read_b64_tr_b16 a[118:119], v9 offset:42016
  v_mfma_f32_16x16x32_bf16 v[80:83], a[76:79], a[32:35], v[80:83]
  ds_read_b64_tr_b16 a[120:121], v9 offset:41152
  buffer_load_dwordx4 v11, s[44:47], s56 offen offset:1024 lds
  v_mfma_f32_16x16x32_bf16 v[84:87], a[76:79], a[36:39], v[84:87]
  ds_read_b64_tr_b16 a[122:123], v9 offset:42048
  v_mfma_f32_16x16x32_bf16 v[88:91], a[76:79], a[40:43], v[88:91]
  v_accvgpr_mov_b32 a200, a232
  v_mfma_f32_16x16x32_bf16 v[92:95], a[76:79], a[44:47], v[92:95]
  v_accvgpr_mov_b32 a201, a233
  v_mfma_f32_16x16x32_bf16 v[96:99], a[80:83], a[32:35], v[96:99]
  buffer_load_dwordx4 v12, s[44:47], s56 offen offset:2048 lds
  v_mfma_f32_16x16x32_bf16 v[100:103], a[80:83], a[36:39], v[100:103]
  v_accvgpr_mov_b32 a202, a234
  v_mfma_f32_16x16x32_bf16 v[104:107], a[80:83], a[40:43], v[104:107]
  v_accvgpr_mov_b32 a203, a235
  v_mfma_f32_16x16x32_bf16 v[108:111], a[80:83], a[44:47], v[108:111]
  v_accvgpr_mov_b32 a204, a236
  v_mfma_f32_16x16x32_bf16 v[112:115], a[84:87], a[32:35], v[112:115]
  buffer_load_dwordx4 v13, s[44:47], s56 offen offset:3072 lds
  v_mfma_f32_16x16x32_bf16 v[116:119], a[84:87], a[36:39], v[116:119]
  s_add_u32 s57, s56, s60
  s_add_u32 s56, s56, 128
  v_mfma_f32_16x16x32_bf16 v[120:123], a[84:87], a[40:43], v[120:123]
  buffer_store_dwordx4 a[144:147], v26, s[52:55], s27 offen offset:0 sc1
  v_mfma_f32_16x16x32_bf16 v[124:127], a[84:87], a[44:47], v[124:127]
  v_accvgpr_mov_b32 a205, a237
  v_mfma_f32_16x16x32_bf16 v[128:131], a[88:91], a[32:35], v[128:131]
  buffer_store_dwordx4 a[148:151], v26, s[52:55], s27 offen offset:1024 sc1
  v_mfma_f32_16x16x32_bf16 v[132:135], a[88:91], a[36:39], v[132:135]
  v_accvgpr_mov_b32 a206, a238
  v_mfma_f32_16x16x32_bf16 v[136:139], a[88:91], a[40:43], v[136:139]
  v_accvgpr_mov_b32 a207, a239
  v_mfma_f32_16x16x32_bf16 v[140:143], a[88:91], a[44:47], v[140:143]
  s_waitcnt vmcnt(22) lgkmcnt(0)
  s_barrier
  v_mfma_f32_16x16x32_bf16 v[144:147], a[96:99], a[32:35], v[144:147]
  ds_read_b128 a[48:51], v2 offset:0
  v_accvgpr_mov_b32 a144, a176
  v_mfma_f32_16x16x32_bf16 v[148:151], a[96:99], a[36:39], v[148:151]
  ds_read_b128 a[52:55], v2 offset:2048
  v_accvgpr_mov_b32 a145, a177
  v_mfma_f32_16x16x32_bf16 v[152:155], a[96:99], a[40:43], v[152:155]
  ds_read_b128 a[56:59], v2 offset:4096
  v_accvgpr_mov_b32 a146, a178
  v_mfma_f32_16x16x32_bf16 v[156:159], a[96:99], a[44:47], v[156:159]
  ds_read_b128 a[60:63], v2 offset:6144
  v_mfma_f32_16x16x32_bf16 v[160:163], a[100:103], a[32:35], v[160:163]
  ds_read_b64_tr_b16 a[64:65], v9 offset:49152
  v_mfma_f32_16x16x32_bf16 v[164:167], a[100:103], a[36:39], v[164:167]
  ds_read_b64_tr_b16 a[66:67], v9 offset:50048
  v_mfma_f32_16x16x32_bf16 v[168:171], a[100:103], a[40:43], v[168:171]
  ds_read_b64_tr_b16 a[68:69], v9 offset:49184
  v_mfma_f32_16x16x32_bf16 v[172:175], a[100:103], a[44:47], v[172:175]
  ds_read_b64_tr_b16 a[70:71], v9 offset:50080
  s_add_u32 m0, s64, 32768
  v_mfma_f32_16x16x32_bf16 v[176:179], a[104:107], a[32:35], v[176:179]
  ds_read_b64_tr_b16 a[72:73], v9 offset:49216
  buffer_load_dwordx4 v14, s[48:51], s58 offen offset:0 lds
  v_mfma_f32_16x16x32_bf16 v[180:183], a[104:107], a[36:39], v[180:183]
  ds_read_b64_tr_b16 a[74:75], v9 offset:50112
  v_mfma_f32_16x16x32_bf16 v[184:187], a[104:107], a[40:43], v[184:187]
  ds_read_b64_tr_b16 a[76:77], v9 offset:49248
  v_mfma_f32_16x16x32_bf16 v[188:191], a[104:107], a[44:47], v[188:191]
  ds_read_b64_tr_b16 a[78:79], v9 offset:50144
  v_mfma_f32_16x16x32_bf16 v[192:195], a[108:111], a[32:35], v[192:195]
  ds_read_b64_tr_b16 a[80:81], v9 offset:49280
  buffer_load_dwordx4 v15, s[48:51], s58 offen offset:1024 lds
  v_mfma_f32_16x16x32_bf16 v[196:199], a[108:111], a[36:39], v[196:199]
  ds_read_b64_tr_b16 a[82:83], v9 offset:50176
  v_mfma_f32_16x16x32_bf16 v[200:203], a[108:111], a[40:43], v[200:203]
  ds_read_b64_tr_b16 a[84:85], v9 offset:49312
  v_mfma_f32_16x16x32_bf16 v[204:207], a[108:111], a[44:47], v[204:207]
  ds_read_b64_tr_b16 a[86:87], v9 offset:50208
  v_mfma_f32_16x16x32_bf16 v[208:211], a[112:115], a[32:35], v[208:211]
  ds_read_b64_tr_b16 a[88:89], v9 offset:49344
  buffer_load_dwordx4 v16, s[48:51], s58 offen offset:2048 lds
  v_mfma_f32_16x16x32_bf16 v[212:215], a[112:115], a[36:39], v[212:215]
  ds_read_b64_tr_b16 a[90:91], v9 offset:50240
  s_add_u32 s72, s72, 1
  v_mfma_f32_16x16x32_bf16 v[216:219], a[112:115], a[40:43], v[216:219]
  s_cmp_eq_u32 s72, 3
  s_cselect_b32 s73, s75, s74
  s_cselect_b32 s72, 0, s72
  v_mfma_f32_16x16x32_bf16 v[220:223], a[112:115], a[44:47], v[220:223]
  v_accvgpr_mov_b32 a147, a179
  v_mfma_f32_16x16x32_bf16 v[224:227], a[116:119], a[32:35], v[224:227]
  buffer_load_dwordx4 v17, s[48:51], s58 offen offset:3072 lds
  v_mfma_f32_16x16x32_bf16 v[228:231], a[116:119], a[36:39], v[228:231]
  s_add_u32 s58, s58, s59
  v_mfma_f32_16x16x32_bf16 v[232:235], a[116:119], a[40:43], v[232:235]
  v_accvgpr_mov_b32 a148, a180
  v_mfma_f32_16x16x32_bf16 v[236:239], a[116:119], a[44:47], v[236:239]
  v_accvgpr_mov_b32 a149, a181
  v_mfma_f32_16x16x32_bf16 v[240:243], a[120:123], a[32:35], v[240:243]
  v_add_u32 v1, s73, v1
  v_add_u32 v2, s73, v2
  v_mfma_f32_16x16x32_bf16 v[244:247], a[120:123], a[36:39], v[244:247]
  v_accvgpr_mov_b32 a150, a182
  v_mfma_f32_16x16x32_bf16 v[248:251], a[120:123], a[40:43], v[248:251]
  v_accvgpr_mov_b32 a151, a183
  v_mfma_f32_16x16x32_bf16 v[252:255], a[120:123], a[44:47], v[252:255]
  s_waitcnt lgkmcnt(0)
  v_mfma_f32_16x16x32_bf16 v[32:35], a[64:67], a[48:51], v[32:35]
  ds_read_b64_tr_b16 a[96:97], v9 offset:57344
  v_accvgpr_mov_b32 a176, a208
  v_mfma_f32_16x16x32_bf16 v[36:39], a[64:67], a[52:55], v[36:39]
  ds_read_b64_tr_b16 a[98:99], v9 offset:58240
  v_accvgpr_mov_b32 a177, a209
  v_mfma_f32_16x16x32_bf16 v[40:43], a[64:67], a[56:59], v[40:43]
  ds_read_b64_tr_b16 a[100:101], v9 offset:57376
  v_accvgpr_mov_b32 a178, a210
  v_mfma_f32_16x16x32_bf16 v[44:47], a[64:67], a[60:63], v[44:47]
  ds_read_b64_tr_b16 a[102:103], v9 offset:58272
  v_accvgpr_mov_b32 a179, a211
  v_mfma_f32_16x16x32_bf16 v[48:51], a[68:71], a[48:51], v[48:51]
  ds_read_b64_tr_b16 a[104:105], v9 offset:57408
  v_accvgpr_mov_b32 a180, a212
  v_mfma_f32_16x16x32_bf16 v[52:55], a[68:71], a[52:55], v[52:55]
  ds_read_b64_tr_b16 a[106:107], v9 offset:58304
  v_accvgpr_mov_b32 a181, a213
  v_mfma_f32_16x16x32_bf16 v[56:59], a[68:71], a[56:59], v[56:59]
  ds_read_b64_tr_b16 a[108:109], v9 offset:57440
  v_accvgpr_mov_b32 a182, a214
  v_mfma_f32_16x16x32_bf16 v[60:63], a[68:71], a[60:63], v[60:63]
  ds_read_b64_tr_b16 a[110:111], v9 offset:58336
  s_add_u32 m0, s61, 4096
  v_mfma_f32_16x16x32_bf16 v[64:67], a[72:75], a[48:51], v[64:67]
  ds_read_b64_tr_b16 a[112:113], v9 offset:57472
  buffer_load_dwordx4 v10, s[44:47], s57 offen offset:0 lds
  v_mfma_f32_16x16x32_bf16 v[68:71], a[72:75], a[52:55], v[68:71]
  ds_read_b64_tr_b16 a[114:115], v9 offset:58368
  v_accvgpr_mov_b32 a183, a215
  v_mfma_f32_16x16x32_bf16 v[72:75], a[72:75], a[56:59], v[72:75]
  ds_read_b64_tr_b16 a[116:117], v9 offset:57504
  v_mfma_f32_16x16x32_bf16 v[76:79], a[72:75], a[60:63], v[76:79]
  ds_read_b64_tr_b16 a[118:119], v9 offset:58400
  v_mfma_f32_16x16x32_bf16 v[80:83], a[76:79], a[48:51], v[80:83]
  ds_read_b64_tr_b16 a[120:121], v9 offset:57536
  buffer_load_dwordx4 v11, s[44:47], s57 offen offset:1024 lds
  v_mfma_f32_16x16x32_bf16 v[84:87], a[76:79], a[52:55], v[84:87]
  ds_read_b64_tr_b16 a[122:123], v9 offset:58432
  v_mfma_f32_16x16x32_bf16 v[88:91], a[76:79], a[56:59], v[88:91]
  v_accvgpr_mov_b32 a208, a240
  v_mfma_f32_16x16x32_bf16 v[92:95], a[76:79], a[60:63], v[92:95]
  v_accvgpr_mov_b32 a209, a241
  v_mfma_f32_16x16x32_bf16 v[96:99], a[80:83], a[48:51], v[96:99]
  buffer_load_dwordx4 v12, s[44:47], s57 offen offset:2048 lds
  v_mfma_f32_16x16x32_bf16 v[100:103], a[80:83], a[52:55], v[100:103]
  v_accvgpr_mov_b32 a210, a242
  v_mfma_f32_16x16x32_bf16 v[104:107], a[80:83], a[56:59], v[104:107]
  v_accvgpr_mov_b32 a211, a243
  v_mfma_f32_16x16x32_bf16 v[108:111], a[80:83], a[60:63], v[108:111]
  v_accvgpr_mov_b32 a212, a244
  v_mfma_f32_16x16x32_bf16 v[112:115], a[84:87], a[48:51], v[112:115]
  buffer_load_dwordx4 v13, s[44:47], s57 offen offset:3072 lds
  v_mfma_f32_16x16x32_bf16 v[116:119], a[84:87], a[52:55], v[116:119]
  s_add_u32 s61, s61, 8192
  s_cmp_eq_u32 s61, s63
  s_cselect_b32 s61, s62, s61
  v_mfma_f32_16x16x32_bf16 v[120:123], a[84:87], a[56:59], v[120:123]
  buffer_store_dwordx4 a[152:155], v26, s[52:55], s27 offen offset:2048 sc1
  v_mfma_f32_16x16x32_bf16 v[124:127], a[84:87], a[60:63], v[124:127]
  v_accvgpr_mov_b32 a213, a245
  v_mfma_f32_16x16x32_bf16 v[128:131], a[88:91], a[48:51], v[128:131]
  buffer_store_dwordx4 a[156:159], v26, s[52:55], s27 offen offset:3072 sc1
  v_mfma_f32_16x16x32_bf16 v[132:135], a[88:91], a[52:55], v[132:135]
  v_accvgpr_mov_b32 a214, a246
  v_mfma_f32_16x16x32_bf16 v[136:139], a[88:91], a[56:59], v[136:139]
  v_accvgpr_mov_b32 a215, a247
  v_mfma_f32_16x16x32_bf16 v[140:143], a[88:91], a[60:63], v[140:143]
  s_sub_u32 s66, s66, 1
  s_cmp_lg_u32 s66, 4
  s_cbranch_scc1 mk_ga_top
.p2align 6
mk_gb_top:
  s_waitcnt vmcnt(16) lgkmcnt(0)
  s_barrier
  v_mfma_f32_16x16x32_bf16 v[144:147], a[96:99], a[48:51], v[144:147]
  ds_read_b128 a[32:35], v1 offset:0
  v_mfma_f32_16x16x32_bf16 v[148:151], a[96:99], a[52:55], v[148:151]
  ds_read_b128 a[36:39], v1 offset:2048
  v_mfma_f32_16x16x32_bf16 v[152:155], a[96:99], a[56:59], v[152:155]
  ds_read_b128 a[40:43], v1 offset:4096
  v_mfma_f32_16x16x32_bf16 v[156:159], a[96:99], a[60:63], v[156:159]
  ds_read_b128 a[44:47], v1 offset:6144
  v_mfma_f32_16x16x32_bf16 v[160:163], a[100:103], a[48:51], v[160:163]
  ds_read_b64_tr_b16 a[64:65], v9 offset:0
  v_mfma_f32_16x16x32_bf16 v[164:167], a[100:103], a[52:55], v[164:167]
  ds_read_b64_tr_b16 a[66:67], v9 offset:896
  v_mfma_f32_16x16x32_bf16 v[168:171], a[100:103], a[56:59], v[168:171]
  ds_read_b64_tr_b16 a[68:69], v9 offset:32
  v_mfma_f32_16x16x32_bf16 v[172:175], a[100:103], a[60:63], v[172:175]
  ds_read_b64_tr_b16 a[70:71], v9 offset:928
  s_add_u32 m0, s64, 49152
  v_mfma_f32_16x16x32_bf16 v[176:179], a[104:107], a[48:51], v[176:179]
  ds_read_b64_tr_b16 a[72:73], v9 offset:64
  buffer_load_dwordx4 v14, s[48:51], s58 offen offset:0 lds
  v_mfma_f32_16x16x32_bf16 v[180:183], a[104:107], a[52:55], v[180:183]
  ds_read_b64_tr_b16 a[74:75], v9 offset:960
  v_mfma_f32_16x16x32_bf16 v[184:187], a[104:107], a[56:59], v[184:187]
  ds_read_b64_tr_b16 a[76:77], v9 offset:96
  v_mfma_f32_16x16x32_bf16 v[188:191], a[104:107], a[60:63], v[188:191]
  ds_read_b64_tr_b16 a[78:79], v9 offset:992
  v_mfma_f32_16x16x32_bf16 v[192:195], a[108:111], a[48:51], v[192:195]
  ds_read_b64_tr_b16 a[80:81], v9 offset:128
  buffer_load_dwordx4 v15, s[48:51], s58 offen offset:1024 lds
  v_mfma_f32_16x16x32_bf16 v[196:199], a[108:111], a[52:55], v[196:199]
  ds_read_b64_tr_b16 a[82:83], v9 offset:1024
  v_mfma_f32_16x16x32_bf16 v[200:203], a[108:111], a[56:59], v[200:203]
  ds_read_b64_tr_b16 a[84:85], v9 offset:160
  v_mfma_f32_16x16x32_bf16 v[204:207], a[108:111], a[60:63], v[204:207]
  ds_read_b64_tr_b16 a[86:87], v9 offset:1056
  v_mfma_f32_16x16x32_bf16 v[208:211], a[112:115], a[48:51], v[208:211]
  ds_read_b64_tr_b16 a[88:89], v9 offset:192
  buffer_load_dwordx4 v16, s[48:51], s58 offen offset:2048 lds
  v_mfma_f32_16x16x32_bf16 v[212:215], a[112:115], a[52:55], v[212:215]
  ds_read_b64_tr_b16 a[90:91], v9 offset:1088
  v_mfma_f32_16x16x32_bf16 v[216:219], a[112:115], a[56:59], v[216:219]
  v_mfma_f32_16x16x32_bf16 v[220:223], a[112:115], a[60:63], v[220:223]
  v_mfma_f32_16x16x32_bf16 v[224:227], a[116:119], a[48:51], v[224:227]
  buffer_load_dwordx4 v17, s[48:51], s58 offen offset:3072 lds
  v_mfma_f32_16x16x32_bf16 v[228:231], a[116:119], a[52:55], v[228:231]
  s_add_u32 s58, s58, s59
  v_mfma_f32_16x16x32_bf16 v[232:235], a[116:119], a[56:59], v[232:235]
  v_mfma_f32_16x16x32_bf16 v[236:239], a[116:119], a[60:63], v[236:239]
  v_mfma_f32_16x16x32_bf16 v[240:243], a[120:123], a[48:51], v[240:243]
  v_mfma_f32_16x16x32_bf16 v[244:247], a[120:123], a[52:55], v[244:247]
  v_mfma_f32_16x16x32_bf16 v[248:251], a[120:123], a[56:59], v[248:251]
  v_mfma_f32_16x16x32_bf16 v[252:255], a[120:123], a[60:63], v[252:255]
  s_cmp_lg_u32 s66, 1
  s_cbranch_scc1 mk_gb_nsx
  s_mov_b32 s44, s81
  s_mov_b32 s45, s82
  s_mov_b32 s46, s83
  s_mov_b32 s56, s84
  s_mov_b32 s60, s85
mk_gb_nsx:
  s_waitcnt lgkmcnt(0)
  v_mfma_f32_16x16x32_bf16 v[32:35], a[64:67], a[32:35], v[32:35]
  ds_read_b64_tr_b16 a[96:97], v9 offset:8192
  v_mfma_f32_16x16x32_bf16 v[36:39], a[64:67], a[36:39], v[36:39]
  ds_read_b64_tr_b16 a[98:99], v9 offset:9088
  v_mfma_f32_16x16x32_bf16 v[40:43], a[64:67], a[40:43], v[40:43]
  ds_read_b64_tr_b16 a[100:101], v9 offset:8224
  v_mfma_f32_16x16x32_bf16 v[44:47], a[64:67], a[44:47], v[44:47]
  ds_read_b64_tr_b16 a[102:103], v9 offset:9120
  v_mfma_f32_16x16x32_bf16 v[48:51], a[68:71], a[32:35], v[48:51]
  ds_read_b64_tr_b16 a[104:105], v9 offset:8256
  v_mfma_f32_16x16x32_bf16 v[52:55], a[68:71], a[36:39], v[52:55]
  ds_read_b64_tr_b16 a[106:107], v9 offset:9152
  v_mfma_f32_16x16x32_bf16 v[56:59], a[68:71], a[40:43], v[56:59]
  ds_read_b64_tr_b16 a[108:109], v9 offset:8288
  v_mfma_f32_16x16x32_bf16 v[60:63], a[68:71], a[44:47], v[60:63]
  ds_read_b64_tr_b16 a[110:111], v9 offset:9184
  s_mov_b32 m0, s61
  v_mfma_f32_16x16x32_bf16 v[64:67], a[72:75], a[32:35], v[64:67]
  ds_read_b64_tr_b16 a[112:113], v9 offset:8320
  buffer_load_dwordx4 v10, s[44:47], s56 offen offset:0 lds
  v_mfma_f32_16x16x32_bf16 v[68:71], a[72:75], a[36:39], v[68:71]
  ds_read_b64_tr_b16 a[114:115], v9 offset:9216
  v_mfma_f32_16x16x32_bf16 v[72:75], a[72:75], a[40:43], v[72:75]
  ds_read_b64_tr_b16 a[116:117], v9 offset:8352
  v_mfma_f32_16x16x32_bf16 v[76:79], a[72:75], a[44:47], v[76:79]
  ds_read_b64_tr_b16 a[118:119], v9 offset:9248
  v_mfma_f32_16x16x32_bf16 v[80:83], a[76:79], a[32:35], v[80:83]
  ds_read_b64_tr_b16 a[120:121], v9 offset:8384
  buffer_load_dwordx4 v11, s[44:47], s56 offen offset:1024 lds
  v_mfma_f32_16x16x32_bf16 v[84:87], a[76:79], a[36:39], v[84:87]
  ds_read_b64_tr_b16 a[122:123], v9 offset:9280
  v_mfma_f32_16x16x32_bf16 v[88:91], a[76:79], a[40:43], v[88:91]
  v_mfma_f32_16x16x32_bf16 v[92:95], a[76:79], a[44:47], v[92:95]
  v_mfma_f32_16x16x32_bf16 v[96:99], a[80:83], a[32:35], v[96:99]
  buffer_load_dwordx4 v12, s[44:47], s56 offen offset:2048 lds
  v_mfma_f32_16x16x32_bf16 v[100:103], a[80:83], a[36:39], v[100:103]
  v_mfma_f32_16x16x32_bf16 v[104:107], a[80:83], a[40:43], v[104:107]
  v_mfma_f32_16x16x32_bf16 v[108:111], a[80:83], a[44:47], v[108:111]
  v_mfma_f32_16x16x32_bf16 v[112:115], a[84:87], a[32:35], v[112:115]
  buffer_load_dwordx4 v13, s[44:47], s56 offen offset:3072 lds
  v_mfma_f32_16x16x32_bf16 v[116:119], a[84:87], a[36:39], v[116:119]
  s_add_u32 s57, s56, s60
  s_add_u32 s56, s56, 128
  v_mfma_f32_16x16x32_bf16 v[120:123], a[84:87], a[40:43], v[120:123]
  v_mfma_f32_16x16x32_bf16 v[124:127], a[84:87], a[44:47], v[124:127]
  v_mfma_f32_16x16x32_bf16 v[128:131], a[88:91], a[32:35], v[128:131]
  v_mfma_f32_16x16x32_bf16 v[132:135], a[88:91], a[36:39], v[132:135]
  v_mfma_f32_16x16x32_bf16 v[136:139], a[88:91], a[40:43], v[136:139]
  v_mfma_f32_16x16x32_bf16 v[140:143], a[88:91], a[44:47], v[140:143]
  s_cmp_lg_u32 s66, 1
  s_cbranch_scc1 mk_gb_nsw
  s_mov_b32 s48, s86
  s_mov_b32 s49, s87
  s_mov_b32 s50, s88
  s_mov_b32 s58, s89
  s_mov_b32 s59, s90
  s_mov_b32 s64, s91
  s_mov_b32 s65, s92
mk_gb_nsw:
  s_waitcnt vmcnt(16) lgkmcnt(0)
  s_barrier
  v_mfma_f32_16x16x32_bf16 v[144:147], a[96:99], a[32:35], v[144:147]
  ds_read_b128 a[48:51], v2 offset:0
  v_mfma_f32_16x16x32_bf16 v[148:151], a[96:99], a[36:39], v[148:151]
  ds_read_b128 a[52:55], v2 offset:2048
  v_mfma_f32_16x16x32_bf16 v[152:155], a[96:99], a[40:43], v[152:155]
  ds_read_b128 a[56:59], v2 offset:4096
  v_mfma_f32_16x16x32_bf16 v[156:159], a[96:99], a[44:47], v[156:159]
  ds_read_b128 a[60:63], v2 offset:6144
  v_mfma_f32_16x16x32_bf16 v[160:163], a[100:103], a[32:35], v[160:163]
  ds_read_b64_tr_b16 a[64:65], v9 offset:16384
  v_mfma_f32_16x16x32_bf16 v[164:167], a[100:103], a[36:39], v[164:167]
  ds_read_b64_tr_b16 a[66:67], v9 offset:17280
  v_mfma_f32_16x16x32_bf16 v[168:171], a[100:103], a[40:43], v[168:171]
  ds_read_b64_tr_b16 a[68:69], v9 offset:16416
  v_mfma_f32_16x16x32_bf16 v[172:175], a[100:103], a[44:47], v[172:175]
  ds_read_b64_tr_b16 a[70:71], v9 offset:17312
  s_add_u32 m0, s64, 0
  v_mfma_f32_16x16x32_bf16 v[176:179], a[104:107], a[32:35], v[176:179]
  ds_read_b64_tr_b16 a[72:73], v9 offset:16448
  buffer_load_dwordx4 v14, s[48:51], s58 offen offset:0 lds
  v_mfma_f32_16x16x32_bf16 v[180:183], a[104:107], a[36:39], v[180:183]
  ds_read_b64_tr_b16 a[74:75], v9 offset:17344
  v_mfma_f32_16x16x32_bf16 v[184:187], a[104:107], a[40:43], v[184:187]
  ds_read_b64_tr_b16 a[76:77], v9 offset:16480
  v_mfma_f32_16x16x32_bf16 v[188:191], a[104:107], a[44:47], v[188:191]
  ds_read_b64_tr_b16 a[78:79], v9 offset:17376
  v_mfma_f32_16x16x32_bf16 v[192:195], a[108:111], a[32:35], v[192:195]
  ds_read_b64_tr_b16 a[80:81], v9 offset:16512
  buffer_load_dwordx4 v15, s[48:51], s58 offen offset:1024 lds
  v_mfma_f32_16x16x32_bf16 v[196:199], a[108:111], a[36:39], v[196:199]
  ds_read_b64_tr_b16 a[82:83], v9 offset:17408
  v_mfma_f32_16x16x32_bf16 v[200:203], a[108:111], a[40:43], v[200:203]
  ds_read_b64_tr_b16 a[84:85], v9 offset:16544
  v_mfma_f32_16x16x32_bf16 v[204:207], a[108:111], a[44:47], v[204:207]
  ds_read_b64_tr_b16 a[86:87], v9 offset:17440
  v_mfma_f32_16x16x32_bf16 v[208:211], a[112:115], a[32:35], v[208:211]
  ds_read_b64_tr_b16 a[88:89], v9 offset:16576
  buffer_load_dwordx4 v16, s[48:51], s58 offen offset:2048 lds
  v_mfma_f32_16x16x32_bf16 v[212:215], a[112:115], a[36:39], v[212:215]
  ds_read_b64_tr_b16 a[90:91], v9 offset:17472
  s_add_u32 s72, s72, 1
  v_mfma_f32_16x16x32_bf16 v[216:219], a[112:115], a[40:43], v[216:219]
  s_cmp_eq_u32 s72, 3
  s_cselect_b32 s73, s75, s74
  s_cselect_b32 s72, 0, s72
  v_mfma_f32_16x16x32_bf16 v[220:223], a[112:115], a[44:47], v[220:223]
  v_mfma_f32_16x16x32_bf16 v[224:227], a[116:119], a[32:35], v[224:227]
  buffer_load_dwordx4 v17, s[48:51], s58 offen offset:3072 lds
  v_mfma_f32_16x16x32_bf16 v[228:231], a[116:119], a[36:39], v[228:231]
  s_add_u32 s58, s58, s59
  v_mfma_f32_16x16x32_bf16 v[232:235], a[116:119], a[40:43], v[232:235]
  v_mfma_f32_16x16x32_bf16 v[236:239], a[116:119], a[44:47], v[236:239]
  v_mfma_f32_16x16x32_bf16 v[240:243], a[120:123], a[32:35], v[240:243]
  v_add_u32 v1, s73, v1
  v_add_u32 v2, s73, v2
  v_mfma_f32_16x16x32_bf16 v[244:247], a[120:123], a[36:39], v[244:247]
  v_mfma_f32_16x16x32_bf16 v[248:251], a[120:123], a[40:43], v[248:251]
  v_mfma_f32_16x16x32_bf16 v[252:255], a[120:123], a[44:47], v[252:255]
mk_gb_entry:
  s_waitcnt lgkmcnt(0)
  v_mfma_f32_16x16x32_bf16 v[32:35], a[64:67], a[48:51], v[32:35]
  ds_read_b64_tr_b16 a[96:97], v9 offset:24576
  v_mfma_f32_16x16x32_bf16 v[36:39], a[64:67], a[52:55], v[36:39]
  ds_read_b64_tr_b16 a[98:99], v9 offset:25472
  v_mfma_f32_16x16x32_bf16 v[40:43], a[64:67], a[56:59], v[40:43]
  ds_read_b64_tr_b16 a[100:101], v9 offset:24608
  v_mfma_f32_16x16x32_bf16 v[44:47], a[64:67], a[60:63], v[44:47]
  ds_read_b64_tr_b16 a[102:103], v9 offset:25504
  v_mfma_f32_16x16x32_bf16 v[48:51], a[68:71], a[48:51], v[48:51]
  ds_read_b64_tr_b16 a[104:105], v9 offset:24640
  v_mfma_f32_16x16x32_bf16 v[52:55], a[68:71], a[52:55], v[52:55]
  ds_read_b64_tr_b16 a[106:107], v9 offset:25536
  v_mfma_f32_16x16x32_bf16 v[56:59], a[68:71], a[56:59], v[56:59]
  ds_read_b64_tr_b16 a[108:109], v9 offset:24672
  v_mfma_f32_16x16x32_bf16 v[60:63], a[68:71], a[60:63], v[60:63]
  ds_read_b64_tr_b16 a[110:111], v9 offset:25568
  s_add_u32 m0, s61, 4096
  v_mfma_f32_16x16x32_bf16 v[64:67], a[72:75], a[48:51], v[64:67]
  ds_read_b64_tr_b16 a[112:113], v9 offset:24704
  buffer_load_dwordx4 v10, s[44:47], s57 offen offset:0 lds
  v_mfma_f32_16x16x32_bf16 v[68:71], a[72:75], a[52:55], v[68:71]
  ds_read_b64_tr_b16 a[114:115], v9 offset:25600
  v_mfma_f32_16x16x32_bf16 v[72:75], a[72:75], a[56:59], v[72:75]
  ds_read_b64_tr_b16 a[116:117], v9 offset:24736
  v_mfma_f32_16x16x32_bf16 v[76:79], a[72:75], a[60:63], v[76:79]
  ds_read_b64_tr_b16 a[118:119], v9 offset:25632
  v_mfma_f32_16x16x32_bf16 v[80:83], a[76:79], a[48:51], v[80:83]
  ds_read_b64_tr_b16 a[120:121], v9 offset:24768
  buffer_load_dwordx4 v11, s[44:47], s57 offen offset:1024 lds
  v_mfma_f32_16x16x32_bf16 v[84:87], a[76:79], a[52:55], v[84:87]
  ds_read_b64_tr_b16 a[122:123], v9 offset:25664
  v_mfma_f32_16x16x32_bf16 v[88:91], a[76:79], a[56:59], v[88:91]
  v_mfma_f32_16x16x32_bf16 v[92:95], a[76:79], a[60:63], v[92:95]
  v_mfma_f32_16x16x32_bf16 v[96:99], a[80:83], a[48:51], v[96:99]
  buffer_load_dwordx4 v12, s[44:47], s57 offen offset:2048 lds
  v_mfma_f32_16x16x32_bf16 v[100:103], a[80:83], a[52:55], v[100:103]
  v_mfma_f32_16x16x32_bf16 v[104:107], a[80:83], a[56:59], v[104:107]
  v_mfma_f32_16x16x32_bf16 v[108:111], a[80:83], a[60:63], v[108:111]
  v_mfma_f32_16x16x32_bf16 v[112:115], a[84:87], a[48:51], v[112:115]
  buffer_load_dwordx4 v13, s[44:47], s57 offen offset:3072 lds
  v_mfma_f32_16x16x32_bf16 v[116:119], a[84:87], a[52:55], v[116:119]
  s_add_u32 s61, s61, 8192
  s_cmp_eq_u32 s61, s63
  s_cselect_b32 s61, s62, s61
  v_mfma_f32_16x16x32_bf16 v[120:123], a[84:87], a[56:59], v[120:123]
  v_mfma_f32_16x16x32_bf16 v[124:127], a[84:87], a[60:63], v[124:127]
  v_mfma_f32_16x16x32_bf16 v[128:131], a[88:91], a[48:51], v[128:131]
  v_mfma_f32_16x16x32_bf16 v[132:135], a[88:91], a[52:55], v[132:135]
  v_mfma_f32_16x16x32_bf16 v[136:139], a[88:91], a[56:59], v[136:139]
  v_mfma_f32_16x16x32_bf16 v[140:143], a[88:91], a[60:63], v[140:143]
  s_waitcnt vmcnt(16) lgkmcnt(0)
  s_barrier
  v_mfma_f32_16x16x32_bf16 v[144:147], a[96:99], a[48:51], v[144:147]
  ds_read_b128 a[32:35], v1 offset:0
  v_mfma_f32_16x16x32_bf16 v[148:151], a[96:99], a[52:55], v[148:151]
  ds_read_b128 a[36:39], v1 offset:2048
  v_mfma_f32_16x16x32_bf16 v[152:155], a[96:99], a[56:59], v[152:155]
  ds_read_b128 a[40:43], v1 offset:4096
  v_mfma_f32_16x16x32_bf16 v[156:159], a[96:99], a[60:63], v[156:159]
  ds_read_b128 a[44:47], v1 offset:6144
  v_mfma_f32_16x16x32_bf16 v[160:163], a[100:103], a[48:51], v[160:163]
  ds_read_b64_tr_b16 a[64:65], v9 offset:32768
  v_mfma_f32_16x16x32_bf16 v[164:167], a[100:103], a[52:55], v[164:167]
  ds_read_b64_tr_b16 a[66:67], v9 offset:33664
  v_mfma_f32_16x16x32_bf16 v[168:171], a[100:103], a[56:59], v[168:171]
  ds_read_b64_tr_b16 a[68:69], v9 offset:32800
  v_mfma_f32_16x16x32_bf16 v[172:175], a[100:103], a[60:63], v[172:175]
  ds_read_b64_tr_b16 a[70:71], v9 offset:33696
  s_add_u32 m0, s64, 16384
  v_mfma_f32_16x16x32_bf16 v[176:179], a[104:107], a[48:51], v[176:179]
  ds_read_b64_tr_b16 a[72:73], v9 offset:32832
  buffer_load_dwordx4 v14, s[48:51], s58 offen offset:0 lds
  v_mfma_f32_16x16x32_bf16 v[180:183], a[104:107], a[52:55], v[180:183]
  ds_read_b64_tr_b16 a[74:75], v9 offset:33728
  v_mfma_f32_16x16x32_bf16 v[184:187], a[104:107], a[56:59], v[184:187]
  ds_read_b64_tr_b16 a[76:77], v9 offset:32864
  v_mfma_f32_16x16x32_bf16 v[188:191], a[104:107], a[60:63], v[188:191]
  ds_read_b64_tr_b16 a[78:79], v9 offset:33760
  v_mfma_f32_16x16x32_bf16 v[192:195], a[108:111], a[48:51], v[192:195]
  ds_read_b64_tr_b16 a[80:81], v9 offset:32896
  buffer_load_dwordx4 v15, s[48:51], s58 offen offset:1024 lds
  v_mfma_f32_16x16x32_bf16 v[196:199], a[108:111], a[52:55], v[196:199]
  ds_read_b64_tr_b16 a[82:83], v9 offset:33792
  v_mfma_f32_16x16x32_bf16 v[200:203], a[108:111], a[56:59], v[200:203]
  ds_read_b64_tr_b16 a[84:85], v9 offset:32928
  v_mfma_f32_16x16x32_bf16 v[204:207], a[108:111], a[60:63], v[204:207]
  ds_read_b64_tr_b16 a[86:87], v9 offset:33824
  v_mfma_f32_16x16x32_bf16 v[208:211], a[112:115], a[48:51], v[208:211]
  ds_read_b64_tr_b16 a[88:89], v9 offset:32960
  buffer_load_dwordx4 v16, s[48:51], s58 offen offset:2048 lds
  v_mfma_f32_16x16x32_bf16 v[212:215], a[112:115], a[52:55], v[212:215]
  ds_read_b64_tr_b16 a[90:91], v9 offset:33856
  v_mfma_f32_16x16x32_bf16 v[216:219], a[112:115], a[56:59], v[216:219]
  v_mfma_f32_16x16x32_bf16 v[220:223], a[112:115], a[60:63], v[220:223]
  v_mfma_f32_16x16x32_bf16 v[224:227], a[116:119], a[48:51], v[224:227]
  buffer_load_dwordx4 v17, s[48:51], s58 offen offset:3072 lds
  v_mfma_f32_16x16x32_bf16 v[228:231], a[116:119], a[52:55], v[228:231]
  s_add_u32 s58, s58, s59
  v_mfma_f32_16x16x32_bf16 v[232:235], a[116:119], a[56:59], v[232:235]
  v_mfma_f32_16x16x32_bf16 v[236:239], a[116:119], a[60:63], v[236:239]
  v_mfma_f32_16x16x32_bf16 v[240:243], a[120:123], a[48:51], v[240:243]
  v_mfma_f32_16x16x32_bf16 v[244:247], a[120:123], a[52:55], v[244:247]
  v_mfma_f32_16x16x32_bf16 v[248:251], a[120:123], a[56:59], v[248:251]
  v_mfma_f32_16x16x32_bf16 v[252:255], a[120:123], a[60:63], v[252:255]
  s_waitcnt lgkmcnt(0)
  v_mfma_f32_16x16x32_bf16 v[32:35], a[64:67], a[32:35], v[32:35]
  ds_read_b64_tr_b16 a[96:97], v9 offset:40960
  v_mfma_f32_16x16x32_bf16 v[36:39], a[64:67], a[36:39], v[36:39]
  ds_read_b64_tr_b16 a[98:99], v9 offset:41856
  v_mfma_f32_16x16x32_bf16 v[40:43], a[64:67], a[40:43], v[40:43]
  ds_read_b64_tr_b16 a[100:101], v9 offset:40992
  v_mfma_f32_16x16x32_bf16 v[44:47], a[64:67], a[44:47], v[44:47]
  ds_read_b64_tr_b16 a[102:103], v9 offset:41888
  v_mfma_f32_16x16x32_bf16 v[48:51], a[68:71], a[32:35], v[48:51]
  ds_read_b64_tr_b16 a[104:105], v9 offset:41024
  v_mfma_f32_16x16x32_bf16 v[52:55], a[68:71], a[36:39], v[52:55]
  ds_read_b64_tr_b16 a[106:107], v9 offset:41920
  v_mfma_f32_16x16x32_bf16 v[56:59], a[68:71], a[40:43], v[56:59]
  ds_read_b64_tr_b16 a[108:109], v9 offset:41056
  v_mfma_f32_16x16x32_bf16 v[60:63], a[68:71], a[44:47], v[60:63]
  ds_read_b64_tr_b16 a[110:111], v9 offset:41952
  s_mov_b32 m0, s61
  v_mfma_f32_16x16x32_bf16 v[64:67], a[72:75], a[32:35], v[64:67]
  ds_read_b64_tr_b16 a[112:113], v9 offset:41088
  buffer_load_dwordx4 v10, s[44:47], s56 offen offset:0 lds
  v_mfma_f32_16x16x32_bf16 v[68:71], a[72:75], a[36:39], v[68:71]
  ds_read_b64_tr_b16 a[114:115], v9 offset:41984
  v_mfma_f32_16x16x32_bf16 v[72:75], a[72:75], a[40:43], v[72:75]
  ds_read_b64_tr_b16 a[116:117], v9 offset:41120
  v_mfma_f32_16x16x32_bf16 v[76:79], a[72:75], a[44:47], v[76:79]
  ds_read_b64_tr_b16 a[118:119], v9 offset:42016
  v_mfma_f32_16x16x32_bf16 v[80:83], a[76:79], a[32:35], v[80:83]
  ds_read_b64_tr_b16 a[120:121], v9 offset:41152
  buffer_load_dwordx4 v11, s[44:47], s56 offen offset:1024 lds
  v_mfma_f32_16x16x32_bf16 v[84:87], a[76:79], a[36:39], v[84:87]
  ds_read_b64_tr_b16 a[122:123], v9 offset:42048
  v_mfma_f32_16x16x32_bf16 v[88:91], a[76:79], a[40:43], v[88:91]
  v_mfma_f32_16x16x32_bf16 v[92:95], a[76:79], a[44:47], v[92:95]
  v_mfma_f32_16x16x32_bf16 v[96:99], a[80:83], a[32:35], v[96:99]
  buffer_load_dwordx4 v12, s[44:47], s56 offen offset:2048 lds
  v_mfma_f32_16x16x32_bf16 v[100:103], a[80:83], a[36:39], v[100:103]
  v_mfma_f32_16x16x32_bf16 v[104:107], a[80:83], a[40:43], v[104:107]
  v_mfma_f32_16x16x32_bf16 v[108:111], a[80:83], a[44:47], v[108:111]
  v_mfma_f32_16x16x32_bf16 v[112:115], a[84:87], a[32:35], v[112:115]
  buffer_load_dwordx4 v13, s[44:47], s56 offen offset:3072 lds
  v_mfma_f32_16x16x32_bf16 v[116:119], a[84:87], a[36:39], v[116:119]
  s_add_u32 s57, s56, s60
  s_add_u32 s56, s56, 128
  v_mfma_f32_16x16x32_bf16 v[120:123], a[84:87], a[40:43], v[120:123]
  v_mfma_f32_16x16x32_bf16 v[124:127], a[84:87], a[44:47], v[124:127]
  v_mfma_f32_16x16x32_bf16 v[128:131], a[88:91], a[32:35], v[128:131]
  v_mfma_f32_16x16x32_bf16 v[132:135], a[88:91], a[36:39], v[132:135]
  v_mfma_f32_16x16x32_bf16 v[136:139], a[88:91], a[40:43], v[136:139]
  v_mfma_f32_16x16x32_bf16 v[140:143], a[88:91], a[44:47], v[140:143]
  s_cmp_lg_u32 s66, 4
  s_cbranch_scc1 hk_5
  s_cmp_lg_u32 s67, 0
  s_cbranch_scc1 fs_6
  v_mov_b32 v24, 0x1010101
  s_mov_b64 exec, 1
  buffer_store_dword v24, off, s[52:55], s93 sc1
  s_mov_b64 exec, -1
fs_6:
  buffer_load_dword v25, v29, s[8:11], 0 offen sc1
hk_5:
  s_cmp_lg_u32 s66, 1
  s_cbranch_scc1 hk_4
  s_mov_b32 s7, 0x1010101
  s_mov_b32 s76, 0x40000
  v_cmp_ne_u32 vcc, s7, v25
  s_nop 1
  s_cmp_eq_u64 vcc, 0
  s_cbranch_scc1 pok_7
pspin_8:
  s_sleep 8
  buffer_load_dword v25, v29, s[8:11], 0 offen sc1
  s_sub_u32 s76, s76, 1
  s_cmp_eq_u32 s76, 0
  s_cbranch_scc1 pok_7
  s_waitcnt vmcnt(0)
  v_cmp_ne_u32 vcc, s7, v25
  s_nop 1
  s_cmp_eq_u64 vcc, 0
  s_cbranch_scc0 pspin_8
pok_7:
  buffer_load_dword v25, v29, s[52:55], s34 offen sc1
hk_4:
  s_waitcnt vmcnt(16) lgkmcnt(0)
  s_barrier
  v_mfma_f32_16x16x32_bf16 v[144:147], a[96:99], a[32:35], v[144:147]
  ds_read_b128 a[48:51], v2 offset:0
  v_mfma_f32_16x16x32_bf16 v[148:151], a[96:99], a[36:39], v[148:151]
  ds_read_b128 a[52:55], v2 offset:2048
  v_mfma_f32_16x16x32_bf16 v[152:155], a[96:99], a[40:43], v[152:155]
  ds_read_b128 a[56:59], v2 offset:4096
  v_mfma_f32_16x16x32_bf16 v[156:159], a[96:99], a[44:47], v[156:159]
  ds_read_b128 a[60:63], v2 offset:6144
  v_mfma_f32_16x16x32_bf16 v[160:163], a[100:103], a[32:35], v[160:163]
  ds_read_b64_tr_b16 a[64:65], v9 offset:49152
  v_mfma_f32_16x16x32_bf16 v[164:167], a[100:103], a[36:39], v[164:167]
  ds_read_b64_tr_b16 a[66:67], v9 offset:50048
  v_mfma_f32_16x16x32_bf16 v[168:171], a[100:103], a[40:43], v[168:171]
  ds_read_b64_tr_b16 a[68:69], v9 offset:49184
  v_mfma_f32_16x16x32_bf16 v[172:175], a[100:103], a[44:47], v[172:175]
  ds_read_b64_tr_b16 a[70:71], v9 offset:50080
  s_add_u32 m0, s64, 32768
  v_mfma_f32_16x16x32_bf16 v[176:179], a[104:107], a[32:35], v[176:179]
  ds_read_b64_tr_b16 a[72:73], v9 offset:49216
  buffer_load_dwordx4 v14, s[48:51], s58 offen offset:0 lds
  v_mfma_f32_16x16x32_bf16 v[180:183], a[104:107], a[36:39], v[180:183]
  ds_read_b64_tr_b16 a[74:75], v9 offset:50112
  v_mfma_f32_16x16x32_bf16 v[184:187], a[104:107], a[40:43], v[184:187]
  ds_read_b64_tr_b16 a[76:77], v9 offset:49248
  v_mfma_f32_16x16x32_bf16 v[188:191], a[104:107], a[44:47], v[188:191]
  ds_read_b64_tr_b16 a[78:79], v9 offset:50144
  v_mfma_f32_16x16x32_bf16 v[192:195], a[108:111], a[32:35], v[192:195]
  ds_read_b64_tr_b16 a[80:81], v9 offset:49280
  buffer_load_dwordx4 v15, s[48:51], s58 offen offset:1024 lds
  v_mfma_f32_16x16x32_bf16 v[196:199], a[108:111], a[36:39], v[196:199]
  ds_read_b64_tr_b16 a[82:83], v9 offset:50176
  v_mfma_f32_16x16x32_bf16 v[200:203], a[108:111], a[40:43], v[200:203]
  ds_read_b64_tr_b16 a[84:85], v9 offset:49312
  v_mfma_f32_16x16x32_bf16 v[204:207], a[108:111], a[44:47], v[204:207]
  ds_read_b64_tr_b16 a[86:87], v9 offset:50208
  v_mfma_f32_16x16x32_bf16 v[208:211], a[112:115], a[32:35], v[208:211]
  ds_read_b64_tr_b16 a[88:89], v9 offset:49344
  buffer_load_dwordx4 v16, s[48:51], s58 offen offset:2048 lds
  v_mfma_f32_16x16x32_bf16 v[212:215], a[112:115], a[36:39], v[212:215]
  ds_read_b64_tr_b16 a[90:91], v9 offset:50240
  s_add_u32 s72, s72, 1
  v_mfma_f32_16x16x32_bf16 v[216:219], a[112:115], a[40:43], v[216:219]
  s_cmp_eq_u32 s72, 3
  s_cselect_b32 s73, s75, s74
  s_cselect_b32 s72, 0, s72
  v_mfma_f32_16x16x32_bf16 v[220:223], a[112:115], a[44:47], v[220:223]
  v_mfma_f32_16x16x32_bf16 v[224:227], a[116:119], a[32:35], v[224:227]
  buffer_load_dwordx4 v17, s[48:51], s58 offen offset:3072 lds
  v_mfma_f32_16x16x32_bf16 v[228:231], a[116:119], a[36:39], v[228:231]
  s_add_u32 s58, s58, s59
  v_mfma_f32_16x16x32_bf16 v[232:235], a[116:119], a[40:43], v[232:235]
  v_mfma_f32_16x16x32_bf16 v[236:239], a[116:119], a[44:47], v[236:239]
  v_mfma_f32_16x16x32_bf16 v[240:243], a[120:123], a[32:35], v[240:243]
  v_add_u32 v1, s73, v1
  v_add_u32 v2, s73, v2
  v_mfma_f32_16x16x32_bf16 v[244:247], a[120:123], a[36:39], v[244:247]
  v_mfma_f32_16x16x32_bf16 v[248:251], a[120:123], a[40:43], v[248:251]
  v_mfma_f32_16x16x32_bf16 v[252:255], a[120:123], a[44:47], v[252:255]
  s_waitcnt lgkmcnt(0)
  v_mfma_f32_16x16x32_bf16 v[32:35], a[64:67], a[48:51], v[32:35]
  ds_read_b64_tr_b16 a[96:97], v9 offset:57344
  v_mfma_f32_16x16x32_bf16 v[36:39], a[64:67], a[52:55], v[36:39]
  ds_read_b64_tr_b16 a[98:99], v9 offset:58240
  v_mfma_f32_16x16x32_bf16 v[40:43], a[64:67], a[56:59], v[40:43]
  ds_read_b64_tr_b16 a[100:101], v9 offset:57376
  v_mfma_f32_16x16x32_bf16 v[44:47], a[64:67], a[60:63], v[44:47]
  ds_read_b64_tr_b16 a[102:103], v9 offset:58272
  v_mfma_f32_16x16x32_bf16 v[48:51], a[68:71], a[48:51], v[48:51]
  ds_read_b64_tr_b16 a[104:105], v9 offset:57408
  v_mfma_f32_16x16x32_bf16 v[52:55], a[68:71], a[52:55], v[52:55]
  ds_read_b64_tr_b16 a[106:107], v9 offset:58304
  v_mfma_f32_16x16x32_bf16 v[56:59], a[68:71], a[56:59], v[56:59]
  ds_read_b64_tr_b16 a[108:109], v9 offset:57440
  v_mfma_f32_16x16x32_bf16 v[60:63], a[68:71], a[60:63], v[60:63]
  ds_read_b64_tr_b16 a[110:111], v9 offset:58336
  s_add_u32 m0, s61, 4096
  v_mfma_f32_16x16x32_bf16 v[64:67], a[72:75], a[48:51], v[64:67]
  ds_read_b64_tr_b16 a[112:113], v9 offset:57472
  buffer_load_dwordx4 v10, s[44:47], s57 offen offset:0 lds
  v_mfma_f32_16x16x32_bf16 v[68:71], a[72:75], a[52:55], v[68:71]
  ds_read_b64_tr_b16 a[114:115], v9 offset:58368
  v_mfma_f32_16x16x32_bf16 v[72:75], a[72:75], a[56:59], v[72:75]
  ds_read_b64_tr_b16 a[116:117], v9 offset:57504
  v_mfma_f32_16x16x32_bf16 v[76:79], a[72:75], a[60:63], v[76:79]
  ds_read_b64_tr_b16 a[118:119], v9 offset:58400
  v_mfma_f32_16x16x32_bf16 v[80:83], a[76:79], a[48:51], v[80:83]
  ds_read_b64_tr_b16 a[120:121], v9 offset:57536
  buffer_load_dwordx4 v11, s[44:47], s57 offen offset:1024 lds
  v_mfma_f32_16x16x32_bf16 v[84:87], a[76:79], a[52:55], v[84:87]
  ds_read_b64_tr_b16 a[122:123], v9 offset:58432
  v_mfma_f32_16x16x32_bf16 v[88:91], a[76:79], a[56:59], v[88:91]
  v_mfma_f32_16x16x32_bf16 v[92:95], a[76:79], a[60:63], v[92:95]
  v_mfma_f32_16x16x32_bf16 v[96:99], a[80:83], a[48:51], v[96:99]
  buffer_load_dwordx4 v12, s[44:47], s57 offen offset:2048 lds
  v_mfma_f32_16x16x32_bf16 v[100:103], a[80:83], a[52:55], v[100:103]
  v_mfma_f32_16x16x32_bf16 v[104:107], a[80:83], a[56:59], v[104:107]
  v_mfma_f32_16x16x32_bf16 v[108:111], a[80:83], a[60:63], v[108:111]
  v_mfma_f32_16x16x32_bf16 v[112:115], a[84:87], a[48:51], v[112:115]
  buffer_load_dwordx4 v13, s[44:47], s57 offen offset:3072 lds
  v_mfma_f32_16x16x32_bf16 v[116:119], a[84:87], a[52:55], v[116:119]
  s_add_u32 s61, s61, 8192
  s_cmp_eq_u32 s61, s63
  s_cselect_b32 s61, s62, s61
  v_mfma_f32_16x16x32_bf16 v[120:123], a[84:87], a[56:59], v[120:123]
  v_mfma_f32_16x16x32_bf16 v[124:127], a[84:87], a[60:63], v[124:127]
  v_mfma_f32_16x16x32_bf16 v[128:131], a[88:91], a[48:51], v[128:131]
  v_mfma_f32_16x16x32_bf16 v[132:135], a[88:91], a[52:55], v[132:135]
  v_mfma_f32_16x16x32_bf16 v[136:139], a[88:91], a[56:59], v[136:139]
  v_mfma_f32_16x16x32_bf16 v[140:143], a[88:91], a[60:63], v[140:143]
  s_sub_u32 s66, s66, 1
  s_cmp_lg_u32 s66, 0
  s_cbranch_scc1 mk_gb_top
  s_waitcnt vmcnt(0) lgkmcnt(0)
  s_barrier
  v_mfma_f32_16x16x32_bf16 v[144:147], a[96:99], a[48:51], v[144:147]
  v_mfma_f32_16x16x32_bf16 v[148:151], a[96:99], a[52:55], v[148:151]
  v_mfma_f32_16x16x32_bf16 v[152:155], a[96:99], a[56:59], v[152:155]
  v_mfma_f32_16x16x32_bf16 v[156:159], a[96:99], a[60:63], v[156:159]
  v_mfma_f32_16x16x32_bf16 v[160:163], a[100:103], a[48:51], v[160:163]
  v_mfma_f32_16x16x32_bf16 v[164:167], a[100:103], a[52:55], v[164:167]
  v_mfma_f32_16x16x32_bf16 v[168:171], a[100:103], a[56:59], v[168:171]
  v_mfma_f32_16x16x32_bf16 v[172:175], a[100:103], a[60:63], v[172:175]
  v_mfma_f32_16x16x32_bf16 v[176:179], a[104:107], a[48:51], v[176:179]
  v_mfma_f32_16x16x32_bf16 v[180:183], a[104:107], a[52:55], v[180:183]
  v_mfma_f32_16x16x32_bf16 v[184:187], a[104:107], a[56:59], v[184:187]
  v_mfma_f32_16x16x32_bf16 v[188:191], a[104:107], a[60:63], v[188:191]
  v_mfma_f32_16x16x32_bf16 v[192:195], a[108:111], a[48:51], v[192:195]
  v_mfma_f32_16x16x32_bf16 v[196:199], a[108:111], a[52:55], v[196:199]
  v_mfma_f32_16x16x32_bf16 v[200:203], a[108:111], a[56:59], v[200:203]
  v_mfma_f32_16x16x32_bf16 v[204:207], a[108:111], a[60:63], v[204:207]
  v_mfma_f32_16x16x32_bf16 v[208:211], a[112:115], a[48:51], v[208:211]
  v_mfma_f32_16x16x32_bf16 v[212:215], a[112:115], a[52:55], v[212:215]
  v_mfma_f32_16x16x32_bf16 v[216:219], a[112:115], a[56:59], v[216:219]
  v_mfma_f32_16x16x32_bf16 v[220:223], a[112:115], a[60:63], v[220:223]
  v_mfma_f32_16x16x32_bf16 v[224:227], a[116:119], a[48:51], v[224:227]
  v_mfma_f32_16x16x32_bf16 v[228:231], a[116:119], a[52:55], v[228:231]
  v_mfma_f32_16x16x32_bf16 v[232:235], a[116:119], a[56:59], v[232:235]
  v_mfma_f32_16x16x32_bf16 v[236:239], a[116:119], a[60:63], v[236:239]
  v_mfma_f32_16x16x32_bf16 v[240:243], a[120:123], a[48:51], v[240:243]
  v_mfma_f32_16x16x32_bf16 v[244:247], a[120:123], a[52:55], v[244:247]
  v_mfma_f32_16x16x32_bf16 v[248:251], a[120:123], a[56:59], v[248:251]
  v_mfma_f32_16x16x32_bf16 v[252:255], a[120:123], a[60:63], v[252:255]
  s_lshl_b32 s76, s69, 10
  s_lshl_b32 s77, s67, 8
  s_add_u32 s76, s76, s77
  s_add_u32 s76, s76, 83886080
  v_and_b32 v31, 15, v0
  v_lshlrev_b32 v31, 2, v31
  buffer_load_dword v20, v31, s[52:55], s76 offen offset:0 sc1
  buffer_load_dword v21, v31, s[52:55], s76 offen offset:64 sc1
  buffer_load_dword v22, v31, s[52:55], s76 offen offset:128 sc1
  buffer_load_dword v23, v31, s[52:55], s76 offen offset:192 sc1
  s_mul_i32 s80, s69, 3932160
  s_mul_i32 s76, s71, 7168
  s_add_u32 s80, s80, s76
  s_add_u32 s80, s80, 50593792
  s_mul_i32 s76, s67, 983040
  v_lshlrev_b32 v26, 4, v0
  v_add_u32 v26, s76, v26
  s_mov_b32 s68, 1
  s_mov_b32 s79, s34
  s_mov_b32 s7, 0x1010101
  s_mov_b32 s76, 0x40000
  v_cmp_ne_u32 vcc, s7, v25
  s_nop 1
  s_and_b32 vcc_lo, vcc_lo, 0xffff
  s_cmp_eq_u32 vcc_lo, 0
  s_cbranch_scc0 mk_late
  s_and_b32 s28, s2, 7
  s_lshr_b32 s29, s2, 3
  s_lshl_b32 s16, s28, 2
  s_bfe_u32 s28, s29, 0x20002
  s_add_u32 s16, s16, s28
  s_and_b32 s36, s29, 3
  s_lshr_b32 s29, s29, 4
  s_lshl_b32 s29, s29, 2
  s_add_u32 s36, s36, s29
  s_sub_u32 s35, 15, s36
  v_lshlrev_b32 v1, 4, v0
  s_lshl_b32 s23, s67, 12
  v_add_u32 v2, s23, v1
  s_mov_b32 s21, s23
  s_add_u32 s22, s23, 163840
  s_lshl_b32 s28, s16, 19
  s_add_u32 s24, s28, 16777216
  s_add_u32 s25, s28, 33538048
  s_lshl_b32 s29, s35, 15
  s_add_u32 s29, s29, 16384
  s_add_u32 s26, s24, s29
  s_add_u32 s27, s26, 16777216
  v_and_b32 v24, 31, v0
  v_lshrrev_b32 v25, 5, v0
  v_lshlrev_b32 v25, 2, v25
  v_sub_u32 v4, v24, v25
  v_lshlrev_b32 v24, 2, v24
  s_mov_b32 m0, s21
  s_nop 0
  buffer_load_dwordx4 v2, s[52:55], s24 offen offset:0 sc1 lds
  buffer_load_dwordx4 v2, s[52:55], s24 offen offset:1024 sc1 lds
  buffer_load_dwordx4 v2, s[52:55], s24 offen offset:2048 sc1 lds
  buffer_load_dwordx4 v2, s[52:55], s24 offen offset:3072 sc1 lds
  s_add_u32 s21, s21, 32768
  s_cmp_eq_u32 s21, s22
  s_cselect_b32 s21, s23, s21
  s_add_u32 s24, s24, 16384
  s_min_u32 s24, s24, s26
  s_add_u32 s25, s25, 16384
  s_min_u32 s25, s25, s27
  s_lshl_b32 s29, s35, 2
  s_add_u32 s29, s29, s67
  s_lshl_b32 s30, s29, 13
  s_lshl_b32 s28, s16, 19
  s_add_u32 s30, s30, s28
  s_add_u32 s28, s30, 4096
  buffer_load_dwordx4 a[0:3], v1, s[52:55], s30 offen offset:0 sc1
  buffer_load_dwordx4 a[4:7], v1, s[52:55], s30 offen offset:1024 sc1
  buffer_load_dwordx4 a[8:11], v1, s[52:55], s30 offen offset:2048 sc1
  buffer_load_dwordx4 a[12:15], v1, s[52:55], s30 offen offset:3072 sc1
  buffer_load_dwordx4 a[16:19], v1, s[52:55], s28 offen offset:0 sc1
  buffer_load_dwordx4 a[20:23], v1, s[52:55], s28 offen offset:1024 sc1
  buffer_load_dwordx4 a[24:27], v1, s[52:55], s28 offen offset:2048 sc1
  buffer_load_dwordx4 a[28:31], v1, s[52:55], s28 offen offset:3072 sc1
  s_lshl_b32 s29, s29, 7
  s_add_u32 s29, s29, 83886080
  buffer_load_dword v8, v24, s[52:55], s29 offen sc1
  s_lshl_b32 s29, s36, 2
  s_add_u32 s29, s29, s67
  s_lshl_b32 s30, s29, 13
  s_lshl_b32 s28, s16, 19
  s_add_u32 s30, s30, s28
  s_add_u32 s28, s30, 4096
  buffer_load_dwordx4 a[32:35], v1, s[52:55], s30 offen offset:0 sc1
  buffer_load_dwordx4 a[36:39], v1, s[52:55], s30 offen offset:1024 sc1
  buffer_load_dwordx4 a[40:43], v1, s[52:55], s30 offen offset:2048 sc1
  buffer_load_dwordx4 a[44:47], v1, s[52:55], s30 offen offset:3072 sc1
  buffer_load_dwordx4 a[48:51], v1, s[52:55], s28 offen offset:0 sc1
  buffer_load_dwordx4 a[52:55], v1, s[52:55], s28 offen offset:1024 sc1
  buffer_load_dwordx4 a[56:59], v1, s[52:55], s28 offen offset:2048 sc1
  buffer_load_dwordx4 a[60:63], v1, s[52:55], s28 offen offset:3072 sc1
  s_lshl_b32 s29, s29, 7
  s_add_u32 s29, s29, 83886080
  buffer_load_dword v9, v24, s[52:55], s29 offen sc1
  s_mov_b32 m0, s21
  s_nop 0
  buffer_load_dwordx4 v2, s[52:55], s24 offen offset:0 sc1 lds
  buffer_load_dwordx4 v2, s[52:55], s24 offen offset:1024 sc1 lds
  buffer_load_dwordx4 v2, s[52:55], s24 offen offset:2048 sc1 lds
  buffer_load_dwordx4 v2, s[52:55], s24 offen offset:3072 sc1 lds
  s_add_u32 m0, s21, 16384
  s_nop 0
  buffer_load_dwordx4 v2, s[52:55], s25 offen offset:0 sc1 lds
  buffer_load_dwordx4 v2, s[52:55], s25 offen offset:1024 sc1 lds
  buffer_load_dwordx4 v2, s[52:55], s25 offen offset:2048 sc1 lds
  buffer_load_dwordx4 v2, s[52:55], s25 offen offset:3072 sc1 lds
  s_add_u32 s21, s21, 32768
  s_cmp_eq_u32 s21, s22
  s_cselect_b32 s21, s23, s21
  s_add_u32 s24, s24, 16384
  s_min_u32 s24, s24, s26
  s_add_u32 s25, s25, 16384
  s_min_u32 s25, s25, s27
  s_mov_b32 m0, s21
  s_nop 0
  buffer_load_dwordx4 v2, s[52:55], s24 offen offset:0 sc1 lds
  buffer_load_dwordx4 v2, s[52:55], s24 offen offset:1024 sc1 lds
  buffer_load_dwordx4 v2, s[52:55], s24 offen offset:2048 sc1 lds
  buffer_load_dwordx4 v2, s[52:55], s24 offen offset:3072 sc1 lds
  s_add_u32 m0, s21, 16384
  s_nop 0
  buffer_load_dwordx4 v2, s[52:55], s25 offen offset:0 sc1 lds
  buffer_load_dwordx4 v2, s[52:55], s25 offen offset:1024 sc1 lds
  buffer_load_dwordx4 v2, s[52:55], s25 offen offset:2048 sc1 lds
  buffer_load_dwordx4 v2, s[52:55], s25 offen offset:3072 sc1 lds
  s_add_u32 s21, s21, 32768
  s_cmp_eq_u32 s21, s22
  s_cselect_b32 s21, s23, s21
  s_add_u32 s24, s24, 16384
  s_min_u32 s24, s24, s26
  s_add_u32 s25, s25, 16384
  s_min_u32 s25, s25, s27
  s_mov_b32 s31, 0x45800000
  s_mov_b32 s32, 0xf149f2ca
  s_mov_b32 s20, 0
  s_mov_b32 s33, 83951616
  s_lshl_b32 s28, s35, 2
  s_sub_i32 s37, s28, 2
  s_add_u32 s39, s28, s67
  s_lshl_b32 s39, s39, 5
  s_lshl_b32 s28, s36, 2
  s_sub_i32 s38, s28, 2
  s_add_u32 s40, s28, s67
  s_lshl_b32 s40, s40, 5
  s_lshl_b32 s19, s36, 1
  s_add_u32 s19, s19, 1
  s_sub_u32 s34, s35, s36
  s_lshl_b32 s34, s34, 1
  s_sub_u32 s34, s34, 1
  s_mov_b32 s68, 0
  s_branch mk_epi
mk_late:
  s_waitcnt vmcnt(0)
mk_epi:
  s_mov_b32 s96, 0xbdd2d3e8
  s_mov_b32 s97, 0xbdd2d3e8
  v_mov_b32 v10, 0xc0135761
  v_mov_b32 v11, 0xc0135761
  v_pk_mul_f32 v[12:13], v[32:33], v[32:33]
  v_pk_mul_f32 v[14:15], v[34:35], v[34:35]
  v_pk_mul_f32 v[16:17], v[36:37], v[36:37]
  v_pk_mul_f32 v[18:19], v[38:39], v[38:39]
  v_pk_fma_f32 v[12:13], v[12:13], s[96:97], v[10:11]
  v_pk_fma_f32 v[14:15], v[14:15], s[96:97], v[10:11]
  v_pk_fma_f32 v[16:17], v[16:17], s[96:97], v[10:11]
  v_pk_fma_f32 v[18:19], v[18:19], s[96:97], v[10:11]
  v_pk_mul_f32 v[12:13], v[12:13], v[32:33]
  v_pk_mul_f32 v[14:15], v[14:15], v[34:35]
  v_pk_mul_f32 v[16:17], v[16:17], v[36:37]
  v_pk_mul_f32 v[18:19], v[18:19], v[38:39]
  v_exp_f32 v12, v12
  v_exp_f32 v13, v13
  v_exp_f32 v14, v14
  v_exp_f32 v15, v15
  v_exp_f32 v16, v16
  v_exp_f32 v17, v17
  v_exp_f32 v18, v18
  v_exp_f32 v19, v19
  v_pk_mul_f32 v[32:33], v[32:33], v[144:145]
  v_pk_mul_f32 v[34:35], v[34:35], v[146:147]
  v_pk_mul_f32 v[36:37], v[36:37], v[148:149]
  v_pk_mul_f32 v[38:39], v[38:39], v[150:151]
  s_waitcnt vmcnt(38)
  v_sub_f32 v20, 1.0, v20
  v_max_f32 v20, 0x0da24260, v20
  v_rcp_f32 v20, v20
  v_sub_f32 v21, 1.0, v21
  v_max_f32 v21, 0x0da24260, v21
  v_rcp_f32 v21, v21
  v_sub_f32 v22, 1.0, v22
  v_max_f32 v22, 0x0da24260, v22
  v_rcp_f32 v22, v22
  v_sub_f32 v23, 1.0, v23
  v_max_f32 v23, 0x0da24260, v23
  v_rcp_f32 v23, v23
  s_nop 0
  v_pk_fma_f32 v[12:13], v[12:13], v[20:21], v[20:21] op_sel:[0,0,0] op_sel_hi:[1,0,0]
  v_pk_fma_f32 v[14:15], v[14:15], v[20:21], v[20:21] op_sel:[0,0,0] op_sel_hi:[1,0,0]
  v_pk_fma_f32 v[16:17], v[16:17], v[20:21], v[20:21] op_sel:[0,1,1] op_sel_hi:[1,1,1]
  v_pk_fma_f32 v[18:19], v[18:19], v[20:21], v[20:21] op_sel:[0,1,1] op_sel_hi:[1,1,1]
  v_rcp_f32 v12, v12
  v_rcp_f32 v13, v13
  v_rcp_f32 v14, v14
  v_rcp_f32 v15, v15
  v_rcp_f32 v16, v16
  v_rcp_f32 v17, v17
  v_rcp_f32 v18, v18
  v_rcp_f32 v19, v19
  s_nop 0
  v_pk_mul_f32 v[32:33], v[32:33], v[12:13]
  v_pk_mul_f32 v[34:35], v[34:35], v[14:15]
  v_pk_mul_f32 v[36:37], v[36:37], v[16:17]
  v_pk_mul_f32 v[38:39], v[38:39], v[18:19]
  v_cvt_pk_bf16_f32 v144, v32, v33
  v_cvt_pk_bf16_f32 v145, v34, v35
  v_cvt_pk_bf16_f32 v146, v36, v37
  v_cvt_pk_bf16_f32 v147, v38, v39
  v_pk_mul_f32 v[12:13], v[40:41], v[40:41]
  v_pk_mul_f32 v[14:15], v[42:43], v[42:43]
  v_pk_mul_f32 v[16:17], v[44:45], v[44:45]
  v_pk_mul_f32 v[18:19], v[46:47], v[46:47]
  s_add_u32 s76, s80, 0
  v_permlane16_swap_b32 v144, v146
  v_permlane16_swap_b32 v145, v147
  buffer_store_dwordx4 v[144:147], v26, s[52:55], s76 offen offset:0 sc1
  v_pk_fma_f32 v[12:13], v[12:13], s[96:97], v[10:11]
  v_pk_fma_f32 v[14:15], v[14:15], s[96:97], v[10:11]
  v_pk_fma_f32 v[16:17], v[16:17], s[96:97], v[10:11]
  v_pk_fma_f32 v[18:19], v[18:19], s[96:97], v[10:11]
  v_pk_mul_f32 v[12:13], v[12:13], v[40:41]
  v_pk_mul_f32 v[14:15], v[14:15], v[42:43]
  v_pk_mul_f32 v[16:17], v[16:17], v[44:45]
  v_pk_mul_f32 v[18:19], v[18:19], v[46:47]
  v_exp_f32 v12, v12
  v_exp_f32 v13, v13
  v_exp_f32 v14, v14
  v_exp_f32 v15, v15
  v_exp_f32 v16, v16
  v_exp_f32 v17, v17
  v_exp_f32 v18, v18
  v_exp_f32 v19, v19
  v_pk_mul_f32 v[40:41], v[40:41], v[152:153]
  v_pk_mul_f32 v[42:43], v[42:43], v[154:155]
  v_pk_mul_f32 v[44:45], v[44:45], v[156:157]
  v_pk_mul_f32 v[46:47], v[46:47], v[158:159]
  v_pk_fma_f32 v[12:13], v[12:13], v[22:23], v[22:23] op_sel:[0,0,0] op_sel_hi:[1,0,0]
  v_pk_fma_f32 v[14:15], v[14:15], v[22:23], v[22:23] op_sel:[0,0,0] op_sel_hi:[1,0,0]
  v_pk_fma_f32 v[16:17], v[16:17], v[22:23], v[22:23] op_sel:[0,1,1] op_sel_hi:[1,1,1]
  v_pk_fma_f32 v[18:19], v[18:19], v[22:23], v[22:23] op_sel:[0,1,1] op_sel_hi:[1,1,1]
  v_rcp_f32 v12, v12
  v_rcp_f32 v13, v13
  v_rcp_f32 v14, v14
  v_rcp_f32 v15, v15
  v_rcp_f32 v16, v16
  v_rcp_f32 v17, v17
  v_rcp_f32 v18, v18
  v_rcp_f32 v19, v19
  s_nop 0
  v_pk_mul_f32 v[40:41], v[40:41], v[12:13]
  v_pk_mul_f32 v[42:43], v[42:43], v[14:15]
  v_pk_mul_f32 v[44:45], v[44:45], v[16:17]
  v_pk_mul_f32 v[46:47], v[46:47], v[18:19]
  v_cvt_pk_bf16_f32 v152, v40, v41
  v_cvt_pk_bf16_f32 v153, v42, v43
  v_cvt_pk_bf16_f32 v154, v44, v45
  v_cvt_pk_bf16_f32 v155, v46, v47
  v_pk_mul_f32 v[12:13], v[48:49], v[48:49]
  v_pk_mul_f32 v[14:15], v[50:51], v[50:51]
  v_pk_mul_f32 v[16:17], v[52:53], v[52:53]
  v_pk_mul_f32 v[18:19], v[54:55], v[54:55]
  s_add_u32 s76, s80, 491520
  v_permlane16_swap_b32 v152, v154
  v_permlane16_swap_b32 v153, v155
  buffer_store_dwordx4 v[152:155], v26, s[52:55], s76 offen offset:0 sc1
  v_pk_fma_f32 v[12:13], v[12:13], s[96:97], v[10:11]
  v_pk_fma_f32 v[14:15], v[14:15], s[96:97], v[10:11]
  v_pk_fma_f32 v[16:17], v[16:17], s[96:97], v[10:11]
  v_pk_fma_f32 v[18:19], v[18:19], s[96:97], v[10:11]
  v_pk_mul_f32 v[12:13], v[12:13], v[48:49]
  v_pk_mul_f32 v[14:15], v[14:15], v[50:51]
  v_pk_mul_f32 v[16:17], v[16:17], v[52:53]
  v_pk_mul_f32 v[18:19], v[18:19], v[54:55]
  v_exp_f32 v12, v12
  v_exp_f32 v13, v13
  v_exp_f32 v14, v14
  v_exp_f32 v15, v15
  v_exp_f32 v16, v16
  v_exp_f32 v17, v17
  v_exp_f32 v18, v18
  v_exp_f32 v19, v19
  v_pk_mul_f32 v[48:49], v[48:49], v[160:161]
  v_pk_mul_f32 v[50:51], v[50:51], v[162:163]
  v_pk_mul_f32 v[52:53], v[52:53], v[164:165]
  v_pk_mul_f32 v[54:55], v[54:55], v[166:167]
  v_pk_fma_f32 v[12:13], v[12:13], v[20:21], v[20:21] op_sel:[0,0,0] op_sel_hi:[1,0,0]
  v_pk_fma_f32 v[14:15], v[14:15], v[20:21], v[20:21] op_sel:[0,0,0] op_sel_hi:[1,0,0]
  v_pk_fma_f32 v[16:17], v[16:17], v[20:21], v[20:21] op_sel:[0,1,1] op_sel_hi:[1,1,1]
  v_pk_fma_f32 v[18:19], v[18:19], v[20:21], v[20:21] op_sel:[0,1,1] op_sel_hi:[1,1,1]
  v_rcp_f32 v12, v12
  v_rcp_f32 v13, v13
  v_rcp_f32 v14, v14
  v_rcp_f32 v15, v15
  v_rcp_f32 v16, v16
  v_rcp_f32 v17, v17
  v_rcp_f32 v18, v18
  v_rcp_f32 v19, v19
  s_nop 0
  v_pk_mul_f32 v[48:49], v[48:49], v[12:13]
  v_pk_mul_f32 v[50:51], v[50:51], v[14:15]
  v_pk_mul_f32 v[52:53], v[52:53], v[16:17]
  v_pk_mul_f32 v[54:55], v[54:55], v[18:19]
  v_cvt_pk_bf16_f32 v160, v48, v49
  v_cvt_pk_bf16_f32 v161, v50, v51
  v_cvt_pk_bf16_f32 v162, v52, v53
  v_cvt_pk_bf16_f32 v163, v54, v55
  s_cmp_eq_u32 s68, 0
  s_cbranch_scc1 mp_11
  buffer_load_dword v25, v29, s[52:55], s79 offen sc1
mp_11:
  v_pk_mul_f32 v[12:13], v[56:57], v[56:57]
  v_pk_mul_f32 v[14:15], v[58:59], v[58:59]
  v_pk_mul_f32 v[16:17], v[60:61], v[60:61]
  v_pk_mul_f32 v[18:19], v[62:63], v[62:63]
  s_add_u32 s76, s80, 0
  v_permlane16_swap_b32 v160, v162
  v_permlane16_swap_b32 v161, v163
  buffer_store_dwordx4 v[160:163], v26, s[52:55], s76 offen offset:1024 sc1
  v_pk_fma_f32 v[12:13], v[12:13], s[96:97], v[10:11]
  v_pk_fma_f32 v[14:15], v[14:15], s[96:97], v[10:11]
  v_pk_fma_f32 v[16:17], v[16:17], s[96:97], v[10:11]
  v_pk_fma_f32 v[18:19], v[18:19], s[96:97], v[10:11]
  v_pk_mul_f32 v[12:13], v[12:13], v[56:57]
  v_pk_mul_f32 v[14:15], v[14:15], v[58:59]
  v_pk_mul_f32 v[16:17], v[16:17], v[60:61]
  v_pk_mul_f32 v[18:19], v[18:19], v[62:63]
  v_exp_f32 v12, v12
  v_exp_f32 v13, v13
  v_exp_f32 v14, v14
  v_exp_f32 v15, v15
  v_exp_f32 v16, v16
  v_exp_f32 v17, v17
  v_exp_f32 v18, v18
  v_exp_f32 v19, v19
  v_pk_mul_f32 v[56:57], v[56:57], v[168:169]
  v_pk_mul_f32 v[58:59], v[58:59], v[170:171]
  v_pk_mul_f32 v[60:61], v[60:61], v[172:173]
  v_pk_mul_f32 v[62:63], v[62:63], v[174:175]
  v_pk_fma_f32 v[12:13], v[12:13], v[22:23], v[22:23] op_sel:[0,0,0] op_sel_hi:[1,0,0]
  v_pk_fma_f32 v[14:15], v[14:15], v[22:23], v[22:23] op_sel:[0,0,0] op_sel_hi:[1,0,0]
  v_pk_fma_f32 v[16:17], v[16:17], v[22:23], v[22:23] op_sel:[0,1,1] op_sel_hi:[1,1,1]
  v_pk_fma_f32 v[18:19], v[18:19], v[22:23], v[22:23] op_sel:[0,1,1] op_sel_hi:[1,1,1]
  v_rcp_f32 v12, v12
  v_rcp_f32 v13, v13
  v_rcp_f32 v14, v14
  v_rcp_f32 v15, v15
  v_rcp_f32 v16, v16
  v_rcp_f32 v17, v17
  v_rcp_f32 v18, v18
  v_rcp_f32 v19, v19
  s_nop 0
  v_pk_mul_f32 v[56:57], v[56:57], v[12:13]
  v_pk_mul_f32 v[58:59], v[58:59], v[14:15]
  v_pk_mul_f32 v[60:61], v[60:61], v[16:17]
  v_pk_mul_f32 v[62:63], v[62:63], v[18:19]
  v_cvt_pk_bf16_f32 v168, v56, v57
  v_cvt_pk_bf16_f32 v169, v58, v59
  v_cvt_pk_bf16_f32 v170, v60, v61
  v_cvt_pk_bf16_f32 v171, v62, v63
  v_pk_mul_f32 v[12:13], v[64:65], v[64:65]
  v_pk_mul_f32 v[14:15], v[66:67], v[66:67]
  v_pk_mul_f32 v[16:17], v[68:69], v[68:69]
  v_pk_mul_f32 v[18:19], v[70:71], v[70:71]
  s_add_u32 s76, s80, 491520
  v_permlane16_swap_b32 v168, v170
  v_permlane16_swap_b32 v169, v171
  buffer_store_dwordx4 v[168:171], v26, s[52:55], s76 offen offset:1024 sc1
  v_pk_fma_f32 v[12:13], v[12:13], s[96:97], v[10:11]
  v_pk_fma_f32 v[14:15], v[14:15], s[96:97], v[10:11]
  v_pk_fma_f32 v[16:17], v[16:17], s[96:97], v[10:11]
  v_pk_fma_f32 v[18:19], v[18:19], s[96:97], v[10:11]
  v_pk_mul_f32 v[12:13], v[12:13], v[64:65]
  v_pk_mul_f32 v[14:15], v[14:15], v[66:67]
  v_pk_mul_f32 v[16:17], v[16:17], v[68:69]
  v_pk_mul_f32 v[18:19], v[18:19], v[70:71]
  v_exp_f32 v12, v12
  v_exp_f32 v13, v13
  v_exp_f32 v14, v14
  v_exp_f32 v15, v15
  v_exp_f32 v16, v16
  v_exp_f32 v17, v17
  v_exp_f32 v18, v18
  v_exp_f32 v19, v19
  v_pk_mul_f32 v[64:65], v[64:65], v[176:177]
  v_pk_mul_f32 v[66:67], v[66:67], v[178:179]
  v_pk_mul_f32 v[68:69], v[68:69], v[180:181]
  v_pk_mul_f32 v[70:71], v[70:71], v[182:183]
  v_pk_fma_f32 v[12:13], v[12:13], v[20:21], v[20:21] op_sel:[0,0,0] op_sel_hi:[1,0,0]
  v_pk_fma_f32 v[14:15], v[14:15], v[20:21], v[20:21] op_sel:[0,0,0] op_sel_hi:[1,0,0]
  v_pk_fma_f32 v[16:17], v[16:17], v[20:21], v[20:21] op_sel:[0,1,1] op_sel_hi:[1,1,1]
  v_pk_fma_f32 v[18:19], v[18:19], v[20:21], v[20:21] op_sel:[0,1,1] op_sel_hi:[1,1,1]
  v_rcp_f32 v12, v12
  v_rcp_f32 v13, v13
  v_rcp_f32 v14, v14
  v_rcp_f32 v15, v15
  v_rcp_f32 v16, v16
  v_rcp_f32 v17, v17
  v_rcp_f32 v18, v18
  v_rcp_f32 v19, v19
  s_nop 0
  v_pk_mul_f32 v[64:65], v[64:65], v[12:13]
  v_pk_mul_f32 v[66:67], v[66:67], v[14:15]
  v_pk_mul_f32 v[68:69], v[68:69], v[16:17]
  v_pk_mul_f32 v[70:71], v[70:71], v[18:19]
  v_cvt_pk_bf16_f32 v176, v64, v65
  v_cvt_pk_bf16_f32 v177, v66, v67
  v_cvt_pk_bf16_f32 v178, v68, v69
  v_cvt_pk_bf16_f32 v179, v70, v71
  v_pk_mul_f32 v[12:13], v[72:73], v[72:73]
  v_pk_mul_f32 v[14:15], v[74:75], v[74:75]
  v_pk_mul_f32 v[16:17], v[76:77], v[76:77]
  v_pk_mul_f32 v[18:19], v[78:79], v[78:79]
  s_add_u32 s76, s80, 0
  v_permlane16_swap_b32 v176, v178
  v_permlane16_swap_b32 v177, v179
  buffer_store_dwordx4 v[176:179], v26, s[52:55], s76 offen offset:2048 sc1
  v_pk_fma_f32 v[12:13], v[12:13], s[96:97], v[10:11]
  v_pk_fma_f32 v[14:15], v[14:15], s[96:97], v[10:11]
  v_pk_fma_f32 v[16:17], v[16:17], s[96:97], v[10:11]
  v_pk_fma_f32 v[18:19], v[18:19], s[96:97], v[10:11]
  v_pk_mul_f32 v[12:13], v[12:13], v[72:73]
  v_pk_mul_f32 v[14:15], v[14:15], v[74:75]
  v_pk_mul_f32 v[16:17], v[16:17], v[76:77]
  v_pk_mul_f32 v[18:19], v[18:19], v[78:79]
  v_exp_f32 v12, v12
  v_exp_f32 v13, v13
  v_exp_f32 v14, v14
  v_exp_f32 v15, v15
  v_exp_f32 v16, v16
  v_exp_f32 v17, v17
  v_exp_f32 v18, v18
  v_exp_f32 v19, v19
  v_pk_mul_f32 v[72:73], v[72:73], v[184:185]
  v_pk_mul_f32 v[74:75], v[74:75], v[186:187]
  v_pk_mul_f32 v[76:77], v[76:77], v[188:189]
  v_pk_mul_f32 v[78:79], v[78:79], v[190:191]
  v_pk_fma_f32 v[12:13], v[12:13], v[22:23], v[22:23] op_sel:[0,0,0] op_sel_hi:[1,0,0]
  v_pk_fma_f32 v[14:15], v[14:15], v[22:23], v[22:23] op_sel:[0,0,0] op_sel_hi:[1,0,0]
  v_pk_fma_f32 v[16:17], v[16:17], v[22:23], v[22:23] op_sel:[0,1,1] op_sel_hi:[1,1,1]
  v_pk_fma_f32 v[18:19], v[18:19], v[22:23], v[22:23] op_sel:[0,1,1] op_sel_hi:[1,1,1]
  v_rcp_f32 v12, v12
  v_rcp_f32 v13, v13
  v_rcp_f32 v14, v14
  v_rcp_f32 v15, v15
  v_rcp_f32 v16, v16
  v_rcp_f32 v17, v17
  v_rcp_f32 v18, v18
  v_rcp_f32 v19, v19
  s_nop 0
  v_pk_mul_f32 v[72:73], v[72:73], v[12:13]
  v_pk_mul_f32 v[74:75], v[74:75], v[14:15]
  v_pk_mul_f32 v[76:77], v[76:77], v[16:17]
  v_pk_mul_f32 v[78:79], v[78:79], v[18:19]
  v_cvt_pk_bf16_f32 v184, v72, v73
  v_cvt_pk_bf16_f32 v185, v74, v75
  v_cvt_pk_bf16_f32 v186, v76, v77
  v_cvt_pk_bf16_f32 v187, v78, v79
  v_pk_mul_f32 v[12:13], v[80:81], v[80:81]
  v_pk_mul_f32 v[14:15], v[82:83], v[82:83]
  v_pk_mul_f32 v[16:17], v[84:85], v[84:85]
  v_pk_mul_f32 v[18:19], v[86:87], v[86:87]
  s_add_u32 s76, s80, 491520
  v_permlane16_swap_b32 v184, v186
  v_permlane16_swap_b32 v185, v187
  buffer_store_dwordx4 v[184:187], v26, s[52:55], s76 offen offset:2048 sc1
  v_pk_fma_f32 v[12:13], v[12:13], s[96:97], v[10:11]
  v_pk_fma_f32 v[14:15], v[14:15], s[96:97], v[10:11]
  v_pk_fma_f32 v[16:17], v[16:17], s[96:97], v[10:11]
  v_pk_fma_f32 v[18:19], v[18:19], s[96:97], v[10:11]
  v_pk_mul_f32 v[12:13], v[12:13], v[80:81]
  v_pk_mul_f32 v[14:15], v[14:15], v[82:83]
  v_pk_mul_f32 v[16:17], v[16:17], v[84:85]
  v_pk_mul_f32 v[18:19], v[18:19], v[86:87]
  v_exp_f32 v12, v12
  v_exp_f32 v13, v13
  v_exp_f32 v14, v14
  v_exp_f32 v15, v15
  v_exp_f32 v16, v16
  v_exp_f32 v17, v17
  v_exp_f32 v18, v18
  v_exp_f32 v19, v19
  v_pk_mul_f32 v[80:81], v[80:81], v[192:193]
  v_pk_mul_f32 v[82:83], v[82:83], v[194:195]
  v_pk_mul_f32 v[84:85], v[84:85], v[196:197]
  v_pk_mul_f32 v[86:87], v[86:87], v[198:199]
  v_pk_fma_f32 v[12:13], v[12:13], v[20:21], v[20:21] op_sel:[0,0,0] op_sel_hi:[1,0,0]
  v_pk_fma_f32 v[14:15], v[14:15], v[20:21], v[20:21] op_sel:[0,0,0] op_sel_hi:[1,0,0]
  v_pk_fma_f32 v[16:17], v[16:17], v[20:21], v[20:21] op_sel:[0,1,1] op_sel_hi:[1,1,1]
  v_pk_fma_f32 v[18:19], v[18:19], v[20:21], v[20:21] op_sel:[0,1,1] op_sel_hi:[1,1,1]
  v_rcp_f32 v12, v12
  v_rcp_f32 v13, v13
  v_rcp_f32 v14, v14
  v_rcp_f32 v15, v15
  v_rcp_f32 v16, v16
  v_rcp_f32 v17, v17
  v_rcp_f32 v18, v18
  v_rcp_f32 v19, v19
  s_nop 0
  v_pk_mul_f32 v[80:81], v[80:81], v[12:13]
  v_pk_mul_f32 v[82:83], v[82:83], v[14:15]
  v_pk_mul_f32 v[84:85], v[84:85], v[16:17]
  v_pk_mul_f32 v[86:87], v[86:87], v[18:19]
  v_cvt_pk_bf16_f32 v192, v80, v81
  v_cvt_pk_bf16_f32 v193, v82, v83
  v_cvt_pk_bf16_f32 v194, v84, v85
  v_cvt_pk_bf16_f32 v195, v86, v87
  s_cmp_eq_u32 s68, 0
  s_cbranch_scc1 mc_12
  s_waitcnt vmcnt(4)
  s_mov_b32 s7, 0x1010101
  s_mov_b32 s77, 0x40000
  v_cmp_ne_u32 vcc, s7, v25
  s_nop 1
  s_and_b32 vcc_lo, vcc_lo, 0xffff
  s_cmp_eq_u32 vcc_lo, 0
  s_cbranch_scc0 mc_12
  s_and_b32 s28, s2, 7
  s_lshr_b32 s29, s2, 3
  s_lshl_b32 s16, s28, 2
  s_bfe_u32 s28, s29, 0x20002
  s_add_u32 s16, s16, s28
  s_and_b32 s36, s29, 3
  s_lshr_b32 s29, s29, 4
  s_lshl_b32 s29, s29, 2
  s_add_u32 s36, s36, s29
  s_sub_u32 s35, 15, s36
  v_lshlrev_b32 v1, 4, v0
  s_lshl_b32 s23, s67, 12
  v_add_u32 v2, s23, v1
  s_mov_b32 s21, s23
  s_add_u32 s22, s23, 163840
  s_lshl_b32 s28, s16, 19
  s_add_u32 s24, s28, 16777216
  s_add_u32 s25, s28, 33538048
  s_lshl_b32 s29, s35, 15
  s_add_u32 s29, s29, 16384
  s_add_u32 s26, s24, s29
  s_add_u32 s27, s26, 16777216
  v_and_b32 v24, 31, v0
  v_lshrrev_b32 v25, 5, v0
  v_lshlrev_b32 v25, 2, v25
  v_sub_u32 v4, v24, v25
  v_lshlrev_b32 v24, 2, v24
  s_mov_b32 m0, s21
  s_nop 0
  buffer_load_dwordx4 v2, s[52:55], s24 offen offset:0 sc1 lds
  buffer_load_dwordx4 v2, s[52:55], s24 offen offset:1024 sc1 lds
  buffer_load_dwordx4 v2, s[52:55], s24 offen offset:2048 sc1 lds
  buffer_load_dwordx4 v2, s[52:55], s24 offen offset:3072 sc1 lds
  s_add_u32 s21, s21, 32768
  s_cmp_eq_u32 s21, s22
  s_cselect_b32 s21, s23, s21
  s_add_u32 s24, s24, 16384
  s_min_u32 s24, s24, s26
  s_add_u32 s25, s25, 16384
  s_min_u32 s25, s25, s27
  s_lshl_b32 s29, s35, 2
  s_add_u32 s29, s29, s67
  s_lshl_b32 s30, s29, 13
  s_lshl_b32 s28, s16, 19
  s_add_u32 s30, s30, s28
  s_add_u32 s28, s30, 4096
  buffer_load_dwordx4 a[0:3], v1, s[52:55], s30 offen offset:0 sc1
  buffer_load_dwordx4 a[4:7], v1, s[52:55], s30 offen offset:1024 sc1
  buffer_load_dwordx4 a[8:11], v1, s[52:55], s30 offen offset:2048 sc1
  buffer_load_dwordx4 a[12:15], v1, s[52:55], s30 offen offset:3072 sc1
  buffer_load_dwordx4 a[16:19], v1, s[52:55], s28 offen offset:0 sc1
  buffer_load_dwordx4 a[20:23], v1, s[52:55], s28 offen offset:1024 sc1
  buffer_load_dwordx4 a[24:27], v1, s[52:55], s28 offen offset:2048 sc1
  buffer_load_dwordx4 a[28:31], v1, s[52:55], s28 offen offset:3072 sc1
  s_lshl_b32 s29, s29, 7
  s_add_u32 s29, s29, 83886080
  buffer_load_dword v8, v24, s[52:55], s29 offen sc1
  s_lshl_b32 s29, s36, 2
  s_add_u32 s29, s29, s67
  s_lshl_b32 s30, s29, 13
  s_lshl_b32 s28, s16, 19
  s_add_u32 s30, s30, s28
  s_add_u32 s28, s30, 4096
  buffer_load_dwordx4 a[32:35], v1, s[52:55], s30 offen offset:0 sc1
  buffer_load_dwordx4 a[36:39], v1, s[52:55], s30 offen offset:1024 sc1
  buffer_load_dwordx4 a[40:43], v1, s[52:55], s30 offen offset:2048 sc1
  buffer_load_dwordx4 a[44:47], v1, s[52:55], s30 offen offset:3072 sc1
  buffer_load_dwordx4 a[48:51], v1, s[52:55], s28 offen offset:0 sc1
  buffer_load_dwordx4 a[52:55], v1, s[52:55], s28 offen offset:1024 sc1
  buffer_load_dwordx4 a[56:59], v1, s[52:55], s28 offen offset:2048 sc1
  buffer_load_dwordx4 a[60:63], v1, s[52:55], s28 offen offset:3072 sc1
  s_lshl_b32 s29, s29, 7
  s_add_u32 s29, s29, 83886080
  buffer_load_dword v9, v24, s[52:55], s29 offen sc1
  s_mov_b32 m0, s21
  s_nop 0
  buffer_load_dwordx4 v2, s[52:55], s24 offen offset:0 sc1 lds
  buffer_load_dwordx4 v2, s[52:55], s24 offen offset:1024 sc1 lds
  buffer_load_dwordx4 v2, s[52:55], s24 offen offset:2048 sc1 lds
  buffer_load_dwordx4 v2, s[52:55], s24 offen offset:3072 sc1 lds
  s_add_u32 m0, s21, 16384
  s_nop 0
  buffer_load_dwordx4 v2, s[52:55], s25 offen offset:0 sc1 lds
  buffer_load_dwordx4 v2, s[52:55], s25 offen offset:1024 sc1 lds
  buffer_load_dwordx4 v2, s[52:55], s25 offen offset:2048 sc1 lds
  buffer_load_dwordx4 v2, s[52:55], s25 offen offset:3072 sc1 lds
  s_add_u32 s21, s21, 32768
  s_cmp_eq_u32 s21, s22
  s_cselect_b32 s21, s23, s21
  s_add_u32 s24, s24, 16384
  s_min_u32 s24, s24, s26
  s_add_u32 s25, s25, 16384
  s_min_u32 s25, s25, s27
  s_mov_b32 m0, s21
  s_nop 0
  buffer_load_dwordx4 v2, s[52:55], s24 offen offset:0 sc1 lds
  buffer_load_dwordx4 v2, s[52:55], s24 offen offset:1024 sc1 lds
  buffer_load_dwordx4 v2, s[52:55], s24 offen offset:2048 sc1 lds
  buffer_load_dwordx4 v2, s[52:55], s24 offen offset:3072 sc1 lds
  s_add_u32 m0, s21, 16384
  s_nop 0
  buffer_load_dwordx4 v2, s[52:55], s25 offen offset:0 sc1 lds
  buffer_load_dwordx4 v2, s[52:55], s25 offen offset:1024 sc1 lds
  buffer_load_dwordx4 v2, s[52:55], s25 offen offset:2048 sc1 lds
  buffer_load_dwordx4 v2, s[52:55], s25 offen offset:3072 sc1 lds
  s_add_u32 s21, s21, 32768
  s_cmp_eq_u32 s21, s22
  s_cselect_b32 s21, s23, s21
  s_add_u32 s24, s24, 16384
  s_min_u32 s24, s24, s26
  s_add_u32 s25, s25, 16384
  s_min_u32 s25, s25, s27
  s_mov_b32 s31, 0x45800000
  s_mov_b32 s32, 0xf149f2ca
  s_mov_b32 s20, 0
  s_mov_b32 s33, 83951616
  s_lshl_b32 s28, s35, 2
  s_sub_i32 s37, s28, 2
  s_add_u32 s39, s28, s67
  s_lshl_b32 s39, s39, 5
  s_lshl_b32 s28, s36, 2
  s_sub_i32 s38, s28, 2
  s_add_u32 s40, s28, s67
  s_lshl_b32 s40, s40, 5
  s_lshl_b32 s19, s36, 1
  s_add_u32 s19, s19, 1
  s_sub_u32 s34, s35, s36
  s_lshl_b32 s34, s34, 1
  s_sub_u32 s34, s34, 1
  s_mov_b32 s68, 2
mc_12:
  v_pk_mul_f32 v[12:13], v[88:89], v[88:89]
  v_pk_mul_f32 v[14:15], v[90:91], v[90:91]
  v_pk_mul_f32 v[16:17], v[92:93], v[92:93]
  v_pk_mul_f32 v[18:19], v[94:95], v[94:95]
  s_add_u32 s76, s80, 0
  v_permlane16_swap_b32 v192, v194
  v_permlane16_swap_b32 v193, v195
  buffer_store_dwordx4 v[192:195], v26, s[52:55], s76 offen offset:3072 sc1
  v_pk_fma_f32 v[12:13], v[12:13], s[96:97], v[10:11]
  v_pk_fma_f32 v[14:15], v[14:15], s[96:97], v[10:11]
  v_pk_fma_f32 v[16:17], v[16:17], s[96:97], v[10:11]
  v_pk_fma_f32 v[18:19], v[18:19], s[96:97], v[10:11]
  v_pk_mul_f32 v[12:13], v[12:13], v[88:89]
  v_pk_mul_f32 v[14:15], v[14:15], v[90:91]
  v_pk_mul_f32 v[16:17], v[16:17], v[92:93]
  v_pk_mul_f32 v[18:19], v[18:19], v[94:95]
  v_exp_f32 v12, v12
  v_exp_f32 v13, v13
  v_exp_f32 v14, v14
  v_exp_f32 v15, v15
  v_exp_f32 v16, v16
  v_exp_f32 v17, v17
  v_exp_f32 v18, v18
  v_exp_f32 v19, v19
  v_pk_mul_f32 v[88:89], v[88:89], v[200:201]
  v_pk_mul_f32 v[90:91], v[90:91], v[202:203]
  v_pk_mul_f32 v[92:93], v[92:93], v[204:205]
  v_pk_mul_f32 v[94:95], v[94:95], v[206:207]
  v_pk_fma_f32 v[12:13], v[12:13], v[22:23], v[22:23] op_sel:[0,0,0] op_sel_hi:[1,0,0]
  v_pk_fma_f32 v[14:15], v[14:15], v[22:23], v[22:23] op_sel:[0,0,0] op_sel_hi:[1,0,0]
  v_pk_fma_f32 v[16:17], v[16:17], v[22:23], v[22:23] op_sel:[0,1,1] op_sel_hi:[1,1,1]
  v_pk_fma_f32 v[18:19], v[18:19], v[22:23], v[22:23] op_sel:[0,1,1] op_sel_hi:[1,1,1]
  v_rcp_f32 v12, v12
  v_rcp_f32 v13, v13
  v_rcp_f32 v14, v14
  v_rcp_f32 v15, v15
  v_rcp_f32 v16, v16
  v_rcp_f32 v17, v17
  v_rcp_f32 v18, v18
  v_rcp_f32 v19, v19
  s_nop 0
  v_pk_mul_f32 v[88:89], v[88:89], v[12:13]
  v_pk_mul_f32 v[90:91], v[90:91], v[14:15]
  v_pk_mul_f32 v[92:93], v[92:93], v[16:17]
  v_pk_mul_f32 v[94:95], v[94:95], v[18:19]
  v_cvt_pk_bf16_f32 v200, v88, v89
  v_cvt_pk_bf16_f32 v201, v90, v91
  v_cvt_pk_bf16_f32 v202, v92, v93
  v_cvt_pk_bf16_f32 v203, v94, v95
  v_pk_mul_f32 v[12:13], v[96:97], v[96:97]
  v_pk_mul_f32 v[14:15], v[98:99], v[98:99]
  v_pk_mul_f32 v[16:17], v[100:101], v[100:101]
  v_pk_mul_f32 v[18:19], v[102:103], v[102:103]
  s_add_u32 s76, s80, 491520
  v_permlane16_swap_b32 v200, v202
  v_permlane16_swap_b32 v201, v203
  buffer_store_dwordx4 v[200:203], v26, s[52:55], s76 offen offset:3072 sc1
  v_pk_fma_f32 v[12:13], v[12:13], s[96:97], v[10:11]
  v_pk_fma_f32 v[14:15], v[14:15], s[96:97], v[10:11]
  v_pk_fma_f32 v[16:17], v[16:17], s[96:97], v[10:11]
  v_pk_fma_f32 v[18:19], v[18:19], s[96:97], v[10:11]
  v_pk_mul_f32 v[12:13], v[12:13], v[96:97]
  v_pk_mul_f32 v[14:15], v[14:15], v[98:99]
  v_pk_mul_f32 v[16:17], v[16:17], v[100:101]
  v_pk_mul_f32 v[18:19], v[18:19], v[102:103]
  v_exp_f32 v12, v12
  v_exp_f32 v13, v13
  v_exp_f32 v14, v14
  v_exp_f32 v15, v15
  v_exp_f32 v16, v16
  v_exp_f32 v17, v17
  v_exp_f32 v18, v18
  v_exp_f32 v19, v19
  v_pk_mul_f32 v[96:97], v[96:97], v[208:209]
  v_pk_mul_f32 v[98:99], v[98:99], v[210:211]
  v_pk_mul_f32 v[100:101], v[100:101], v[212:213]
  v_pk_mul_f32 v[102:103], v[102:103], v[214:215]
  v_pk_fma_f32 v[12:13], v[12:13], v[20:21], v[20:21] op_sel:[0,0,0] op_sel_hi:[1,0,0]
  v_pk_fma_f32 v[14:15], v[14:15], v[20:21], v[20:21] op_sel:[0,0,0] op_sel_hi:[1,0,0]
  v_pk_fma_f32 v[16:17], v[16:17], v[20:21], v[20:21] op_sel:[0,1,1] op_sel_hi:[1,1,1]
  v_pk_fma_f32 v[18:19], v[18:19], v[20:21], v[20:21] op_sel:[0,1,1] op_sel_hi:[1,1,1]
  v_rcp_f32 v12, v12
  v_rcp_f32 v13, v13
  v_rcp_f32 v14, v14
  v_rcp_f32 v15, v15
  v_rcp_f32 v16, v16
  v_rcp_f32 v17, v17
  v_rcp_f32 v18, v18
  v_rcp_f32 v19, v19
  s_nop 0
  v_pk_mul_f32 v[96:97], v[96:97], v[12:13]
  v_pk_mul_f32 v[98:99], v[98:99], v[14:15]
  v_pk_mul_f32 v[100:101], v[100:101], v[16:17]
  v_pk_mul_f32 v[102:103], v[102:103], v[18:19]
  v_cvt_pk_bf16_f32 v208, v96, v97
  v_cvt_pk_bf16_f32 v209, v98, v99
  v_cvt_pk_bf16_f32 v210, v100, v101
  v_cvt_pk_bf16_f32 v211, v102, v103
  v_pk_mul_f32 v[12:13], v[104:105], v[104:105]
  v_pk_mul_f32 v[14:15], v[106:107], v[106:107]
  v_pk_mul_f32 v[16:17], v[108:109], v[108:109]
  v_pk_mul_f32 v[18:19], v[110:111], v[110:111]
  s_add_u32 s76, s80, 4096
  v_permlane16_swap_b32 v208, v210
  v_permlane16_swap_b32 v209, v211
  buffer_store_dwordx4 v[208:211], v26, s[52:55], s76 offen offset:0 sc1
  v_pk_fma_f32 v[12:13], v[12:13], s[96:97], v[10:11]
  v_pk_fma_f32 v[14:15], v[14:15], s[96:97], v[10:11]
  v_pk_fma_f32 v[16:17], v[16:17], s[96:97], v[10:11]
  v_pk_fma_f32 v[18:19], v[18:19], s[96:97], v[10:11]
  v_pk_mul_f32 v[12:13], v[12:13], v[104:105]
  v_pk_mul_f32 v[14:15], v[14:15], v[106:107]
  v_pk_mul_f32 v[16:17], v[16:17], v[108:109]
  v_pk_mul_f32 v[18:19], v[18:19], v[110:111]
  v_exp_f32 v12, v12
  v_exp_f32 v13, v13
  v_exp_f32 v14, v14
  v_exp_f32 v15, v15
  v_exp_f32 v16, v16
  v_exp_f32 v17, v17
  v_exp_f32 v18, v18
  v_exp_f32 v19, v19
  v_pk_mul_f32 v[104:105], v[104:105], v[216:217]
  v_pk_mul_f32 v[106:107], v[106:107], v[218:219]
  v_pk_mul_f32 v[108:109], v[108:109], v[220:221]
  v_pk_mul_f32 v[110:111], v[110:111], v[222:223]
  v_pk_fma_f32 v[12:13], v[12:13], v[22:23], v[22:23] op_sel:[0,0,0] op_sel_hi:[1,0,0]
  v_pk_fma_f32 v[14:15], v[14:15], v[22:23], v[22:23] op_sel:[0,0,0] op_sel_hi:[1,0,0]
  v_pk_fma_f32 v[16:17], v[16:17], v[22:23], v[22:23] op_sel:[0,1,1] op_sel_hi:[1,1,1]
  v_pk_fma_f32 v[18:19], v[18:19], v[22:23], v[22:23] op_sel:[0,1,1] op_sel_hi:[1,1,1]
  v_rcp_f32 v12, v12
  v_rcp_f32 v13, v13
  v_rcp_f32 v14, v14
  v_rcp_f32 v15, v15
  v_rcp_f32 v16, v16
  v_rcp_f32 v17, v17
  v_rcp_f32 v18, v18
  v_rcp_f32 v19, v19
  s_nop 0
  v_pk_mul_f32 v[104:105], v[104:105], v[12:13]
  v_pk_mul_f32 v[106:107], v[106:107], v[14:15]
  v_pk_mul_f32 v[108:109], v[108:109], v[16:17]
  v_pk_mul_f32 v[110:111], v[110:111], v[18:19]
  v_cvt_pk_bf16_f32 v216, v104, v105
  v_cvt_pk_bf16_f32 v217, v106, v107
  v_cvt_pk_bf16_f32 v218, v108, v109
  v_cvt_pk_bf16_f32 v219, v110, v111
  v_pk_mul_f32 v[12:13], v[112:113], v[112:113]
  v_pk_mul_f32 v[14:15], v[114:115], v[114:115]
  v_pk_mul_f32 v[16:17], v[116:117], v[116:117]
  v_pk_mul_f32 v[18:19], v[118:119], v[118:119]
  s_add_u32 s76, s80, 495616
  v_permlane16_swap_b32 v216, v218
  v_permlane16_swap_b32 v217, v219
  buffer_store_dwordx4 v[216:219], v26, s[52:55], s76 offen offset:0 sc1
  v_pk_fma_f32 v[12:13], v[12:13], s[96:97], v[10:11]
  v_pk_fma_f32 v[14:15], v[14:15], s[96:97], v[10:11]
  v_pk_fma_f32 v[16:17], v[16:17], s[96:97], v[10:11]
  v_pk_fma_f32 v[18:19], v[18:19], s[96:97], v[10:11]
  v_pk_mul_f32 v[12:13], v[12:13], v[112:113]
  v_pk_mul_f32 v[14:15], v[14:15], v[114:115]
  v_pk_mul_f32 v[16:17], v[16:17], v[116:117]
  v_pk_mul_f32 v[18:19], v[18:19], v[118:119]
  v_exp_f32 v12, v12
  v_exp_f32 v13, v13
  v_exp_f32 v14, v14
  v_exp_f32 v15, v15
  v_exp_f32 v16, v16
  v_exp_f32 v17, v17
  v_exp_f32 v18, v18
  v_exp_f32 v19, v19
  v_pk_mul_f32 v[112:113], v[112:113], v[224:225]
  v_pk_mul_f32 v[114:115], v[114:115], v[226:227]
  v_pk_mul_f32 v[116:117], v[116:117], v[228:229]
  v_pk_mul_f32 v[118:119], v[118:119], v[230:231]
  v_pk_fma_f32 v[12:13], v[12:13], v[20:21], v[20:21] op_sel:[0,0,0] op_sel_hi:[1,0,0]
  v_pk_fma_f32 v[14:15], v[14:15], v[20:21], v[20:21] op_sel:[0,0,0] op_sel_hi:[1,0,0]
  v_pk_fma_f32 v[16:17], v[16:17], v[20:21], v[20:21] op_sel:[0,1,1] op_sel_hi:[1,1,1]
  v_pk_fma_f32 v[18:19], v[18:19], v[20:21], v[20:21] op_sel:[0,1,1] op_sel_hi:[1,1,1]
  v_rcp_f32 v12, v12
  v_rcp_f32 v13, v13
  v_rcp_f32 v14, v14
  v_rcp_f32 v15, v15
  v_rcp_f32 v16, v16
  v_rcp_f32 v17, v17
  v_rcp_f32 v18, v18
  v_rcp_f32 v19, v19
  s_nop 0
  v_pk_mul_f32 v[112:113], v[112:113], v[12:13]
  v_pk_mul_f32 v[114:115], v[114:115], v[14:15]
  v_pk_mul_f32 v[116:117], v[116:117], v[16:17]
  v_pk_mul_f32 v[118:119], v[118:119], v[18:19]
  v_cvt_pk_bf16_f32 v224, v112, v113
  v_cvt_pk_bf16_f32 v225, v114, v115
  v_cvt_pk_bf16_f32 v226, v116, v117
  v_cvt_pk_bf16_f32 v227, v118, v119
  v_pk_mul_f32 v[12:13], v[120:121], v[120:121]
  v_pk_mul_f32 v[14:15], v[122:123], v[122:123]
  v_pk_mul_f32 v[16:17], v[124:125], v[124:125]
  v_pk_mul_f32 v[18:19], v[126:127], v[126:127]
  s_add_u32 s76, s80, 4096
  v_permlane16_swap_b32 v224, v226
  v_permlane16_swap_b32 v225, v227
  buffer_store_dwordx4 v[224:227], v26, s[52:55], s76 offen offset:1024 sc1
  v_pk_fma_f32 v[12:13], v[12:13], s[96:97], v[10:11]
  v_pk_fma_f32 v[14:15], v[14:15], s[96:97], v[10:11]
  v_pk_fma_f32 v[16:17], v[16:17], s[96:97], v[10:11]
  v_pk_fma_f32 v[18:19], v[18:19], s[96:97], v[10:11]
  v_pk_mul_f32 v[12:13], v[12:13], v[120:121]
  v_pk_mul_f32 v[14:15], v[14:15], v[122:123]
  v_pk_mul_f32 v[16:17], v[16:17], v[124:125]
  v_pk_mul_f32 v[18:19], v[18:19], v[126:127]
  v_exp_f32 v12, v12
  v_exp_f32 v13, v13
  v_exp_f32 v14, v14
  v_exp_f32 v15, v15
  v_exp_f32 v16, v16
  v_exp_f32 v17, v17
  v_exp_f32 v18, v18
  v_exp_f32 v19, v19
  v_pk_mul_f32 v[120:121], v[120:121], v[232:233]
  v_pk_mul_f32 v[122:123], v[122:123], v[234:235]
  v_pk_mul_f32 v[124:125], v[124:125], v[236:237]
  v_pk_mul_f32 v[126:127], v[126:127], v[238:239]
  v_pk_fma_f32 v[12:13], v[12:13], v[22:23], v[22:23] op_sel:[0,0,0] op_sel_hi:[1,0,0]
  v_pk_fma_f32 v[14:15], v[14:15], v[22:23], v[22:23] op_sel:[0,0,0] op_sel_hi:[1,0,0]
  v_pk_fma_f32 v[16:17], v[16:17], v[22:23], v[22:23] op_sel:[0,1,1] op_sel_hi:[1,1,1]
  v_pk_fma_f32 v[18:19], v[18:19], v[22:23], v[22:23] op_sel:[0,1,1] op_sel_hi:[1,1,1]
  v_rcp_f32 v12, v12
  v_rcp_f32 v13, v13
  v_rcp_f32 v14, v14
  v_rcp_f32 v15, v15
  v_rcp_f32 v16, v16
  v_rcp_f32 v17, v17
  v_rcp_f32 v18, v18
  v_rcp_f32 v19, v19
  s_nop 0
  v_pk_mul_f32 v[120:121], v[120:121], v[12:13]
  v_pk_mul_f32 v[122:123], v[122:123], v[14:15]
  v_pk_mul_f32 v[124:125], v[124:125], v[16:17]
  v_pk_mul_f32 v[126:127], v[126:127], v[18:19]
  v_cvt_pk_bf16_f32 v232, v120, v121
  v_cvt_pk_bf16_f32 v233, v122, v123
  v_cvt_pk_bf16_f32 v234, v124, v125
  v_cvt_pk_bf16_f32 v235, v126, v127
  v_pk_mul_f32 v[12:13], v[128:129], v[128:129]
  v_pk_mul_f32 v[14:15], v[130:131], v[130:131]
  v_pk_mul_f32 v[16:17], v[132:133], v[132:133]
  v_pk_mul_f32 v[18:19], v[134:135], v[134:135]
  s_add_u32 s76, s80, 495616
  v_permlane16_swap_b32 v232, v234
  v_permlane16_swap_b32 v233, v235
  buffer_store_dwordx4 v[232:235], v26, s[52:55], s76 offen offset:1024 sc1
  v_pk_fma_f32 v[12:13], v[12:13], s[96:97], v[10:11]
  v_pk_fma_f32 v[14:15], v[14:15], s[96:97], v[10:11]
  v_pk_fma_f32 v[16:17], v[16:17], s[96:97], v[10:11]
  v_pk_fma_f32 v[18:19], v[18:19], s[96:97], v[10:11]
  v_pk_mul_f32 v[12:13], v[12:13], v[128:129]
  v_pk_mul_f32 v[14:15], v[14:15], v[130:131]
  v_pk_mul_f32 v[16:17], v[16:17], v[132:133]
  v_pk_mul_f32 v[18:19], v[18:19], v[134:135]
  v_exp_f32 v12, v12
  v_exp_f32 v13, v13
  v_exp_f32 v14, v14
  v_exp_f32 v15, v15
  v_exp_f32 v16, v16
  v_exp_f32 v17, v17
  v_exp_f32 v18, v18
  v_exp_f32 v19, v19
  v_pk_mul_f32 v[128:129], v[128:129], v[240:241]
  v_pk_mul_f32 v[130:131], v[130:131], v[242:243]
  v_pk_mul_f32 v[132:133], v[132:133], v[244:245]
  v_pk_mul_f32 v[134:135], v[134:135], v[246:247]
  v_pk_fma_f32 v[12:13], v[12:13], v[20:21], v[20:21] op_sel:[0,0,0] op_sel_hi:[1,0,0]
  v_pk_fma_f32 v[14:15], v[14:15], v[20:21], v[20:21] op_sel:[0,0,0] op_sel_hi:[1,0,0]
  v_pk_fma_f32 v[16:17], v[16:17], v[20:21], v[20:21] op_sel:[0,1,1] op_sel_hi:[1,1,1]
  v_pk_fma_f32 v[18:19], v[18:19], v[20:21], v[20:21] op_sel:[0,1,1] op_sel_hi:[1,1,1]
  v_rcp_f32 v12, v12
  v_rcp_f32 v13, v13
  v_rcp_f32 v14, v14
  v_rcp_f32 v15, v15
  v_rcp_f32 v16, v16
  v_rcp_f32 v17, v17
  v_rcp_f32 v18, v18
  v_rcp_f32 v19, v19
  s_nop 0
  v_pk_mul_f32 v[128:129], v[128:129], v[12:13]
  v_pk_mul_f32 v[130:131], v[130:131], v[14:15]
  v_pk_mul_f32 v[132:133], v[132:133], v[16:17]
  v_pk_mul_f32 v[134:135], v[134:135], v[18:19]
  v_cvt_pk_bf16_f32 v240, v128, v129
  v_cvt_pk_bf16_f32 v241, v130, v131
  v_cvt_pk_bf16_f32 v242, v132, v133
  v_cvt_pk_bf16_f32 v243, v134, v135
  v_pk_mul_f32 v[12:13], v[136:137], v[136:137]
  v_pk_mul_f32 v[14:15], v[138:139], v[138:139]
  v_pk_mul_f32 v[16:17], v[140:141], v[140:141]
  v_pk_mul_f32 v[18:19], v[142:143], v[142:143]
  s_add_u32 s76, s80, 4096
  v_permlane16_swap_b32 v240, v242
  v_permlane16_swap_b32 v241, v243
  buffer_store_dwordx4 v[240:243], v26, s[52:55], s76 offen offset:2048 sc1
  v_pk_fma_f32 v[12:13], v[12:13], s[96:97], v[10:11]
  v_pk_fma_f32 v[14:15], v[14:15], s[96:97], v[10:11]
  v_pk_fma_f32 v[16:17], v[16:17], s[96:97], v[10:11]
  v_pk_fma_f32 v[18:19], v[18:19], s[96:97], v[10:11]
  v_pk_mul_f32 v[12:13], v[12:13], v[136:137]
  v_pk_mul_f32 v[14:15], v[14:15], v[138:139]
  v_pk_mul_f32 v[16:17], v[16:17], v[140:141]
  v_pk_mul_f32 v[18:19], v[18:19], v[142:143]
  v_exp_f32 v12, v12
  v_exp_f32 v13, v13
  v_exp_f32 v14, v14
  v_exp_f32 v15, v15
  v_exp_f32 v16, v16
  v_exp_f32 v17, v17
  v_exp_f32 v18, v18
  v_exp_f32 v19, v19
  v_pk_mul_f32 v[136:137], v[136:137], v[248:249]
  v_pk_mul_f32 v[138:139], v[138:139], v[250:251]
  v_pk_mul_f32 v[140:141], v[140:141], v[252:253]
  v_pk_mul_f32 v[142:143], v[142:143], v[254:255]
  v_pk_fma_f32 v[12:13], v[12:13], v[22:23], v[22:23] op_sel:[0,0,0] op_sel_hi:[1,0,0]
  v_pk_fma_f32 v[14:15], v[14:15], v[22:23], v[22:23] op_sel:[0,0,0] op_sel_hi:[1,0,0]
  v_pk_fma_f32 v[16:17], v[16:17], v[22:23], v[22:23] op_sel:[0,1,1] op_sel_hi:[1,1,1]
  v_pk_fma_f32 v[18:19], v[18:19], v[22:23], v[22:23] op_sel:[0,1,1] op_sel_hi:[1,1,1]
  v_rcp_f32 v12, v12
  v_rcp_f32 v13, v13
  v_rcp_f32 v14, v14
  v_rcp_f32 v15, v15
  v_rcp_f32 v16, v16
  v_rcp_f32 v17, v17
  v_rcp_f32 v18, v18
  v_rcp_f32 v19, v19
  s_nop 0
  v_pk_mul_f32 v[136:137], v[136:137], v[12:13]
  v_pk_mul_f32 v[138:139], v[138:139], v[14:15]
  v_pk_mul_f32 v[140:141], v[140:141], v[16:17]
  v_pk_mul_f32 v[142:143], v[142:143], v[18:19]
  v_cvt_pk_bf16_f32 v248, v136, v137
  v_cvt_pk_bf16_f32 v249, v138, v139
  v_cvt_pk_bf16_f32 v250, v140, v141
  v_cvt_pk_bf16_f32 v251, v142, v143
  s_nop 0
  s_add_u32 s76, s80, 495616
  v_permlane16_swap_b32 v248, v250
  v_permlane16_swap_b32 v249, v251
  buffer_store_dwordx4 v[248:251], v26, s[52:55], s76 offen offset:2048 sc1
  s_cmp_eq_u32 s68, 0
  s_cbranch_scc1 mk_att
  s_cmp_eq_u32 s68, 2
  s_cbranch_scc1 mk_att2
  buffer_load_dword v25, v29, s[52:55], s79 offen sc1
  s_waitcnt vmcnt(0)
  s_mov_b32 s7, 0x1010101
  s_mov_b32 s76, 0x40000
  v_cmp_ne_u32 vcc, s7, v25
  s_nop 1
  s_and_b32 vcc_lo, vcc_lo, 0xffff
  s_cmp_eq_u32 vcc_lo, 0
  s_cbranch_scc1 pok_15
pspin_16:
  s_sleep 8
  buffer_load_dword v25, v29, s[52:55], s79 offen sc1
  s_sub_u32 s76, s76, 1
  s_cmp_eq_u32 s76, 0
  s_cbranch_scc1 pok_15
  s_waitcnt vmcnt(0)
  v_cmp_ne_u32 vcc, s7, v25
  s_nop 1
  s_and_b32 vcc_lo, vcc_lo, 0xffff
  s_cmp_eq_u32 vcc_lo, 0
  s_cbranch_scc0 pspin_16
pok_15:
  s_and_b32 s28, s2, 7
  s_lshr_b32 s29, s2, 3
  s_lshl_b32 s16, s28, 2
  s_bfe_u32 s28, s29, 0x20002
  s_add_u32 s16, s16, s28
  s_and_b32 s36, s29, 3
  s_lshr_b32 s29, s29, 4
  s_lshl_b32 s29, s29, 2
  s_add_u32 s36, s36, s29
  s_sub_u32 s35, 15, s36
  v_lshlrev_b32 v1, 4, v0
  s_lshl_b32 s23, s67, 12
  v_add_u32 v2, s23, v1
  s_mov_b32 s21, s23
  s_add_u32 s22, s23, 163840
  s_lshl_b32 s28, s16, 19
  s_add_u32 s24, s28, 16777216
  s_add_u32 s25, s28, 33538048
  s_lshl_b32 s29, s35, 15
  s_add_u32 s29, s29, 16384
  s_add_u32 s26, s24, s29
  s_add_u32 s27, s26, 16777216
  v_and_b32 v24, 31, v0
  v_lshrrev_b32 v25, 5, v0
  v_lshlrev_b32 v25, 2, v25
  v_sub_u32 v4, v24, v25
  v_lshlrev_b32 v24, 2, v24
  s_mov_b32 m0, s21
  s_nop 0
  buffer_load_dwordx4 v2, s[52:55], s24 offen offset:0 sc1 lds
  buffer_load_dwordx4 v2, s[52:55], s24 offen offset:1024 sc1 lds
  buffer_load_dwordx4 v2, s[52:55], s24 offen offset:2048 sc1 lds
  buffer_load_dwordx4 v2, s[52:55], s24 offen offset:3072 sc1 lds
  s_add_u32 s21, s21, 32768
  s_cmp_eq_u32 s21, s22
  s_cselect_b32 s21, s23, s21
  s_add_u32 s24, s24, 16384
  s_min_u32 s24, s24, s26
  s_add_u32 s25, s25, 16384
  s_min_u32 s25, s25, s27
  s_lshl_b32 s29, s35, 2
  s_add_u32 s29, s29, s67
  s_lshl_b32 s30, s29, 13
  s_lshl_b32 s28, s16, 19
  s_add_u32 s30, s30, s28
  s_add_u32 s28, s30, 4096
  buffer_load_dwordx4 a[0:3], v1, s[52:55], s30 offen offset:0 sc1
  buffer_load_dwordx4 a[4:7], v1, s[52:55], s30 offen offset:1024 sc1
  buffer_load_dwordx4 a[8:11], v1, s[52:55], s30 offen offset:2048 sc1
  buffer_load_dwordx4 a[12:15], v1, s[52:55], s30 offen offset:3072 sc1
  buffer_load_dwordx4 a[16:19], v1, s[52:55], s28 offen offset:0 sc1
  buffer_load_dwordx4 a[20:23], v1, s[52:55], s28 offen offset:1024 sc1
  buffer_load_dwordx4 a[24:27], v1, s[52:55], s28 offen offset:2048 sc1
  buffer_load_dwordx4 a[28:31], v1, s[52:55], s28 offen offset:3072 sc1
  s_lshl_b32 s29, s29, 7
  s_add_u32 s29, s29, 83886080
  buffer_load_dword v8, v24, s[52:55], s29 offen sc1
  s_lshl_b32 s29, s36, 2
  s_add_u32 s29, s29, s67
  s_lshl_b32 s30, s29, 13
  s_lshl_b32 s28, s16, 19
  s_add_u32 s30, s30, s28
  s_add_u32 s28, s30, 4096
  buffer_load_dwordx4 a[32:35], v1, s[52:55], s30 offen offset:0 sc1
  buffer_load_dwordx4 a[36:39], v1, s[52:55], s30 offen offset:1024 sc1
  buffer_load_dwordx4 a[40:43], v1, s[52:55], s30 offen offset:2048 sc1
  buffer_load_dwordx4 a[44:47], v1, s[52:55], s30 offen offset:3072 sc1
  buffer_load_dwordx4 a[48:51], v1, s[52:55], s28 offen offset:0 sc1
  buffer_load_dwordx4 a[52:55], v1, s[52:55], s28 offen offset:1024 sc1
  buffer_load_dwordx4 a[56:59], v1, s[52:55], s28 offen offset:2048 sc1
  buffer_load_dwordx4 a[60:63], v1, s[52:55], s28 offen offset:3072 sc1
  s_lshl_b32 s29, s29, 7
  s_add_u32 s29, s29, 83886080
  buffer_load_dword v9, v24, s[52:55], s29 offen sc1
  s_mov_b32 m0, s21
  s_nop 0
  buffer_load_dwordx4 v2, s[52:55], s24 offen offset:0 sc1 lds
  buffer_load_dwordx4 v2, s[52:55], s24 offen offset:1024 sc1 lds
  buffer_load_dwordx4 v2, s[52:55], s24 offen offset:2048 sc1 lds
  buffer_load_dwordx4 v2, s[52:55], s24 offen offset:3072 sc1 lds
  s_add_u32 m0, s21, 16384
  s_nop 0
  buffer_load_dwordx4 v2, s[52:55], s25 offen offset:0 sc1 lds
  buffer_load_dwordx4 v2, s[52:55], s25 offen offset:1024 sc1 lds
  buffer_load_dwordx4 v2, s[52:55], s25 offen offset:2048 sc1 lds
  buffer_load_dwordx4 v2, s[52:55], s25 offen offset:3072 sc1 lds
  s_add_u32 s21, s21, 32768
  s_cmp_eq_u32 s21, s22
  s_cselect_b32 s21, s23, s21
  s_add_u32 s24, s24, 16384
  s_min_u32 s24, s24, s26
  s_add_u32 s25, s25, 16384
  s_min_u32 s25, s25, s27
  s_mov_b32 m0, s21
  s_nop 0
  buffer_load_dwordx4 v2, s[52:55], s24 offen offset:0 sc1 lds
  buffer_load_dwordx4 v2, s[52:55], s24 offen offset:1024 sc1 lds
  buffer_load_dwordx4 v2, s[52:55], s24 offen offset:2048 sc1 lds
  buffer_load_dwordx4 v2, s[52:55], s24 offen offset:3072 sc1 lds
  s_add_u32 m0, s21, 16384
  s_nop 0
  buffer_load_dwordx4 v2, s[52:55], s25 offen offset:0 sc1 lds
  buffer_load_dwordx4 v2, s[52:55], s25 offen offset:1024 sc1 lds
  buffer_load_dwordx4 v2, s[52:55], s25 offen offset:2048 sc1 lds
  buffer_load_dwordx4 v2, s[52:55], s25 offen offset:3072 sc1 lds
  s_add_u32 s21, s21, 32768
  s_cmp_eq_u32 s21, s22
  s_cselect_b32 s21, s23, s21
  s_add_u32 s24, s24, 16384
  s_min_u32 s24, s24, s26
  s_add_u32 s25, s25, 16384
  s_min_u32 s25, s25, s27
  s_mov_b32 s31, 0x45800000
  s_mov_b32 s32, 0xf149f2ca
  s_mov_b32 s20, 0
  s_mov_b32 s33, 83951616
  s_lshl_b32 s28, s35, 2
  s_sub_i32 s37, s28, 2
  s_add_u32 s39, s28, s67
  s_lshl_b32 s39, s39, 5
  s_lshl_b32 s28, s36, 2
  s_sub_i32 s38, s28, 2
  s_add_u32 s40, s28, s67
  s_lshl_b32 s40, s40, 5
  s_lshl_b32 s19, s36, 1
  s_add_u32 s19, s19, 1
  s_sub_u32 s34, s35, s36
  s_lshl_b32 s34, s34, 1
  s_sub_u32 s34, s34, 1
  s_waitcnt vmcnt(0)
mk_att2:
  s_waitcnt vmcnt(8)
mk_att:
  s_load_dwordx2 s[12:13], s[0:1], 40
  s_load_dwordx2 s[44:45], s[0:1], 72
  s_mov_b32 s14, 8388608
  s_mov_b32 s46, 7340032
  s_lshl_b32 s28, s2, 2
  s_add_u32 s28, s28, s67
  s_mul_i32 s28, s28, 512
  v_lshlrev_b32 v15, 7, v0
  v_add_u32 v15, s28, v15
  v_cmp_gt_u32 vcc, 4, v0
  v_mov_b32 v28, 0x70000000
  v_mov_b32 v6, 0
  v_cndmask_b32 v15, v28, v15, vcc
  s_waitcnt vmcnt(14) lgkmcnt(0)
  s_barrier
  v_mov_b32 v3, v1
  ds_read_b128 a[64:67], v3 offset:0
  ds_read_b128 a[68:71], v3 offset:1024
  ds_read_b128 a[72:75], v3 offset:2048
  ds_read_b128 a[76:79], v3 offset:3072
  ds_read_b128 a[80:83], v3 offset:4096
  ds_read_b128 a[84:87], v3 offset:5120
  ds_read_b128 a[88:91], v3 offset:6144
  ds_read_b128 a[92:95], v3 offset:7168
  s_mov_b32 m0, s21
  s_mov_b32 s29, 0
  buffer_load_dwordx4 v2, s[52:55], s24 offen offset:0 sc1 lds
  buffer_load_dwordx4 v2, s[52:55], s24 offen offset:1024 sc1 lds
  buffer_load_dwordx4 v2, s[52:55], s24 offen offset:2048 sc1 lds
  buffer_load_dwordx4 v2, s[52:55], s24 offen offset:3072 sc1 lds
  s_lshl_b32 s30, s29, 5
  s_sub_i32 s30, s40, s30
  v_add_u32 v12, s30, v4
  v_mov_b32 v13, s32
  v_cmp_gt_i32 s[56:57], 0, v12
  v_cmp_gt_i32 s[58:59], 1, v12
  v_cmp_gt_i32 s[60:61], 2, v12
  v_cmp_gt_i32 s[62:63], 3, v12
  v_cndmask_b32 v160, v6, v13, s[56:57]
  v_cndmask_b32 v161, v6, v13, s[58:59]
  v_cndmask_b32 v162, v6, v13, s[60:61]
  v_cndmask_b32 v163, v6, v13, s[62:63]
  v_cmp_gt_i32 s[56:57], 8, v12
  v_cmp_gt_i32 s[58:59], 9, v12
  v_cmp_gt_i32 s[60:61], 10, v12
  v_cmp_gt_i32 s[62:63], 11, v12
  v_cndmask_b32 v164, v6, v13, s[56:57]
  v_cndmask_b32 v165, v6, v13, s[58:59]
  v_cndmask_b32 v166, v6, v13, s[60:61]
  v_cndmask_b32 v167, v6, v13, s[62:63]
  v_cmp_gt_i32 s[56:57], 16, v12
  v_cmp_gt_i32 s[58:59], 17, v12
  v_cmp_gt_i32 s[60:61], 18, v12
  v_cmp_gt_i32 s[62:63], 19, v12
  v_cndmask_b32 v168, v6, v13, s[56:57]
  v_cndmask_b32 v169, v6, v13, s[58:59]
  v_cndmask_b32 v170, v6, v13, s[60:61]
  v_cndmask_b32 v171, v6, v13, s[62:63]
  v_cmp_gt_i32 s[56:57], 24, v12
  v_cmp_gt_i32 s[58:59], 25, v12
  v_cmp_gt_i32 s[60:61], 26, v12
  v_cmp_gt_i32 s[62:63], 27, v12
  v_cndmask_b32 v172, v6, v13, s[56:57]
  v_cndmask_b32 v173, v6, v13, s[58:59]
  v_cndmask_b32 v174, v6, v13, s[60:61]
  v_cndmask_b32 v175, v6, v13, s[62:63]
  v_mov_b32 v224, 0
  v_mov_b32 v225, 0
  v_mov_b32 v226, 0
  v_mov_b32 v227, 0
  v_mov_b32 v7, 0
  v_mov_b32 v24, 0
  s_waitcnt lgkmcnt(0)
  v_mfma_f32_32x32x16_bf16 v[48:63], a[64:67], a[0:3], 0
  s_add_u32 m0, s21, 16384
  v_mfma_f32_32x32x16_bf16 v[176:191], a[64:67], a[32:35], v[160:175]
  ds_read_b128 a[64:67], v3 offset:8192
  v_mfma_f32_32x32x16_bf16 v[48:63], a[68:71], a[4:7], v[48:63]
  buffer_load_dwordx4 v2, s[52:55], s25 offen offset:0 sc1 lds
  v_mfma_f32_32x32x16_bf16 v[176:191], a[68:71], a[36:39], v[176:191]
  ds_read_b128 a[68:71], v3 offset:9216
  v_mfma_f32_32x32x16_bf16 v[48:63], a[72:75], a[8:11], v[48:63]
  buffer_load_dwordx4 v2, s[52:55], s25 offen offset:1024 sc1 lds
  v_mfma_f32_32x32x16_bf16 v[176:191], a[72:75], a[40:43], v[176:191]
  ds_read_b128 a[72:75], v3 offset:10240
  v_mfma_f32_32x32x16_bf16 v[48:63], a[76:79], a[12:15], v[48:63]
  buffer_load_dwordx4 v2, s[52:55], s25 offen offset:2048 sc1 lds
  v_mfma_f32_32x32x16_bf16 v[176:191], a[76:79], a[44:47], v[176:191]
  ds_read_b128 a[76:79], v3 offset:11264
  v_mfma_f32_32x32x16_bf16 v[48:63], a[80:83], a[16:19], v[48:63]
  buffer_load_dwordx4 v2, s[52:55], s25 offen offset:3072 sc1 lds
  v_mfma_f32_32x32x16_bf16 v[176:191], a[80:83], a[48:51], v[176:191]
  ds_read_b128 a[80:83], v3 offset:12288
  v_mfma_f32_32x32x16_bf16 v[48:63], a[84:87], a[20:23], v[48:63]
  s_add_u32 s21, s21, 32768
  s_cmp_eq_u32 s21, s22
  s_cselect_b32 s21, s23, s21
  s_add_u32 s24, s24, 16384
  s_min_u32 s24, s24, s26
  s_add_u32 s25, s25, 16384
  v_mfma_f32_32x32x16_bf16 v[176:191], a[84:87], a[52:55], v[176:191]
  ds_read_b128 a[84:87], v3 offset:13312
  s_min_u32 s25, s25, s27
  buffer_load_dword v28, v15, s[12:15], 0 offen
  buffer_load_dword v28, v15, s[44:47], 0 offen
  v_add_u32 v15, 524288, v15
  s_mov_b32 s29, 1
  v_mfma_f32_32x32x16_bf16 v[48:63], a[88:91], a[24:27], v[48:63]
  s_lshl_b32 s30, s29, 5
  s_sub_i32 s30, s40, s30
  v_add_u32 v12, s30, v4
  v_mov_b32 v13, s32
  v_cmp_gt_i32 s[56:57], 0, v12
  v_cmp_gt_i32 s[58:59], 1, v12
  v_mfma_f32_32x32x16_bf16 v[176:191], a[88:91], a[56:59], v[176:191]
  ds_read_b128 a[88:91], v3 offset:14336
  v_cmp_gt_i32 s[60:61], 2, v12
  v_cmp_gt_i32 s[62:63], 3, v12
  v_cndmask_b32 v160, v6, v13, s[56:57]
  v_cndmask_b32 v161, v6, v13, s[58:59]
  v_cndmask_b32 v162, v6, v13, s[60:61]
  v_mfma_f32_32x32x16_bf16 v[48:63], a[92:95], a[28:31], v[48:63]
  v_cndmask_b32 v163, v6, v13, s[62:63]
  v_cmp_gt_i32 s[56:57], 8, v12
  v_cmp_gt_i32 s[58:59], 9, v12
  v_cmp_gt_i32 s[60:61], 10, v12
  v_cmp_gt_i32 s[62:63], 11, v12
  v_cndmask_b32 v164, v6, v13, s[56:57]
  v_mfma_f32_32x32x16_bf16 v[176:191], a[92:95], a[60:63], v[176:191]
  ds_read_b128 a[92:95], v3 offset:15360
  v_cndmask_b32 v165, v6, v13, s[58:59]
  v_cndmask_b32 v166, v6, v13, s[60:61]
  v_cndmask_b32 v167, v6, v13, s[62:63]
  v_cmp_gt_i32 s[56:57], 16, v12
  v_cmp_gt_i32 s[58:59], 17, v12
  v_mfma_f32_32x32x16_bf16 v[96:111], a[0:3], v[224:227], 0
  v_cmp_gt_i32 s[60:61], 18, v12
  v_cmp_gt_i32 s[62:63], 19, v12
  v_cndmask_b32 v168, v6, v13, s[56:57]
  v_cndmask_b32 v169, v6, v13, s[58:59]
  v_cndmask_b32 v170, v6, v13, s[60:61]
  v_cndmask_b32 v171, v6, v13, s[62:63]
  v_mfma_f32_32x32x16_bf16 v[112:127], a[0:3], v[224:227], 0
  v_cmp_gt_i32 s[56:57], 24, v12
  v_cmp_gt_i32 s[58:59], 25, v12
  v_cmp_gt_i32 s[60:61], 26, v12
  v_cmp_gt_i32 s[62:63], 27, v12
  v_cndmask_b32 v172, v6, v13, s[56:57]
  v_cndmask_b32 v173, v6, v13, s[58:59]
  v_mfma_f32_32x32x16_bf16 v[128:143], a[0:3], v[224:227], 0
  v_cndmask_b32 v174, v6, v13, s[60:61]
  v_cndmask_b32 v175, v6, v13, s[62:63]
  v_mfma_f32_32x32x16_bf16 v[144:159], a[0:3], v[224:227], 0
  s_waitcnt lgkmcnt(0)
  v_mfma_f32_32x32x16_bf16 a[128:143], a[0:3], v[224:227], 0
  v_max3_f32 v5, v48, v49, v50
  v_max3_f32 v5, v5, v51, v52
  v_max3_f32 v5, v5, v53, v54
  v_max3_f32 v5, v5, v55, v56
  v_max3_f32 v5, v5, v57, v58
  v_max3_f32 v5, v5, v59, v60
  v_mfma_f32_32x32x16_bf16 a[144:159], a[0:3], v[224:227], 0
  v_max3_f32 v5, v5, v61, v62
  v_max_f32 v5, v5, v63
  v_mov_b32 v11, v5
  s_nop 1
  v_permlane32_swap_b32 v5, v11
  s_nop 1
  v_mfma_f32_32x32x16_bf16 a[160:175], a[0:3], v[224:227], 0
  v_max_f32 v5, v5, v11
  v_sub_f32 v48, v48, v5
  v_sub_f32 v49, v49, v5
  v_sub_f32 v50, v50, v5
  v_sub_f32 v51, v51, v5
  v_sub_f32 v52, v52, v5
  v_mfma_f32_32x32x16_bf16 a[176:191], a[0:3], v[224:227], 0
  v_sub_f32 v53, v53, v5
  v_sub_f32 v54, v54, v5
  v_sub_f32 v55, v55, v5
  v_sub_f32 v56, v56, v5
  v_sub_f32 v57, v57, v5
  v_sub_f32 v58, v58, v5
  v_mfma_f32_32x32x16_bf16 v[64:79], a[64:67], a[0:3], 0
  v_sub_f32 v59, v59, v5
  v_sub_f32 v60, v60, v5
  v_sub_f32 v61, v61, v5
  v_sub_f32 v62, v62, v5
  v_sub_f32 v63, v63, v5
  v_exp_f32 v48, v48
  v_mfma_f32_32x32x16_bf16 v[192:207], a[64:67], a[32:35], v[160:175]
  v_exp_f32 v49, v49
  v_exp_f32 v50, v50
  v_exp_f32 v51, v51
  v_mfma_f32_32x32x16_bf16 v[64:79], a[68:71], a[4:7], v[64:79]
  v_exp_f32 v52, v52
  v_exp_f32 v53, v53
  v_exp_f32 v54, v54
  v_mfma_f32_32x32x16_bf16 v[192:207], a[68:71], a[36:39], v[192:207]
  v_exp_f32 v55, v55
  v_exp_f32 v56, v56
  v_exp_f32 v57, v57
  v_mfma_f32_32x32x16_bf16 v[64:79], a[72:75], a[8:11], v[64:79]
  v_exp_f32 v58, v58
  v_exp_f32 v59, v59
  v_exp_f32 v60, v60
  v_mfma_f32_32x32x16_bf16 v[192:207], a[72:75], a[40:43], v[192:207]
  v_exp_f32 v61, v61
  v_exp_f32 v62, v62
  v_exp_f32 v63, v63
  v_mfma_f32_32x32x16_bf16 v[64:79], a[76:79], a[12:15], v[64:79]
  v_add_f32 v26, v48, v49
  v_add_f32 v26, v26, v50
  v_add_f32 v26, v26, v51
  v_add_f32 v26, v26, v52
  v_add_f32 v26, v26, v53
  v_add_f32 v26, v26, v54
  v_mfma_f32_32x32x16_bf16 v[192:207], a[76:79], a[44:47], v[192:207]
  v_add_f32 v26, v26, v55
  v_add_f32 v26, v26, v56
  v_add_f32 v26, v26, v57
  v_add_f32 v26, v26, v58
  v_add_f32 v26, v26, v59
  v_add_f32 v26, v26, v60
  v_mfma_f32_32x32x16_bf16 v[64:79], a[80:83], a[16:19], v[64:79]
  v_add_f32 v26, v26, v61
  v_add_f32 v26, v26, v62
  v_add_f32 v26, v26, v63
  v_cvt_pk_bf16_f32 v80, v48, v49
  v_cvt_pk_bf16_f32 v81, v50, v51
  v_cvt_pk_bf16_f32 v82, v52, v53
  v_mfma_f32_32x32x16_bf16 v[192:207], a[80:83], a[48:51], v[192:207]
  v_cvt_pk_bf16_f32 v83, v54, v55
  v_cvt_pk_bf16_f32 v84, v56, v57
  v_cvt_pk_bf16_f32 v85, v58, v59
  v_cvt_pk_bf16_f32 v86, v60, v61
  v_cvt_pk_bf16_f32 v87, v62, v63
  v_max3_f32 v6, v176, v177, v178
  v_mfma_f32_32x32x16_bf16 v[64:79], a[84:87], a[20:23], v[64:79]
  v_max3_f32 v6, v6, v179, v180
  v_max3_f32 v6, v6, v181, v182
  v_max3_f32 v6, v6, v183, v184
  v_max3_f32 v6, v6, v185, v186
  v_max3_f32 v6, v6, v187, v188
  v_max3_f32 v6, v6, v189, v190
  v_mfma_f32_32x32x16_bf16 v[192:207], a[84:87], a[52:55], v[192:207]
  v_max_f32 v6, v6, v191
  v_mov_b32 v11, v6
  s_nop 1
  v_permlane32_swap_b32 v6, v11
  s_nop 1
  v_max_f32 v6, v6, v11
  v_mfma_f32_32x32x16_bf16 v[64:79], a[88:91], a[24:27], v[64:79]
  v_sub_f32 v176, v176, v6
  v_sub_f32 v177, v177, v6
  v_sub_f32 v178, v178, v6
  v_sub_f32 v179, v179, v6
  v_sub_f32 v180, v180, v6
  v_sub_f32 v181, v181, v6
  v_mfma_f32_32x32x16_bf16 v[192:207], a[88:91], a[56:59], v[192:207]
  v_sub_f32 v182, v182, v6
  v_sub_f32 v183, v183, v6
  v_sub_f32 v184, v184, v6
  v_sub_f32 v185, v185, v6
  v_sub_f32 v186, v186, v6
  v_sub_f32 v187, v187, v6
  v_mfma_f32_32x32x16_bf16 v[64:79], a[92:95], a[28:31], v[64:79]
  v_sub_f32 v188, v188, v6
  v_sub_f32 v189, v189, v6
  v_sub_f32 v190, v190, v6
  v_sub_f32 v191, v191, v6
  v_exp_f32 v176, v176
  v_mfma_f32_32x32x16_bf16 v[192:207], a[92:95], a[60:63], v[192:207]
  v_exp_f32 v177, v177
  v_exp_f32 v178, v178
  v_exp_f32 v179, v179
  v_exp_f32 v180, v180
  v_exp_f32 v181, v181
  v_exp_f32 v182, v182
  v_exp_f32 v183, v183
  v_exp_f32 v184, v184
  v_exp_f32 v185, v185
  v_exp_f32 v186, v186
  v_exp_f32 v187, v187
  v_exp_f32 v188, v188
  v_exp_f32 v189, v189
  v_exp_f32 v190, v190
  v_exp_f32 v191, v191
  v_add_f32 v27, v176, v177
  v_add_f32 v27, v27, v178
  v_add_f32 v27, v27, v179
  v_add_f32 v27, v27, v180
  v_add_f32 v27, v27, v181
  v_add_f32 v27, v27, v182
  v_add_f32 v27, v27, v183
  v_add_f32 v27, v27, v184
  v_add_f32 v27, v27, v185
  v_add_f32 v27, v27, v186
  v_add_f32 v27, v27, v187
  v_add_f32 v27, v27, v188
  v_add_f32 v27, v27, v189
  v_add_f32 v27, v27, v190
  v_add_f32 v27, v27, v191
  v_cvt_pk_bf16_f32 v208, v176, v177
  v_cvt_pk_bf16_f32 v209, v178, v179
  v_cvt_pk_bf16_f32 v210, v180, v181
  v_cvt_pk_bf16_f32 v211, v182, v183
  v_cvt_pk_bf16_f32 v212, v184, v185
  v_cvt_pk_bf16_f32 v213, v186, v187
  v_cvt_pk_bf16_f32 v214, v188, v189
  v_cvt_pk_bf16_f32 v215, v190, v191
  s_add_u32 s20, s20, 32768
  s_cmp_eq_u32 s20, 163840
  s_cselect_b32 s20, 0, s20
  s_waitcnt vmcnt(10)
  s_barrier
  v_add_u32 v3, s20, v1
  s_add_u32 s28, s2, 83951616
  s_cmp_lg_u32 s67, 0
  s_cbranch_scc1 fs_17
  v_mov_b32 v10, 1
  s_mov_b64 exec, 1
  buffer_store_byte v10, off, s[52:55], s28 sc1
  s_mov_b64 exec, -1
fs_17:
  ds_read_b128 a[64:67], v3 offset:0
  ds_read_b128 a[68:71], v3 offset:1024
  ds_read_b128 a[72:75], v3 offset:2048
  ds_read_b128 a[76:79], v3 offset:3072
  ds_read_b128 a[80:83], v3 offset:4096
  ds_read_b128 a[84:87], v3 offset:5120
  ds_read_b128 a[88:91], v3 offset:6144
  ds_read_b128 a[92:95], v3 offset:7168
  s_mov_b32 m0, s21
  s_mov_b32 s29, 2
  buffer_load_dwordx4 v2, s[52:55], s24 offen offset:0 sc1 lds
  buffer_load_dwordx4 v2, s[52:55], s24 offen offset:1024 sc1 lds
  buffer_load_dwordx4 v2, s[52:55], s24 offen offset:2048 sc1 lds
  buffer_load_dwordx4 v2, s[52:55], s24 offen offset:3072 sc1 lds
  v_sub_f32 v64, v64, v5
  v_sub_f32 v65, v65, v5
  v_sub_f32 v66, v66, v5
  v_sub_f32 v67, v67, v5
  v_sub_f32 v68, v68, v5
  v_sub_f32 v69, v69, v5
  v_sub_f32 v70, v70, v5
  v_sub_f32 v71, v71, v5
  v_sub_f32 v72, v72, v5
  v_sub_f32 v73, v73, v5
  v_sub_f32 v74, v74, v5
  v_sub_f32 v75, v75, v5
  v_sub_f32 v76, v76, v5
  v_sub_f32 v77, v77, v5
  v_sub_f32 v78, v78, v5
  v_sub_f32 v79, v79, v5
  v_sub_f32 v5, 0, v5
  v_sub_f32 v192, v192, v6
  v_sub_f32 v193, v193, v6
  v_sub_f32 v194, v194, v6
  v_sub_f32 v195, v195, v6
  v_sub_f32 v196, v196, v6
  v_sub_f32 v197, v197, v6
  v_sub_f32 v198, v198, v6
  v_sub_f32 v199, v199, v6
  v_sub_f32 v200, v200, v6
  v_sub_f32 v201, v201, v6
  v_sub_f32 v202, v202, v6
  v_sub_f32 v203, v203, v6
  v_sub_f32 v204, v204, v6
  v_sub_f32 v205, v205, v6
  v_sub_f32 v206, v206, v6
  v_sub_f32 v207, v207, v6
  v_sub_f32 v6, 0, v6
  v_mov_b32 v32, v5
  v_mov_b32 v33, v5
  v_mov_b32 v34, v5
  v_mov_b32 v35, v5
  v_mov_b32 v36, v5
  v_mov_b32 v37, v5
  v_mov_b32 v38, v5
  v_mov_b32 v39, v5
  v_mov_b32 v40, v5
  v_mov_b32 v41, v5
  v_mov_b32 v42, v5
  v_mov_b32 v43, v5
  v_mov_b32 v44, v5
  v_mov_b32 v45, v5
  v_mov_b32 v46, v5
  v_mov_b32 v47, v5
  s_lshl_b32 s30, s29, 5
  s_sub_i32 s30, s40, s30
  v_add_u32 v12, s30, v4
  v_mov_b32 v13, s32
  v_cmp_gt_i32 s[56:57], 0, v12
  v_cmp_gt_i32 s[58:59], 1, v12
  v_cmp_gt_i32 s[60:61], 2, v12
  v_cmp_gt_i32 s[62:63], 3, v12
  v_cndmask_b32 v160, v6, v13, s[56:57]
  v_cndmask_b32 v161, v6, v13, s[58:59]
  v_cndmask_b32 v162, v6, v13, s[60:61]
  v_cndmask_b32 v163, v6, v13, s[62:63]
  v_cmp_gt_i32 s[56:57], 8, v12
  v_cmp_gt_i32 s[58:59], 9, v12
  v_cmp_gt_i32 s[60:61], 10, v12
  v_cmp_gt_i32 s[62:63], 11, v12
  v_cndmask_b32 v164, v6, v13, s[56:57]
  v_cndmask_b32 v165, v6, v13, s[58:59]
  v_cndmask_b32 v166, v6, v13, s[60:61]
  v_cndmask_b32 v167, v6, v13, s[62:63]
  v_cmp_gt_i32 s[56:57], 16, v12
  v_cmp_gt_i32 s[58:59], 17, v12
  v_cmp_gt_i32 s[60:61], 18, v12
  v_cmp_gt_i32 s[62:63], 19, v12
  v_cndmask_b32 v168, v6, v13, s[56:57]
  v_cndmask_b32 v169, v6, v13, s[58:59]
  v_cndmask_b32 v170, v6, v13, s[60:61]
  v_cndmask_b32 v171, v6, v13, s[62:63]
  v_cmp_gt_i32 s[56:57], 24, v12
  v_cmp_gt_i32 s[58:59], 25, v12
  v_cmp_gt_i32 s[60:61], 26, v12
  v_cmp_gt_i32 s[62:63], 27, v12
  v_cndmask_b32 v172, v6, v13, s[56:57]
  v_cndmask_b32 v173, v6, v13, s[58:59]
  v_cndmask_b32 v174, v6, v13, s[60:61]
  v_cndmask_b32 v175, v6, v13, s[62:63]
  s_mov_b32 s18, 1
  s_branch mk_dentry
.p2align 6
mk_dloop:
  s_waitcnt vmcnt(22)
  s_barrier
  v_add_u32 v3, s20, v1
  s_waitcnt lgkmcnt(4)
  v_mfma_f32_32x32x16_bf16 v[96:111], a[96:99], v[88:91], v[96:111]
  ds_read_b128 a[64:67], v3 offset:0
  s_mov_b32 m0, s21
  v_add_f32 v26, v26, v21
  v_cvt_pk_bf16_f32 v82, v20, v21
  v_exp_f32 v23, v55
  v_mfma_f32_32x32x16_bf16 a[128:143], a[96:99], v[216:219], a[128:143]
  buffer_load_dwordx4 v2, s[52:55], s24 offen offset:0 sc1 lds
  v_add_f32 v26, v26, v22
  v_exp_f32 v16, v56
  v_add_f32 v26, v26, v23
  v_cvt_pk_bf16_f32 v83, v22, v23
  v_mfma_f32_32x32x16_bf16 v[112:127], a[100:103], v[88:91], v[112:127]
  ds_read_b128 a[68:71], v3 offset:1024
  v_exp_f32 v17, v57
  v_add_f32 v26, v26, v16
  v_exp_f32 v18, v58
  v_mfma_f32_32x32x16_bf16 a[144:159], a[100:103], v[216:219], a[144:159]
  v_add_f32 v26, v26, v17
  v_cvt_pk_bf16_f32 v84, v16, v17
  v_exp_f32 v19, v59
  v_add_f32 v26, v26, v18
  v_mfma_f32_32x32x16_bf16 v[128:143], a[104:107], v[88:91], v[128:143]
  ds_read_b128 a[72:75], v3 offset:2048
  v_exp_f32 v20, v60
  v_add_f32 v26, v26, v19
  v_cvt_pk_bf16_f32 v85, v18, v19
  v_mfma_f32_32x32x16_bf16 a[160:175], a[104:107], v[216:219], a[160:175]
  buffer_load_dwordx4 v2, s[52:55], s24 offen offset:1024 sc1 lds
  v_exp_f32 v21, v61
  v_add_f32 v26, v26, v20
  v_exp_f32 v22, v62
  v_mfma_f32_32x32x16_bf16 v[144:159], a[108:111], v[88:91], v[144:159]
  ds_read_b128 a[76:79], v3 offset:3072
  v_add_f32 v26, v26, v21
  v_cvt_pk_bf16_f32 v86, v20, v21
  v_exp_f32 v23, v63
  v_add_f32 v26, v26, v22
  v_mfma_f32_32x32x16_bf16 a[176:191], a[108:111], v[216:219], a[176:191]
  v_add_f32 v26, v26, v23
  v_cvt_pk_bf16_f32 v87, v22, v23
  v_cmp_lt_f32 vcc, s31, v26
  s_waitcnt lgkmcnt(4)
  v_mfma_f32_32x32x16_bf16 v[96:111], a[112:115], v[92:95], v[96:111]
  ds_read_b128 a[80:83], v3 offset:4096
  v_mfma_f32_32x32x16_bf16 a[128:143], a[112:115], v[220:223], a[128:143]
  buffer_load_dwordx4 v2, s[52:55], s24 offen offset:2048 sc1 lds
  v_mfma_f32_32x32x16_bf16 v[112:127], a[116:119], v[92:95], v[112:127]
  ds_read_b128 a[84:87], v3 offset:5120
  v_mfma_f32_32x32x16_bf16 a[144:159], a[116:119], v[220:223], a[144:159]
  v_mfma_f32_32x32x16_bf16 v[128:143], a[120:123], v[92:95], v[128:143]
  ds_read_b128 a[88:91], v3 offset:6144
  v_mfma_f32_32x32x16_bf16 a[160:175], a[120:123], v[220:223], a[160:175]
  buffer_load_dwordx4 v2, s[52:55], s24 offen offset:3072 sc1 lds
  v_mfma_f32_32x32x16_bf16 v[144:159], a[124:127], v[92:95], v[144:159]
  ds_read_b128 a[92:95], v3 offset:7168
  v_mfma_f32_32x32x16_bf16 a[176:191], a[124:127], v[220:223], a[176:191]
  s_or_b64 vcc, vcc, s[42:43]
  s_cmp_ge_i32 s18, s38
  s_cbranch_scc1 asp_19
  s_cbranch_vccnz asl_20
aret_18:
  s_add_u32 s18, s18, 1
mk_dentry:
  s_waitcnt lgkmcnt(4)
  v_mfma_f32_32x32x16_bf16 v[48:63], a[64:67], a[0:3], v[32:47]
  ds_read_b128 a[96:99], v3 offset:16384
  s_add_u32 m0, s21, 16384
  v_add_f32 v24, v24, v27
  v_exp_f32 v16, v192
  v_mfma_f32_32x32x16_bf16 v[176:191], a[64:67], a[32:35], v[160:175]
  buffer_load_dwordx4 v2, s[52:55], s25 offen offset:0 sc1 lds
  v_exp_f32 v17, v193
  v_exp_f32 v18, v194
  v_add_f32 v27, v16, v17
  v_mfma_f32_32x32x16_bf16 v[48:63], a[68:71], a[4:7], v[48:63]
  ds_read_b128 a[100:103], v3 offset:17408
  v_cvt_pk_bf16_f32 v216, v16, v17
  v_exp_f32 v19, v195
  v_add_f32 v27, v27, v18
  v_mfma_f32_32x32x16_bf16 v[176:191], a[68:71], a[36:39], v[176:191]
  v_exp_f32 v20, v196
  v_add_f32 v27, v27, v19
  v_cvt_pk_bf16_f32 v217, v18, v19
  v_exp_f32 v21, v197
  v_mfma_f32_32x32x16_bf16 v[48:63], a[72:75], a[8:11], v[48:63]
  ds_read_b128 a[104:107], v3 offset:18432
  v_add_f32 v27, v27, v20
  v_exp_f32 v22, v198
  v_add_f32 v27, v27, v21
  v_cvt_pk_bf16_f32 v218, v20, v21
  v_mfma_f32_32x32x16_bf16 v[176:191], a[72:75], a[40:43], v[176:191]
  buffer_load_dwordx4 v2, s[52:55], s25 offen offset:1024 sc1 lds
  v_exp_f32 v23, v199
  v_add_f32 v27, v27, v22
  v_exp_f32 v16, v200
  v_mfma_f32_32x32x16_bf16 v[48:63], a[76:79], a[12:15], v[48:63]
  ds_read_b128 a[108:111], v3 offset:19456
  v_add_f32 v27, v27, v23
  v_cvt_pk_bf16_f32 v219, v22, v23
  v_exp_f32 v17, v201
  v_add_f32 v27, v27, v16
  v_mfma_f32_32x32x16_bf16 v[176:191], a[76:79], a[44:47], v[176:191]
  v_exp_f32 v18, v202
  v_add_f32 v27, v27, v17
  v_cvt_pk_bf16_f32 v220, v16, v17
  s_waitcnt lgkmcnt(4)
  v_mfma_f32_32x32x16_bf16 v[48:63], a[80:83], a[16:19], v[48:63]
  ds_read_b128 a[112:115], v3 offset:20480
  v_exp_f32 v19, v203
  v_add_f32 v27, v27, v18
  v_exp_f32 v20, v204
  v_mfma_f32_32x32x16_bf16 v[176:191], a[80:83], a[48:51], v[176:191]
  buffer_load_dwordx4 v2, s[52:55], s25 offen offset:2048 sc1 lds
  v_add_f32 v27, v27, v19
  v_cvt_pk_bf16_f32 v221, v18, v19
  v_exp_f32 v21, v205
  v_add_f32 v27, v27, v20
  v_mfma_f32_32x32x16_bf16 v[48:63], a[84:87], a[20:23], v[48:63]
  ds_read_b128 a[116:119], v3 offset:21504
  v_exp_f32 v22, v206
  v_add_f32 v27, v27, v21
  v_cvt_pk_bf16_f32 v222, v20, v21
  v_mfma_f32_32x32x16_bf16 v[176:191], a[84:87], a[52:55], v[176:191]
  v_exp_f32 v23, v207
  v_add_f32 v27, v27, v22
  v_add_f32 v27, v27, v23
  v_cvt_pk_bf16_f32 v223, v22, v23
  v_cmp_lt_f32 s[42:43], s31, v27
  v_mfma_f32_32x32x16_bf16 v[48:63], a[88:91], a[24:27], v[48:63]
  ds_read_b128 a[120:123], v3 offset:22528
  v_add_f32 v7, v7, v26
  v_exp_f32 v16, v64
  v_exp_f32 v17, v65
  v_mfma_f32_32x32x16_bf16 v[176:191], a[88:91], a[56:59], v[176:191]
  buffer_load_dwordx4 v2, s[52:55], s25 offen offset:3072 sc1 lds
  v_exp_f32 v18, v66
  v_add_f32 v26, v16, v17
  v_cvt_pk_bf16_f32 v88, v16, v17
  v_mfma_f32_32x32x16_bf16 v[48:63], a[92:95], a[28:31], v[48:63]
  ds_read_b128 a[124:127], v3 offset:23552
  v_exp_f32 v19, v67
  v_add_f32 v26, v26, v18
  v_exp_f32 v20, v68
  v_mfma_f32_32x32x16_bf16 v[176:191], a[92:95], a[60:63], v[176:191]
  v_add_f32 v26, v26, v19
  v_cvt_pk_bf16_f32 v89, v18, v19
  v_exp_f32 v21, v69
  v_add_f32 v26, v26, v20
  s_waitcnt lgkmcnt(4)
  v_mfma_f32_32x32x16_bf16 v[96:111], a[96:99], v[80:83], v[96:111]
  ds_read_b128 a[64:67], v3 offset:8192
  v_exp_f32 v22, v70
  v_add_f32 v26, v26, v21
  v_cvt_pk_bf16_f32 v90, v20, v21
  v_mfma_f32_32x32x16_bf16 a[128:143], a[96:99], v[208:211], a[128:143]
  v_exp_f32 v23, v71
  v_add_f32 v26, v26, v22
  v_exp_f32 v16, v72
  v_add_f32 v26, v26, v23
  v_mfma_f32_32x32x16_bf16 v[112:127], a[100:103], v[80:83], v[112:127]
  ds_read_b128 a[68:71], v3 offset:9216
  s_add_u32 s21, s21, 32768
  s_cmp_eq_u32 s21, s22
  s_cselect_b32 s21, s23, s21
  v_cvt_pk_bf16_f32 v91, v22, v23
  v_mfma_f32_32x32x16_bf16 a[144:159], a[100:103], v[208:211], a[144:159]
  v_exp_f32 v17, v73
  v_add_f32 v26, v26, v16
  v_exp_f32 v18, v74
  v_add_f32 v26, v26, v17
  v_mfma_f32_32x32x16_bf16 v[128:143], a[104:107], v[80:83], v[128:143]
  ds_read_b128 a[72:75], v3 offset:10240
  buffer_load_dword v28, v15, s[12:15], 0 offen
  v_cvt_pk_bf16_f32 v92, v16, v17
  v_exp_f32 v19, v75
  v_add_f32 v26, v26, v18
  v_mfma_f32_32x32x16_bf16 a[160:175], a[104:107], v[208:211], a[160:175]
  v_exp_f32 v20, v76
  v_add_f32 v26, v26, v19
  v_cvt_pk_bf16_f32 v93, v18, v19
  v_exp_f32 v21, v77
  v_mfma_f32_32x32x16_bf16 v[144:159], a[108:111], v[80:83], v[144:159]
  ds_read_b128 a[76:79], v3 offset:11264
  s_add_u32 s24, s24, 16384
  s_min_u32 s24, s24, s26
  v_add_f32 v26, v26, v20
  v_exp_f32 v22, v78
  v_mfma_f32_32x32x16_bf16 a[176:191], a[108:111], v[208:211], a[176:191]
  v_add_f32 v26, v26, v21
  v_cvt_pk_bf16_f32 v94, v20, v21
  v_exp_f32 v23, v79
  v_add_f32 v26, v26, v22
  s_waitcnt lgkmcnt(4)
  v_mfma_f32_32x32x16_bf16 v[96:111], a[112:115], v[84:87], v[96:111]
  ds_read_b128 a[80:83], v3 offset:12288
  v_add_f32 v26, v26, v23
  v_cvt_pk_bf16_f32 v95, v22, v23
  v_cmp_lt_f32 vcc, s31, v26
  v_mfma_f32_32x32x16_bf16 a[128:143], a[112:115], v[212:215], a[128:143]
  v_mfma_f32_32x32x16_bf16 v[112:127], a[116:119], v[84:87], v[112:127]
  ds_read_b128 a[84:87], v3 offset:13312
  s_add_u32 s25, s25, 16384
  s_min_u32 s25, s25, s27
  v_mfma_f32_32x32x16_bf16 a[144:159], a[116:119], v[212:215], a[144:159]
  v_mfma_f32_32x32x16_bf16 v[128:143], a[120:123], v[84:87], v[128:143]
  ds_read_b128 a[88:91], v3 offset:14336
  v_mfma_f32_32x32x16_bf16 a[160:175], a[120:123], v[212:215], a[160:175]
  v_mfma_f32_32x32x16_bf16 v[144:159], a[124:127], v[84:87], v[144:159]
  ds_read_b128 a[92:95], v3 offset:15360
  v_mfma_f32_32x32x16_bf16 a[176:191], a[124:127], v[212:215], a[176:191]
  s_or_b64 vcc, vcc, s[42:43]
  s_cmp_ge_i32 s18, s38
  s_cbranch_scc1 asp_22
  s_cbranch_vccnz asl_23
aret_21:
  s_add_u32 s18, s18, 1
  s_waitcnt lgkmcnt(4)
  v_mfma_f32_32x32x16_bf16 v[64:79], a[64:67], a[0:3], v[32:47]
  ds_read_b128 a[96:99], v3 offset:24576
  v_add_f32 v24, v24, v27
  v_exp_f32 v16, v176
  v_exp_f32 v17, v177
  v_mfma_f32_32x32x16_bf16 v[192:207], a[64:67], a[32:35], v[160:175]
  v_exp_f32 v18, v178
  v_add_f32 v27, v16, v17
  v_cvt_pk_bf16_f32 v208, v16, v17
  v_exp_f32 v19, v179
  v_mfma_f32_32x32x16_bf16 v[64:79], a[68:71], a[4:7], v[64:79]
  ds_read_b128 a[100:103], v3 offset:25600
  v_add_f32 v27, v27, v18
  v_exp_f32 v20, v180
  v_add_f32 v27, v27, v19
  v_cvt_pk_bf16_f32 v209, v18, v19
  v_mfma_f32_32x32x16_bf16 v[192:207], a[68:71], a[36:39], v[192:207]
  v_exp_f32 v21, v181
  v_add_f32 v27, v27, v20
  v_exp_f32 v22, v182
  v_add_f32 v27, v27, v21
  v_mfma_f32_32x32x16_bf16 v[64:79], a[72:75], a[8:11], v[64:79]
  ds_read_b128 a[104:107], v3 offset:26624
  buffer_load_dword v28, v15, s[44:47], 0 offen
  v_add_u32 v15, 524288, v15
  v_cvt_pk_bf16_f32 v210, v20, v21
  v_exp_f32 v23, v183
  v_mfma_f32_32x32x16_bf16 v[192:207], a[72:75], a[40:43], v[192:207]
  v_add_f32 v27, v27, v22
  v_exp_f32 v16, v184
  v_add_f32 v27, v27, v23
  v_cvt_pk_bf16_f32 v211, v22, v23
  v_mfma_f32_32x32x16_bf16 v[64:79], a[76:79], a[12:15], v[64:79]
  ds_read_b128 a[108:111], v3 offset:27648
  v_exp_f32 v17, v185
  v_add_f32 v27, v27, v16
  v_exp_f32 v18, v186
  v_mfma_f32_32x32x16_bf16 v[192:207], a[76:79], a[44:47], v[192:207]
  v_add_f32 v27, v27, v17
  v_cvt_pk_bf16_f32 v212, v16, v17
  v_exp_f32 v19, v187
  v_add_f32 v27, v27, v18
  s_waitcnt lgkmcnt(4)
  v_mfma_f32_32x32x16_bf16 v[64:79], a[80:83], a[16:19], v[64:79]
  ds_read_b128 a[112:115], v3 offset:28672
  v_exp_f32 v20, v188
  v_add_f32 v27, v27, v19
  v_cvt_pk_bf16_f32 v213, v18, v19
  v_mfma_f32_32x32x16_bf16 v[192:207], a[80:83], a[48:51], v[192:207]
  v_exp_f32 v21, v189
  v_add_f32 v27, v27, v20
  v_exp_f32 v22, v190
  v_add_f32 v27, v27, v21
  v_mfma_f32_32x32x16_bf16 v[64:79], a[84:87], a[20:23], v[64:79]
  ds_read_b128 a[116:119], v3 offset:29696
  v_cvt_pk_bf16_f32 v214, v20, v21
  v_exp_f32 v23, v191
  v_add_f32 v27, v27, v22
  v_add_f32 v27, v27, v23
  v_mfma_f32_32x32x16_bf16 v[192:207], a[84:87], a[52:55], v[192:207]
  v_cvt_pk_bf16_f32 v215, v22, v23
  v_cmp_lt_f32 s[42:43], s31, v27
  v_add_f32 v7, v7, v26
  v_exp_f32 v16, v48
  v_mfma_f32_32x32x16_bf16 v[64:79], a[88:91], a[24:27], v[64:79]
  ds_read_b128 a[120:123], v3 offset:30720
  v_exp_f32 v17, v49
  v_exp_f32 v18, v50
  v_add_f32 v26, v16, v17
  v_mfma_f32_32x32x16_bf16 v[192:207], a[88:91], a[56:59], v[192:207]
  v_cvt_pk_bf16_f32 v80, v16, v17
  v_exp_f32 v19, v51
  v_add_f32 v26, v26, v18
  v_exp_f32 v20, v52
  v_mfma_f32_32x32x16_bf16 v[64:79], a[92:95], a[28:31], v[64:79]
  ds_read_b128 a[124:127], v3 offset:31744
  s_add_u32 s20, s20, 32768
  s_cmp_eq_u32 s20, 163840
  s_cselect_b32 s20, 0, s20
  v_add_f32 v26, v26, v19
  v_cvt_pk_bf16_f32 v81, v18, v19
  v_mfma_f32_32x32x16_bf16 v[192:207], a[92:95], a[60:63], v[192:207]
  v_exp_f32 v21, v53
  v_add_f32 v26, v26, v20
  v_exp_f32 v22, v54
  s_sub_u32 s19, s19, 1
  s_cmp_lg_u32 s19, 0
  s_cbranch_scc1 mk_dloop
  s_waitcnt vmcnt(22)
  s_barrier
  v_add_u32 v3, s20, v1
  s_waitcnt lgkmcnt(4)
  v_mfma_f32_32x32x16_bf16 v[96:111], a[96:99], v[88:91], v[96:111]
  ds_read_b128 a[64:67], v3 offset:0
  s_mov_b32 m0, s21
  v_add_f32 v26, v26, v21
  v_cvt_pk_bf16_f32 v82, v20, v21
  v_exp_f32 v23, v55
  v_mfma_f32_32x32x16_bf16 a[128:143], a[96:99], v[216:219], a[128:143]
  buffer_load_dwordx4 v2, s[52:55], s24 offen offset:0 sc1 lds
  v_add_f32 v26, v26, v22
  v_exp_f32 v16, v56
  v_add_f32 v26, v26, v23
  v_cvt_pk_bf16_f32 v83, v22, v23
  v_mfma_f32_32x32x16_bf16 v[112:127], a[100:103], v[88:91], v[112:127]
  ds_read_b128 a[68:71], v3 offset:1024
  v_exp_f32 v17, v57
  v_add_f32 v26, v26, v16
  v_exp_f32 v18, v58
  v_mfma_f32_32x32x16_bf16 a[144:159], a[100:103], v[216:219], a[144:159]
  v_add_f32 v26, v26, v17
  v_cvt_pk_bf16_f32 v84, v16, v17
  v_exp_f32 v19, v59
  v_add_f32 v26, v26, v18
  v_mfma_f32_32x32x16_bf16 v[128:143], a[104:107], v[88:91], v[128:143]
  ds_read_b128 a[72:75], v3 offset:2048
  v_exp_f32 v20, v60
  v_add_f32 v26, v26, v19
  v_cvt_pk_bf16_f32 v85, v18, v19
  v_mfma_f32_32x32x16_bf16 a[160:175], a[104:107], v[216:219], a[160:175]
  buffer_load_dwordx4 v2, s[52:55], s24 offen offset:1024 sc1 lds
  v_exp_f32 v21, v61
  v_add_f32 v26, v26, v20
  v_exp_f32 v22, v62
  v_mfma_f32_32x32x16_bf16 v[144:159], a[108:111], v[88:91], v[144:159]
  ds_read_b128 a[76:79], v3 offset:3072
  v_add_f32 v26, v26, v21
  v_cvt_pk_bf16_f32 v86, v20, v21
  v_exp_f32 v23, v63
  v_add_f32 v26, v26, v22
  v_mfma_f32_32x32x16_bf16 a[176:191], a[108:111], v[216:219], a[176:191]
  v_add_f32 v26, v26, v23
  v_cvt_pk_bf16_f32 v87, v22, v23
  v_cmp_lt_f32 vcc, s31, v26
  s_waitcnt lgkmcnt(4)
  v_mfma_f32_32x32x16_bf16 v[96:111], a[112:115], v[92:95], v[96:111]
  ds_read_b128 a[80:83], v3 offset:4096
  v_mfma_f32_32x32x16_bf16 a[128:143], a[112:115], v[220:223], a[128:143]
  buffer_load_dwordx4 v2, s[52:55], s24 offen offset:2048 sc1 lds
  v_mfma_f32_32x32x16_bf16 v[112:127], a[116:119], v[92:95], v[112:127]
  ds_read_b128 a[84:87], v3 offset:5120
  v_mfma_f32_32x32x16_bf16 a[144:159], a[116:119], v[220:223], a[144:159]
  v_mfma_f32_32x32x16_bf16 v[128:143], a[120:123], v[92:95], v[128:143]
  ds_read_b128 a[88:91], v3 offset:6144
  v_mfma_f32_32x32x16_bf16 a[160:175], a[120:123], v[220:223], a[160:175]
  buffer_load_dwordx4 v2, s[52:55], s24 offen offset:3072 sc1 lds
  v_mfma_f32_32x32x16_bf16 v[144:159], a[124:127], v[92:95], v[144:159]
  ds_read_b128 a[92:95], v3 offset:7168
  v_mfma_f32_32x32x16_bf16 a[176:191], a[124:127], v[220:223], a[176:191]
  s_or_b64 vcc, vcc, s[42:43]
  s_cmp_ge_i32 s18, s38
  s_cbranch_scc1 asp_25
  s_cbranch_vccnz asl_26
aret_24:
  s_add_u32 s18, s18, 1
  s_waitcnt lgkmcnt(4)
  v_mfma_f32_32x32x16_bf16 v[48:63], a[64:67], a[0:3], v[32:47]
  ds_read_b128 a[96:99], v3 offset:16384
  s_add_u32 m0, s21, 16384
  v_add_f32 v24, v24, v27
  v_exp_f32 v16, v192
  v_mfma_f32_32x32x16_bf16 v[48:63], a[68:71], a[4:7], v[48:63]
  ds_read_b128 a[100:103], v3 offset:17408
  buffer_load_dwordx4 v2, s[52:55], s25 offen offset:0 sc1 lds
  v_exp_f32 v17, v193
  v_exp_f32 v18, v194
  v_mfma_f32_32x32x16_bf16 v[48:63], a[72:75], a[8:11], v[48:63]
  ds_read_b128 a[104:107], v3 offset:18432
  v_add_f32 v27, v16, v17
  v_cvt_pk_bf16_f32 v216, v16, v17
  v_exp_f32 v19, v195
  v_add_f32 v27, v27, v18
  v_mfma_f32_32x32x16_bf16 v[48:63], a[76:79], a[12:15], v[48:63]
  ds_read_b128 a[108:111], v3 offset:19456
  buffer_load_dwordx4 v2, s[52:55], s25 offen offset:1024 sc1 lds
  v_exp_f32 v20, v196
  v_add_f32 v27, v27, v19
  s_waitcnt lgkmcnt(4)
  v_mfma_f32_32x32x16_bf16 v[48:63], a[80:83], a[16:19], v[48:63]
  ds_read_b128 a[112:115], v3 offset:20480
  v_cvt_pk_bf16_f32 v217, v18, v19
  v_exp_f32 v21, v197
  v_add_f32 v27, v27, v20
  v_mfma_f32_32x32x16_bf16 v[48:63], a[84:87], a[20:23], v[48:63]
  ds_read_b128 a[116:119], v3 offset:21504
  buffer_load_dwordx4 v2, s[52:55], s25 offen offset:2048 sc1 lds
  v_exp_f32 v22, v198
  v_add_f32 v27, v27, v21
  v_cvt_pk_bf16_f32 v218, v20, v21
  v_mfma_f32_32x32x16_bf16 v[48:63], a[88:91], a[24:27], v[48:63]
  ds_read_b128 a[120:123], v3 offset:22528
  v_exp_f32 v23, v199
  v_add_f32 v27, v27, v22
  v_exp_f32 v16, v200
  v_mfma_f32_32x32x16_bf16 v[48:63], a[92:95], a[28:31], v[48:63]
  ds_read_b128 a[124:127], v3 offset:23552
  buffer_load_dwordx4 v2, s[52:55], s25 offen offset:3072 sc1 lds
  v_add_f32 v27, v27, v23
  v_cvt_pk_bf16_f32 v219, v22, v23
  s_waitcnt lgkmcnt(4)
  v_mfma_f32_32x32x16_bf16 v[96:111], a[96:99], v[80:83], v[96:111]
  ds_read_b128 a[64:67], v3 offset:8192
  v_exp_f32 v17, v201
  v_add_f32 v27, v27, v16
  v_exp_f32 v18, v202
  v_mfma_f32_32x32x16_bf16 a[128:143], a[96:99], v[208:211], a[128:143]
  v_add_f32 v27, v27, v17
  v_cvt_pk_bf16_f32 v220, v16, v17
  v_exp_f32 v19, v203
  v_add_f32 v27, v27, v18
  v_mfma_f32_32x32x16_bf16 v[112:127], a[100:103], v[80:83], v[112:127]
  ds_read_b128 a[68:71], v3 offset:9216
  s_add_u32 s21, s21, 32768
  s_cmp_eq_u32 s21, s22
  s_cselect_b32 s21, s23, s21
  v_exp_f32 v20, v204
  v_mfma_f32_32x32x16_bf16 a[144:159], a[100:103], v[208:211], a[144:159]
  v_add_f32 v27, v27, v19
  v_cvt_pk_bf16_f32 v221, v18, v19
  v_exp_f32 v21, v205
  v_add_f32 v27, v27, v20
  v_mfma_f32_32x32x16_bf16 v[128:143], a[104:107], v[80:83], v[128:143]
  ds_read_b128 a[72:75], v3 offset:10240
  buffer_load_dword v28, v15, s[12:15], 0 offen
  v_exp_f32 v22, v206
  v_add_f32 v27, v27, v21
  v_cvt_pk_bf16_f32 v222, v20, v21
  v_mfma_f32_32x32x16_bf16 a[160:175], a[104:107], v[208:211], a[160:175]
  v_exp_f32 v23, v207
  v_add_f32 v27, v27, v22
  v_add_f32 v27, v27, v23
  v_cvt_pk_bf16_f32 v223, v22, v23
  v_cmp_lt_f32 s[42:43], s31, v27
  v_mfma_f32_32x32x16_bf16 v[144:159], a[108:111], v[80:83], v[144:159]
  ds_read_b128 a[76:79], v3 offset:11264
  s_add_u32 s24, s24, 16384
  s_min_u32 s24, s24, s26
  v_add_f32 v7, v7, v26
  v_exp_f32 v16, v64
  v_mfma_f32_32x32x16_bf16 a[176:191], a[108:111], v[208:211], a[176:191]
  v_exp_f32 v17, v65
  v_exp_f32 v18, v66
  v_add_f32 v26, v16, v17
  s_waitcnt lgkmcnt(4)
  v_mfma_f32_32x32x16_bf16 v[96:111], a[112:115], v[84:87], v[96:111]
  ds_read_b128 a[80:83], v3 offset:12288
  v_cvt_pk_bf16_f32 v88, v16, v17
  v_exp_f32 v19, v67
  v_add_f32 v26, v26, v18
  v_mfma_f32_32x32x16_bf16 a[128:143], a[112:115], v[212:215], a[128:143]
  v_exp_f32 v20, v68
  v_add_f32 v26, v26, v19
  v_cvt_pk_bf16_f32 v89, v18, v19
  v_exp_f32 v21, v69
  v_mfma_f32_32x32x16_bf16 v[112:127], a[116:119], v[84:87], v[112:127]
  ds_read_b128 a[84:87], v3 offset:13312
  s_add_u32 s25, s25, 16384
  s_min_u32 s25, s25, s27
  v_add_f32 v26, v26, v20
  v_exp_f32 v22, v70
  v_mfma_f32_32x32x16_bf16 a[144:159], a[116:119], v[212:215], a[144:159]
  v_add_f32 v26, v26, v21
  v_cvt_pk_bf16_f32 v90, v20, v21
  v_exp_f32 v23, v71
  v_add_f32 v26, v26, v22
  v_mfma_f32_32x32x16_bf16 v[128:143], a[120:123], v[84:87], v[128:143]
  ds_read_b128 a[88:91], v3 offset:14336
  v_exp_f32 v16, v72
  v_add_f32 v26, v26, v23
  v_cvt_pk_bf16_f32 v91, v22, v23
  v_mfma_f32_32x32x16_bf16 a[160:175], a[120:123], v[212:215], a[160:175]
  v_exp_f32 v17, v73
  v_add_f32 v26, v26, v16
  v_exp_f32 v18, v74
  v_add_f32 v26, v26, v17
  v_mfma_f32_32x32x16_bf16 v[144:159], a[124:127], v[84:87], v[144:159]
  ds_read_b128 a[92:95], v3 offset:15360
  v_cvt_pk_bf16_f32 v92, v16, v17
  v_exp_f32 v19, v75
  v_add_f32 v26, v26, v18
  v_mfma_f32_32x32x16_bf16 a[176:191], a[124:127], v[212:215], a[176:191]
  v_exp_f32 v20, v76
  v_add_f32 v26, v26, v19
  v_cvt_pk_bf16_f32 v93, v18, v19
  v_exp_f32 v21, v77
  v_add_f32 v26, v26, v20
  v_exp_f32 v22, v78
  v_add_f32 v26, v26, v21
  v_cvt_pk_bf16_f32 v94, v20, v21
  v_exp_f32 v23, v79
  v_add_f32 v26, v26, v22
  v_add_f32 v26, v26, v23
  v_cvt_pk_bf16_f32 v95, v22, v23
  v_cmp_lt_f32 vcc, s31, v26
  s_or_b64 vcc, vcc, s[42:43]
  s_cmp_ge_i32 s18, s37
  s_cbranch_scc1 asp_28
  s_cbranch_vccnz asl_29
aret_27:
  s_add_u32 s18, s18, 1
  s_waitcnt lgkmcnt(4)
  v_mfma_f32_32x32x16_bf16 v[64:79], a[64:67], a[0:3], v[32:47]
  ds_read_b128 a[96:99], v3 offset:24576
  v_add_f32 v7, v7, v26
  v_exp_f32 v16, v48
  v_mfma_f32_32x32x16_bf16 v[64:79], a[68:71], a[4:7], v[64:79]
  ds_read_b128 a[100:103], v3 offset:25600
  v_exp_f32 v17, v49
  v_exp_f32 v18, v50
  v_mfma_f32_32x32x16_bf16 v[64:79], a[72:75], a[8:11], v[64:79]
  ds_read_b128 a[104:107], v3 offset:26624
  buffer_load_dword v28, v15, s[44:47], 0 offen
  v_add_u32 v15, 524288, v15
  v_add_f32 v26, v16, v17
  v_cvt_pk_bf16_f32 v80, v16, v17
  v_mfma_f32_32x32x16_bf16 v[64:79], a[76:79], a[12:15], v[64:79]
  ds_read_b128 a[108:111], v3 offset:27648
  v_exp_f32 v19, v51
  v_add_f32 v26, v26, v18
  s_waitcnt lgkmcnt(4)
  v_mfma_f32_32x32x16_bf16 v[64:79], a[80:83], a[16:19], v[64:79]
  ds_read_b128 a[112:115], v3 offset:28672
  v_exp_f32 v20, v52
  v_add_f32 v26, v26, v19
  v_cvt_pk_bf16_f32 v81, v18, v19
  v_mfma_f32_32x32x16_bf16 v[64:79], a[84:87], a[20:23], v[64:79]
  ds_read_b128 a[116:119], v3 offset:29696
  v_exp_f32 v21, v53
  v_add_f32 v26, v26, v20
  v_mfma_f32_32x32x16_bf16 v[64:79], a[88:91], a[24:27], v[64:79]
  ds_read_b128 a[120:123], v3 offset:30720
  s_add_u32 s20, s20, 32768
  s_cmp_eq_u32 s20, 163840
  s_cselect_b32 s20, 0, s20
  v_mfma_f32_32x32x16_bf16 v[64:79], a[92:95], a[28:31], v[64:79]
  ds_read_b128 a[124:127], v3 offset:31744
  v_exp_f32 v22, v54
  v_add_f32 v26, v26, v21
  s_waitcnt vmcnt(22)
  s_barrier
  v_add_u32 v3, s20, v1
  s_waitcnt lgkmcnt(4)
  v_mfma_f32_32x32x16_bf16 v[96:111], a[96:99], v[88:91], v[96:111]
  ds_read_b128 a[64:67], v3 offset:0
  s_mov_b32 m0, s21
  v_cvt_pk_bf16_f32 v82, v20, v21
  v_exp_f32 v23, v55
  v_mfma_f32_32x32x16_bf16 a[128:143], a[96:99], v[216:219], a[128:143]
  buffer_load_dwordx4 v2, s[52:55], s24 offen offset:0 sc1 lds
  v_add_f32 v26, v26, v22
  v_exp_f32 v16, v56
  v_add_f32 v26, v26, v23
  v_mfma_f32_32x32x16_bf16 v[112:127], a[100:103], v[88:91], v[112:127]
  ds_read_b128 a[68:71], v3 offset:1024
  v_cvt_pk_bf16_f32 v83, v22, v23
  v_exp_f32 v17, v57
  v_add_f32 v26, v26, v16
  v_mfma_f32_32x32x16_bf16 a[144:159], a[100:103], v[216:219], a[144:159]
  v_exp_f32 v18, v58
  v_add_f32 v26, v26, v17
  v_cvt_pk_bf16_f32 v84, v16, v17
  v_mfma_f32_32x32x16_bf16 v[128:143], a[104:107], v[88:91], v[128:143]
  ds_read_b128 a[72:75], v3 offset:2048
  v_exp_f32 v19, v59
  v_add_f32 v26, v26, v18
  v_mfma_f32_32x32x16_bf16 a[160:175], a[104:107], v[216:219], a[160:175]
  buffer_load_dwordx4 v2, s[52:55], s24 offen offset:1024 sc1 lds
  v_exp_f32 v20, v60
  v_add_f32 v26, v26, v19
  v_cvt_pk_bf16_f32 v85, v18, v19
  v_mfma_f32_32x32x16_bf16 v[144:159], a[108:111], v[88:91], v[144:159]
  ds_read_b128 a[76:79], v3 offset:3072
  v_exp_f32 v21, v61
  v_add_f32 v26, v26, v20
  v_mfma_f32_32x32x16_bf16 a[176:191], a[108:111], v[216:219], a[176:191]
  v_exp_f32 v22, v62
  v_add_f32 v26, v26, v21
  v_cvt_pk_bf16_f32 v86, v20, v21
  s_waitcnt lgkmcnt(4)
  v_mfma_f32_32x32x16_bf16 v[96:111], a[112:115], v[92:95], v[96:111]
  ds_read_b128 a[80:83], v3 offset:4096
  v_exp_f32 v23, v63
  v_add_f32 v26, v26, v22
  v_add_f32 v26, v26, v23
  v_mfma_f32_32x32x16_bf16 a[128:143], a[112:115], v[220:223], a[128:143]
  buffer_load_dwordx4 v2, s[52:55], s24 offen offset:2048 sc1 lds
  v_cvt_pk_bf16_f32 v87, v22, v23
  v_cmp_lt_f32 vcc, s31, v26
  v_mfma_f32_32x32x16_bf16 v[112:127], a[116:119], v[92:95], v[112:127]
  ds_read_b128 a[84:87], v3 offset:5120
  v_mfma_f32_32x32x16_bf16 a[144:159], a[116:119], v[220:223], a[144:159]
  v_mfma_f32_32x32x16_bf16 v[128:143], a[120:123], v[92:95], v[128:143]
  ds_read_b128 a[88:91], v3 offset:6144
  v_mfma_f32_32x32x16_bf16 a[160:175], a[120:123], v[220:223], a[160:175]
  buffer_load_dwordx4 v2, s[52:55], s24 offen offset:3072 sc1 lds
  v_mfma_f32_32x32x16_bf16 v[144:159], a[124:127], v[92:95], v[144:159]
  ds_read_b128 a[92:95], v3 offset:7168
  v_mfma_f32_32x32x16_bf16 a[176:191], a[124:127], v[220:223], a[176:191]
  s_cmp_ge_i32 s18, s37
  s_cbranch_scc1 asp_31
  s_cbranch_vccnz asl_32
aret_30:
  s_add_u32 s18, s18, 1
  v_add_f32 v24, v24, v27
  v_mov_b32 v10, v24
  s_lshl_b32 s29, s36, 2
  s_add_u32 s29, s29, s67
  v_permlane32_swap_b32 v10, v24
  s_mul_i32 s29, s29, 491520
  s_lshl_b32 s30, s16, 13
  v_add_f32 v10, v24, v10
  v_rcp_f32 v10, v10
  s_add_u32 s29, s29, s30
  s_add_u32 s29, s29, 50331648
  v_mul_f32 v10, v10, v9
  s_add_u32 s30, s29, 4096
  v_mov_b32 v11, v10
  v_accvgpr_read_b32 v160, a128
  v_accvgpr_read_b32 v161, a129
  v_accvgpr_read_b32 v162, a130
  v_accvgpr_read_b32 v163, a131
  v_accvgpr_read_b32 v164, a132
  v_accvgpr_read_b32 v165, a133
  v_accvgpr_read_b32 v166, a134
  v_accvgpr_read_b32 v167, a135
  v_accvgpr_read_b32 v168, a136
  v_accvgpr_read_b32 v169, a137
  v_accvgpr_read_b32 v170, a138
  v_accvgpr_read_b32 v171, a139
  v_accvgpr_read_b32 v172, a140
  v_accvgpr_read_b32 v173, a141
  v_accvgpr_read_b32 v174, a142
  v_accvgpr_read_b32 v175, a143
  v_pk_mul_f32 v[160:161], v[160:161], v[10:11]
  v_pk_mul_f32 v[162:163], v[162:163], v[10:11]
  v_pk_mul_f32 v[164:165], v[164:165], v[10:11]
  v_pk_mul_f32 v[166:167], v[166:167], v[10:11]
  v_pk_mul_f32 v[168:169], v[168:169], v[10:11]
  v_pk_mul_f32 v[170:171], v[170:171], v[10:11]
  v_pk_mul_f32 v[172:173], v[172:173], v[10:11]
  v_pk_mul_f32 v[174:175], v[174:175], v[10:11]
  v_cvt_pk_bf16_f32 v160, v160, v161
  v_cvt_pk_bf16_f32 v161, v162, v163
  v_cvt_pk_bf16_f32 v162, v164, v165
  v_cvt_pk_bf16_f32 v163, v166, v167
  buffer_store_dwordx4 v[160:163], v1, s[52:55], s29 offen offset:0 sc1
  v_cvt_pk_bf16_f32 v168, v168, v169
  v_cvt_pk_bf16_f32 v169, v170, v171
  v_cvt_pk_bf16_f32 v170, v172, v173
  v_cvt_pk_bf16_f32 v171, v174, v175
  buffer_store_dwordx4 v[168:171], v1, s[52:55], s29 offen offset:1024 sc1
  v_accvgpr_read_b32 v176, a144
  v_accvgpr_read_b32 v177, a145
  v_accvgpr_read_b32 v178, a146
  v_accvgpr_read_b32 v179, a147
  v_accvgpr_read_b32 v180, a148
  v_accvgpr_read_b32 v181, a149
  v_accvgpr_read_b32 v182, a150
  v_accvgpr_read_b32 v183, a151
  v_accvgpr_read_b32 v184, a152
  v_accvgpr_read_b32 v185, a153
  v_accvgpr_read_b32 v186, a154
  v_accvgpr_read_b32 v187, a155
  v_accvgpr_read_b32 v188, a156
  v_accvgpr_read_b32 v189, a157
  v_accvgpr_read_b32 v190, a158
  v_accvgpr_read_b32 v191, a159
  v_pk_mul_f32 v[176:177], v[176:177], v[10:11]
  v_pk_mul_f32 v[178:179], v[178:179], v[10:11]
  v_pk_mul_f32 v[180:181], v[180:181], v[10:11]
  v_pk_mul_f32 v[182:183], v[182:183], v[10:11]
  v_pk_mul_f32 v[184:185], v[184:185], v[10:11]
  v_pk_mul_f32 v[186:187], v[186:187], v[10:11]
  v_pk_mul_f32 v[188:189], v[188:189], v[10:11]
  v_pk_mul_f32 v[190:191], v[190:191], v[10:11]
  v_cvt_pk_bf16_f32 v176, v176, v177
  v_cvt_pk_bf16_f32 v177, v178, v179
  v_cvt_pk_bf16_f32 v178, v180, v181
  v_cvt_pk_bf16_f32 v179, v182, v183
  buffer_store_dwordx4 v[176:179], v1, s[52:55], s29 offen offset:2048 sc1
  v_cvt_pk_bf16_f32 v184, v184, v185
  v_cvt_pk_bf16_f32 v185, v186, v187
  v_cvt_pk_bf16_f32 v186, v188, v189
  v_cvt_pk_bf16_f32 v187, v190, v191
  buffer_store_dwordx4 v[184:187], v1, s[52:55], s29 offen offset:3072 sc1
  v_accvgpr_read_b32 v192, a160
  v_accvgpr_read_b32 v193, a161
  v_accvgpr_read_b32 v194, a162
  v_accvgpr_read_b32 v195, a163
  v_accvgpr_read_b32 v196, a164
  v_accvgpr_read_b32 v197, a165
  v_accvgpr_read_b32 v198, a166
  v_accvgpr_read_b32 v199, a167
  v_accvgpr_read_b32 v200, a168
  v_accvgpr_read_b32 v201, a169
  v_accvgpr_read_b32 v202, a170
  v_accvgpr_read_b32 v203, a171
  v_accvgpr_read_b32 v204, a172
  v_accvgpr_read_b32 v205, a173
  v_accvgpr_read_b32 v206, a174
  v_accvgpr_read_b32 v207, a175
  v_pk_mul_f32 v[192:193], v[192:193], v[10:11]
  v_pk_mul_f32 v[194:195], v[194:195], v[10:11]
  v_pk_mul_f32 v[196:197], v[196:197], v[10:11]
  v_pk_mul_f32 v[198:199], v[198:199], v[10:11]
  v_pk_mul_f32 v[200:201], v[200:201], v[10:11]
  v_pk_mul_f32 v[202:203], v[202:203], v[10:11]
  v_pk_mul_f32 v[204:205], v[204:205], v[10:11]
  v_pk_mul_f32 v[206:207], v[206:207], v[10:11]
  v_cvt_pk_bf16_f32 v192, v192, v193
  v_cvt_pk_bf16_f32 v193, v194, v195
  v_cvt_pk_bf16_f32 v194, v196, v197
  v_cvt_pk_bf16_f32 v195, v198, v199
  buffer_store_dwordx4 v[192:195], v1, s[52:55], s30 offen offset:0 sc1
  v_cvt_pk_bf16_f32 v200, v200, v201
  v_cvt_pk_bf16_f32 v201, v202, v203
  v_cvt_pk_bf16_f32 v202, v204, v205
  v_cvt_pk_bf16_f32 v203, v206, v207
  buffer_store_dwordx4 v[200:203], v1, s[52:55], s30 offen offset:1024 sc1
  v_accvgpr_read_b32 v208, a176
  v_accvgpr_read_b32 v209, a177
  v_accvgpr_read_b32 v210, a178
  v_accvgpr_read_b32 v211, a179
  v_accvgpr_read_b32 v212, a180
  v_accvgpr_read_b32 v213, a181
  v_accvgpr_read_b32 v214, a182
  v_accvgpr_read_b32 v215, a183
  v_accvgpr_read_b32 v216, a184
  v_accvgpr_read_b32 v217, a185
  v_accvgpr_read_b32 v218, a186
  v_accvgpr_read_b32 v219, a187
  v_accvgpr_read_b32 v220, a188
  v_accvgpr_read_b32 v221, a189
  v_accvgpr_read_b32 v222, a190
  v_accvgpr_read_b32 v223, a191
  v_pk_mul_f32 v[208:209], v[208:209], v[10:11]
  v_pk_mul_f32 v[210:211], v[210:211], v[10:11]
  v_pk_mul_f32 v[212:213], v[212:213], v[10:11]
  v_pk_mul_f32 v[214:215], v[214:215], v[10:11]
  v_pk_mul_f32 v[216:217], v[216:217], v[10:11]
  v_pk_mul_f32 v[218:219], v[218:219], v[10:11]
  v_pk_mul_f32 v[220:221], v[220:221], v[10:11]
  v_pk_mul_f32 v[222:223], v[222:223], v[10:11]
  v_cvt_pk_bf16_f32 v208, v208, v209
  v_cvt_pk_bf16_f32 v209, v210, v211
  v_cvt_pk_bf16_f32 v210, v212, v213
  v_cvt_pk_bf16_f32 v211, v214, v215
  buffer_store_dwordx4 v[208:211], v1, s[52:55], s30 offen offset:2048 sc1
  v_cvt_pk_bf16_f32 v216, v216, v217
  v_cvt_pk_bf16_f32 v217, v218, v219
  v_cvt_pk_bf16_f32 v218, v220, v221
  v_cvt_pk_bf16_f32 v219, v222, v223
  buffer_store_dwordx4 v[216:219], v1, s[52:55], s30 offen offset:3072 sc1
  s_branch mk_sentry
.p2align 6
mk_aloop:
  s_waitcnt vmcnt(22)
  s_barrier
  v_add_u32 v3, s20, v1
  s_waitcnt lgkmcnt(4)
  v_mfma_f32_32x32x16_bf16 v[96:111], a[96:99], v[88:91], v[96:111]
  ds_read_b128 a[64:67], v3 offset:0
  s_mov_b32 m0, s21
  v_add_f32 v26, v26, v16
  v_exp_f32 v18, v58
  v_add_f32 v26, v26, v17
  v_mfma_f32_32x32x16_bf16 v[112:127], a[100:103], v[88:91], v[112:127]
  ds_read_b128 a[68:71], v3 offset:1024
  buffer_load_dwordx4 v2, s[52:55], s24 offen offset:0 sc1 lds
  v_cvt_pk_bf16_f32 v84, v16, v17
  v_exp_f32 v19, v59
  v_add_f32 v26, v26, v18
  v_mfma_f32_32x32x16_bf16 v[128:143], a[104:107], v[88:91], v[128:143]
  ds_read_b128 a[72:75], v3 offset:2048
  v_exp_f32 v20, v60
  v_add_f32 v26, v26, v19
  v_cvt_pk_bf16_f32 v85, v18, v19
  v_mfma_f32_32x32x16_bf16 v[144:159], a[108:111], v[88:91], v[144:159]
  ds_read_b128 a[76:79], v3 offset:3072
  buffer_load_dwordx4 v2, s[52:55], s24 offen offset:1024 sc1 lds
  v_exp_f32 v21, v61
  v_add_f32 v26, v26, v20
  s_waitcnt lgkmcnt(4)
  v_mfma_f32_32x32x16_bf16 v[96:111], a[112:115], v[92:95], v[96:111]
  ds_read_b128 a[80:83], v3 offset:4096
  v_exp_f32 v22, v62
  v_add_f32 v26, v26, v21
  v_cvt_pk_bf16_f32 v86, v20, v21
  v_mfma_f32_32x32x16_bf16 v[112:127], a[116:119], v[92:95], v[112:127]
  ds_read_b128 a[84:87], v3 offset:5120
  buffer_load_dwordx4 v2, s[52:55], s24 offen offset:2048 sc1 lds
  v_exp_f32 v23, v63
  v_add_f32 v26, v26, v22
  v_add_f32 v26, v26, v23
  v_mfma_f32_32x32x16_bf16 v[128:143], a[120:123], v[92:95], v[128:143]
  ds_read_b128 a[88:91], v3 offset:6144
  v_cvt_pk_bf16_f32 v87, v22, v23
  v_cmp_lt_f32 vcc, s31, v26
  v_mfma_f32_32x32x16_bf16 v[144:159], a[124:127], v[92:95], v[144:159]
  ds_read_b128 a[92:95], v3 offset:7168
  buffer_load_dwordx4 v2, s[52:55], s24 offen offset:3072 sc1 lds
  s_cmp_ge_i32 s18, s37
  s_cbranch_scc1 asp_34
  s_cbranch_vccnz asl_35
aret_33:
  s_add_u32 s18, s18, 1
mk_sentry:
  s_waitcnt lgkmcnt(4)
  v_mfma_f32_32x32x16_bf16 v[48:63], a[64:67], a[0:3], v[32:47]
  ds_read_b128 a[96:99], v3 offset:16384
  s_add_u32 m0, s21, 16384
  v_add_f32 v7, v7, v26
  v_exp_f32 v16, v64
  v_mfma_f32_32x32x16_bf16 v[48:63], a[68:71], a[4:7], v[48:63]
  ds_read_b128 a[100:103], v3 offset:17408
  buffer_load_dwordx4 v2, s[52:55], s25 offen offset:0 sc1 lds
  v_exp_f32 v17, v65
  v_exp_f32 v18, v66
  v_mfma_f32_32x32x16_bf16 v[48:63], a[72:75], a[8:11], v[48:63]
  ds_read_b128 a[104:107], v3 offset:18432
  v_add_f32 v26, v16, v17
  v_cvt_pk_bf16_f32 v88, v16, v17
  v_exp_f32 v19, v67
  v_add_f32 v26, v26, v18
  v_mfma_f32_32x32x16_bf16 v[48:63], a[76:79], a[12:15], v[48:63]
  ds_read_b128 a[108:111], v3 offset:19456
  buffer_load_dwordx4 v2, s[52:55], s25 offen offset:1024 sc1 lds
  v_exp_f32 v20, v68
  v_add_f32 v26, v26, v19
  s_waitcnt lgkmcnt(4)
  v_mfma_f32_32x32x16_bf16 v[48:63], a[80:83], a[16:19], v[48:63]
  ds_read_b128 a[112:115], v3 offset:20480
  v_cvt_pk_bf16_f32 v89, v18, v19
  v_exp_f32 v21, v69
  v_add_f32 v26, v26, v20
  v_mfma_f32_32x32x16_bf16 v[48:63], a[84:87], a[20:23], v[48:63]
  ds_read_b128 a[116:119], v3 offset:21504
  buffer_load_dwordx4 v2, s[52:55], s25 offen offset:2048 sc1 lds
  v_exp_f32 v22, v70
  v_add_f32 v26, v26, v21
  v_cvt_pk_bf16_f32 v90, v20, v21
  v_mfma_f32_32x32x16_bf16 v[48:63], a[88:91], a[24:27], v[48:63]
  ds_read_b128 a[120:123], v3 offset:22528
  v_exp_f32 v23, v71
  v_add_f32 v26, v26, v22
  v_exp_f32 v16, v72
  v_mfma_f32_32x32x16_bf16 v[48:63], a[92:95], a[28:31], v[48:63]
  ds_read_b128 a[124:127], v3 offset:23552
  buffer_load_dwordx4 v2, s[52:55], s25 offen offset:3072 sc1 lds
  v_add_f32 v26, v26, v23
  v_cvt_pk_bf16_f32 v91, v22, v23
  s_waitcnt lgkmcnt(4)
  v_mfma_f32_32x32x16_bf16 v[96:111], a[96:99], v[80:83], v[96:111]
  ds_read_b128 a[64:67], v3 offset:8192
  v_exp_f32 v17, v73
  v_add_f32 v26, v26, v16
  v_exp_f32 v18, v74
  v_mfma_f32_32x32x16_bf16 v[112:127], a[100:103], v[80:83], v[112:127]
  ds_read_b128 a[68:71], v3 offset:9216
  s_add_u32 s21, s21, 32768
  s_cmp_eq_u32 s21, s22
  s_cselect_b32 s21, s23, s21
  v_add_f32 v26, v26, v17
  v_cvt_pk_bf16_f32 v92, v16, v17
  v_mfma_f32_32x32x16_bf16 v[128:143], a[104:107], v[80:83], v[128:143]
  ds_read_b128 a[72:75], v3 offset:10240
  buffer_load_dword v28, v15, s[12:15], 0 offen
  v_exp_f32 v19, v75
  v_add_f32 v26, v26, v18
  v_mfma_f32_32x32x16_bf16 v[144:159], a[108:111], v[80:83], v[144:159]
  ds_read_b128 a[76:79], v3 offset:11264
  s_add_u32 s24, s24, 16384
  s_min_u32 s24, s24, s26
  v_exp_f32 v20, v76
  s_waitcnt lgkmcnt(4)
  v_mfma_f32_32x32x16_bf16 v[96:111], a[112:115], v[84:87], v[96:111]
  ds_read_b128 a[80:83], v3 offset:12288
  v_add_f32 v26, v26, v19
  v_cvt_pk_bf16_f32 v93, v18, v19
  v_exp_f32 v21, v77
  v_add_f32 v26, v26, v20
  v_mfma_f32_32x32x16_bf16 v[112:127], a[116:119], v[84:87], v[112:127]
  ds_read_b128 a[84:87], v3 offset:13312
  s_add_u32 s25, s25, 16384
  s_min_u32 s25, s25, s27
  v_exp_f32 v22, v78
  v_add_f32 v26, v26, v21
  v_mfma_f32_32x32x16_bf16 v[128:143], a[120:123], v[84:87], v[128:143]
  ds_read_b128 a[88:91], v3 offset:14336
  v_cvt_pk_bf16_f32 v94, v20, v21
  v_exp_f32 v23, v79
  v_add_f32 v26, v26, v22
  v_add_f32 v26, v26, v23
  v_mfma_f32_32x32x16_bf16 v[144:159], a[124:127], v[84:87], v[144:159]
  ds_read_b128 a[92:95], v3 offset:15360
  v_cvt_pk_bf16_f32 v95, v22, v23
  v_cmp_lt_f32 vcc, s31, v26
  s_cmp_ge_i32 s18, s37
  s_cbranch_scc1 asp_37
  s_cbranch_vccnz asl_38
aret_36:
  s_add_u32 s18, s18, 1
  s_waitcnt lgkmcnt(4)
  v_mfma_f32_32x32x16_bf16 v[64:79], a[64:67], a[0:3], v[32:47]
  ds_read_b128 a[96:99], v3 offset:24576
  v_add_f32 v7, v7, v26
  v_exp_f32 v16, v48
  v_exp_f32 v17, v49
  v_mfma_f32_32x32x16_bf16 v[64:79], a[68:71], a[4:7], v[64:79]
  ds_read_b128 a[100:103], v3 offset:25600
  v_exp_f32 v18, v50
  v_add_f32 v26, v16, v17
  v_cvt_pk_bf16_f32 v80, v16, v17
  v_mfma_f32_32x32x16_bf16 v[64:79], a[72:75], a[8:11], v[64:79]
  ds_read_b128 a[104:107], v3 offset:26624
  buffer_load_dword v28, v15, s[44:47], 0 offen
  v_add_u32 v15, 524288, v15
  v_exp_f32 v19, v51
  v_add_f32 v26, v26, v18
  v_mfma_f32_32x32x16_bf16 v[64:79], a[76:79], a[12:15], v[64:79]
  ds_read_b128 a[108:111], v3 offset:27648
  v_exp_f32 v20, v52
  v_add_f32 v26, v26, v19
  v_cvt_pk_bf16_f32 v81, v18, v19
  s_waitcnt lgkmcnt(4)
  v_mfma_f32_32x32x16_bf16 v[64:79], a[80:83], a[16:19], v[64:79]
  ds_read_b128 a[112:115], v3 offset:28672
  v_exp_f32 v21, v53
  v_add_f32 v26, v26, v20
  v_exp_f32 v22, v54
  v_mfma_f32_32x32x16_bf16 v[64:79], a[84:87], a[20:23], v[64:79]
  ds_read_b128 a[116:119], v3 offset:29696
  v_add_f32 v26, v26, v21
  v_cvt_pk_bf16_f32 v82, v20, v21
  v_exp_f32 v23, v55
  v_add_f32 v26, v26, v22
  v_mfma_f32_32x32x16_bf16 v[64:79], a[88:91], a[24:27], v[64:79]
  ds_read_b128 a[120:123], v3 offset:30720
  s_add_u32 s20, s20, 32768
  s_cmp_eq_u32 s20, 163840
  s_cselect_b32 s20, 0, s20
  v_exp_f32 v16, v56
  v_mfma_f32_32x32x16_bf16 v[64:79], a[92:95], a[28:31], v[64:79]
  ds_read_b128 a[124:127], v3 offset:31744
  v_add_f32 v26, v26, v23
  v_cvt_pk_bf16_f32 v83, v22, v23
  v_exp_f32 v17, v57
  s_sub_u32 s34, s34, 1
  s_cmp_lg_u32 s34, 0
  s_cbranch_scc1 mk_aloop
  s_waitcnt vmcnt(22)
  s_barrier
  v_add_u32 v3, s20, v1
  buffer_load_dword v14, v29, s[52:55], s33 offen sc1
  s_waitcnt lgkmcnt(4)
  v_mfma_f32_32x32x16_bf16 v[96:111], a[96:99], v[88:91], v[96:111]
  s_mov_b32 m0, s21
  v_add_f32 v26, v26, v16
  v_exp_f32 v18, v58
  v_add_f32 v26, v26, v17
  v_cvt_pk_bf16_f32 v84, v16, v17
  v_mfma_f32_32x32x16_bf16 v[112:127], a[100:103], v[88:91], v[112:127]
  buffer_load_dwordx4 v2, s[52:55], s24 offen offset:0 sc1 lds
  v_exp_f32 v19, v59
  v_add_f32 v26, v26, v18
  v_exp_f32 v20, v60
  v_mfma_f32_32x32x16_bf16 v[128:143], a[104:107], v[88:91], v[128:143]
  v_add_f32 v26, v26, v19
  v_cvt_pk_bf16_f32 v85, v18, v19
  v_exp_f32 v21, v61
  v_add_f32 v26, v26, v20
  v_mfma_f32_32x32x16_bf16 v[144:159], a[108:111], v[88:91], v[144:159]
  buffer_load_dwordx4 v2, s[52:55], s24 offen offset:1024 sc1 lds
  v_exp_f32 v22, v62
  v_add_f32 v26, v26, v21
  v_cvt_pk_bf16_f32 v86, v20, v21
  s_waitcnt lgkmcnt(0)
  v_mfma_f32_32x32x16_bf16 v[96:111], a[112:115], v[92:95], v[96:111]
  v_exp_f32 v23, v63
  v_add_f32 v26, v26, v22
  v_add_f32 v26, v26, v23
  v_cvt_pk_bf16_f32 v87, v22, v23
  v_cmp_lt_f32 vcc, s31, v26
  v_mfma_f32_32x32x16_bf16 v[112:127], a[116:119], v[92:95], v[112:127]
  buffer_load_dwordx4 v2, s[52:55], s24 offen offset:2048 sc1 lds
  v_mfma_f32_32x32x16_bf16 v[128:143], a[120:123], v[92:95], v[128:143]
  v_mfma_f32_32x32x16_bf16 v[144:159], a[124:127], v[92:95], v[144:159]
  buffer_load_dwordx4 v2, s[52:55], s24 offen offset:3072 sc1 lds
  s_cbranch_vccnz asl_41
aret_39:
  s_add_u32 s18, s18, 1
  ds_read_b128 a[96:99], v3 offset:16384
  s_add_u32 m0, s21, 16384
  v_add_f32 v7, v7, v26
  v_exp_f32 v16, v64
  ds_read_b128 a[100:103], v3 offset:17408
  buffer_load_dwordx4 v2, s[52:55], s25 offen offset:0 sc1 lds
  v_exp_f32 v17, v65
  v_exp_f32 v18, v66
  ds_read_b128 a[104:107], v3 offset:18432
  v_add_f32 v26, v16, v17
  v_cvt_pk_bf16_f32 v88, v16, v17
  v_exp_f32 v19, v67
  v_add_f32 v26, v26, v18
  ds_read_b128 a[108:111], v3 offset:19456
  buffer_load_dwordx4 v2, s[52:55], s25 offen offset:1024 sc1 lds
  v_exp_f32 v20, v68
  v_add_f32 v26, v26, v19
  v_cvt_pk_bf16_f32 v89, v18, v19
  ds_read_b128 a[112:115], v3 offset:20480
  v_exp_f32 v21, v69
  v_add_f32 v26, v26, v20
  v_exp_f32 v22, v70
  ds_read_b128 a[116:119], v3 offset:21504
  buffer_load_dwordx4 v2, s[52:55], s25 offen offset:2048 sc1 lds
  v_add_f32 v26, v26, v21
  v_cvt_pk_bf16_f32 v90, v20, v21
  v_exp_f32 v23, v71
  ds_read_b128 a[120:123], v3 offset:22528
  v_add_f32 v26, v26, v22
  v_exp_f32 v16, v72
  v_add_f32 v26, v26, v23
  v_cvt_pk_bf16_f32 v91, v22, v23
  ds_read_b128 a[124:127], v3 offset:23552
  buffer_load_dwordx4 v2, s[52:55], s25 offen offset:3072 sc1 lds
  v_exp_f32 v17, v73
  v_add_f32 v26, v26, v16
  s_waitcnt lgkmcnt(4)
  v_mfma_f32_32x32x16_bf16 v[96:111], a[96:99], v[80:83], v[96:111]
  v_exp_f32 v18, v74
  v_add_f32 v26, v26, v17
  v_cvt_pk_bf16_f32 v92, v16, v17
  v_exp_f32 v19, v75
  v_mfma_f32_32x32x16_bf16 v[112:127], a[100:103], v[80:83], v[112:127]
  s_add_u32 s21, s21, 32768
  s_cmp_eq_u32 s21, s22
  s_cselect_b32 s21, s23, s21
  v_add_f32 v26, v26, v18
  v_exp_f32 v20, v76
  v_mfma_f32_32x32x16_bf16 v[128:143], a[104:107], v[80:83], v[128:143]
  buffer_load_dword v28, v15, s[12:15], 0 offen
  v_add_f32 v26, v26, v19
  v_cvt_pk_bf16_f32 v93, v18, v19
  v_exp_f32 v21, v77
  v_add_f32 v26, v26, v20
  v_mfma_f32_32x32x16_bf16 v[144:159], a[108:111], v[80:83], v[144:159]
  s_add_u32 s24, s24, 16384
  s_min_u32 s24, s24, s26
  v_exp_f32 v22, v78
  v_add_f32 v26, v26, v21
  s_waitcnt lgkmcnt(0)
  v_mfma_f32_32x32x16_bf16 v[96:111], a[112:115], v[84:87], v[96:111]
  v_cvt_pk_bf16_f32 v94, v20, v21
  v_exp_f32 v23, v79
  v_add_f32 v26, v26, v22
  v_add_f32 v26, v26, v23
  v_cvt_pk_bf16_f32 v95, v22, v23
  v_mfma_f32_32x32x16_bf16 v[112:127], a[116:119], v[84:87], v[112:127]
  s_add_u32 s25, s25, 16384
  s_min_u32 s25, s25, s27
  v_cmp_lt_f32 vcc, s31, v26
  v_mfma_f32_32x32x16_bf16 v[128:143], a[120:123], v[84:87], v[128:143]
  v_mfma_f32_32x32x16_bf16 v[144:159], a[124:127], v[84:87], v[144:159]
  s_cbranch_vccnz asl_44
aret_42:
  s_add_u32 s18, s18, 1
  ds_read_b128 a[96:99], v3 offset:24576
  ds_read_b128 a[100:103], v3 offset:25600
  ds_read_b128 a[104:107], v3 offset:26624
  ds_read_b128 a[108:111], v3 offset:27648
  ds_read_b128 a[112:115], v3 offset:28672
  ds_read_b128 a[116:119], v3 offset:29696
  ds_read_b128 a[120:123], v3 offset:30720
  ds_read_b128 a[124:127], v3 offset:31744
  v_add_f32 v7, v7, v26
  s_waitcnt lgkmcnt(4)
  v_mfma_f32_32x32x16_bf16 v[96:111], a[96:99], v[88:91], v[96:111]
  v_mfma_f32_32x32x16_bf16 v[112:127], a[100:103], v[88:91], v[112:127]
  v_mfma_f32_32x32x16_bf16 v[128:143], a[104:107], v[88:91], v[128:143]
  v_mfma_f32_32x32x16_bf16 v[144:159], a[108:111], v[88:91], v[144:159]
  s_waitcnt lgkmcnt(0)
  v_mfma_f32_32x32x16_bf16 v[96:111], a[112:115], v[92:95], v[96:111]
  v_mfma_f32_32x32x16_bf16 v[112:127], a[116:119], v[92:95], v[112:127]
  v_mfma_f32_32x32x16_bf16 v[128:143], a[120:123], v[92:95], v[128:143]
  v_mfma_f32_32x32x16_bf16 v[144:159], a[124:127], v[92:95], v[144:159]
  s_load_dwordx2 s[84:85], s[0:1], 40
  s_load_dwordx2 s[86:87], s[0:1], 72
  s_load_dwordx2 s[88:89], s[0:1], 88
  s_and_b32 s75, s2, 7
  s_lshr_b32 s76, s2, 3
  s_lshr_b32 s70, s75, 1
  s_and_b32 s68, s75, 1
  s_and_b32 s77, s76, 3
  s_lshl_b32 s68, s68, 2
  s_add_u32 s68, s68, s77
  s_lshr_b32 s69, s76, 2
  s_lshl_b32 s78, s68, 3
  s_add_u32 s78, s78, s69
  s_mov_b32 s46, 4194304
  s_lshl_b32 s74, s67, 12
  v_lshrrev_b32 v32, 4, v0
  v_and_b32 v33, 15, v0
  v_lshlrev_b32 v34, 9, v32
  v_lshl_add_u32 v16, v33, 4, v34
  v_add_u32 v17, 491520, v16
  v_lshlrev_b32 v34, 1, v32
  v_lshrrev_b32 v35, 1, v33
  v_xor_b32 v34, v34, v35
  v_and_b32 v35, 1, v0
  v_lshlrev_b32 v36, 11, v32
  v_lshl_add_u32 v36, v35, 4, v36
  v_lshl_add_u32 v20, v34, 5, v36
  v_add_u32 v21, 7168, v20
  v_xor_b32 v34, 1, v34
  v_lshl_add_u32 v36, v34, 5, v36
  v_add_u32 v22, 14336, v36
  v_add_u32 v23, 21504, v36
  v_bfe_u32 v33, v0, 2, 2
  v_lshl_add_u32 v34, v32, 3, v33
  v_lshlrev_b32 v34, 8, v34
  v_and_b32 v35, 3, v0
  v_lshl_add_u32 v34, v35, 3, v34
  v_lshlrev_b32 v33, 1, v33
  v_and_b32 v35, 1, v32
  v_xor_b32 v33, v33, v35
  s_lshl_b32 s75, s70, 1
  v_xor_b32 v33, s75, v33
  v_xor_b32 v35, 0, v33
  v_lshl_add_u32 v160, v35, 5, v34
  v_add_u32 v232, 0x10000, v160
  v_xor_b32 v35, 1, v33
  v_lshl_add_u32 v161, v35, 5, v34
  v_add_u32 v233, 0x10000, v161
  v_xor_b32 v35, 2, v33
  v_lshl_add_u32 v162, v35, 5, v34
  v_add_u32 v234, 0x10000, v162
  v_xor_b32 v35, 3, v33
  v_lshl_add_u32 v163, v35, 5, v34
  v_add_u32 v235, 0x10000, v163
  v_xor_b32 v35, 4, v33
  v_lshl_add_u32 v164, v35, 5, v34
  v_add_u32 v236, 0x10000, v164
  v_xor_b32 v35, 5, v33
  v_lshl_add_u32 v165, v35, 5, v34
  v_add_u32 v237, 0x10000, v165
  v_xor_b32 v35, 6, v33
  v_lshl_add_u32 v166, v35, 5, v34
  v_add_u32 v238, 0x10000, v166
  v_xor_b32 v35, 7, v33
  v_lshl_add_u32 v167, v35, 5, v34
  v_add_u32 v239, 0x10000, v167
  s_lshl_b32 s75, s68, 2
  s_add_u32 s75, s75, s67
  s_mul_i32 s80, s75, 983040
  s_add_u32 s80, s80, 50331648
  s_mul_i32 s75, s70, 57344
  s_add_u32 s71, s80, s75
  s_add_u32 s71, s71, 262144
  s_lshl_b32 s75, s70, 16
  s_add_u32 s80, s80, s75
  s_lshl_b32 s81, s67, 15
  s_lshl_b32 s75, s69, 8
  s_add_u32 s81, s81, s75
  s_mul_i32 s75, s70, 1835008
  s_add_u32 s72, s81, s75
  s_lshl_b32 s75, s70, 21
  s_add_u32 s81, s81, s75
  s_mov_b32 s73, 5
  s_lshl_b32 s82, s68, 1
  s_lshr_b32 s75, s67, 1
  s_add_u32 s82, s82, s75
  s_lshl_b32 s82, s82, 7
  s_add_u32 s82, s82, 83955712
  s_waitcnt vmcnt(0) lgkmcnt(0)
  s_barrier
  s_mov_b32 s48, s86
  s_mov_b32 s49, s87
  s_mov_b32 s50, 7340032
  s_mov_b32 s44, s88
  s_mov_b32 s45, s89
  s_mov_b32 s7, 0x1010101
  s_mov_b32 s75, 0x40000
  v_cmp_ne_u32 vcc, s7, v14
  s_nop 1
  s_cmp_eq_u64 vcc, 0
  s_cbranch_scc1 pok_45
pspin_46:
  s_sleep 8
  buffer_load_dword v14, v29, s[52:55], s33 offen sc1
  s_sub_u32 s75, s75, 1
  s_cmp_eq_u32 s75, 0
  s_cbranch_scc1 pok_45
  s_waitcnt vmcnt(0)
  v_cmp_ne_u32 vcc, s7, v14
  s_nop 1
  s_cmp_eq_u64 vcc, 0
  s_cbranch_scc0 pspin_46
pok_45:
  s_add_u32 m0, s74, 0
  s_nop 0
  buffer_load_dwordx4 v20, s[48:51], s72 offen offset:0 lds
  buffer_load_dwordx4 v21, s[48:51], s72 offen offset:1024 lds
  buffer_load_dwordx4 v22, s[48:51], s72 offen offset:2048 lds
  buffer_load_dwordx4 v23, s[48:51], s72 offen offset:3072 lds
  buffer_load_dwordx4 a[96:99], v16, s[52:55], s71 offen offset:0 sc1
  buffer_load_dwordx4 a[100:103], v16, s[52:55], s71 offen offset:256 sc1
  buffer_load_dwordx4 a[104:107], v17, s[52:55], s71 offen offset:0 sc1
  buffer_load_dwordx4 a[108:111], v17, s[52:55], s71 offen offset:256 sc1
  buffer_load_dwordx4 a[112:115], v16, s[52:55], s71 offen offset:2048 sc1
  buffer_load_dwordx4 a[116:119], v16, s[52:55], s71 offen offset:2304 sc1
  buffer_load_dwordx4 a[120:123], v17, s[52:55], s71 offen offset:2048 sc1
  buffer_load_dwordx4 a[124:127], v17, s[52:55], s71 offen offset:2304 sc1
  s_add_u32 s72, s72, 131072
  s_add_u32 s71, s71, 4096
  s_add_u32 m0, s74, 16384
  s_nop 0
  buffer_load_dwordx4 v20, s[48:51], s72 offen offset:0 lds
  buffer_load_dwordx4 v21, s[48:51], s72 offen offset:1024 lds
  buffer_load_dwordx4 v22, s[48:51], s72 offen offset:2048 lds
  buffer_load_dwordx4 v23, s[48:51], s72 offen offset:3072 lds
  buffer_load_dwordx4 a[128:131], v16, s[52:55], s71 offen offset:0 sc1
  buffer_load_dwordx4 a[132:135], v16, s[52:55], s71 offen offset:256 sc1
  buffer_load_dwordx4 a[136:139], v17, s[52:55], s71 offen offset:0 sc1
  buffer_load_dwordx4 a[140:143], v17, s[52:55], s71 offen offset:256 sc1
  buffer_load_dwordx4 a[144:147], v16, s[52:55], s71 offen offset:2048 sc1
  buffer_load_dwordx4 a[148:151], v16, s[52:55], s71 offen offset:2304 sc1
  buffer_load_dwordx4 a[152:155], v17, s[52:55], s71 offen offset:2048 sc1
  buffer_load_dwordx4 a[156:159], v17, s[52:55], s71 offen offset:2304 sc1
  s_add_u32 s72, s72, 131072
  s_add_u32 s71, s71, 4096
  s_add_u32 m0, s74, 32768
  s_nop 0
  buffer_load_dwordx4 v20, s[48:51], s72 offen offset:0 lds
  buffer_load_dwordx4 v21, s[48:51], s72 offen offset:1024 lds
  buffer_load_dwordx4 v22, s[48:51], s72 offen offset:2048 lds
  buffer_load_dwordx4 v23, s[48:51], s72 offen offset:3072 lds
  buffer_load_dwordx4 a[160:163], v16, s[52:55], s71 offen offset:0 sc1
  buffer_load_dwordx4 a[164:167], v16, s[52:55], s71 offen offset:256 sc1
  buffer_load_dwordx4 a[168:171], v17, s[52:55], s71 offen offset:0 sc1
  buffer_load_dwordx4 a[172:175], v17, s[52:55], s71 offen offset:256 sc1
  buffer_load_dwordx4 a[176:179], v16, s[52:55], s71 offen offset:2048 sc1
  buffer_load_dwordx4 a[180:183], v16, s[52:55], s71 offen offset:2304 sc1
  buffer_load_dwordx4 a[184:187], v17, s[52:55], s71 offen offset:2048 sc1
  buffer_load_dwordx4 a[188:191], v17, s[52:55], s71 offen offset:2304 sc1
  s_add_u32 s72, s72, 131072
  s_add_u32 s71, s71, 4096
  s_add_u32 m0, s74, 49152
  s_nop 0
  buffer_load_dwordx4 v20, s[48:51], s72 offen offset:0 lds
  buffer_load_dwordx4 v21, s[48:51], s72 offen offset:1024 lds
  buffer_load_dwordx4 v22, s[48:51], s72 offen offset:2048 lds
  buffer_load_dwordx4 v23, s[48:51], s72 offen offset:3072 lds
  buffer_load_dwordx4 a[192:195], v16, s[52:55], s71 offen offset:0 sc1
  buffer_load_dwordx4 a[196:199], v16, s[52:55], s71 offen offset:256 sc1
  buffer_load_dwordx4 a[200:203], v17, s[52:55], s71 offen offset:0 sc1
  buffer_load_dwordx4 a[204:207], v17, s[52:55], s71 offen offset:256 sc1
  buffer_load_dwordx4 a[208:211], v16, s[52:55], s71 offen offset:2048 sc1
  buffer_load_dwordx4 a[212:215], v16, s[52:55], s71 offen offset:2304 sc1
  buffer_load_dwordx4 a[216:219], v17, s[52:55], s71 offen offset:2048 sc1
  buffer_load_dwordx4 a[220:223], v17, s[52:55], s71 offen offset:2304 sc1
  s_add_u32 s72, s72, 131072
  s_add_u32 s71, s71, 4096
mk_nopro:
  v_mov_b32 v10, v7
  s_lshl_b32 s29, s35, 2
  s_add_u32 s29, s29, s67
  v_permlane32_swap_b32 v10, v7
  s_mul_i32 s29, s29, 491520
  s_lshl_b32 s30, s16, 13
  v_add_f32 v10, v7, v10
  v_rcp_f32 v10, v10
  s_add_u32 s29, s29, s30
  s_add_u32 s29, s29, 50331648
  v_mul_f32 v10, v10, v8
  s_add_u32 s30, s29, 4096
  v_mov_b32 v11, v10
  v_pk_mul_f32 v[96:97], v[96:97], v[10:11]
  v_pk_mul_f32 v[98:99], v[98:99], v[10:11]
  v_pk_mul_f32 v[100:101], v[100:101], v[10:11]
  v_pk_mul_f32 v[102:103], v[102:103], v[10:11]
  v_pk_mul_f32 v[104:105], v[104:105], v[10:11]
  v_pk_mul_f32 v[106:107], v[106:107], v[10:11]
  v_pk_mul_f32 v[108:109], v[108:109], v[10:11]
  v_pk_mul_f32 v[110:111], v[110:111], v[10:11]
  v_cvt_pk_bf16_f32 v96, v96, v97
  v_cvt_pk_bf16_f32 v97, v98, v99
  v_cvt_pk_bf16_f32 v98, v100, v101
  v_cvt_pk_bf16_f32 v99, v102, v103
  buffer_store_dwordx4 v[96:99], v1, s[52:55], s29 offen offset:0 sc1
  v_cvt_pk_bf16_f32 v104, v104, v105
  v_cvt_pk_bf16_f32 v105, v106, v107
  v_cvt_pk_bf16_f32 v106, v108, v109
  v_cvt_pk_bf16_f32 v107, v110, v111
  buffer_store_dwordx4 v[104:107], v1, s[52:55], s29 offen offset:1024 sc1
  v_pk_mul_f32 v[112:113], v[112:113], v[10:11]
  v_pk_mul_f32 v[114:115], v[114:115], v[10:11]
  v_pk_mul_f32 v[116:117], v[116:117], v[10:11]
  v_pk_mul_f32 v[118:119], v[118:119], v[10:11]
  v_pk_mul_f32 v[120:121], v[120:121], v[10:11]
  v_pk_mul_f32 v[122:123], v[122:123], v[10:11]
  v_pk_mul_f32 v[124:125], v[124:125], v[10:11]
  v_pk_mul_f32 v[126:127], v[126:127], v[10:11]
  v_cvt_pk_bf16_f32 v112, v112, v113
  v_cvt_pk_bf16_f32 v113, v114, v115
  v_cvt_pk_bf16_f32 v114, v116, v117
  v_cvt_pk_bf16_f32 v115, v118, v119
  buffer_store_dwordx4 v[112:115], v1, s[52:55], s29 offen offset:2048 sc1
  v_cvt_pk_bf16_f32 v120, v120, v121
  v_cvt_pk_bf16_f32 v121, v122, v123
  v_cvt_pk_bf16_f32 v122, v124, v125
  v_cvt_pk_bf16_f32 v123, v126, v127
  buffer_store_dwordx4 v[120:123], v1, s[52:55], s29 offen offset:3072 sc1
  v_pk_mul_f32 v[128:129], v[128:129], v[10:11]
  v_pk_mul_f32 v[130:131], v[130:131], v[10:11]
  v_pk_mul_f32 v[132:133], v[132:133], v[10:11]
  v_pk_mul_f32 v[134:135], v[134:135], v[10:11]
  v_pk_mul_f32 v[136:137], v[136:137], v[10:11]
  v_pk_mul_f32 v[138:139], v[138:139], v[10:11]
  v_pk_mul_f32 v[140:141], v[140:141], v[10:11]
  v_pk_mul_f32 v[142:143], v[142:143], v[10:11]
  v_cvt_pk_bf16_f32 v128, v128, v129
  v_cvt_pk_bf16_f32 v129, v130, v131
  v_cvt_pk_bf16_f32 v130, v132, v133
  v_cvt_pk_bf16_f32 v131, v134, v135
  buffer_store_dwordx4 v[128:131], v1, s[52:55], s30 offen offset:0 sc1
  v_cvt_pk_bf16_f32 v136, v136, v137
  v_cvt_pk_bf16_f32 v137, v138, v139
  v_cvt_pk_bf16_f32 v138, v140, v141
  v_cvt_pk_bf16_f32 v139, v142, v143
  buffer_store_dwordx4 v[136:139], v1, s[52:55], s30 offen offset:1024 sc1
  v_pk_mul_f32 v[144:145], v[144:145], v[10:11]
  v_pk_mul_f32 v[146:147], v[146:147], v[10:11]
  v_pk_mul_f32 v[148:149], v[148:149], v[10:11]
  v_pk_mul_f32 v[150:151], v[150:151], v[10:11]
  v_pk_mul_f32 v[152:153], v[152:153], v[10:11]
  v_pk_mul_f32 v[154:155], v[154:155], v[10:11]
  v_pk_mul_f32 v[156:157], v[156:157], v[10:11]
  v_pk_mul_f32 v[158:159], v[158:159], v[10:11]
  v_cvt_pk_bf16_f32 v144, v144, v145
  v_cvt_pk_bf16_f32 v145, v146, v147
  v_cvt_pk_bf16_f32 v146, v148, v149
  v_cvt_pk_bf16_f32 v147, v150, v151
  buffer_store_dwordx4 v[144:147], v1, s[52:55], s30 offen offset:2048 sc1
  v_cvt_pk_bf16_f32 v152, v152, v153
  v_cvt_pk_bf16_f32 v153, v154, v155
  v_cvt_pk_bf16_f32 v154, v156, v157
  v_cvt_pk_bf16_f32 v155, v158, v159
  buffer_store_dwordx4 v[152:155], v1, s[52:55], s30 offen offset:3072 sc1
  s_lshl_b32 s37, s35, 7
  s_lshl_b32 s29, s16, 2
  s_add_u32 s37, s37, s29
  s_add_u32 s37, s37, s67
  s_add_u32 s37, s37, 83955712
  s_lshl_b32 s38, s36, 7
  s_lshl_b32 s29, s16, 2
  s_add_u32 s38, s38, s29
  s_add_u32 s38, s38, s67
  s_add_u32 s38, s38, 83955712
  v_mov_b32 v14, 1
  s_mov_b64 exec, 1
  buffer_store_byte v14, off, s[52:55], s38 sc1
  s_mov_b64 exec, -1
fs_47:
  s_waitcnt vmcnt(45) lgkmcnt(0)
  s_barrier
  ds_read_b64_tr_b16 v[168:169], v160 offset:0
  ds_read_b64_tr_b16 v[170:171], v160 offset:1024
  ds_read_b64_tr_b16 v[172:173], v161 offset:0
  ds_read_b64_tr_b16 v[174:175], v161 offset:1024
  ds_read_b64_tr_b16 v[176:177], v162 offset:0
  ds_read_b64_tr_b16 v[178:179], v162 offset:1024
  ds_read_b64_tr_b16 v[180:181], v163 offset:0
  ds_read_b64_tr_b16 v[182:183], v163 offset:1024
  ds_read_b64_tr_b16 v[184:185], v164 offset:0
  ds_read_b64_tr_b16 v[186:187], v164 offset:1024
  ds_read_b64_tr_b16 v[188:189], v165 offset:0
  ds_read_b64_tr_b16 v[190:191], v165 offset:1024
  ds_read_b64_tr_b16 v[192:193], v166 offset:0
  ds_read_b64_tr_b16 v[194:195], v166 offset:1024
  ds_read_b64_tr_b16 v[196:197], v167 offset:0
  ds_read_b64_tr_b16 v[198:199], v167 offset:1024
  s_add_u32 m0, s74, 65536
  s_nop 0
  buffer_load_dwordx4 v20, s[48:51], s72 offen offset:0 lds
  buffer_load_dwordx4 v21, s[48:51], s72 offen offset:1024 lds
  buffer_load_dwordx4 v22, s[48:51], s72 offen offset:2048 lds
  buffer_load_dwordx4 v23, s[48:51], s72 offen offset:3072 lds
  s_waitcnt lgkmcnt(0)
  v_mfma_f32_16x16x32_bf16 v[32:35], v[168:171], a[96:99], 0
  ds_read_b64_tr_b16 v[200:201], v160 offset:8192
  v_mfma_f32_16x16x32_bf16 v[36:39], v[168:171], a[100:103], 0
  ds_read_b64_tr_b16 v[202:203], v160 offset:9216
  v_mfma_f32_16x16x32_bf16 v[40:43], v[168:171], a[104:107], 0
  ds_read_b64_tr_b16 v[204:205], v161 offset:8192
  v_mfma_f32_16x16x32_bf16 v[44:47], v[168:171], a[108:111], 0
  ds_read_b64_tr_b16 v[206:207], v161 offset:9216
  v_mfma_f32_16x16x32_bf16 v[48:51], v[172:175], a[96:99], 0
  ds_read_b64_tr_b16 v[208:209], v162 offset:8192
  v_mfma_f32_16x16x32_bf16 v[52:55], v[172:175], a[100:103], 0
  ds_read_b64_tr_b16 v[210:211], v162 offset:9216
  v_mfma_f32_16x16x32_bf16 v[56:59], v[172:175], a[104:107], 0
  ds_read_b64_tr_b16 v[212:213], v163 offset:8192
  v_mfma_f32_16x16x32_bf16 v[60:63], v[172:175], a[108:111], 0
  ds_read_b64_tr_b16 v[214:215], v163 offset:9216
  v_mfma_f32_16x16x32_bf16 v[64:67], v[176:179], a[96:99], 0
  ds_read_b64_tr_b16 v[216:217], v164 offset:8192
  v_mfma_f32_16x16x32_bf16 v[68:71], v[176:179], a[100:103], 0
  ds_read_b64_tr_b16 v[218:219], v164 offset:9216
  v_mfma_f32_16x16x32_bf16 v[72:75], v[176:179], a[104:107], 0
  ds_read_b64_tr_b16 v[220:221], v165 offset:8192
  v_mfma_f32_16x16x32_bf16 v[76:79], v[176:179], a[108:111], 0
  ds_read_b64_tr_b16 v[222:223], v165 offset:9216
  v_mfma_f32_16x16x32_bf16 v[80:83], v[180:183], a[96:99], 0
  ds_read_b64_tr_b16 v[224:225], v166 offset:8192
  v_mfma_f32_16x16x32_bf16 v[84:87], v[180:183], a[100:103], 0
  ds_read_b64_tr_b16 v[226:227], v166 offset:9216
  v_mfma_f32_16x16x32_bf16 v[88:91], v[180:183], a[104:107], 0
  ds_read_b64_tr_b16 v[228:229], v167 offset:8192
  buffer_load_dwordx4 a[224:227], v16, s[52:55], s71 offen offset:0 sc1
  v_mfma_f32_16x16x32_bf16 v[92:95], v[180:183], a[108:111], 0
  ds_read_b64_tr_b16 v[230:231], v167 offset:9216
  v_mfma_f32_16x16x32_bf16 v[96:99], v[184:187], a[96:99], 0
  buffer_load_dwordx4 a[228:231], v16, s[52:55], s71 offen offset:256 sc1
  v_mfma_f32_16x16x32_bf16 v[100:103], v[184:187], a[100:103], 0
  v_mfma_f32_16x16x32_bf16 v[104:107], v[184:187], a[104:107], 0
  buffer_load_dwordx4 a[232:235], v17, s[52:55], s71 offen offset:0 sc1
  v_mfma_f32_16x16x32_bf16 v[108:111], v[184:187], a[108:111], 0
  v_mfma_f32_16x16x32_bf16 v[112:115], v[188:191], a[96:99], 0
  buffer_load_dwordx4 a[236:239], v17, s[52:55], s71 offen offset:256 sc1
  v_mfma_f32_16x16x32_bf16 v[116:119], v[188:191], a[100:103], 0
  v_mfma_f32_16x16x32_bf16 v[120:123], v[188:191], a[104:107], 0
  buffer_load_dwordx4 a[240:243], v16, s[52:55], s71 offen offset:2048 sc1
  v_mfma_f32_16x16x32_bf16 v[124:127], v[188:191], a[108:111], 0
  v_mfma_f32_16x16x32_bf16 v[128:131], v[192:195], a[96:99], 0
  buffer_load_dwordx4 a[244:247], v16, s[52:55], s71 offen offset:2304 sc1
  v_mfma_f32_16x16x32_bf16 v[132:135], v[192:195], a[100:103], 0
  v_mfma_f32_16x16x32_bf16 v[136:139], v[192:195], a[104:107], 0
  buffer_load_dwordx4 a[248:251], v17, s[52:55], s71 offen offset:2048 sc1
  v_mfma_f32_16x16x32_bf16 v[140:143], v[192:195], a[108:111], 0
  v_mfma_f32_16x16x32_bf16 v[144:147], v[196:199], a[96:99], 0
  buffer_load_dwordx4 a[252:255], v17, s[52:55], s71 offen offset:2304 sc1
  v_mfma_f32_16x16x32_bf16 v[148:151], v[196:199], a[100:103], 0
  s_add_u32 s72, s72, 131072
  s_add_u32 s71, s71, 4096
  v_mfma_f32_16x16x32_bf16 v[152:155], v[196:199], a[104:107], 0
  v_mfma_f32_16x16x32_bf16 v[156:159], v[196:199], a[108:111], 0
  s_branch mk_o1
.p2align 6
mk_oloop:
  s_cmp_lg_u32 s73, 3
  s_cbranch_scc1 osw_48
  s_waitcnt vmcnt(12)
  s_mov_b32 s7, 0x1010101
  s_mov_b32 s75, 0x40000
  v_cmp_ne_u32 vcc, s7, v13
  s_nop 1
  s_cmp_eq_u32 vcc_lo, 0
  s_cbranch_scc1 pok_51
pspin_52:
  s_sleep 8
  buffer_load_dword v13, v29, s[52:55], s82 offen sc1
  s_sub_u32 s75, s75, 1
  s_cmp_eq_u32 s75, 0
  s_cbranch_scc1 pok_51
  s_waitcnt vmcnt(0)
  v_cmp_ne_u32 vcc, s7, v13
  s_nop 1
  s_cmp_eq_u32 vcc_lo, 0
  s_cbranch_scc0 pspin_52
pok_51:
  s_mov_b32 s48, s84
  s_mov_b32 s49, s85
  s_mov_b32 s50, 8388608
  s_mov_b32 s71, s80
  s_mov_b32 s72, s81
  v_add_u32 v21, 8192, v21
  v_subrev_u32 v22, 8192, v22
osw_48:
  s_waitcnt vmcnt(36) lgkmcnt(0)
  s_barrier
  v_mfma_f32_16x16x32_bf16 v[32:35], v[200:203], a[240:243], v[32:35]
  ds_read_b64_tr_b16 v[168:169], v160 offset:0
  v_mfma_f32_16x16x32_bf16 v[36:39], v[200:203], a[244:247], v[36:39]
  ds_read_b64_tr_b16 v[170:171], v160 offset:1024
  v_mfma_f32_16x16x32_bf16 v[40:43], v[200:203], a[248:251], v[40:43]
  ds_read_b64_tr_b16 v[172:173], v161 offset:0
  v_mfma_f32_16x16x32_bf16 v[44:47], v[200:203], a[252:255], v[44:47]
  ds_read_b64_tr_b16 v[174:175], v161 offset:1024
  v_mfma_f32_16x16x32_bf16 v[48:51], v[204:207], a[240:243], v[48:51]
  ds_read_b64_tr_b16 v[176:177], v162 offset:0
  v_mfma_f32_16x16x32_bf16 v[52:55], v[204:207], a[244:247], v[52:55]
  ds_read_b64_tr_b16 v[178:179], v162 offset:1024
  v_mfma_f32_16x16x32_bf16 v[56:59], v[204:207], a[248:251], v[56:59]
  ds_read_b64_tr_b16 v[180:181], v163 offset:0
  v_mfma_f32_16x16x32_bf16 v[60:63], v[204:207], a[252:255], v[60:63]
  ds_read_b64_tr_b16 v[182:183], v163 offset:1024
  v_mfma_f32_16x16x32_bf16 v[64:67], v[208:211], a[240:243], v[64:67]
  ds_read_b64_tr_b16 v[184:185], v164 offset:0
  v_mfma_f32_16x16x32_bf16 v[68:71], v[208:211], a[244:247], v[68:71]
  ds_read_b64_tr_b16 v[186:187], v164 offset:1024
  v_mfma_f32_16x16x32_bf16 v[72:75], v[208:211], a[248:251], v[72:75]
  ds_read_b64_tr_b16 v[188:189], v165 offset:0
  v_mfma_f32_16x16x32_bf16 v[76:79], v[208:211], a[252:255], v[76:79]
  ds_read_b64_tr_b16 v[190:191], v165 offset:1024
  v_mfma_f32_16x16x32_bf16 v[80:83], v[212:215], a[240:243], v[80:83]
  ds_read_b64_tr_b16 v[192:193], v166 offset:0
  v_mfma_f32_16x16x32_bf16 v[84:87], v[212:215], a[244:247], v[84:87]
  ds_read_b64_tr_b16 v[194:195], v166 offset:1024
  v_mfma_f32_16x16x32_bf16 v[88:91], v[212:215], a[248:251], v[88:91]
  ds_read_b64_tr_b16 v[196:197], v167 offset:0
  v_mfma_f32_16x16x32_bf16 v[92:95], v[212:215], a[252:255], v[92:95]
  ds_read_b64_tr_b16 v[198:199], v167 offset:1024
  s_add_u32 m0, s74, 65536
  v_mfma_f32_16x16x32_bf16 v[96:99], v[216:219], a[240:243], v[96:99]
  buffer_load_dwordx4 v20, s[48:51], s72 offen offset:0 lds
  v_mfma_f32_16x16x32_bf16 v[100:103], v[216:219], a[244:247], v[100:103]
  v_mfma_f32_16x16x32_bf16 v[104:107], v[216:219], a[248:251], v[104:107]
  v_mfma_f32_16x16x32_bf16 v[108:111], v[216:219], a[252:255], v[108:111]
  v_mfma_f32_16x16x32_bf16 v[112:115], v[220:223], a[240:243], v[112:115]
  buffer_load_dwordx4 v21, s[48:51], s72 offen offset:1024 lds
  v_mfma_f32_16x16x32_bf16 v[116:119], v[220:223], a[244:247], v[116:119]
  v_mfma_f32_16x16x32_bf16 v[120:123], v[220:223], a[248:251], v[120:123]
  v_mfma_f32_16x16x32_bf16 v[124:127], v[220:223], a[252:255], v[124:127]
  v_mfma_f32_16x16x32_bf16 v[128:131], v[224:227], a[240:243], v[128:131]
  buffer_load_dwordx4 v22, s[48:51], s72 offen offset:2048 lds
  v_mfma_f32_16x16x32_bf16 v[132:135], v[224:227], a[244:247], v[132:135]
  v_mfma_f32_16x16x32_bf16 v[136:139], v[224:227], a[248:251], v[136:139]
  v_mfma_f32_16x16x32_bf16 v[140:143], v[224:227], a[252:255], v[140:143]
  v_mfma_f32_16x16x32_bf16 v[144:147], v[228:231], a[240:243], v[144:147]
  buffer_load_dwordx4 v23, s[48:51], s72 offen offset:3072 lds
  v_mfma_f32_16x16x32_bf16 v[148:151], v[228:231], a[244:247], v[148:151]
  v_mfma_f32_16x16x32_bf16 v[152:155], v[228:231], a[248:251], v[152:155]
  v_mfma_f32_16x16x32_bf16 v[156:159], v[228:231], a[252:255], v[156:159]
  s_waitcnt lgkmcnt(0)
  v_mfma_f32_16x16x32_bf16 v[32:35], v[168:171], a[96:99], v[32:35]
  ds_read_b64_tr_b16 v[200:201], v160 offset:8192
  v_mfma_f32_16x16x32_bf16 v[36:39], v[168:171], a[100:103], v[36:39]
  ds_read_b64_tr_b16 v[202:203], v160 offset:9216
  v_mfma_f32_16x16x32_bf16 v[40:43], v[168:171], a[104:107], v[40:43]
  ds_read_b64_tr_b16 v[204:205], v161 offset:8192
  v_mfma_f32_16x16x32_bf16 v[44:47], v[168:171], a[108:111], v[44:47]
  ds_read_b64_tr_b16 v[206:207], v161 offset:9216
  v_mfma_f32_16x16x32_bf16 v[48:51], v[172:175], a[96:99], v[48:51]
  ds_read_b64_tr_b16 v[208:209], v162 offset:8192
  v_mfma_f32_16x16x32_bf16 v[52:55], v[172:175], a[100:103], v[52:55]
  ds_read_b64_tr_b16 v[210:211], v162 offset:9216
  v_mfma_f32_16x16x32_bf16 v[56:59], v[172:175], a[104:107], v[56:59]
  ds_read_b64_tr_b16 v[212:213], v163 offset:8192
  v_mfma_f32_16x16x32_bf16 v[60:63], v[172:175], a[108:111], v[60:63]
  ds_read_b64_tr_b16 v[214:215], v163 offset:9216
  v_mfma_f32_16x16x32_bf16 v[64:67], v[176:179], a[96:99], v[64:67]
  ds_read_b64_tr_b16 v[216:217], v164 offset:8192
  v_mfma_f32_16x16x32_bf16 v[68:71], v[176:179], a[100:103], v[68:71]
  ds_read_b64_tr_b16 v[218:219], v164 offset:9216
  v_mfma_f32_16x16x32_bf16 v[72:75], v[176:179], a[104:107], v[72:75]
  ds_read_b64_tr_b16 v[220:221], v165 offset:8192
  v_mfma_f32_16x16x32_bf16 v[76:79], v[176:179], a[108:111], v[76:79]
  ds_read_b64_tr_b16 v[222:223], v165 offset:9216
  v_mfma_f32_16x16x32_bf16 v[80:83], v[180:183], a[96:99], v[80:83]
  ds_read_b64_tr_b16 v[224:225], v166 offset:8192
  v_mfma_f32_16x16x32_bf16 v[84:87], v[180:183], a[100:103], v[84:87]
  ds_read_b64_tr_b16 v[226:227], v166 offset:9216
  v_mfma_f32_16x16x32_bf16 v[88:91], v[180:183], a[104:107], v[88:91]
  ds_read_b64_tr_b16 v[228:229], v167 offset:8192
  buffer_load_dwordx4 a[224:227], v16, s[52:55], s71 offen offset:0 sc1
  v_mfma_f32_16x16x32_bf16 v[92:95], v[180:183], a[108:111], v[92:95]
  ds_read_b64_tr_b16 v[230:231], v167 offset:9216
  v_mfma_f32_16x16x32_bf16 v[96:99], v[184:187], a[96:99], v[96:99]
  buffer_load_dwordx4 a[228:231], v16, s[52:55], s71 offen offset:256 sc1
  v_mfma_f32_16x16x32_bf16 v[100:103], v[184:187], a[100:103], v[100:103]
  v_mfma_f32_16x16x32_bf16 v[104:107], v[184:187], a[104:107], v[104:107]
  buffer_load_dwordx4 a[232:235], v17, s[52:55], s71 offen offset:0 sc1
  v_mfma_f32_16x16x32_bf16 v[108:111], v[184:187], a[108:111], v[108:111]
  v_mfma_f32_16x16x32_bf16 v[112:115], v[188:191], a[96:99], v[112:115]
  buffer_load_dwordx4 a[236:239], v17, s[52:55], s71 offen offset:256 sc1
  v_mfma_f32_16x16x32_bf16 v[116:119], v[188:191], a[100:103], v[116:119]
  v_mfma_f32_16x16x32_bf16 v[120:123], v[188:191], a[104:107], v[120:123]
  buffer_load_dwordx4 a[240:243], v16, s[52:55], s71 offen offset:2048 sc1
  v_mfma_f32_16x16x32_bf16 v[124:127], v[188:191], a[108:111], v[124:127]
  v_mfma_f32_16x16x32_bf16 v[128:131], v[192:195], a[96:99], v[128:131]
  buffer_load_dwordx4 a[244:247], v16, s[52:55], s71 offen offset:2304 sc1
  v_mfma_f32_16x16x32_bf16 v[132:135], v[192:195], a[100:103], v[132:135]
  v_mfma_f32_16x16x32_bf16 v[136:139], v[192:195], a[104:107], v[136:139]
  buffer_load_dwordx4 a[248:251], v17, s[52:55], s71 offen offset:2048 sc1
  v_mfma_f32_16x16x32_bf16 v[140:143], v[192:195], a[108:111], v[140:143]
  v_mfma_f32_16x16x32_bf16 v[144:147], v[196:199], a[96:99], v[144:147]
  buffer_load_dwordx4 a[252:255], v17, s[52:55], s71 offen offset:2304 sc1
  v_mfma_f32_16x16x32_bf16 v[148:151], v[196:199], a[100:103], v[148:151]
  s_add_u32 s72, s72, 131072
  s_add_u32 s71, s71, 4096
  v_mfma_f32_16x16x32_bf16 v[152:155], v[196:199], a[104:107], v[152:155]
  v_mfma_f32_16x16x32_bf16 v[156:159], v[196:199], a[108:111], v[156:159]
mk_o1:
  s_waitcnt vmcnt(36) lgkmcnt(0)
  s_barrier
  v_mfma_f32_16x16x32_bf16 v[32:35], v[200:203], a[112:115], v[32:35]
  ds_read_b64_tr_b16 v[168:169], v160 offset:16384
  v_mfma_f32_16x16x32_bf16 v[36:39], v[200:203], a[116:119], v[36:39]
  ds_read_b64_tr_b16 v[170:171], v160 offset:17408
  v_mfma_f32_16x16x32_bf16 v[40:43], v[200:203], a[120:123], v[40:43]
  ds_read_b64_tr_b16 v[172:173], v161 offset:16384
  v_mfma_f32_16x16x32_bf16 v[44:47], v[200:203], a[124:127], v[44:47]
  ds_read_b64_tr_b16 v[174:175], v161 offset:17408
  v_mfma_f32_16x16x32_bf16 v[48:51], v[204:207], a[112:115], v[48:51]
  ds_read_b64_tr_b16 v[176:177], v162 offset:16384
  v_mfma_f32_16x16x32_bf16 v[52:55], v[204:207], a[116:119], v[52:55]
  ds_read_b64_tr_b16 v[178:179], v162 offset:17408
  v_mfma_f32_16x16x32_bf16 v[56:59], v[204:207], a[120:123], v[56:59]
  ds_read_b64_tr_b16 v[180:181], v163 offset:16384
  v_mfma_f32_16x16x32_bf16 v[60:63], v[204:207], a[124:127], v[60:63]
  ds_read_b64_tr_b16 v[182:183], v163 offset:17408
  v_mfma_f32_16x16x32_bf16 v[64:67], v[208:211], a[112:115], v[64:67]
  ds_read_b64_tr_b16 v[184:185], v164 offset:16384
  v_mfma_f32_16x16x32_bf16 v[68:71], v[208:211], a[116:119], v[68:71]
  ds_read_b64_tr_b16 v[186:187], v164 offset:17408
  v_mfma_f32_16x16x32_bf16 v[72:75], v[208:211], a[120:123], v[72:75]
  ds_read_b64_tr_b16 v[188:189], v165 offset:16384
  v_mfma_f32_16x16x32_bf16 v[76:79], v[208:211], a[124:127], v[76:79]
  ds_read_b64_tr_b16 v[190:191], v165 offset:17408
  v_mfma_f32_16x16x32_bf16 v[80:83], v[212:215], a[112:115], v[80:83]
  ds_read_b64_tr_b16 v[192:193], v166 offset:16384
  v_mfma_f32_16x16x32_bf16 v[84:87], v[212:215], a[116:119], v[84:87]
  ds_read_b64_tr_b16 v[194:195], v166 offset:17408
  v_mfma_f32_16x16x32_bf16 v[88:91], v[212:215], a[120:123], v[88:91]
  ds_read_b64_tr_b16 v[196:197], v167 offset:16384
  v_mfma_f32_16x16x32_bf16 v[92:95], v[212:215], a[124:127], v[92:95]
  ds_read_b64_tr_b16 v[198:199], v167 offset:17408
  s_add_u32 m0, s74, 0
  v_mfma_f32_16x16x32_bf16 v[96:99], v[216:219], a[112:115], v[96:99]
  buffer_load_dwordx4 v20, s[48:51], s72 offen offset:0 lds
  v_mfma_f32_16x16x32_bf16 v[100:103], v[216:219], a[116:119], v[100:103]
  v_mfma_f32_16x16x32_bf16 v[104:107], v[216:219], a[120:123], v[104:107]
  v_mfma_f32_16x16x32_bf16 v[108:111], v[216:219], a[124:127], v[108:111]
  v_mfma_f32_16x16x32_bf16 v[112:115], v[220:223], a[112:115], v[112:115]
  buffer_load_dwordx4 v21, s[48:51], s72 offen offset:1024 lds
  v_mfma_f32_16x16x32_bf16 v[116:119], v[220:223], a[116:119], v[116:119]
  v_mfma_f32_16x16x32_bf16 v[120:123], v[220:223], a[120:123], v[120:123]
  v_mfma_f32_16x16x32_bf16 v[124:127], v[220:223], a[124:127], v[124:127]
  v_mfma_f32_16x16x32_bf16 v[128:131], v[224:227], a[112:115], v[128:131]
  buffer_load_dwordx4 v22, s[48:51], s72 offen offset:2048 lds
  v_mfma_f32_16x16x32_bf16 v[132:135], v[224:227], a[116:119], v[132:135]
  v_mfma_f32_16x16x32_bf16 v[136:139], v[224:227], a[120:123], v[136:139]
  v_mfma_f32_16x16x32_bf16 v[140:143], v[224:227], a[124:127], v[140:143]
  v_mfma_f32_16x16x32_bf16 v[144:147], v[228:231], a[112:115], v[144:147]
  buffer_load_dwordx4 v23, s[48:51], s72 offen offset:3072 lds
  v_mfma_f32_16x16x32_bf16 v[148:151], v[228:231], a[116:119], v[148:151]
  v_mfma_f32_16x16x32_bf16 v[152:155], v[228:231], a[120:123], v[152:155]
  v_mfma_f32_16x16x32_bf16 v[156:159], v[228:231], a[124:127], v[156:159]
  s_waitcnt lgkmcnt(0)
  v_mfma_f32_16x16x32_bf16 v[32:35], v[168:171], a[128:131], v[32:35]
  ds_read_b64_tr_b16 v[200:201], v160 offset:24576
  v_mfma_f32_16x16x32_bf16 v[36:39], v[168:171], a[132:135], v[36:39]
  ds_read_b64_tr_b16 v[202:203], v160 offset:25600
  v_mfma_f32_16x16x32_bf16 v[40:43], v[168:171], a[136:139], v[40:43]
  ds_read_b64_tr_b16 v[204:205], v161 offset:24576
  v_mfma_f32_16x16x32_bf16 v[44:47], v[168:171], a[140:143], v[44:47]
  ds_read_b64_tr_b16 v[206:207], v161 offset:25600
  v_mfma_f32_16x16x32_bf16 v[48:51], v[172:175], a[128:131], v[48:51]
  ds_read_b64_tr_b16 v[208:209], v162 offset:24576
  v_mfma_f32_16x16x32_bf16 v[52:55], v[172:175], a[132:135], v[52:55]
  ds_read_b64_tr_b16 v[210:211], v162 offset:25600
  v_mfma_f32_16x16x32_bf16 v[56:59], v[172:175], a[136:139], v[56:59]
  ds_read_b64_tr_b16 v[212:213], v163 offset:24576
  v_mfma_f32_16x16x32_bf16 v[60:63], v[172:175], a[140:143], v[60:63]
  ds_read_b64_tr_b16 v[214:215], v163 offset:25600
  v_mfma_f32_16x16x32_bf16 v[64:67], v[176:179], a[128:131], v[64:67]
  ds_read_b64_tr_b16 v[216:217], v164 offset:24576
  v_mfma_f32_16x16x32_bf16 v[68:71], v[176:179], a[132:135], v[68:71]
  ds_read_b64_tr_b16 v[218:219], v164 offset:25600
  v_mfma_f32_16x16x32_bf16 v[72:75], v[176:179], a[136:139], v[72:75]
  ds_read_b64_tr_b16 v[220:221], v165 offset:24576
  v_mfma_f32_16x16x32_bf16 v[76:79], v[176:179], a[140:143], v[76:79]
  ds_read_b64_tr_b16 v[222:223], v165 offset:25600
  v_mfma_f32_16x16x32_bf16 v[80:83], v[180:183], a[128:131], v[80:83]
  ds_read_b64_tr_b16 v[224:225], v166 offset:24576
  v_mfma_f32_16x16x32_bf16 v[84:87], v[180:183], a[132:135], v[84:87]
  ds_read_b64_tr_b16 v[226:227], v166 offset:25600
  v_mfma_f32_16x16x32_bf16 v[88:91], v[180:183], a[136:139], v[88:91]
  ds_read_b64_tr_b16 v[228:229], v167 offset:24576
  buffer_load_dwordx4 a[96:99], v16, s[52:55], s71 offen offset:0 sc1
  v_mfma_f32_16x16x32_bf16 v[92:95], v[180:183], a[140:143], v[92:95]
  ds_read_b64_tr_b16 v[230:231], v167 offset:25600
  v_mfma_f32_16x16x32_bf16 v[96:99], v[184:187], a[128:131], v[96:99]
  buffer_load_dwordx4 a[100:103], v16, s[52:55], s71 offen offset:256 sc1
  v_mfma_f32_16x16x32_bf16 v[100:103], v[184:187], a[132:135], v[100:103]
  v_mfma_f32_16x16x32_bf16 v[104:107], v[184:187], a[136:139], v[104:107]
  buffer_load_dwordx4 a[104:107], v17, s[52:55], s71 offen offset:0 sc1
  v_mfma_f32_16x16x32_bf16 v[108:111], v[184:187], a[140:143], v[108:111]
  v_mfma_f32_16x16x32_bf16 v[112:115], v[188:191], a[128:131], v[112:115]
  buffer_load_dwordx4 a[108:111], v17, s[52:55], s71 offen offset:256 sc1
  v_mfma_f32_16x16x32_bf16 v[116:119], v[188:191], a[132:135], v[116:119]
  v_mfma_f32_16x16x32_bf16 v[120:123], v[188:191], a[136:139], v[120:123]
  buffer_load_dwordx4 a[112:115], v16, s[52:55], s71 offen offset:2048 sc1
  v_mfma_f32_16x16x32_bf16 v[124:127], v[188:191], a[140:143], v[124:127]
  v_mfma_f32_16x16x32_bf16 v[128:131], v[192:195], a[128:131], v[128:131]
  buffer_load_dwordx4 a[116:119], v16, s[52:55], s71 offen offset:2304 sc1
  v_mfma_f32_16x16x32_bf16 v[132:135], v[192:195], a[132:135], v[132:135]
  v_mfma_f32_16x16x32_bf16 v[136:139], v[192:195], a[136:139], v[136:139]
  buffer_load_dwordx4 a[120:123], v17, s[52:55], s71 offen offset:2048 sc1
  v_mfma_f32_16x16x32_bf16 v[140:143], v[192:195], a[140:143], v[140:143]
  v_mfma_f32_16x16x32_bf16 v[144:147], v[196:199], a[128:131], v[144:147]
  buffer_load_dwordx4 a[124:127], v17, s[52:55], s71 offen offset:2304 sc1
  v_mfma_f32_16x16x32_bf16 v[148:151], v[196:199], a[132:135], v[148:151]
  s_add_u32 s72, s72, 131072
  s_add_u32 s71, s71, 4096
  v_mfma_f32_16x16x32_bf16 v[152:155], v[196:199], a[136:139], v[152:155]
  v_mfma_f32_16x16x32_bf16 v[156:159], v[196:199], a[140:143], v[156:159]
  s_cmp_lg_u32 s73, 5
  s_cbranch_scc1 osg_50
  s_waitcnt vmcnt(24)
  v_mov_b32 v14, 1
  s_mov_b64 exec, 1
  buffer_store_byte v14, off, s[52:55], s37 sc1
  s_mov_b64 exec, -1
fs_53:
osg_50:
  s_waitcnt vmcnt(36) lgkmcnt(0)
  s_barrier
  v_mfma_f32_16x16x32_bf16 v[32:35], v[200:203], a[144:147], v[32:35]
  ds_read_b64_tr_b16 v[168:169], v160 offset:32768
  v_mfma_f32_16x16x32_bf16 v[36:39], v[200:203], a[148:151], v[36:39]
  ds_read_b64_tr_b16 v[170:171], v160 offset:33792
  v_mfma_f32_16x16x32_bf16 v[40:43], v[200:203], a[152:155], v[40:43]
  ds_read_b64_tr_b16 v[172:173], v161 offset:32768
  v_mfma_f32_16x16x32_bf16 v[44:47], v[200:203], a[156:159], v[44:47]
  ds_read_b64_tr_b16 v[174:175], v161 offset:33792
  v_mfma_f32_16x16x32_bf16 v[48:51], v[204:207], a[144:147], v[48:51]
  ds_read_b64_tr_b16 v[176:177], v162 offset:32768
  v_mfma_f32_16x16x32_bf16 v[52:55], v[204:207], a[148:151], v[52:55]
  ds_read_b64_tr_b16 v[178:179], v162 offset:33792
  v_mfma_f32_16x16x32_bf16 v[56:59], v[204:207], a[152:155], v[56:59]
  ds_read_b64_tr_b16 v[180:181], v163 offset:32768
  v_mfma_f32_16x16x32_bf16 v[60:63], v[204:207], a[156:159], v[60:63]
  ds_read_b64_tr_b16 v[182:183], v163 offset:33792
  v_mfma_f32_16x16x32_bf16 v[64:67], v[208:211], a[144:147], v[64:67]
  ds_read_b64_tr_b16 v[184:185], v164 offset:32768
  v_mfma_f32_16x16x32_bf16 v[68:71], v[208:211], a[148:151], v[68:71]
  ds_read_b64_tr_b16 v[186:187], v164 offset:33792
  v_mfma_f32_16x16x32_bf16 v[72:75], v[208:211], a[152:155], v[72:75]
  ds_read_b64_tr_b16 v[188:189], v165 offset:32768
  v_mfma_f32_16x16x32_bf16 v[76:79], v[208:211], a[156:159], v[76:79]
  ds_read_b64_tr_b16 v[190:191], v165 offset:33792
  v_mfma_f32_16x16x32_bf16 v[80:83], v[212:215], a[144:147], v[80:83]
  ds_read_b64_tr_b16 v[192:193], v166 offset:32768
  v_mfma_f32_16x16x32_bf16 v[84:87], v[212:215], a[148:151], v[84:87]
  ds_read_b64_tr_b16 v[194:195], v166 offset:33792
  v_mfma_f32_16x16x32_bf16 v[88:91], v[212:215], a[152:155], v[88:91]
  ds_read_b64_tr_b16 v[196:197], v167 offset:32768
  v_mfma_f32_16x16x32_bf16 v[92:95], v[212:215], a[156:159], v[92:95]
  ds_read_b64_tr_b16 v[198:199], v167 offset:33792
  s_add_u32 m0, s74, 16384
  v_mfma_f32_16x16x32_bf16 v[96:99], v[216:219], a[144:147], v[96:99]
  buffer_load_dwordx4 v20, s[48:51], s72 offen offset:0 lds
  v_mfma_f32_16x16x32_bf16 v[100:103], v[216:219], a[148:151], v[100:103]
  v_mfma_f32_16x16x32_bf16 v[104:107], v[216:219], a[152:155], v[104:107]
  v_mfma_f32_16x16x32_bf16 v[108:111], v[216:219], a[156:159], v[108:111]
  v_mfma_f32_16x16x32_bf16 v[112:115], v[220:223], a[144:147], v[112:115]
  buffer_load_dwordx4 v21, s[48:51], s72 offen offset:1024 lds
  v_mfma_f32_16x16x32_bf16 v[116:119], v[220:223], a[148:151], v[116:119]
  v_mfma_f32_16x16x32_bf16 v[120:123], v[220:223], a[152:155], v[120:123]
  v_mfma_f32_16x16x32_bf16 v[124:127], v[220:223], a[156:159], v[124:127]
  v_mfma_f32_16x16x32_bf16 v[128:131], v[224:227], a[144:147], v[128:131]
  buffer_load_dwordx4 v22, s[48:51], s72 offen offset:2048 lds
  v_mfma_f32_16x16x32_bf16 v[132:135], v[224:227], a[148:151], v[132:135]
  v_mfma_f32_16x16x32_bf16 v[136:139], v[224:227], a[152:155], v[136:139]
  v_mfma_f32_16x16x32_bf16 v[140:143], v[224:227], a[156:159], v[140:143]
  v_mfma_f32_16x16x32_bf16 v[144:147], v[228:231], a[144:147], v[144:147]
  buffer_load_dwordx4 v23, s[48:51], s72 offen offset:3072 lds
  v_mfma_f32_16x16x32_bf16 v[148:151], v[228:231], a[148:151], v[148:151]
  v_mfma_f32_16x16x32_bf16 v[152:155], v[228:231], a[152:155], v[152:155]
  v_mfma_f32_16x16x32_bf16 v[156:159], v[228:231], a[156:159], v[156:159]
  s_waitcnt lgkmcnt(0)
  v_mfma_f32_16x16x32_bf16 v[32:35], v[168:171], a[160:163], v[32:35]
  ds_read_b64_tr_b16 v[200:201], v160 offset:40960
  v_mfma_f32_16x16x32_bf16 v[36:39], v[168:171], a[164:167], v[36:39]
  ds_read_b64_tr_b16 v[202:203], v160 offset:41984
  v_mfma_f32_16x16x32_bf16 v[40:43], v[168:171], a[168:171], v[40:43]
  ds_read_b64_tr_b16 v[204:205], v161 offset:40960
  v_mfma_f32_16x16x32_bf16 v[44:47], v[168:171], a[172:175], v[44:47]
  ds_read_b64_tr_b16 v[206:207], v161 offset:41984
  v_mfma_f32_16x16x32_bf16 v[48:51], v[172:175], a[160:163], v[48:51]
  ds_read_b64_tr_b16 v[208:209], v162 offset:40960
  v_mfma_f32_16x16x32_bf16 v[52:55], v[172:175], a[164:167], v[52:55]
  ds_read_b64_tr_b16 v[210:211], v162 offset:41984
  v_mfma_f32_16x16x32_bf16 v[56:59], v[172:175], a[168:171], v[56:59]
  ds_read_b64_tr_b16 v[212:213], v163 offset:40960
  v_mfma_f32_16x16x32_bf16 v[60:63], v[172:175], a[172:175], v[60:63]
  ds_read_b64_tr_b16 v[214:215], v163 offset:41984
  v_mfma_f32_16x16x32_bf16 v[64:67], v[176:179], a[160:163], v[64:67]
  ds_read_b64_tr_b16 v[216:217], v164 offset:40960
  v_mfma_f32_16x16x32_bf16 v[68:71], v[176:179], a[164:167], v[68:71]
  ds_read_b64_tr_b16 v[218:219], v164 offset:41984
  v_mfma_f32_16x16x32_bf16 v[72:75], v[176:179], a[168:171], v[72:75]
  ds_read_b64_tr_b16 v[220:221], v165 offset:40960
  v_mfma_f32_16x16x32_bf16 v[76:79], v[176:179], a[172:175], v[76:79]
  ds_read_b64_tr_b16 v[222:223], v165 offset:41984
  v_mfma_f32_16x16x32_bf16 v[80:83], v[180:183], a[160:163], v[80:83]
  ds_read_b64_tr_b16 v[224:225], v166 offset:40960
  v_mfma_f32_16x16x32_bf16 v[84:87], v[180:183], a[164:167], v[84:87]
  ds_read_b64_tr_b16 v[226:227], v166 offset:41984
  v_mfma_f32_16x16x32_bf16 v[88:91], v[180:183], a[168:171], v[88:91]
  ds_read_b64_tr_b16 v[228:229], v167 offset:40960
  buffer_load_dwordx4 a[128:131], v16, s[52:55], s71 offen offset:0 sc1
  v_mfma_f32_16x16x32_bf16 v[92:95], v[180:183], a[172:175], v[92:95]
  ds_read_b64_tr_b16 v[230:231], v167 offset:41984
  v_mfma_f32_16x16x32_bf16 v[96:99], v[184:187], a[160:163], v[96:99]
  buffer_load_dwordx4 a[132:135], v16, s[52:55], s71 offen offset:256 sc1
  v_mfma_f32_16x16x32_bf16 v[100:103], v[184:187], a[164:167], v[100:103]
  v_mfma_f32_16x16x32_bf16 v[104:107], v[184:187], a[168:171], v[104:107]
  buffer_load_dwordx4 a[136:139], v17, s[52:55], s71 offen offset:0 sc1
  v_mfma_f32_16x16x32_bf16 v[108:111], v[184:187], a[172:175], v[108:111]
  v_mfma_f32_16x16x32_bf16 v[112:115], v[188:191], a[160:163], v[112:115]
  buffer_load_dwordx4 a[140:143], v17, s[52:55], s71 offen offset:256 sc1
  v_mfma_f32_16x16x32_bf16 v[116:119], v[188:191], a[164:167], v[116:119]
  v_mfma_f32_16x16x32_bf16 v[120:123], v[188:191], a[168:171], v[120:123]
  buffer_load_dwordx4 a[144:147], v16, s[52:55], s71 offen offset:2048 sc1
  v_mfma_f32_16x16x32_bf16 v[124:127], v[188:191], a[172:175], v[124:127]
  v_mfma_f32_16x16x32_bf16 v[128:131], v[192:195], a[160:163], v[128:131]
  buffer_load_dwordx4 a[148:151], v16, s[52:55], s71 offen offset:2304 sc1
  v_mfma_f32_16x16x32_bf16 v[132:135], v[192:195], a[164:167], v[132:135]
  v_mfma_f32_16x16x32_bf16 v[136:139], v[192:195], a[168:171], v[136:139]
  buffer_load_dwordx4 a[152:155], v17, s[52:55], s71 offen offset:2048 sc1
  v_mfma_f32_16x16x32_bf16 v[140:143], v[192:195], a[172:175], v[140:143]
  v_mfma_f32_16x16x32_bf16 v[144:147], v[196:199], a[160:163], v[144:147]
  buffer_load_dwordx4 a[156:159], v17, s[52:55], s71 offen offset:2304 sc1
  v_mfma_f32_16x16x32_bf16 v[148:151], v[196:199], a[164:167], v[148:151]
  s_add_u32 s72, s72, 131072
  s_add_u32 s71, s71, 4096
  v_mfma_f32_16x16x32_bf16 v[152:155], v[196:199], a[168:171], v[152:155]
  v_mfma_f32_16x16x32_bf16 v[156:159], v[196:199], a[172:175], v[156:159]
  s_waitcnt vmcnt(36) lgkmcnt(0)
  s_barrier
  v_mfma_f32_16x16x32_bf16 v[32:35], v[200:203], a[176:179], v[32:35]
  ds_read_b64_tr_b16 v[168:169], v160 offset:49152
  v_mfma_f32_16x16x32_bf16 v[36:39], v[200:203], a[180:183], v[36:39]
  ds_read_b64_tr_b16 v[170:171], v160 offset:50176
  v_mfma_f32_16x16x32_bf16 v[40:43], v[200:203], a[184:187], v[40:43]
  ds_read_b64_tr_b16 v[172:173], v161 offset:49152
  v_mfma_f32_16x16x32_bf16 v[44:47], v[200:203], a[188:191], v[44:47]
  ds_read_b64_tr_b16 v[174:175], v161 offset:50176
  v_mfma_f32_16x16x32_bf16 v[48:51], v[204:207], a[176:179], v[48:51]
  ds_read_b64_tr_b16 v[176:177], v162 offset:49152
  v_mfma_f32_16x16x32_bf16 v[52:55], v[204:207], a[180:183], v[52:55]
  ds_read_b64_tr_b16 v[178:179], v162 offset:50176
  v_mfma_f32_16x16x32_bf16 v[56:59], v[204:207], a[184:187], v[56:59]
  ds_read_b64_tr_b16 v[180:181], v163 offset:49152
  v_mfma_f32_16x16x32_bf16 v[60:63], v[204:207], a[188:191], v[60:63]
  ds_read_b64_tr_b16 v[182:183], v163 offset:50176
  v_mfma_f32_16x16x32_bf16 v[64:67], v[208:211], a[176:179], v[64:67]
  ds_read_b64_tr_b16 v[184:185], v164 offset:49152
  v_mfma_f32_16x16x32_bf16 v[68:71], v[208:211], a[180:183], v[68:71]
  ds_read_b64_tr_b16 v[186:187], v164 offset:50176
  v_mfma_f32_16x16x32_bf16 v[72:75], v[208:211], a[184:187], v[72:75]
  ds_read_b64_tr_b16 v[188:189], v165 offset:49152
  v_mfma_f32_16x16x32_bf16 v[76:79], v[208:211], a[188:191], v[76:79]
  ds_read_b64_tr_b16 v[190:191], v165 offset:50176
  v_mfma_f32_16x16x32_bf16 v[80:83], v[212:215], a[176:179], v[80:83]
  ds_read_b64_tr_b16 v[192:193], v166 offset:49152
  v_mfma_f32_16x16x32_bf16 v[84:87], v[212:215], a[180:183], v[84:87]
  ds_read_b64_tr_b16 v[194:195], v166 offset:50176
  v_mfma_f32_16x16x32_bf16 v[88:91], v[212:215], a[184:187], v[88:91]
  ds_read_b64_tr_b16 v[196:197], v167 offset:49152
  v_mfma_f32_16x16x32_bf16 v[92:95], v[212:215], a[188:191], v[92:95]
  ds_read_b64_tr_b16 v[198:199], v167 offset:50176
  s_add_u32 m0, s74, 32768
  v_mfma_f32_16x16x32_bf16 v[96:99], v[216:219], a[176:179], v[96:99]
  buffer_load_dwordx4 v20, s[48:51], s72 offen offset:0 lds
  v_mfma_f32_16x16x32_bf16 v[100:103], v[216:219], a[180:183], v[100:103]
  v_mfma_f32_16x16x32_bf16 v[104:107], v[216:219], a[184:187], v[104:107]
  v_mfma_f32_16x16x32_bf16 v[108:111], v[216:219], a[188:191], v[108:111]
  v_mfma_f32_16x16x32_bf16 v[112:115], v[220:223], a[176:179], v[112:115]
  buffer_load_dwordx4 v21, s[48:51], s72 offen offset:1024 lds
  v_mfma_f32_16x16x32_bf16 v[116:119], v[220:223], a[180:183], v[116:119]
  v_mfma_f32_16x16x32_bf16 v[120:123], v[220:223], a[184:187], v[120:123]
  v_mfma_f32_16x16x32_bf16 v[124:127], v[220:223], a[188:191], v[124:127]
  v_mfma_f32_16x16x32_bf16 v[128:131], v[224:227], a[176:179], v[128:131]
  buffer_load_dwordx4 v22, s[48:51], s72 offen offset:2048 lds
  v_mfma_f32_16x16x32_bf16 v[132:135], v[224:227], a[180:183], v[132:135]
  v_mfma_f32_16x16x32_bf16 v[136:139], v[224:227], a[184:187], v[136:139]
  v_mfma_f32_16x16x32_bf16 v[140:143], v[224:227], a[188:191], v[140:143]
  v_mfma_f32_16x16x32_bf16 v[144:147], v[228:231], a[176:179], v[144:147]
  buffer_load_dwordx4 v23, s[48:51], s72 offen offset:3072 lds
  v_mfma_f32_16x16x32_bf16 v[148:151], v[228:231], a[180:183], v[148:151]
  v_mfma_f32_16x16x32_bf16 v[152:155], v[228:231], a[184:187], v[152:155]
  v_mfma_f32_16x16x32_bf16 v[156:159], v[228:231], a[188:191], v[156:159]
  s_waitcnt lgkmcnt(0)
  v_mfma_f32_16x16x32_bf16 v[32:35], v[168:171], a[192:195], v[32:35]
  ds_read_b64_tr_b16 v[200:201], v160 offset:57344
  v_mfma_f32_16x16x32_bf16 v[36:39], v[168:171], a[196:199], v[36:39]
  ds_read_b64_tr_b16 v[202:203], v160 offset:58368
  v_mfma_f32_16x16x32_bf16 v[40:43], v[168:171], a[200:203], v[40:43]
  ds_read_b64_tr_b16 v[204:205], v161 offset:57344
  v_mfma_f32_16x16x32_bf16 v[44:47], v[168:171], a[204:207], v[44:47]
  ds_read_b64_tr_b16 v[206:207], v161 offset:58368
  v_mfma_f32_16x16x32_bf16 v[48:51], v[172:175], a[192:195], v[48:51]
  ds_read_b64_tr_b16 v[208:209], v162 offset:57344
  v_mfma_f32_16x16x32_bf16 v[52:55], v[172:175], a[196:199], v[52:55]
  ds_read_b64_tr_b16 v[210:211], v162 offset:58368
  v_mfma_f32_16x16x32_bf16 v[56:59], v[172:175], a[200:203], v[56:59]
  ds_read_b64_tr_b16 v[212:213], v163 offset:57344
  v_mfma_f32_16x16x32_bf16 v[60:63], v[172:175], a[204:207], v[60:63]
  ds_read_b64_tr_b16 v[214:215], v163 offset:58368
  v_mfma_f32_16x16x32_bf16 v[64:67], v[176:179], a[192:195], v[64:67]
  ds_read_b64_tr_b16 v[216:217], v164 offset:57344
  v_mfma_f32_16x16x32_bf16 v[68:71], v[176:179], a[196:199], v[68:71]
  ds_read_b64_tr_b16 v[218:219], v164 offset:58368
  v_mfma_f32_16x16x32_bf16 v[72:75], v[176:179], a[200:203], v[72:75]
  ds_read_b64_tr_b16 v[220:221], v165 offset:57344
  v_mfma_f32_16x16x32_bf16 v[76:79], v[176:179], a[204:207], v[76:79]
  ds_read_b64_tr_b16 v[222:223], v165 offset:58368
  v_mfma_f32_16x16x32_bf16 v[80:83], v[180:183], a[192:195], v[80:83]
  ds_read_b64_tr_b16 v[224:225], v166 offset:57344
  v_mfma_f32_16x16x32_bf16 v[84:87], v[180:183], a[196:199], v[84:87]
  ds_read_b64_tr_b16 v[226:227], v166 offset:58368
  v_mfma_f32_16x16x32_bf16 v[88:91], v[180:183], a[200:203], v[88:91]
  ds_read_b64_tr_b16 v[228:229], v167 offset:57344
  buffer_load_dwordx4 a[160:163], v16, s[52:55], s71 offen offset:0 sc1
  v_mfma_f32_16x16x32_bf16 v[92:95], v[180:183], a[204:207], v[92:95]
  ds_read_b64_tr_b16 v[230:231], v167 offset:58368
  v_mfma_f32_16x16x32_bf16 v[96:99], v[184:187], a[192:195], v[96:99]
  buffer_load_dwordx4 a[164:167], v16, s[52:55], s71 offen offset:256 sc1
  v_mfma_f32_16x16x32_bf16 v[100:103], v[184:187], a[196:199], v[100:103]
  v_mfma_f32_16x16x32_bf16 v[104:107], v[184:187], a[200:203], v[104:107]
  buffer_load_dwordx4 a[168:171], v17, s[52:55], s71 offen offset:0 sc1
  v_mfma_f32_16x16x32_bf16 v[108:111], v[184:187], a[204:207], v[108:111]
  v_mfma_f32_16x16x32_bf16 v[112:115], v[188:191], a[192:195], v[112:115]
  buffer_load_dwordx4 a[172:175], v17, s[52:55], s71 offen offset:256 sc1
  v_mfma_f32_16x16x32_bf16 v[116:119], v[188:191], a[196:199], v[116:119]
  v_mfma_f32_16x16x32_bf16 v[120:123], v[188:191], a[200:203], v[120:123]
  buffer_load_dwordx4 a[176:179], v16, s[52:55], s71 offen offset:2048 sc1
  v_mfma_f32_16x16x32_bf16 v[124:127], v[188:191], a[204:207], v[124:127]
  v_mfma_f32_16x16x32_bf16 v[128:131], v[192:195], a[192:195], v[128:131]
  buffer_load_dwordx4 a[180:183], v16, s[52:55], s71 offen offset:2304 sc1
  v_mfma_f32_16x16x32_bf16 v[132:135], v[192:195], a[196:199], v[132:135]
  v_mfma_f32_16x16x32_bf16 v[136:139], v[192:195], a[200:203], v[136:139]
  buffer_load_dwordx4 a[184:187], v17, s[52:55], s71 offen offset:2048 sc1
  v_mfma_f32_16x16x32_bf16 v[140:143], v[192:195], a[204:207], v[140:143]
  v_mfma_f32_16x16x32_bf16 v[144:147], v[196:199], a[192:195], v[144:147]
  buffer_load_dwordx4 a[188:191], v17, s[52:55], s71 offen offset:2304 sc1
  v_mfma_f32_16x16x32_bf16 v[148:151], v[196:199], a[196:199], v[148:151]
  s_add_u32 s72, s72, 131072
  s_add_u32 s71, s71, 4096
  v_mfma_f32_16x16x32_bf16 v[152:155], v[196:199], a[200:203], v[152:155]
  v_mfma_f32_16x16x32_bf16 v[156:159], v[196:199], a[204:207], v[156:159]
  s_cmp_lg_u32 s73, 4
  s_cbranch_scc1 opl_49
  buffer_load_dword v13, v29, s[52:55], s82 offen sc1
opl_49:
  s_waitcnt vmcnt(36) lgkmcnt(0)
  s_barrier
  v_mfma_f32_16x16x32_bf16 v[32:35], v[200:203], a[208:211], v[32:35]
  ds_read_b64_tr_b16 v[168:169], v232 offset:0
  v_mfma_f32_16x16x32_bf16 v[36:39], v[200:203], a[212:215], v[36:39]
  ds_read_b64_tr_b16 v[170:171], v232 offset:1024
  v_mfma_f32_16x16x32_bf16 v[40:43], v[200:203], a[216:219], v[40:43]
  ds_read_b64_tr_b16 v[172:173], v233 offset:0
  v_mfma_f32_16x16x32_bf16 v[44:47], v[200:203], a[220:223], v[44:47]
  ds_read_b64_tr_b16 v[174:175], v233 offset:1024
  v_mfma_f32_16x16x32_bf16 v[48:51], v[204:207], a[208:211], v[48:51]
  ds_read_b64_tr_b16 v[176:177], v234 offset:0
  v_mfma_f32_16x16x32_bf16 v[52:55], v[204:207], a[212:215], v[52:55]
  ds_read_b64_tr_b16 v[178:179], v234 offset:1024
  v_mfma_f32_16x16x32_bf16 v[56:59], v[204:207], a[216:219], v[56:59]
  ds_read_b64_tr_b16 v[180:181], v235 offset:0
  v_mfma_f32_16x16x32_bf16 v[60:63], v[204:207], a[220:223], v[60:63]
  ds_read_b64_tr_b16 v[182:183], v235 offset:1024
  v_mfma_f32_16x16x32_bf16 v[64:67], v[208:211], a[208:211], v[64:67]
  ds_read_b64_tr_b16 v[184:185], v236 offset:0
  v_mfma_f32_16x16x32_bf16 v[68:71], v[208:211], a[212:215], v[68:71]
  ds_read_b64_tr_b16 v[186:187], v236 offset:1024
  v_mfma_f32_16x16x32_bf16 v[72:75], v[208:211], a[216:219], v[72:75]
  ds_read_b64_tr_b16 v[188:189], v237 offset:0
  v_mfma_f32_16x16x32_bf16 v[76:79], v[208:211], a[220:223], v[76:79]
  ds_read_b64_tr_b16 v[190:191], v237 offset:1024
  v_mfma_f32_16x16x32_bf16 v[80:83], v[212:215], a[208:211], v[80:83]
  ds_read_b64_tr_b16 v[192:193], v238 offset:0
  v_mfma_f32_16x16x32_bf16 v[84:87], v[212:215], a[212:215], v[84:87]
  ds_read_b64_tr_b16 v[194:195], v238 offset:1024
  v_mfma_f32_16x16x32_bf16 v[88:91], v[212:215], a[216:219], v[88:91]
  ds_read_b64_tr_b16 v[196:197], v239 offset:0
  v_mfma_f32_16x16x32_bf16 v[92:95], v[212:215], a[220:223], v[92:95]
  ds_read_b64_tr_b16 v[198:199], v239 offset:1024
  s_add_u32 m0, s74, 49152
  v_mfma_f32_16x16x32_bf16 v[96:99], v[216:219], a[208:211], v[96:99]
  buffer_load_dwordx4 v20, s[48:51], s72 offen offset:0 lds
  v_mfma_f32_16x16x32_bf16 v[100:103], v[216:219], a[212:215], v[100:103]
  v_mfma_f32_16x16x32_bf16 v[104:107], v[216:219], a[216:219], v[104:107]
  v_mfma_f32_16x16x32_bf16 v[108:111], v[216:219], a[220:223], v[108:111]
  v_mfma_f32_16x16x32_bf16 v[112:115], v[220:223], a[208:211], v[112:115]
  buffer_load_dwordx4 v21, s[48:51], s72 offen offset:1024 lds
  v_mfma_f32_16x16x32_bf16 v[116:119], v[220:223], a[212:215], v[116:119]
  v_mfma_f32_16x16x32_bf16 v[120:123], v[220:223], a[216:219], v[120:123]
  v_mfma_f32_16x16x32_bf16 v[124:127], v[220:223], a[220:223], v[124:127]
  v_mfma_f32_16x16x32_bf16 v[128:131], v[224:227], a[208:211], v[128:131]
  buffer_load_dwordx4 v22, s[48:51], s72 offen offset:2048 lds
  v_mfma_f32_16x16x32_bf16 v[132:135], v[224:227], a[212:215], v[132:135]
  v_mfma_f32_16x16x32_bf16 v[136:139], v[224:227], a[216:219], v[136:139]
  v_mfma_f32_16x16x32_bf16 v[140:143], v[224:227], a[220:223], v[140:143]
  v_mfma_f32_16x16x32_bf16 v[144:147], v[228:231], a[208:211], v[144:147]
  buffer_load_dwordx4 v23, s[48:51], s72 offen offset:3072 lds
  v_mfma_f32_16x16x32_bf16 v[148:151], v[228:231], a[212:215], v[148:151]
  v_mfma_f32_16x16x32_bf16 v[152:155], v[228:231], a[216:219], v[152:155]
  v_mfma_f32_16x16x32_bf16 v[156:159], v[228:231], a[220:223], v[156:159]
  s_waitcnt lgkmcnt(0)
  v_mfma_f32_16x16x32_bf16 v[32:35], v[168:171], a[224:227], v[32:35]
  ds_read_b64_tr_b16 v[200:201], v232 offset:8192
  v_mfma_f32_16x16x32_bf16 v[36:39], v[168:171], a[228:231], v[36:39]
  ds_read_b64_tr_b16 v[202:203], v232 offset:9216
  v_mfma_f32_16x16x32_bf16 v[40:43], v[168:171], a[232:235], v[40:43]
  ds_read_b64_tr_b16 v[204:205], v233 offset:8192
  v_mfma_f32_16x16x32_bf16 v[44:47], v[168:171], a[236:239], v[44:47]
  ds_read_b64_tr_b16 v[206:207], v233 offset:9216
  v_mfma_f32_16x16x32_bf16 v[48:51], v[172:175], a[224:227], v[48:51]
  ds_read_b64_tr_b16 v[208:209], v234 offset:8192
  v_mfma_f32_16x16x32_bf16 v[52:55], v[172:175], a[228:231], v[52:55]
  ds_read_b64_tr_b16 v[210:211], v234 offset:9216
  v_mfma_f32_16x16x32_bf16 v[56:59], v[172:175], a[232:235], v[56:59]
  ds_read_b64_tr_b16 v[212:213], v235 offset:8192
  v_mfma_f32_16x16x32_bf16 v[60:63], v[172:175], a[236:239], v[60:63]
  ds_read_b64_tr_b16 v[214:215], v235 offset:9216
  v_mfma_f32_16x16x32_bf16 v[64:67], v[176:179], a[224:227], v[64:67]
  ds_read_b64_tr_b16 v[216:217], v236 offset:8192
  v_mfma_f32_16x16x32_bf16 v[68:71], v[176:179], a[228:231], v[68:71]
  ds_read_b64_tr_b16 v[218:219], v236 offset:9216
  v_mfma_f32_16x16x32_bf16 v[72:75], v[176:179], a[232:235], v[72:75]
  ds_read_b64_tr_b16 v[220:221], v237 offset:8192
  v_mfma_f32_16x16x32_bf16 v[76:79], v[176:179], a[236:239], v[76:79]
  ds_read_b64_tr_b16 v[222:223], v237 offset:9216
  v_mfma_f32_16x16x32_bf16 v[80:83], v[180:183], a[224:227], v[80:83]
  ds_read_b64_tr_b16 v[224:225], v238 offset:8192
  v_mfma_f32_16x16x32_bf16 v[84:87], v[180:183], a[228:231], v[84:87]
  ds_read_b64_tr_b16 v[226:227], v238 offset:9216
  v_mfma_f32_16x16x32_bf16 v[88:91], v[180:183], a[232:235], v[88:91]
  ds_read_b64_tr_b16 v[228:229], v239 offset:8192
  buffer_load_dwordx4 a[192:195], v16, s[52:55], s71 offen offset:0 sc1
  v_mfma_f32_16x16x32_bf16 v[92:95], v[180:183], a[236:239], v[92:95]
  ds_read_b64_tr_b16 v[230:231], v239 offset:9216
  v_mfma_f32_16x16x32_bf16 v[96:99], v[184:187], a[224:227], v[96:99]
  buffer_load_dwordx4 a[196:199], v16, s[52:55], s71 offen offset:256 sc1
  v_mfma_f32_16x16x32_bf16 v[100:103], v[184:187], a[228:231], v[100:103]
  v_mfma_f32_16x16x32_bf16 v[104:107], v[184:187], a[232:235], v[104:107]
  buffer_load_dwordx4 a[200:203], v17, s[52:55], s71 offen offset:0 sc1
  v_mfma_f32_16x16x32_bf16 v[108:111], v[184:187], a[236:239], v[108:111]
  v_mfma_f32_16x16x32_bf16 v[112:115], v[188:191], a[224:227], v[112:115]
  buffer_load_dwordx4 a[204:207], v17, s[52:55], s71 offen offset:256 sc1
  v_mfma_f32_16x16x32_bf16 v[116:119], v[188:191], a[228:231], v[116:119]
  v_mfma_f32_16x16x32_bf16 v[120:123], v[188:191], a[232:235], v[120:123]
  buffer_load_dwordx4 a[208:211], v16, s[52:55], s71 offen offset:2048 sc1
  v_mfma_f32_16x16x32_bf16 v[124:127], v[188:191], a[236:239], v[124:127]
  v_mfma_f32_16x16x32_bf16 v[128:131], v[192:195], a[224:227], v[128:131]
  buffer_load_dwordx4 a[212:215], v16, s[52:55], s71 offen offset:2304 sc1
  v_mfma_f32_16x16x32_bf16 v[132:135], v[192:195], a[228:231], v[132:135]
  v_mfma_f32_16x16x32_bf16 v[136:139], v[192:195], a[232:235], v[136:139]
  buffer_load_dwordx4 a[216:219], v17, s[52:55], s71 offen offset:2048 sc1
  v_mfma_f32_16x16x32_bf16 v[140:143], v[192:195], a[236:239], v[140:143]
  v_mfma_f32_16x16x32_bf16 v[144:147], v[196:199], a[224:227], v[144:147]
  buffer_load_dwordx4 a[220:223], v17, s[52:55], s71 offen offset:2304 sc1
  v_mfma_f32_16x16x32_bf16 v[148:151], v[196:199], a[228:231], v[148:151]
  s_add_u32 s72, s72, 131072
  s_add_u32 s71, s71, 4096
  v_mfma_f32_16x16x32_bf16 v[152:155], v[196:199], a[232:235], v[152:155]
  v_mfma_f32_16x16x32_bf16 v[156:159], v[196:199], a[236:239], v[156:159]
  s_sub_u32 s73, s73, 1
  s_cmp_lg_u32 s73, 0
  s_cbranch_scc1 mk_oloop
  s_waitcnt vmcnt(36) lgkmcnt(0)
  s_barrier
  v_mfma_f32_16x16x32_bf16 v[32:35], v[200:203], a[240:243], v[32:35]
  ds_read_b64_tr_b16 v[168:169], v160 offset:0
  v_mfma_f32_16x16x32_bf16 v[36:39], v[200:203], a[244:247], v[36:39]
  ds_read_b64_tr_b16 v[170:171], v160 offset:1024
  v_mfma_f32_16x16x32_bf16 v[40:43], v[200:203], a[248:251], v[40:43]
  ds_read_b64_tr_b16 v[172:173], v161 offset:0
  v_mfma_f32_16x16x32_bf16 v[44:47], v[200:203], a[252:255], v[44:47]
  ds_read_b64_tr_b16 v[174:175], v161 offset:1024
  v_mfma_f32_16x16x32_bf16 v[48:51], v[204:207], a[240:243], v[48:51]
  ds_read_b64_tr_b16 v[176:177], v162 offset:0
  v_mfma_f32_16x16x32_bf16 v[52:55], v[204:207], a[244:247], v[52:55]
  ds_read_b64_tr_b16 v[178:179], v162 offset:1024
  v_mfma_f32_16x16x32_bf16 v[56:59], v[204:207], a[248:251], v[56:59]
  ds_read_b64_tr_b16 v[180:181], v163 offset:0
  v_mfma_f32_16x16x32_bf16 v[60:63], v[204:207], a[252:255], v[60:63]
  ds_read_b64_tr_b16 v[182:183], v163 offset:1024
  v_mfma_f32_16x16x32_bf16 v[64:67], v[208:211], a[240:243], v[64:67]
  ds_read_b64_tr_b16 v[184:185], v164 offset:0
  v_mfma_f32_16x16x32_bf16 v[68:71], v[208:211], a[244:247], v[68:71]
  ds_read_b64_tr_b16 v[186:187], v164 offset:1024
  v_mfma_f32_16x16x32_bf16 v[72:75], v[208:211], a[248:251], v[72:75]
  ds_read_b64_tr_b16 v[188:189], v165 offset:0
  v_mfma_f32_16x16x32_bf16 v[76:79], v[208:211], a[252:255], v[76:79]
  ds_read_b64_tr_b16 v[190:191], v165 offset:1024
  v_mfma_f32_16x16x32_bf16 v[80:83], v[212:215], a[240:243], v[80:83]
  ds_read_b64_tr_b16 v[192:193], v166 offset:0
  v_mfma_f32_16x16x32_bf16 v[84:87], v[212:215], a[244:247], v[84:87]
  ds_read_b64_tr_b16 v[194:195], v166 offset:1024
  v_mfma_f32_16x16x32_bf16 v[88:91], v[212:215], a[248:251], v[88:91]
  ds_read_b64_tr_b16 v[196:197], v167 offset:0
  v_mfma_f32_16x16x32_bf16 v[92:95], v[212:215], a[252:255], v[92:95]
  ds_read_b64_tr_b16 v[198:199], v167 offset:1024
  s_add_u32 m0, s74, 65536
  v_mfma_f32_16x16x32_bf16 v[96:99], v[216:219], a[240:243], v[96:99]
  buffer_load_dwordx4 v20, s[48:51], s72 offen offset:0 lds
  v_mfma_f32_16x16x32_bf16 v[100:103], v[216:219], a[244:247], v[100:103]
  v_mfma_f32_16x16x32_bf16 v[104:107], v[216:219], a[248:251], v[104:107]
  v_mfma_f32_16x16x32_bf16 v[108:111], v[216:219], a[252:255], v[108:111]
  v_mfma_f32_16x16x32_bf16 v[112:115], v[220:223], a[240:243], v[112:115]
  buffer_load_dwordx4 v21, s[48:51], s72 offen offset:1024 lds
  v_mfma_f32_16x16x32_bf16 v[116:119], v[220:223], a[244:247], v[116:119]
  v_mfma_f32_16x16x32_bf16 v[120:123], v[220:223], a[248:251], v[120:123]
  v_mfma_f32_16x16x32_bf16 v[124:127], v[220:223], a[252:255], v[124:127]
  v_mfma_f32_16x16x32_bf16 v[128:131], v[224:227], a[240:243], v[128:131]
  buffer_load_dwordx4 v22, s[48:51], s72 offen offset:2048 lds
  v_mfma_f32_16x16x32_bf16 v[132:135], v[224:227], a[244:247], v[132:135]
  v_mfma_f32_16x16x32_bf16 v[136:139], v[224:227], a[248:251], v[136:139]
  v_mfma_f32_16x16x32_bf16 v[140:143], v[224:227], a[252:255], v[140:143]
  v_mfma_f32_16x16x32_bf16 v[144:147], v[228:231], a[240:243], v[144:147]
  buffer_load_dwordx4 v23, s[48:51], s72 offen offset:3072 lds
  v_mfma_f32_16x16x32_bf16 v[148:151], v[228:231], a[244:247], v[148:151]
  v_mfma_f32_16x16x32_bf16 v[152:155], v[228:231], a[248:251], v[152:155]
  v_mfma_f32_16x16x32_bf16 v[156:159], v[228:231], a[252:255], v[156:159]
  s_waitcnt lgkmcnt(0)
  v_mfma_f32_16x16x32_bf16 v[32:35], v[168:171], a[96:99], v[32:35]
  ds_read_b64_tr_b16 v[200:201], v160 offset:8192
  v_mfma_f32_16x16x32_bf16 v[36:39], v[168:171], a[100:103], v[36:39]
  ds_read_b64_tr_b16 v[202:203], v160 offset:9216
  v_mfma_f32_16x16x32_bf16 v[40:43], v[168:171], a[104:107], v[40:43]
  ds_read_b64_tr_b16 v[204:205], v161 offset:8192
  v_mfma_f32_16x16x32_bf16 v[44:47], v[168:171], a[108:111], v[44:47]
  ds_read_b64_tr_b16 v[206:207], v161 offset:9216
  v_mfma_f32_16x16x32_bf16 v[48:51], v[172:175], a[96:99], v[48:51]
  ds_read_b64_tr_b16 v[208:209], v162 offset:8192
  v_mfma_f32_16x16x32_bf16 v[52:55], v[172:175], a[100:103], v[52:55]
  ds_read_b64_tr_b16 v[210:211], v162 offset:9216
  v_mfma_f32_16x16x32_bf16 v[56:59], v[172:175], a[104:107], v[56:59]
  ds_read_b64_tr_b16 v[212:213], v163 offset:8192
  v_mfma_f32_16x16x32_bf16 v[60:63], v[172:175], a[108:111], v[60:63]
  ds_read_b64_tr_b16 v[214:215], v163 offset:9216
  v_mfma_f32_16x16x32_bf16 v[64:67], v[176:179], a[96:99], v[64:67]
  ds_read_b64_tr_b16 v[216:217], v164 offset:8192
  v_mfma_f32_16x16x32_bf16 v[68:71], v[176:179], a[100:103], v[68:71]
  ds_read_b64_tr_b16 v[218:219], v164 offset:9216
  v_mfma_f32_16x16x32_bf16 v[72:75], v[176:179], a[104:107], v[72:75]
  ds_read_b64_tr_b16 v[220:221], v165 offset:8192
  v_mfma_f32_16x16x32_bf16 v[76:79], v[176:179], a[108:111], v[76:79]
  ds_read_b64_tr_b16 v[222:223], v165 offset:9216
  v_mfma_f32_16x16x32_bf16 v[80:83], v[180:183], a[96:99], v[80:83]
  ds_read_b64_tr_b16 v[224:225], v166 offset:8192
  v_mfma_f32_16x16x32_bf16 v[84:87], v[180:183], a[100:103], v[84:87]
  ds_read_b64_tr_b16 v[226:227], v166 offset:9216
  v_mfma_f32_16x16x32_bf16 v[88:91], v[180:183], a[104:107], v[88:91]
  ds_read_b64_tr_b16 v[228:229], v167 offset:8192
  buffer_load_dwordx4 a[224:227], v16, s[52:55], s71 offen offset:0 sc1
  v_mfma_f32_16x16x32_bf16 v[92:95], v[180:183], a[108:111], v[92:95]
  ds_read_b64_tr_b16 v[230:231], v167 offset:9216
  v_mfma_f32_16x16x32_bf16 v[96:99], v[184:187], a[96:99], v[96:99]
  buffer_load_dwordx4 a[228:231], v16, s[52:55], s71 offen offset:256 sc1
  v_mfma_f32_16x16x32_bf16 v[100:103], v[184:187], a[100:103], v[100:103]
  v_mfma_f32_16x16x32_bf16 v[104:107], v[184:187], a[104:107], v[104:107]
  buffer_load_dwordx4 a[232:235], v17, s[52:55], s71 offen offset:0 sc1
  v_mfma_f32_16x16x32_bf16 v[108:111], v[184:187], a[108:111], v[108:111]
  v_mfma_f32_16x16x32_bf16 v[112:115], v[188:191], a[96:99], v[112:115]
  buffer_load_dwordx4 a[236:239], v17, s[52:55], s71 offen offset:256 sc1
  v_mfma_f32_16x16x32_bf16 v[116:119], v[188:191], a[100:103], v[116:119]
  v_mfma_f32_16x16x32_bf16 v[120:123], v[188:191], a[104:107], v[120:123]
  buffer_load_dwordx4 a[240:243], v16, s[52:55], s71 offen offset:2048 sc1
  v_mfma_f32_16x16x32_bf16 v[124:127], v[188:191], a[108:111], v[124:127]
  v_mfma_f32_16x16x32_bf16 v[128:131], v[192:195], a[96:99], v[128:131]
  buffer_load_dwordx4 a[244:247], v16, s[52:55], s71 offen offset:2304 sc1
  v_mfma_f32_16x16x32_bf16 v[132:135], v[192:195], a[100:103], v[132:135]
  v_mfma_f32_16x16x32_bf16 v[136:139], v[192:195], a[104:107], v[136:139]
  buffer_load_dwordx4 a[248:251], v17, s[52:55], s71 offen offset:2048 sc1
  v_mfma_f32_16x16x32_bf16 v[140:143], v[192:195], a[108:111], v[140:143]
  v_mfma_f32_16x16x32_bf16 v[144:147], v[196:199], a[96:99], v[144:147]
  buffer_load_dwordx4 a[252:255], v17, s[52:55], s71 offen offset:2304 sc1
  v_mfma_f32_16x16x32_bf16 v[148:151], v[196:199], a[100:103], v[148:151]
  s_add_u32 s72, s72, 131072
  s_add_u32 s71, s71, 4096
  v_mfma_f32_16x16x32_bf16 v[152:155], v[196:199], a[104:107], v[152:155]
  v_mfma_f32_16x16x32_bf16 v[156:159], v[196:199], a[108:111], v[156:159]
  s_lshl_b32 s76, s78, 19
  s_lshl_b32 s77, s67, 13
  s_add_u32 s76, s76, s77
  s_add_u32 s76, s76, 84934656
  s_lshl_b32 s77, s78, 2
  s_add_u32 s77, s77, s67
  s_lshl_b32 s77, s77, 9
  s_add_u32 s77, s77, 84017152
  s_xor_b32 s75, s70, 1
  s_lshl_b32 s96, s75, 7
  s_add_u32 s96, s96, s77
  s_add_u32 s96, s96, 1
  s_lshl_b32 s75, s75, 15
  s_lshl_b32 s79, s70, 17
  s_add_u32 s90, s75, s79
  s_add_u32 s90, s90, s76
  s_add_u32 s91, s90, 4096
  s_xor_b32 s75, s70, 2
  s_lshl_b32 s97, s75, 7
  s_add_u32 s97, s97, s77
  s_add_u32 s97, s97, 2
  s_lshl_b32 s75, s75, 15
  s_lshl_b32 s79, s70, 17
  s_add_u32 s92, s75, s79
  s_add_u32 s92, s92, s76
  s_add_u32 s93, s92, 4096
  s_xor_b32 s75, s70, 3
  s_lshl_b32 s98, s75, 7
  s_add_u32 s98, s98, s77
  s_add_u32 s98, s98, 3
  s_lshl_b32 s75, s75, 15
  s_lshl_b32 s79, s70, 17
  s_add_u32 s94, s75, s79
  s_add_u32 s94, s94, s76
  s_add_u32 s95, s94, 4096
  s_lshl_b32 s75, s70, 7
  s_add_u32 s77, s77, s75
  s_waitcnt vmcnt(36) lgkmcnt(0)
  s_barrier
  v_mfma_f32_16x16x32_bf16 v[32:35], v[200:203], a[112:115], v[32:35]
  ds_read_b64_tr_b16 v[168:169], v162 offset:16384
  v_mfma_f32_16x16x32_bf16 v[36:39], v[200:203], a[116:119], v[36:39]
  ds_read_b64_tr_b16 v[170:171], v162 offset:17408
  v_mfma_f32_16x16x32_bf16 v[40:43], v[200:203], a[120:123], v[40:43]
  ds_read_b64_tr_b16 v[172:173], v163 offset:16384
  v_mfma_f32_16x16x32_bf16 v[44:47], v[200:203], a[124:127], v[44:47]
  ds_read_b64_tr_b16 v[174:175], v163 offset:17408
  v_mfma_f32_16x16x32_bf16 v[48:51], v[204:207], a[112:115], v[48:51]
  ds_read_b64_tr_b16 v[176:177], v162 offset:24576
  v_mfma_f32_16x16x32_bf16 v[52:55], v[204:207], a[116:119], v[52:55]
  ds_read_b64_tr_b16 v[178:179], v162 offset:25600
  v_mfma_f32_16x16x32_bf16 v[56:59], v[204:207], a[120:123], v[56:59]
  ds_read_b64_tr_b16 v[180:181], v163 offset:24576
  v_mfma_f32_16x16x32_bf16 v[60:63], v[204:207], a[124:127], v[60:63]
  ds_read_b64_tr_b16 v[182:183], v163 offset:25600
  v_mfma_f32_16x16x32_bf16 v[64:67], v[208:211], a[112:115], v[64:67]
  v_mfma_f32_16x16x32_bf16 v[68:71], v[208:211], a[116:119], v[68:71]
  v_mfma_f32_16x16x32_bf16 v[72:75], v[208:211], a[120:123], v[72:75]
  v_mfma_f32_16x16x32_bf16 v[76:79], v[208:211], a[124:127], v[76:79]
  v_mfma_f32_16x16x32_bf16 v[80:83], v[212:215], a[112:115], v[80:83]
  v_mfma_f32_16x16x32_bf16 v[84:87], v[212:215], a[116:119], v[84:87]
  v_mfma_f32_16x16x32_bf16 v[88:91], v[212:215], a[120:123], v[88:91]
  v_mfma_f32_16x16x32_bf16 v[92:95], v[212:215], a[124:127], v[92:95]
  v_mfma_f32_16x16x32_bf16 v[96:99], v[216:219], a[112:115], v[96:99]
  v_mfma_f32_16x16x32_bf16 v[100:103], v[216:219], a[116:119], v[100:103]
  v_mfma_f32_16x16x32_bf16 v[104:107], v[216:219], a[120:123], v[104:107]
  v_mfma_f32_16x16x32_bf16 v[108:111], v[216:219], a[124:127], v[108:111]
  v_mfma_f32_16x16x32_bf16 v[112:115], v[220:223], a[112:115], v[112:115]
  v_mfma_f32_16x16x32_bf16 v[116:119], v[220:223], a[116:119], v[116:119]
  v_mfma_f32_16x16x32_bf16 v[120:123], v[220:223], a[120:123], v[120:123]
  v_mfma_f32_16x16x32_bf16 v[124:127], v[220:223], a[124:127], v[124:127]
  v_mfma_f32_16x16x32_bf16 v[128:131], v[224:227], a[112:115], v[128:131]
  v_mfma_f32_16x16x32_bf16 v[132:135], v[224:227], a[116:119], v[132:135]
  v_mfma_f32_16x16x32_bf16 v[136:139], v[224:227], a[120:123], v[136:139]
  v_mfma_f32_16x16x32_bf16 v[140:143], v[224:227], a[124:127], v[140:143]
  v_mfma_f32_16x16x32_bf16 v[144:147], v[228:231], a[112:115], v[144:147]
  v_mfma_f32_16x16x32_bf16 v[148:151], v[228:231], a[116:119], v[148:151]
  v_mfma_f32_16x16x32_bf16 v[152:155], v[228:231], a[120:123], v[152:155]
  v_mfma_f32_16x16x32_bf16 v[156:159], v[228:231], a[124:127], v[156:159]
  s_waitcnt vmcnt(24)
  s_barrier
  s_waitcnt lgkmcnt(4)
  v_mfma_f32_16x16x32_bf16 v[64:67], v[168:171], a[128:131], v[64:67]
  ds_read_b64_tr_b16 v[184:185], v162 offset:32768
  v_mfma_f32_16x16x32_bf16 v[68:71], v[168:171], a[132:135], v[68:71]
  ds_read_b64_tr_b16 v[186:187], v162 offset:33792
  v_mfma_f32_16x16x32_bf16 v[72:75], v[168:171], a[136:139], v[72:75]
  ds_read_b64_tr_b16 v[188:189], v163 offset:32768
  v_mfma_f32_16x16x32_bf16 v[76:79], v[168:171], a[140:143], v[76:79]
  ds_read_b64_tr_b16 v[190:191], v163 offset:33792
  v_mfma_f32_16x16x32_bf16 v[80:83], v[172:175], a[128:131], v[80:83]
  v_mfma_f32_16x16x32_bf16 v[84:87], v[172:175], a[132:135], v[84:87]
  v_mfma_f32_16x16x32_bf16 v[88:91], v[172:175], a[136:139], v[88:91]
  v_mfma_f32_16x16x32_bf16 v[92:95], v[172:175], a[140:143], v[92:95]
  s_waitcnt lgkmcnt(4)
  v_mfma_f32_16x16x32_bf16 v[64:67], v[176:179], a[144:147], v[64:67]
  ds_read_b64_tr_b16 v[192:193], v162 offset:40960
  v_mfma_f32_16x16x32_bf16 v[68:71], v[176:179], a[148:151], v[68:71]
  ds_read_b64_tr_b16 v[194:195], v162 offset:41984
  v_mfma_f32_16x16x32_bf16 v[72:75], v[176:179], a[152:155], v[72:75]
  ds_read_b64_tr_b16 v[196:197], v163 offset:40960
  v_mfma_f32_16x16x32_bf16 v[76:79], v[176:179], a[156:159], v[76:79]
  ds_read_b64_tr_b16 v[198:199], v163 offset:41984
  v_mfma_f32_16x16x32_bf16 v[80:83], v[180:183], a[144:147], v[80:83]
  v_mfma_f32_16x16x32_bf16 v[84:87], v[180:183], a[148:151], v[84:87]
  v_mfma_f32_16x16x32_bf16 v[88:91], v[180:183], a[152:155], v[88:91]
  v_mfma_f32_16x16x32_bf16 v[92:95], v[180:183], a[156:159], v[92:95]
  s_waitcnt vmcnt(12)
  s_barrier
  s_waitcnt lgkmcnt(4)
  v_mfma_f32_16x16x32_bf16 v[64:67], v[184:187], a[160:163], v[64:67]
  ds_read_b64_tr_b16 v[168:169], v162 offset:49152
  v_mfma_f32_16x16x32_bf16 v[68:71], v[184:187], a[164:167], v[68:71]
  ds_read_b64_tr_b16 v[170:171], v162 offset:50176
  v_mfma_f32_16x16x32_bf16 v[72:75], v[184:187], a[168:171], v[72:75]
  ds_read_b64_tr_b16 v[172:173], v163 offset:49152
  v_mfma_f32_16x16x32_bf16 v[76:79], v[184:187], a[172:175], v[76:79]
  ds_read_b64_tr_b16 v[174:175], v163 offset:50176
  v_mfma_f32_16x16x32_bf16 v[80:83], v[188:191], a[160:163], v[80:83]
  v_mfma_f32_16x16x32_bf16 v[84:87], v[188:191], a[164:167], v[84:87]
  v_mfma_f32_16x16x32_bf16 v[88:91], v[188:191], a[168:171], v[88:91]
  v_mfma_f32_16x16x32_bf16 v[92:95], v[188:191], a[172:175], v[92:95]
  s_waitcnt lgkmcnt(4)
  v_mfma_f32_16x16x32_bf16 v[64:67], v[192:195], a[176:179], v[64:67]
  ds_read_b64_tr_b16 v[176:177], v162 offset:57344
  v_mfma_f32_16x16x32_bf16 v[68:71], v[192:195], a[180:183], v[68:71]
  ds_read_b64_tr_b16 v[178:179], v162 offset:58368
  v_mfma_f32_16x16x32_bf16 v[72:75], v[192:195], a[184:187], v[72:75]
  ds_read_b64_tr_b16 v[180:181], v163 offset:57344
  v_mfma_f32_16x16x32_bf16 v[76:79], v[192:195], a[188:191], v[76:79]
  ds_read_b64_tr_b16 v[182:183], v163 offset:58368
  v_mfma_f32_16x16x32_bf16 v[80:83], v[196:199], a[176:179], v[80:83]
  v_mfma_f32_16x16x32_bf16 v[84:87], v[196:199], a[180:183], v[84:87]
  v_mfma_f32_16x16x32_bf16 v[88:91], v[196:199], a[184:187], v[88:91]
  v_mfma_f32_16x16x32_bf16 v[92:95], v[196:199], a[188:191], v[92:95]
  s_waitcnt vmcnt(0)
  s_barrier
  s_waitcnt lgkmcnt(4)
  v_mfma_f32_16x16x32_bf16 v[64:67], v[168:171], a[192:195], v[64:67]
  ds_read_b64_tr_b16 v[184:185], v234 offset:0
  v_mfma_f32_16x16x32_bf16 v[68:71], v[168:171], a[196:199], v[68:71]
  ds_read_b64_tr_b16 v[186:187], v234 offset:1024
  v_mfma_f32_16x16x32_bf16 v[72:75], v[168:171], a[200:203], v[72:75]
  ds_read_b64_tr_b16 v[188:189], v235 offset:0
  v_mfma_f32_16x16x32_bf16 v[76:79], v[168:171], a[204:207], v[76:79]
  ds_read_b64_tr_b16 v[190:191], v235 offset:1024
  v_mfma_f32_16x16x32_bf16 v[80:83], v[172:175], a[192:195], v[80:83]
  v_mfma_f32_16x16x32_bf16 v[84:87], v[172:175], a[196:199], v[84:87]
  v_mfma_f32_16x16x32_bf16 v[88:91], v[172:175], a[200:203], v[88:91]
  v_mfma_f32_16x16x32_bf16 v[92:95], v[172:175], a[204:207], v[92:95]
  s_waitcnt lgkmcnt(4)
  v_mfma_f32_16x16x32_bf16 v[64:67], v[176:179], a[208:211], v[64:67]
  ds_read_b64_tr_b16 v[192:193], v234 offset:8192
  v_mfma_f32_16x16x32_bf16 v[68:71], v[176:179], a[212:215], v[68:71]
  ds_read_b64_tr_b16 v[194:195], v234 offset:9216
  v_mfma_f32_16x16x32_bf16 v[72:75], v[176:179], a[216:219], v[72:75]
  ds_read_b64_tr_b16 v[196:197], v235 offset:8192
  v_mfma_f32_16x16x32_bf16 v[76:79], v[176:179], a[220:223], v[76:79]
  ds_read_b64_tr_b16 v[198:199], v235 offset:9216
  v_mfma_f32_16x16x32_bf16 v[80:83], v[180:183], a[208:211], v[80:83]
  v_mfma_f32_16x16x32_bf16 v[84:87], v[180:183], a[212:215], v[84:87]
  v_mfma_f32_16x16x32_bf16 v[88:91], v[180:183], a[216:219], v[88:91]
  v_mfma_f32_16x16x32_bf16 v[92:95], v[180:183], a[220:223], v[92:95]
  s_waitcnt lgkmcnt(4)
  v_mfma_f32_16x16x32_bf16 v[64:67], v[184:187], a[224:227], v[64:67]
  ds_read_b64_tr_b16 v[168:169], v164 offset:16384
  v_mfma_f32_16x16x32_bf16 v[68:71], v[184:187], a[228:231], v[68:71]
  ds_read_b64_tr_b16 v[170:171], v164 offset:17408
  v_mfma_f32_16x16x32_bf16 v[72:75], v[184:187], a[232:235], v[72:75]
  ds_read_b64_tr_b16 v[172:173], v165 offset:16384
  v_mfma_f32_16x16x32_bf16 v[76:79], v[184:187], a[236:239], v[76:79]
  ds_read_b64_tr_b16 v[174:175], v165 offset:17408
  v_mfma_f32_16x16x32_bf16 v[80:83], v[188:191], a[224:227], v[80:83]
  v_mfma_f32_16x16x32_bf16 v[84:87], v[188:191], a[228:231], v[84:87]
  v_mfma_f32_16x16x32_bf16 v[88:91], v[188:191], a[232:235], v[88:91]
  v_mfma_f32_16x16x32_bf16 v[92:95], v[188:191], a[236:239], v[92:95]
  s_waitcnt lgkmcnt(4)
  v_mfma_f32_16x16x32_bf16 v[64:67], v[192:195], a[240:243], v[64:67]
  ds_read_b64_tr_b16 v[176:177], v164 offset:24576
  v_mfma_f32_16x16x32_bf16 v[68:71], v[192:195], a[244:247], v[68:71]
  ds_read_b64_tr_b16 v[178:179], v164 offset:25600
  v_mfma_f32_16x16x32_bf16 v[72:75], v[192:195], a[248:251], v[72:75]
  ds_read_b64_tr_b16 v[180:181], v165 offset:24576
  v_mfma_f32_16x16x32_bf16 v[76:79], v[192:195], a[252:255], v[76:79]
  ds_read_b64_tr_b16 v[182:183], v165 offset:25600
  v_mfma_f32_16x16x32_bf16 v[80:83], v[196:199], a[240:243], v[80:83]
  v_mfma_f32_16x16x32_bf16 v[84:87], v[196:199], a[244:247], v[84:87]
  v_mfma_f32_16x16x32_bf16 v[88:91], v[196:199], a[248:251], v[88:91]
  v_mfma_f32_16x16x32_bf16 v[92:95], v[196:199], a[252:255], v[92:95]
  s_waitcnt lgkmcnt(4)
  v_mfma_f32_16x16x32_bf16 v[96:99], v[168:171], a[128:131], v[96:99]
  ds_read_b64_tr_b16 v[184:185], v164 offset:32768
  v_mfma_f32_16x16x32_bf16 v[100:103], v[168:171], a[132:135], v[100:103]
  ds_read_b64_tr_b16 v[186:187], v164 offset:33792
  v_mfma_f32_16x16x32_bf16 v[104:107], v[168:171], a[136:139], v[104:107]
  ds_read_b64_tr_b16 v[188:189], v165 offset:32768
  v_mfma_f32_16x16x32_bf16 v[108:111], v[168:171], a[140:143], v[108:111]
  ds_read_b64_tr_b16 v[190:191], v165 offset:33792
  v_mfma_f32_16x16x32_bf16 v[112:115], v[172:175], a[128:131], v[112:115]
  v_mfma_f32_16x16x32_bf16 v[116:119], v[172:175], a[132:135], v[116:119]
  v_mfma_f32_16x16x32_bf16 v[120:123], v[172:175], a[136:139], v[120:123]
  buffer_store_dwordx4 v[64:67], v1, s[52:55], s90 offen offset:0 sc1
  v_mfma_f32_16x16x32_bf16 v[124:127], v[172:175], a[140:143], v[124:127]
  s_waitcnt lgkmcnt(4)
  v_mfma_f32_16x16x32_bf16 v[96:99], v[176:179], a[144:147], v[96:99]
  ds_read_b64_tr_b16 v[192:193], v164 offset:40960
  v_mfma_f32_16x16x32_bf16 v[100:103], v[176:179], a[148:151], v[100:103]
  ds_read_b64_tr_b16 v[194:195], v164 offset:41984
  v_mfma_f32_16x16x32_bf16 v[104:107], v[176:179], a[152:155], v[104:107]
  ds_read_b64_tr_b16 v[196:197], v165 offset:40960
  v_mfma_f32_16x16x32_bf16 v[108:111], v[176:179], a[156:159], v[108:111]
  ds_read_b64_tr_b16 v[198:199], v165 offset:41984
  v_mfma_f32_16x16x32_bf16 v[112:115], v[180:183], a[144:147], v[112:115]
  v_mfma_f32_16x16x32_bf16 v[116:119], v[180:183], a[148:151], v[116:119]
  v_mfma_f32_16x16x32_bf16 v[120:123], v[180:183], a[152:155], v[120:123]
  buffer_store_dwordx4 v[68:71], v1, s[52:55], s90 offen offset:1024 sc1
  v_mfma_f32_16x16x32_bf16 v[124:127], v[180:183], a[156:159], v[124:127]
  s_waitcnt lgkmcnt(4)
  v_mfma_f32_16x16x32_bf16 v[96:99], v[184:187], a[160:163], v[96:99]
  ds_read_b64_tr_b16 v[168:169], v164 offset:49152
  v_mfma_f32_16x16x32_bf16 v[100:103], v[184:187], a[164:167], v[100:103]
  ds_read_b64_tr_b16 v[170:171], v164 offset:50176
  v_mfma_f32_16x16x32_bf16 v[104:107], v[184:187], a[168:171], v[104:107]
  ds_read_b64_tr_b16 v[172:173], v165 offset:49152
  v_mfma_f32_16x16x32_bf16 v[108:111], v[184:187], a[172:175], v[108:111]
  ds_read_b64_tr_b16 v[174:175], v165 offset:50176
  v_mfma_f32_16x16x32_bf16 v[112:115], v[188:191], a[160:163], v[112:115]
  v_mfma_f32_16x16x32_bf16 v[116:119], v[188:191], a[164:167], v[116:119]
  v_mfma_f32_16x16x32_bf16 v[120:123], v[188:191], a[168:171], v[120:123]
  buffer_store_dwordx4 v[72:75], v1, s[52:55], s90 offen offset:2048 sc1
  v_mfma_f32_16x16x32_bf16 v[124:127], v[188:191], a[172:175], v[124:127]
  s_waitcnt lgkmcnt(4)
  v_mfma_f32_16x16x32_bf16 v[96:99], v[192:195], a[176:179], v[96:99]
  ds_read_b64_tr_b16 v[176:177], v164 offset:57344
  v_mfma_f32_16x16x32_bf16 v[100:103], v[192:195], a[180:183], v[100:103]
  ds_read_b64_tr_b16 v[178:179], v164 offset:58368
  v_mfma_f32_16x16x32_bf16 v[104:107], v[192:195], a[184:187], v[104:107]
  ds_read_b64_tr_b16 v[180:181], v165 offset:57344
  v_mfma_f32_16x16x32_bf16 v[108:111], v[192:195], a[188:191], v[108:111]
  ds_read_b64_tr_b16 v[182:183], v165 offset:58368
  v_mfma_f32_16x16x32_bf16 v[112:115], v[196:199], a[176:179], v[112:115]
  v_mfma_f32_16x16x32_bf16 v[116:119], v[196:199], a[180:183], v[116:119]
  v_mfma_f32_16x16x32_bf16 v[120:123], v[196:199], a[184:187], v[120:123]
  buffer_store_dwordx4 v[76:79], v1, s[52:55], s90 offen offset:3072 sc1
  v_mfma_f32_16x16x32_bf16 v[124:127], v[196:199], a[188:191], v[124:127]
  s_waitcnt lgkmcnt(4)
  v_mfma_f32_16x16x32_bf16 v[96:99], v[168:171], a[192:195], v[96:99]
  ds_read_b64_tr_b16 v[184:185], v236 offset:0
  v_mfma_f32_16x16x32_bf16 v[100:103], v[168:171], a[196:199], v[100:103]
  ds_read_b64_tr_b16 v[186:187], v236 offset:1024
  v_mfma_f32_16x16x32_bf16 v[104:107], v[168:171], a[200:203], v[104:107]
  ds_read_b64_tr_b16 v[188:189], v237 offset:0
  v_mfma_f32_16x16x32_bf16 v[108:111], v[168:171], a[204:207], v[108:111]
  ds_read_b64_tr_b16 v[190:191], v237 offset:1024
  v_mfma_f32_16x16x32_bf16 v[112:115], v[172:175], a[192:195], v[112:115]
  v_mfma_f32_16x16x32_bf16 v[116:119], v[172:175], a[196:199], v[116:119]
  v_mfma_f32_16x16x32_bf16 v[120:123], v[172:175], a[200:203], v[120:123]
  buffer_store_dwordx4 v[80:83], v1, s[52:55], s91 offen offset:0 sc1
  v_mfma_f32_16x16x32_bf16 v[124:127], v[172:175], a[204:207], v[124:127]
  s_waitcnt lgkmcnt(4)
  v_mfma_f32_16x16x32_bf16 v[96:99], v[176:179], a[208:211], v[96:99]
  ds_read_b64_tr_b16 v[192:193], v236 offset:8192
  v_mfma_f32_16x16x32_bf16 v[100:103], v[176:179], a[212:215], v[100:103]
  ds_read_b64_tr_b16 v[194:195], v236 offset:9216
  v_mfma_f32_16x16x32_bf16 v[104:107], v[176:179], a[216:219], v[104:107]
  ds_read_b64_tr_b16 v[196:197], v237 offset:8192
  v_mfma_f32_16x16x32_bf16 v[108:111], v[176:179], a[220:223], v[108:111]
  ds_read_b64_tr_b16 v[198:199], v237 offset:9216
  v_mfma_f32_16x16x32_bf16 v[112:115], v[180:183], a[208:211], v[112:115]
  v_mfma_f32_16x16x32_bf16 v[116:119], v[180:183], a[212:215], v[116:119]
  v_mfma_f32_16x16x32_bf16 v[120:123], v[180:183], a[216:219], v[120:123]
  buffer_store_dwordx4 v[84:87], v1, s[52:55], s91 offen offset:1024 sc1
  v_mfma_f32_16x16x32_bf16 v[124:127], v[180:183], a[220:223], v[124:127]
  s_waitcnt lgkmcnt(4)
  v_mfma_f32_16x16x32_bf16 v[96:99], v[184:187], a[224:227], v[96:99]
  ds_read_b64_tr_b16 v[168:169], v166 offset:16384
  v_mfma_f32_16x16x32_bf16 v[100:103], v[184:187], a[228:231], v[100:103]
  ds_read_b64_tr_b16 v[170:171], v166 offset:17408
  v_mfma_f32_16x16x32_bf16 v[104:107], v[184:187], a[232:235], v[104:107]
  ds_read_b64_tr_b16 v[172:173], v167 offset:16384
  v_mfma_f32_16x16x32_bf16 v[108:111], v[184:187], a[236:239], v[108:111]
  ds_read_b64_tr_b16 v[174:175], v167 offset:17408
  v_mfma_f32_16x16x32_bf16 v[112:115], v[188:191], a[224:227], v[112:115]
  v_mfma_f32_16x16x32_bf16 v[116:119], v[188:191], a[228:231], v[116:119]
  v_mfma_f32_16x16x32_bf16 v[120:123], v[188:191], a[232:235], v[120:123]
  buffer_store_dwordx4 v[88:91], v1, s[52:55], s91 offen offset:2048 sc1
  v_mfma_f32_16x16x32_bf16 v[124:127], v[188:191], a[236:239], v[124:127]
  s_waitcnt lgkmcnt(4)
  v_mfma_f32_16x16x32_bf16 v[96:99], v[192:195], a[240:243], v[96:99]
  ds_read_b64_tr_b16 v[176:177], v166 offset:24576
  v_mfma_f32_16x16x32_bf16 v[100:103], v[192:195], a[244:247], v[100:103]
  ds_read_b64_tr_b16 v[178:179], v166 offset:25600
  v_mfma_f32_16x16x32_bf16 v[104:107], v[192:195], a[248:251], v[104:107]
  ds_read_b64_tr_b16 v[180:181], v167 offset:24576
  v_mfma_f32_16x16x32_bf16 v[108:111], v[192:195], a[252:255], v[108:111]
  ds_read_b64_tr_b16 v[182:183], v167 offset:25600
  v_mfma_f32_16x16x32_bf16 v[112:115], v[196:199], a[240:243], v[112:115]
  v_mfma_f32_16x16x32_bf16 v[116:119], v[196:199], a[244:247], v[116:119]
  v_mfma_f32_16x16x32_bf16 v[120:123], v[196:199], a[248:251], v[120:123]
  buffer_store_dwordx4 v[92:95], v1, s[52:55], s91 offen offset:3072 sc1
  v_mfma_f32_16x16x32_bf16 v[124:127], v[196:199], a[252:255], v[124:127]
  s_waitcnt lgkmcnt(4)
  v_mfma_f32_16x16x32_bf16 v[128:131], v[168:171], a[128:131], v[128:131]
  ds_read_b64_tr_b16 v[184:185], v166 offset:32768
  v_mfma_f32_16x16x32_bf16 v[132:135], v[168:171], a[132:135], v[132:135]
  ds_read_b64_tr_b16 v[186:187], v166 offset:33792
  v_mfma_f32_16x16x32_bf16 v[136:139], v[168:171], a[136:139], v[136:139]
  ds_read_b64_tr_b16 v[188:189], v167 offset:32768
  v_mfma_f32_16x16x32_bf16 v[140:143], v[168:171], a[140:143], v[140:143]
  ds_read_b64_tr_b16 v[190:191], v167 offset:33792
  v_mfma_f32_16x16x32_bf16 v[144:147], v[172:175], a[128:131], v[144:147]
  v_mfma_f32_16x16x32_bf16 v[148:151], v[172:175], a[132:135], v[148:151]
  v_mfma_f32_16x16x32_bf16 v[152:155], v[172:175], a[136:139], v[152:155]
  buffer_store_dwordx4 v[96:99], v1, s[52:55], s92 offen offset:0 sc1
  v_mfma_f32_16x16x32_bf16 v[156:159], v[172:175], a[140:143], v[156:159]
  s_waitcnt lgkmcnt(4)
  v_mfma_f32_16x16x32_bf16 v[128:131], v[176:179], a[144:147], v[128:131]
  ds_read_b64_tr_b16 v[192:193], v166 offset:40960
  v_mfma_f32_16x16x32_bf16 v[132:135], v[176:179], a[148:151], v[132:135]
  ds_read_b64_tr_b16 v[194:195], v166 offset:41984
  v_mfma_f32_16x16x32_bf16 v[136:139], v[176:179], a[152:155], v[136:139]
  ds_read_b64_tr_b16 v[196:197], v167 offset:40960
  v_mfma_f32_16x16x32_bf16 v[140:143], v[176:179], a[156:159], v[140:143]
  ds_read_b64_tr_b16 v[198:199], v167 offset:41984
  v_mfma_f32_16x16x32_bf16 v[144:147], v[180:183], a[144:147], v[144:147]
  v_mfma_f32_16x16x32_bf16 v[148:151], v[180:183], a[148:151], v[148:151]
  v_mfma_f32_16x16x32_bf16 v[152:155], v[180:183], a[152:155], v[152:155]
  buffer_store_dwordx4 v[100:103], v1, s[52:55], s92 offen offset:1024 sc1
  v_mfma_f32_16x16x32_bf16 v[156:159], v[180:183], a[156:159], v[156:159]
  s_waitcnt lgkmcnt(4)
  v_mfma_f32_16x16x32_bf16 v[128:131], v[184:187], a[160:163], v[128:131]
  ds_read_b64_tr_b16 v[168:169], v166 offset:49152
  v_mfma_f32_16x16x32_bf16 v[132:135], v[184:187], a[164:167], v[132:135]
  ds_read_b64_tr_b16 v[170:171], v166 offset:50176
  v_mfma_f32_16x16x32_bf16 v[136:139], v[184:187], a[168:171], v[136:139]
  ds_read_b64_tr_b16 v[172:173], v167 offset:49152
  v_mfma_f32_16x16x32_bf16 v[140:143], v[184:187], a[172:175], v[140:143]
  ds_read_b64_tr_b16 v[174:175], v167 offset:50176
  v_mfma_f32_16x16x32_bf16 v[144:147], v[188:191], a[160:163], v[144:147]
  v_mfma_f32_16x16x32_bf16 v[148:151], v[188:191], a[164:167], v[148:151]
  v_mfma_f32_16x16x32_bf16 v[152:155], v[188:191], a[168:171], v[152:155]
  buffer_store_dwordx4 v[104:107], v1, s[52:55], s92 offen offset:2048 sc1
  v_mfma_f32_16x16x32_bf16 v[156:159], v[188:191], a[172:175], v[156:159]
  s_waitcnt lgkmcnt(4)
  v_mfma_f32_16x16x32_bf16 v[128:131], v[192:195], a[176:179], v[128:131]
  ds_read_b64_tr_b16 v[176:177], v166 offset:57344
  v_mfma_f32_16x16x32_bf16 v[132:135], v[192:195], a[180:183], v[132:135]
  ds_read_b64_tr_b16 v[178:179], v166 offset:58368
  v_mfma_f32_16x16x32_bf16 v[136:139], v[192:195], a[184:187], v[136:139]
  ds_read_b64_tr_b16 v[180:181], v167 offset:57344
  v_mfma_f32_16x16x32_bf16 v[140:143], v[192:195], a[188:191], v[140:143]
  ds_read_b64_tr_b16 v[182:183], v167 offset:58368
  v_mfma_f32_16x16x32_bf16 v[144:147], v[196:199], a[176:179], v[144:147]
  v_mfma_f32_16x16x32_bf16 v[148:151], v[196:199], a[180:183], v[148:151]
  v_mfma_f32_16x16x32_bf16 v[152:155], v[196:199], a[184:187], v[152:155]
  buffer_store_dwordx4 v[108:111], v1, s[52:55], s92 offen offset:3072 sc1
  v_mfma_f32_16x16x32_bf16 v[156:159], v[196:199], a[188:191], v[156:159]
  s_waitcnt lgkmcnt(4)
  v_mfma_f32_16x16x32_bf16 v[128:131], v[168:171], a[192:195], v[128:131]
  ds_read_b64_tr_b16 v[184:185], v238 offset:0
  v_mfma_f32_16x16x32_bf16 v[132:135], v[168:171], a[196:199], v[132:135]
  ds_read_b64_tr_b16 v[186:187], v238 offset:1024
  v_mfma_f32_16x16x32_bf16 v[136:139], v[168:171], a[200:203], v[136:139]
  ds_read_b64_tr_b16 v[188:189], v239 offset:0
  v_mfma_f32_16x16x32_bf16 v[140:143], v[168:171], a[204:207], v[140:143]
  ds_read_b64_tr_b16 v[190:191], v239 offset:1024
  v_mfma_f32_16x16x32_bf16 v[144:147], v[172:175], a[192:195], v[144:147]
  v_mfma_f32_16x16x32_bf16 v[148:151], v[172:175], a[196:199], v[148:151]
  v_mfma_f32_16x16x32_bf16 v[152:155], v[172:175], a[200:203], v[152:155]
  buffer_store_dwordx4 v[112:115], v1, s[52:55], s93 offen offset:0 sc1
  v_mfma_f32_16x16x32_bf16 v[156:159], v[172:175], a[204:207], v[156:159]
  s_waitcnt lgkmcnt(4)
  v_mfma_f32_16x16x32_bf16 v[128:131], v[176:179], a[208:211], v[128:131]
  ds_read_b64_tr_b16 v[192:193], v238 offset:8192
  v_mfma_f32_16x16x32_bf16 v[132:135], v[176:179], a[212:215], v[132:135]
  ds_read_b64_tr_b16 v[194:195], v238 offset:9216
  v_mfma_f32_16x16x32_bf16 v[136:139], v[176:179], a[216:219], v[136:139]
  ds_read_b64_tr_b16 v[196:197], v239 offset:8192
  v_mfma_f32_16x16x32_bf16 v[140:143], v[176:179], a[220:223], v[140:143]
  ds_read_b64_tr_b16 v[198:199], v239 offset:9216
  v_mfma_f32_16x16x32_bf16 v[144:147], v[180:183], a[208:211], v[144:147]
  v_mfma_f32_16x16x32_bf16 v[148:151], v[180:183], a[212:215], v[148:151]
  v_mfma_f32_16x16x32_bf16 v[152:155], v[180:183], a[216:219], v[152:155]
  buffer_store_dwordx4 v[116:119], v1, s[52:55], s93 offen offset:1024 sc1
  v_mfma_f32_16x16x32_bf16 v[156:159], v[180:183], a[220:223], v[156:159]
  s_waitcnt lgkmcnt(4)
  v_mfma_f32_16x16x32_bf16 v[128:131], v[184:187], a[224:227], v[128:131]
  ds_read_b64_tr_b16 v[168:169], v160 offset:16384
  v_mfma_f32_16x16x32_bf16 v[132:135], v[184:187], a[228:231], v[132:135]
  ds_read_b64_tr_b16 v[170:171], v160 offset:17408
  v_mfma_f32_16x16x32_bf16 v[136:139], v[184:187], a[232:235], v[136:139]
  ds_read_b64_tr_b16 v[172:173], v161 offset:16384
  v_mfma_f32_16x16x32_bf16 v[140:143], v[184:187], a[236:239], v[140:143]
  ds_read_b64_tr_b16 v[174:175], v161 offset:17408
  v_mfma_f32_16x16x32_bf16 v[144:147], v[188:191], a[224:227], v[144:147]
  v_mfma_f32_16x16x32_bf16 v[148:151], v[188:191], a[228:231], v[148:151]
  v_mfma_f32_16x16x32_bf16 v[152:155], v[188:191], a[232:235], v[152:155]
  buffer_store_dwordx4 v[120:123], v1, s[52:55], s93 offen offset:2048 sc1
  v_mfma_f32_16x16x32_bf16 v[156:159], v[188:191], a[236:239], v[156:159]
  s_waitcnt lgkmcnt(4)
  v_mfma_f32_16x16x32_bf16 v[128:131], v[192:195], a[240:243], v[128:131]
  ds_read_b64_tr_b16 v[176:177], v160 offset:24576
  v_mfma_f32_16x16x32_bf16 v[132:135], v[192:195], a[244:247], v[132:135]
  ds_read_b64_tr_b16 v[178:179], v160 offset:25600
  v_mfma_f32_16x16x32_bf16 v[136:139], v[192:195], a[248:251], v[136:139]
  ds_read_b64_tr_b16 v[180:181], v161 offset:24576
  v_mfma_f32_16x16x32_bf16 v[140:143], v[192:195], a[252:255], v[140:143]
  ds_read_b64_tr_b16 v[182:183], v161 offset:25600
  v_mfma_f32_16x16x32_bf16 v[144:147], v[196:199], a[240:243], v[144:147]
  v_mfma_f32_16x16x32_bf16 v[148:151], v[196:199], a[244:247], v[148:151]
  v_mfma_f32_16x16x32_bf16 v[152:155], v[196:199], a[248:251], v[152:155]
  buffer_store_dwordx4 v[124:127], v1, s[52:55], s93 offen offset:3072 sc1
  v_mfma_f32_16x16x32_bf16 v[156:159], v[196:199], a[252:255], v[156:159]
  s_waitcnt vmcnt(8)
  v_mov_b32 v5, 1
  s_mov_b64 exec, 1
  buffer_store_byte v5, off, s[52:55], s96 sc1
  s_mov_b64 exec, -1
fs_54:
  s_waitcnt lgkmcnt(4)
  v_mfma_f32_16x16x32_bf16 v[32:35], v[168:171], a[128:131], v[32:35]
  ds_read_b64_tr_b16 v[184:185], v160 offset:32768
  v_mfma_f32_16x16x32_bf16 v[36:39], v[168:171], a[132:135], v[36:39]
  ds_read_b64_tr_b16 v[186:187], v160 offset:33792
  v_mfma_f32_16x16x32_bf16 v[40:43], v[168:171], a[136:139], v[40:43]
  ds_read_b64_tr_b16 v[188:189], v161 offset:32768
  v_mfma_f32_16x16x32_bf16 v[44:47], v[168:171], a[140:143], v[44:47]
  ds_read_b64_tr_b16 v[190:191], v161 offset:33792
  v_mfma_f32_16x16x32_bf16 v[48:51], v[172:175], a[128:131], v[48:51]
  v_mfma_f32_16x16x32_bf16 v[52:55], v[172:175], a[132:135], v[52:55]
  v_mfma_f32_16x16x32_bf16 v[56:59], v[172:175], a[136:139], v[56:59]
  buffer_store_dwordx4 v[128:131], v1, s[52:55], s94 offen offset:0 sc1
  v_mfma_f32_16x16x32_bf16 v[60:63], v[172:175], a[140:143], v[60:63]
  s_waitcnt lgkmcnt(4)
  v_mfma_f32_16x16x32_bf16 v[32:35], v[176:179], a[144:147], v[32:35]
  ds_read_b64_tr_b16 v[192:193], v160 offset:40960
  v_mfma_f32_16x16x32_bf16 v[36:39], v[176:179], a[148:151], v[36:39]
  ds_read_b64_tr_b16 v[194:195], v160 offset:41984
  v_mfma_f32_16x16x32_bf16 v[40:43], v[176:179], a[152:155], v[40:43]
  ds_read_b64_tr_b16 v[196:197], v161 offset:40960
  v_mfma_f32_16x16x32_bf16 v[44:47], v[176:179], a[156:159], v[44:47]
  ds_read_b64_tr_b16 v[198:199], v161 offset:41984
  v_mfma_f32_16x16x32_bf16 v[48:51], v[180:183], a[144:147], v[48:51]
  v_mfma_f32_16x16x32_bf16 v[52:55], v[180:183], a[148:151], v[52:55]
  v_mfma_f32_16x16x32_bf16 v[56:59], v[180:183], a[152:155], v[56:59]
  buffer_store_dwordx4 v[132:135], v1, s[52:55], s94 offen offset:1024 sc1
  v_mfma_f32_16x16x32_bf16 v[60:63], v[180:183], a[156:159], v[60:63]
  s_waitcnt lgkmcnt(4)
  v_mfma_f32_16x16x32_bf16 v[32:35], v[184:187], a[160:163], v[32:35]
  ds_read_b64_tr_b16 v[168:169], v160 offset:49152
  v_mfma_f32_16x16x32_bf16 v[36:39], v[184:187], a[164:167], v[36:39]
  ds_read_b64_tr_b16 v[170:171], v160 offset:50176
  v_mfma_f32_16x16x32_bf16 v[40:43], v[184:187], a[168:171], v[40:43]
  ds_read_b64_tr_b16 v[172:173], v161 offset:49152
  v_mfma_f32_16x16x32_bf16 v[44:47], v[184:187], a[172:175], v[44:47]
  ds_read_b64_tr_b16 v[174:175], v161 offset:50176
  v_mfma_f32_16x16x32_bf16 v[48:51], v[188:191], a[160:163], v[48:51]
  v_mfma_f32_16x16x32_bf16 v[52:55], v[188:191], a[164:167], v[52:55]
  v_mfma_f32_16x16x32_bf16 v[56:59], v[188:191], a[168:171], v[56:59]
  buffer_store_dwordx4 v[136:139], v1, s[52:55], s94 offen offset:2048 sc1
  v_mfma_f32_16x16x32_bf16 v[60:63], v[188:191], a[172:175], v[60:63]
  s_waitcnt lgkmcnt(4)
  v_mfma_f32_16x16x32_bf16 v[32:35], v[192:195], a[176:179], v[32:35]
  ds_read_b64_tr_b16 v[176:177], v160 offset:57344
  v_mfma_f32_16x16x32_bf16 v[36:39], v[192:195], a[180:183], v[36:39]
  ds_read_b64_tr_b16 v[178:179], v160 offset:58368
  v_mfma_f32_16x16x32_bf16 v[40:43], v[192:195], a[184:187], v[40:43]
  ds_read_b64_tr_b16 v[180:181], v161 offset:57344
  v_mfma_f32_16x16x32_bf16 v[44:47], v[192:195], a[188:191], v[44:47]
  ds_read_b64_tr_b16 v[182:183], v161 offset:58368
  v_mfma_f32_16x16x32_bf16 v[48:51], v[196:199], a[176:179], v[48:51]
  v_mfma_f32_16x16x32_bf16 v[52:55], v[196:199], a[180:183], v[52:55]
  v_mfma_f32_16x16x32_bf16 v[56:59], v[196:199], a[184:187], v[56:59]
  buffer_store_dwordx4 v[140:143], v1, s[52:55], s94 offen offset:3072 sc1
  v_mfma_f32_16x16x32_bf16 v[60:63], v[196:199], a[188:191], v[60:63]
  s_waitcnt lgkmcnt(4)
  v_mfma_f32_16x16x32_bf16 v[32:35], v[168:171], a[192:195], v[32:35]
  ds_read_b64_tr_b16 v[184:185], v232 offset:0
  v_mfma_f32_16x16x32_bf16 v[36:39], v[168:171], a[196:199], v[36:39]
  ds_read_b64_tr_b16 v[186:187], v232 offset:1024
  v_mfma_f32_16x16x32_bf16 v[40:43], v[168:171], a[200:203], v[40:43]
  ds_read_b64_tr_b16 v[188:189], v233 offset:0
  v_mfma_f32_16x16x32_bf16 v[44:47], v[168:171], a[204:207], v[44:47]
  ds_read_b64_tr_b16 v[190:191], v233 offset:1024
  v_mfma_f32_16x16x32_bf16 v[48:51], v[172:175], a[192:195], v[48:51]
  v_mfma_f32_16x16x32_bf16 v[52:55], v[172:175], a[196:199], v[52:55]
  v_mfma_f32_16x16x32_bf16 v[56:59], v[172:175], a[200:203], v[56:59]
  buffer_store_dwordx4 v[144:147], v1, s[52:55], s95 offen offset:0 sc1
  v_mfma_f32_16x16x32_bf16 v[60:63], v[172:175], a[204:207], v[60:63]
  s_waitcnt lgkmcnt(4)
  v_mfma_f32_16x16x32_bf16 v[32:35], v[176:179], a[208:211], v[32:35]
  ds_read_b64_tr_b16 v[192:193], v232 offset:8192
  v_mfma_f32_16x16x32_bf16 v[36:39], v[176:179], a[212:215], v[36:39]
  ds_read_b64_tr_b16 v[194:195], v232 offset:9216
  v_mfma_f32_16x16x32_bf16 v[40:43], v[176:179], a[216:219], v[40:43]
  ds_read_b64_tr_b16 v[196:197], v233 offset:8192
  v_mfma_f32_16x16x32_bf16 v[44:47], v[176:179], a[220:223], v[44:47]
  ds_read_b64_tr_b16 v[198:199], v233 offset:9216
  v_mfma_f32_16x16x32_bf16 v[48:51], v[180:183], a[208:211], v[48:51]
  v_mfma_f32_16x16x32_bf16 v[52:55], v[180:183], a[212:215], v[52:55]
  v_mfma_f32_16x16x32_bf16 v[56:59], v[180:183], a[216:219], v[56:59]
  buffer_store_dwordx4 v[148:151], v1, s[52:55], s95 offen offset:1024 sc1
  v_mfma_f32_16x16x32_bf16 v[60:63], v[180:183], a[220:223], v[60:63]
  s_waitcnt lgkmcnt(4)
  v_mfma_f32_16x16x32_bf16 v[32:35], v[184:187], a[224:227], v[32:35]
  v_mfma_f32_16x16x32_bf16 v[36:39], v[184:187], a[228:231], v[36:39]
  v_mfma_f32_16x16x32_bf16 v[40:43], v[184:187], a[232:235], v[40:43]
  v_mfma_f32_16x16x32_bf16 v[44:47], v[184:187], a[236:239], v[44:47]
  v_mfma_f32_16x16x32_bf16 v[48:51], v[188:191], a[224:227], v[48:51]
  v_mfma_f32_16x16x32_bf16 v[52:55], v[188:191], a[228:231], v[52:55]
  v_mfma_f32_16x16x32_bf16 v[56:59], v[188:191], a[232:235], v[56:59]
  buffer_store_dwordx4 v[152:155], v1, s[52:55], s95 offen offset:2048 sc1
  v_mfma_f32_16x16x32_bf16 v[60:63], v[188:191], a[236:239], v[60:63]
  s_waitcnt lgkmcnt(0)
  v_mfma_f32_16x16x32_bf16 v[32:35], v[192:195], a[240:243], v[32:35]
  v_mfma_f32_16x16x32_bf16 v[36:39], v[192:195], a[244:247], v[36:39]
  v_mfma_f32_16x16x32_bf16 v[40:43], v[192:195], a[248:251], v[40:43]
  v_mfma_f32_16x16x32_bf16 v[44:47], v[192:195], a[252:255], v[44:47]
  v_mfma_f32_16x16x32_bf16 v[48:51], v[196:199], a[240:243], v[48:51]
  v_mfma_f32_16x16x32_bf16 v[52:55], v[196:199], a[244:247], v[52:55]
  v_mfma_f32_16x16x32_bf16 v[56:59], v[196:199], a[248:251], v[56:59]
  buffer_store_dwordx4 v[156:159], v1, s[52:55], s95 offen offset:3072 sc1
  v_mfma_f32_16x16x32_bf16 v[60:63], v[196:199], a[252:255], v[60:63]
  s_waitcnt vmcnt(9)
  v_mov_b32 v5, 1
  s_mov_b64 exec, 1
  buffer_store_byte v5, off, s[52:55], s97 sc1
  s_mov_b64 exec, -1
fs_55:
  v_and_b32 v2, 15, v0
  v_lshlrev_b32 v2, 11, v2
  v_bfe_u32 v3, v0, 4, 1
  v_lshl_add_u32 v2, v3, 5, v2
  v_lshrrev_b32 v3, 5, v0
  v_lshl_add_u32 v2, v3, 4, v2
  s_waitcnt vmcnt(1)
  v_mov_b32 v5, 1
  s_mov_b64 exec, 1
  buffer_store_byte v5, off, s[52:55], s98 sc1
  s_mov_b64 exec, -1
fs_56:
  buffer_load_dword v6, v29, s[52:55], s77 offen sc1
  s_waitcnt vmcnt(0)
  s_mov_b32 s7, 0x1010100
  s_mov_b32 s75, 0x40000
  v_cmp_ne_u32 vcc, s7, v6
  s_nop 1
  s_bitcmp0_b32 vcc_lo, 0
  s_cbranch_scc1 pok_57
pspin_58:
  s_sleep 2
  buffer_load_dword v6, v29, s[52:55], s77 offen sc1
  s_sub_u32 s75, s75, 1
  s_cmp_eq_u32 s75, 0
  s_cbranch_scc1 pok_57
  s_waitcnt vmcnt(0)
  v_cmp_ne_u32 vcc, s7, v6
  s_nop 1
  s_bitcmp0_b32 vcc_lo, 0
  s_cbranch_scc0 pspin_58
pok_57:
  s_xor_b32 s75, s70, 1
  s_lshl_b32 s75, s75, 17
  s_lshl_b32 s79, s70, 15
  s_add_u32 s75, s75, s79
  s_add_u32 s75, s75, s76
  s_add_u32 s79, s75, 4096
  buffer_load_dwordx4 v[64:67], v1, s[52:55], s75 offen offset:0 sc1
  buffer_load_dwordx4 v[68:71], v1, s[52:55], s75 offen offset:1024 sc1
  buffer_load_dwordx4 v[72:75], v1, s[52:55], s75 offen offset:2048 sc1
  buffer_load_dwordx4 v[76:79], v1, s[52:55], s75 offen offset:3072 sc1
  buffer_load_dwordx4 v[80:83], v1, s[52:55], s79 offen offset:0 sc1
  buffer_load_dwordx4 v[84:87], v1, s[52:55], s79 offen offset:1024 sc1
  buffer_load_dwordx4 v[88:91], v1, s[52:55], s79 offen offset:2048 sc1
  buffer_load_dwordx4 v[92:95], v1, s[52:55], s79 offen offset:3072 sc1
  s_xor_b32 s75, s70, 2
  s_lshl_b32 s75, s75, 17
  s_lshl_b32 s79, s70, 15
  s_add_u32 s75, s75, s79
  s_add_u32 s75, s75, s76
  s_add_u32 s79, s75, 4096
  buffer_load_dwordx4 v[96:99], v1, s[52:55], s75 offen offset:0 sc1
  buffer_load_dwordx4 v[100:103], v1, s[52:55], s75 offen offset:1024 sc1
  buffer_load_dwordx4 v[104:107], v1, s[52:55], s75 offen offset:2048 sc1
  buffer_load_dwordx4 v[108:111], v1, s[52:55], s75 offen offset:3072 sc1
  buffer_load_dwordx4 v[112:115], v1, s[52:55], s79 offen offset:0 sc1
  buffer_load_dwordx4 v[116:119], v1, s[52:55], s79 offen offset:1024 sc1
  buffer_load_dwordx4 v[120:123], v1, s[52:55], s79 offen offset:2048 sc1
  buffer_load_dwordx4 v[124:127], v1, s[52:55], s79 offen offset:3072 sc1
  s_xor_b32 s75, s70, 3
  s_lshl_b32 s75, s75, 17
  s_lshl_b32 s79, s70, 15
  s_add_u32 s75, s75, s79
  s_add_u32 s75, s75, s76
  s_add_u32 s79, s75, 4096
  buffer_load_dwordx4 v[128:131], v1, s[52:55], s75 offen offset:0 sc1
  buffer_load_dwordx4 v[132:135], v1, s[52:55], s75 offen offset:1024 sc1
  buffer_load_dwordx4 v[136:139], v1, s[52:55], s75 offen offset:2048 sc1
  buffer_load_dwordx4 v[140:143], v1, s[52:55], s75 offen offset:3072 sc1
  buffer_load_dwordx4 v[144:147], v1, s[52:55], s79 offen offset:0 sc1
  buffer_load_dwordx4 v[148:151], v1, s[52:55], s79 offen offset:1024 sc1
  buffer_load_dwordx4 v[152:155], v1, s[52:55], s79 offen offset:2048 sc1
  buffer_load_dwordx4 v[156:159], v1, s[52:55], s79 offen offset:3072 sc1
  s_lshl_b32 s75, s68, 2
  s_add_u32 s75, s75, s67
  s_lshl_b32 s75, s75, 17
  s_lshl_b32 s77, s69, 8
  s_add_u32 s75, s75, s77
  s_lshl_b32 s77, s70, 6
  s_add_u32 s75, s75, s77
  s_waitcnt vmcnt(16)
  v_pk_add_f32 v[32:33], v[32:33], v[64:65]
  v_pk_add_f32 v[34:35], v[34:35], v[66:67]
  v_pk_add_f32 v[36:37], v[36:37], v[68:69]
  v_pk_add_f32 v[38:39], v[38:39], v[70:71]
  v_pk_add_f32 v[40:41], v[40:41], v[72:73]
  v_pk_add_f32 v[42:43], v[42:43], v[74:75]
  v_pk_add_f32 v[44:45], v[44:45], v[76:77]
  v_pk_add_f32 v[46:47], v[46:47], v[78:79]
  v_pk_add_f32 v[48:49], v[48:49], v[80:81]
  v_pk_add_f32 v[50:51], v[50:51], v[82:83]
  v_pk_add_f32 v[52:53], v[52:53], v[84:85]
  v_pk_add_f32 v[54:55], v[54:55], v[86:87]
  v_pk_add_f32 v[56:57], v[56:57], v[88:89]
  v_pk_add_f32 v[58:59], v[58:59], v[90:91]
  v_pk_add_f32 v[60:61], v[60:61], v[92:93]
  v_pk_add_f32 v[62:63], v[62:63], v[94:95]
  s_waitcnt vmcnt(8)
  v_pk_add_f32 v[32:33], v[32:33], v[96:97]
  v_pk_add_f32 v[34:35], v[34:35], v[98:99]
  v_pk_add_f32 v[36:37], v[36:37], v[100:101]
  v_pk_add_f32 v[38:39], v[38:39], v[102:103]
  v_pk_add_f32 v[40:41], v[40:41], v[104:105]
  v_pk_add_f32 v[42:43], v[42:43], v[106:107]
  v_pk_add_f32 v[44:45], v[44:45], v[108:109]
  v_pk_add_f32 v[46:47], v[46:47], v[110:111]
  v_pk_add_f32 v[48:49], v[48:49], v[112:113]
  v_pk_add_f32 v[50:51], v[50:51], v[114:115]
  v_pk_add_f32 v[52:53], v[52:53], v[116:117]
  v_pk_add_f32 v[54:55], v[54:55], v[118:119]
  v_pk_add_f32 v[56:57], v[56:57], v[120:121]
  v_pk_add_f32 v[58:59], v[58:59], v[122:123]
  v_pk_add_f32 v[60:61], v[60:61], v[124:125]
  v_pk_add_f32 v[62:63], v[62:63], v[126:127]
  s_waitcnt vmcnt(0)
  v_pk_add_f32 v[32:33], v[32:33], v[128:129]
  v_pk_add_f32 v[34:35], v[34:35], v[130:131]
  v_pk_add_f32 v[36:37], v[36:37], v[132:133]
  v_pk_add_f32 v[38:39], v[38:39], v[134:135]
  v_pk_add_f32 v[40:41], v[40:41], v[136:137]
  v_pk_add_f32 v[42:43], v[42:43], v[138:139]
  v_pk_add_f32 v[44:45], v[44:45], v[140:141]
  v_pk_add_f32 v[46:47], v[46:47], v[142:143]
  v_pk_add_f32 v[48:49], v[48:49], v[144:145]
  v_pk_add_f32 v[50:51], v[50:51], v[146:147]
  v_pk_add_f32 v[52:53], v[52:53], v[148:149]
  v_pk_add_f32 v[54:55], v[54:55], v[150:151]
  v_pk_add_f32 v[56:57], v[56:57], v[152:153]
  v_pk_add_f32 v[58:59], v[58:59], v[154:155]
  v_pk_add_f32 v[60:61], v[60:61], v[156:157]
  v_pk_add_f32 v[62:63], v[62:63], v[158:159]
  v_cvt_pk_bf16_f32 v64, v32, v33
  v_cvt_pk_bf16_f32 v65, v34, v35
  v_cvt_pk_bf16_f32 v66, v48, v49
  v_cvt_pk_bf16_f32 v67, v50, v51
  v_cvt_pk_bf16_f32 v68, v36, v37
  v_cvt_pk_bf16_f32 v69, v38, v39
  v_cvt_pk_bf16_f32 v70, v52, v53
  v_cvt_pk_bf16_f32 v71, v54, v55
  v_cvt_pk_bf16_f32 v72, v40, v41
  v_cvt_pk_bf16_f32 v73, v42, v43
  v_cvt_pk_bf16_f32 v74, v56, v57
  v_cvt_pk_bf16_f32 v75, v58, v59
  v_cvt_pk_bf16_f32 v76, v44, v45
  v_cvt_pk_bf16_f32 v77, v46, v47
  v_cvt_pk_bf16_f32 v78, v60, v61
  v_cvt_pk_bf16_f32 v79, v62, v63
  s_nop 0
  v_permlane16_swap_b32 v64, v66
  v_permlane16_swap_b32 v65, v67
  buffer_store_dwordx4 v[64:67], v2, s[44:47], s75 offen
  s_add_u32 s75, s75, 32768
  v_permlane16_swap_b32 v68, v70
  v_permlane16_swap_b32 v69, v71
  buffer_store_dwordx4 v[68:71], v2, s[44:47], s75 offen
  s_add_u32 s75, s75, 32768
  v_permlane16_swap_b32 v72, v74
  v_permlane16_swap_b32 v73, v75
  buffer_store_dwordx4 v[72:75], v2, s[44:47], s75 offen
  s_add_u32 s75, s75, 32768
  v_permlane16_swap_b32 v76, v78
  v_permlane16_swap_b32 v77, v79
  buffer_store_dwordx4 v[76:79], v2, s[44:47], s75 offen
  s_add_u32 s75, s75, 32768
mk_fin:
mk_end:
  s_endpgm
asp_19:
  s_cbranch_vccz hmask_59
asl_20:
  v_max3_f32 v10, v48, v49, v50
  v_max3_f32 v10, v10, v51, v52
  v_max3_f32 v10, v10, v53, v54
  v_max3_f32 v10, v10, v55, v56
  v_max3_f32 v10, v10, v57, v58
  v_max3_f32 v10, v10, v59, v60
  v_max3_f32 v10, v10, v61, v62
  v_max_f32 v10, v10, v63
  v_mov_b32 v11, v10
  s_nop 1
  v_permlane32_swap_b32 v10, v11
  s_nop 1
  v_max_f32 v10, v10, v11
  v_max_f32 v10, 0, v10
  v_exp_f32 v11, -v10
  v_sub_f32 v5, v5, v10
  v_mul_f32 v7, v7, v11
  v_mul_f32 v96, v96, v11
  v_mul_f32 v97, v97, v11
  v_mul_f32 v98, v98, v11
  v_mul_f32 v99, v99, v11
  v_mul_f32 v100, v100, v11
  v_mul_f32 v101, v101, v11
  v_mul_f32 v102, v102, v11
  v_mul_f32 v103, v103, v11
  v_mul_f32 v104, v104, v11
  v_mul_f32 v105, v105, v11
  v_mul_f32 v106, v106, v11
  v_mul_f32 v107, v107, v11
  v_mul_f32 v108, v108, v11
  v_mul_f32 v109, v109, v11
  v_mul_f32 v110, v110, v11
  v_mul_f32 v111, v111, v11
  v_mul_f32 v112, v112, v11
  v_mul_f32 v113, v113, v11
  v_mul_f32 v114, v114, v11
  v_mul_f32 v115, v115, v11
  v_mul_f32 v116, v116, v11
  v_mul_f32 v117, v117, v11
  v_mul_f32 v118, v118, v11
  v_mul_f32 v119, v119, v11
  v_mul_f32 v120, v120, v11
  v_mul_f32 v121, v121, v11
  v_mul_f32 v122, v122, v11
  v_mul_f32 v123, v123, v11
  v_mul_f32 v124, v124, v11
  v_mul_f32 v125, v125, v11
  v_mul_f32 v126, v126, v11
  v_mul_f32 v127, v127, v11
  v_mul_f32 v128, v128, v11
  v_mul_f32 v129, v129, v11
  v_mul_f32 v130, v130, v11
  v_mul_f32 v131, v131, v11
  v_mul_f32 v132, v132, v11
  v_mul_f32 v133, v133, v11
  v_mul_f32 v134, v134, v11
  v_mul_f32 v135, v135, v11
  v_mul_f32 v136, v136, v11
  v_mul_f32 v137, v137, v11
  v_mul_f32 v138, v138, v11
  v_mul_f32 v139, v139, v11
  v_mul_f32 v140, v140, v11
  v_mul_f32 v141, v141, v11
  v_mul_f32 v142, v142, v11
  v_mul_f32 v143, v143, v11
  v_mul_f32 v144, v144, v11
  v_mul_f32 v145, v145, v11
  v_mul_f32 v146, v146, v11
  v_mul_f32 v147, v147, v11
  v_mul_f32 v148, v148, v11
  v_mul_f32 v149, v149, v11
  v_mul_f32 v150, v150, v11
  v_mul_f32 v151, v151, v11
  v_mul_f32 v152, v152, v11
  v_mul_f32 v153, v153, v11
  v_mul_f32 v154, v154, v11
  v_mul_f32 v155, v155, v11
  v_mul_f32 v156, v156, v11
  v_mul_f32 v157, v157, v11
  v_mul_f32 v158, v158, v11
  v_mul_f32 v159, v159, v11
  v_sub_f32 v64, v64, v10
  v_sub_f32 v65, v65, v10
  v_sub_f32 v66, v66, v10
  v_sub_f32 v67, v67, v10
  v_sub_f32 v68, v68, v10
  v_sub_f32 v69, v69, v10
  v_sub_f32 v70, v70, v10
  v_sub_f32 v71, v71, v10
  v_sub_f32 v72, v72, v10
  v_sub_f32 v73, v73, v10
  v_sub_f32 v74, v74, v10
  v_sub_f32 v75, v75, v10
  v_sub_f32 v76, v76, v10
  v_sub_f32 v77, v77, v10
  v_sub_f32 v78, v78, v10
  v_sub_f32 v79, v79, v10
  v_sub_f32 v48, v48, v10
  v_sub_f32 v49, v49, v10
  v_sub_f32 v50, v50, v10
  v_sub_f32 v51, v51, v10
  v_sub_f32 v52, v52, v10
  v_sub_f32 v53, v53, v10
  v_sub_f32 v54, v54, v10
  v_sub_f32 v55, v55, v10
  v_sub_f32 v56, v56, v10
  v_sub_f32 v57, v57, v10
  v_sub_f32 v58, v58, v10
  v_sub_f32 v59, v59, v10
  v_sub_f32 v60, v60, v10
  v_sub_f32 v61, v61, v10
  v_sub_f32 v62, v62, v10
  v_sub_f32 v63, v63, v10
  v_exp_f32 v48, v48
  v_exp_f32 v49, v49
  v_exp_f32 v50, v50
  v_exp_f32 v51, v51
  v_exp_f32 v52, v52
  v_exp_f32 v53, v53
  v_exp_f32 v54, v54
  v_exp_f32 v55, v55
  v_exp_f32 v56, v56
  v_exp_f32 v57, v57
  v_exp_f32 v58, v58
  v_exp_f32 v59, v59
  v_exp_f32 v60, v60
  v_exp_f32 v61, v61
  v_exp_f32 v62, v62
  v_exp_f32 v63, v63
  v_add_f32 v26, v48, v49
  v_add_f32 v26, v26, v50
  v_add_f32 v26, v26, v51
  v_add_f32 v26, v26, v52
  v_add_f32 v26, v26, v53
  v_add_f32 v26, v26, v54
  v_add_f32 v26, v26, v55
  v_add_f32 v26, v26, v56
  v_add_f32 v26, v26, v57
  v_add_f32 v26, v26, v58
  v_add_f32 v26, v26, v59
  v_add_f32 v26, v26, v60
  v_add_f32 v26, v26, v61
  v_add_f32 v26, v26, v62
  v_add_f32 v26, v26, v63
  v_cvt_pk_bf16_f32 v80, v48, v49
  v_cvt_pk_bf16_f32 v81, v50, v51
  v_cvt_pk_bf16_f32 v82, v52, v53
  v_cvt_pk_bf16_f32 v83, v54, v55
  v_cvt_pk_bf16_f32 v84, v56, v57
  v_cvt_pk_bf16_f32 v85, v58, v59
  v_cvt_pk_bf16_f32 v86, v60, v61
  v_cvt_pk_bf16_f32 v87, v62, v63
  v_max3_f32 v10, v176, v177, v178
  v_max3_f32 v10, v10, v179, v180
  v_max3_f32 v10, v10, v181, v182
  v_max3_f32 v10, v10, v183, v184
  v_max3_f32 v10, v10, v185, v186
  v_max3_f32 v10, v10, v187, v188
  v_max3_f32 v10, v10, v189, v190
  v_max_f32 v10, v10, v191
  v_mov_b32 v11, v10
  s_nop 1
  v_permlane32_swap_b32 v10, v11
  s_nop 1
  v_max_f32 v10, v10, v11
  v_max_f32 v10, 0, v10
  v_exp_f32 v11, -v10
  v_sub_f32 v6, v6, v10
  v_mul_f32 v24, v24, v11
  v_accvgpr_read_b32 v12, a128
  v_mul_f32 v12, v12, v11
  v_accvgpr_write_b32 a128, v12
  v_accvgpr_read_b32 v12, a129
  v_mul_f32 v12, v12, v11
  v_accvgpr_write_b32 a129, v12
  v_accvgpr_read_b32 v12, a130
  v_mul_f32 v12, v12, v11
  v_accvgpr_write_b32 a130, v12
  v_accvgpr_read_b32 v12, a131
  v_mul_f32 v12, v12, v11
  v_accvgpr_write_b32 a131, v12
  v_accvgpr_read_b32 v12, a132
  v_mul_f32 v12, v12, v11
  v_accvgpr_write_b32 a132, v12
  v_accvgpr_read_b32 v12, a133
  v_mul_f32 v12, v12, v11
  v_accvgpr_write_b32 a133, v12
  v_accvgpr_read_b32 v12, a134
  v_mul_f32 v12, v12, v11
  v_accvgpr_write_b32 a134, v12
  v_accvgpr_read_b32 v12, a135
  v_mul_f32 v12, v12, v11
  v_accvgpr_write_b32 a135, v12
  v_accvgpr_read_b32 v12, a136
  v_mul_f32 v12, v12, v11
  v_accvgpr_write_b32 a136, v12
  v_accvgpr_read_b32 v12, a137
  v_mul_f32 v12, v12, v11
  v_accvgpr_write_b32 a137, v12
  v_accvgpr_read_b32 v12, a138
  v_mul_f32 v12, v12, v11
  v_accvgpr_write_b32 a138, v12
  v_accvgpr_read_b32 v12, a139
  v_mul_f32 v12, v12, v11
  v_accvgpr_write_b32 a139, v12
  v_accvgpr_read_b32 v12, a140
  v_mul_f32 v12, v12, v11
  v_accvgpr_write_b32 a140, v12
  v_accvgpr_read_b32 v12, a141
  v_mul_f32 v12, v12, v11
  v_accvgpr_write_b32 a141, v12
  v_accvgpr_read_b32 v12, a142
  v_mul_f32 v12, v12, v11
  v_accvgpr_write_b32 a142, v12
  v_accvgpr_read_b32 v12, a143
  v_mul_f32 v12, v12, v11
  v_accvgpr_write_b32 a143, v12
  v_accvgpr_read_b32 v12, a144
  v_mul_f32 v12, v12, v11
  v_accvgpr_write_b32 a144, v12
  v_accvgpr_read_b32 v12, a145
  v_mul_f32 v12, v12, v11
  v_accvgpr_write_b32 a145, v12
  v_accvgpr_read_b32 v12, a146
  v_mul_f32 v12, v12, v11
  v_accvgpr_write_b32 a146, v12
  v_accvgpr_read_b32 v12, a147
  v_mul_f32 v12, v12, v11
  v_accvgpr_write_b32 a147, v12
  v_accvgpr_read_b32 v12, a148
  v_mul_f32 v12, v12, v11
  v_accvgpr_write_b32 a148, v12
  v_accvgpr_read_b32 v12, a149
  v_mul_f32 v12, v12, v11
  v_accvgpr_write_b32 a149, v12
  v_accvgpr_read_b32 v12, a150
  v_mul_f32 v12, v12, v11
  v_accvgpr_write_b32 a150, v12
  v_accvgpr_read_b32 v12, a151
  v_mul_f32 v12, v12, v11
  v_accvgpr_write_b32 a151, v12
  v_accvgpr_read_b32 v12, a152
  v_mul_f32 v12, v12, v11
  v_accvgpr_write_b32 a152, v12
  v_accvgpr_read_b32 v12, a153
  v_mul_f32 v12, v12, v11
  v_accvgpr_write_b32 a153, v12
  v_accvgpr_read_b32 v12, a154
  v_mul_f32 v12, v12, v11
  v_accvgpr_write_b32 a154, v12
  v_accvgpr_read_b32 v12, a155
  v_mul_f32 v12, v12, v11
  v_accvgpr_write_b32 a155, v12
  v_accvgpr_read_b32 v12, a156
  v_mul_f32 v12, v12, v11
  v_accvgpr_write_b32 a156, v12
  v_accvgpr_read_b32 v12, a157
  v_mul_f32 v12, v12, v11
  v_accvgpr_write_b32 a157, v12
  v_accvgpr_read_b32 v12, a158
  v_mul_f32 v12, v12, v11
  v_accvgpr_write_b32 a158, v12
  v_accvgpr_read_b32 v12, a159
  v_mul_f32 v12, v12, v11
  v_accvgpr_write_b32 a159, v12
  v_accvgpr_read_b32 v12, a160
  v_mul_f32 v12, v12, v11
  v_accvgpr_write_b32 a160, v12
  v_accvgpr_read_b32 v12, a161
  v_mul_f32 v12, v12, v11
  v_accvgpr_write_b32 a161, v12
  v_accvgpr_read_b32 v12, a162
  v_mul_f32 v12, v12, v11
  v_accvgpr_write_b32 a162, v12
  v_accvgpr_read_b32 v12, a163
  v_mul_f32 v12, v12, v11
  v_accvgpr_write_b32 a163, v12
  v_accvgpr_read_b32 v12, a164
  v_mul_f32 v12, v12, v11
  v_accvgpr_write_b32 a164, v12
  v_accvgpr_read_b32 v12, a165
  v_mul_f32 v12, v12, v11
  v_accvgpr_write_b32 a165, v12
  v_accvgpr_read_b32 v12, a166
  v_mul_f32 v12, v12, v11
  v_accvgpr_write_b32 a166, v12
  v_accvgpr_read_b32 v12, a167
  v_mul_f32 v12, v12, v11
  v_accvgpr_write_b32 a167, v12
  v_accvgpr_read_b32 v12, a168
  v_mul_f32 v12, v12, v11
  v_accvgpr_write_b32 a168, v12
  v_accvgpr_read_b32 v12, a169
  v_mul_f32 v12, v12, v11
  v_accvgpr_write_b32 a169, v12
  v_accvgpr_read_b32 v12, a170
  v_mul_f32 v12, v12, v11
  v_accvgpr_write_b32 a170, v12
  v_accvgpr_read_b32 v12, a171
  v_mul_f32 v12, v12, v11
  v_accvgpr_write_b32 a171, v12
  v_accvgpr_read_b32 v12, a172
  v_mul_f32 v12, v12, v11
  v_accvgpr_write_b32 a172, v12
  v_accvgpr_read_b32 v12, a173
  v_mul_f32 v12, v12, v11
  v_accvgpr_write_b32 a173, v12
  v_accvgpr_read_b32 v12, a174
  v_mul_f32 v12, v12, v11
  v_accvgpr_write_b32 a174, v12
  v_accvgpr_read_b32 v12, a175
  v_mul_f32 v12, v12, v11
  v_accvgpr_write_b32 a175, v12
  v_accvgpr_read_b32 v12, a176
  v_mul_f32 v12, v12, v11
  v_accvgpr_write_b32 a176, v12
  v_accvgpr_read_b32 v12, a177
  v_mul_f32 v12, v12, v11
  v_accvgpr_write_b32 a177, v12
  v_accvgpr_read_b32 v12, a178
  v_mul_f32 v12, v12, v11
  v_accvgpr_write_b32 a178, v12
  v_accvgpr_read_b32 v12, a179
  v_mul_f32 v12, v12, v11
  v_accvgpr_write_b32 a179, v12
  v_accvgpr_read_b32 v12, a180
  v_mul_f32 v12, v12, v11
  v_accvgpr_write_b32 a180, v12
  v_accvgpr_read_b32 v12, a181
  v_mul_f32 v12, v12, v11
  v_accvgpr_write_b32 a181, v12
  v_accvgpr_read_b32 v12, a182
  v_mul_f32 v12, v12, v11
  v_accvgpr_write_b32 a182, v12
  v_accvgpr_read_b32 v12, a183
  v_mul_f32 v12, v12, v11
  v_accvgpr_write_b32 a183, v12
  v_accvgpr_read_b32 v12, a184
  v_mul_f32 v12, v12, v11
  v_accvgpr_write_b32 a184, v12
  v_accvgpr_read_b32 v12, a185
  v_mul_f32 v12, v12, v11
  v_accvgpr_write_b32 a185, v12
  v_accvgpr_read_b32 v12, a186
  v_mul_f32 v12, v12, v11
  v_accvgpr_write_b32 a186, v12
  v_accvgpr_read_b32 v12, a187
  v_mul_f32 v12, v12, v11
  v_accvgpr_write_b32 a187, v12
  v_accvgpr_read_b32 v12, a188
  v_mul_f32 v12, v12, v11
  v_accvgpr_write_b32 a188, v12
  v_accvgpr_read_b32 v12, a189
  v_mul_f32 v12, v12, v11
  v_accvgpr_write_b32 a189, v12
  v_accvgpr_read_b32 v12, a190
  v_mul_f32 v12, v12, v11
  v_accvgpr_write_b32 a190, v12
  v_accvgpr_read_b32 v12, a191
  v_mul_f32 v12, v12, v11
  v_accvgpr_write_b32 a191, v12
  v_sub_f32 v192, v192, v10
  v_sub_f32 v193, v193, v10
  v_sub_f32 v194, v194, v10
  v_sub_f32 v195, v195, v10
  v_sub_f32 v196, v196, v10
  v_sub_f32 v197, v197, v10
  v_sub_f32 v198, v198, v10
  v_sub_f32 v199, v199, v10
  v_sub_f32 v200, v200, v10
  v_sub_f32 v201, v201, v10
  v_sub_f32 v202, v202, v10
  v_sub_f32 v203, v203, v10
  v_sub_f32 v204, v204, v10
  v_sub_f32 v205, v205, v10
  v_sub_f32 v206, v206, v10
  v_sub_f32 v207, v207, v10
  v_sub_f32 v176, v176, v10
  v_sub_f32 v177, v177, v10
  v_sub_f32 v178, v178, v10
  v_sub_f32 v179, v179, v10
  v_sub_f32 v180, v180, v10
  v_sub_f32 v181, v181, v10
  v_sub_f32 v182, v182, v10
  v_sub_f32 v183, v183, v10
  v_sub_f32 v184, v184, v10
  v_sub_f32 v185, v185, v10
  v_sub_f32 v186, v186, v10
  v_sub_f32 v187, v187, v10
  v_sub_f32 v188, v188, v10
  v_sub_f32 v189, v189, v10
  v_sub_f32 v190, v190, v10
  v_sub_f32 v191, v191, v10
  v_exp_f32 v176, v176
  v_exp_f32 v177, v177
  v_exp_f32 v178, v178
  v_exp_f32 v179, v179
  v_exp_f32 v180, v180
  v_exp_f32 v181, v181
  v_exp_f32 v182, v182
  v_exp_f32 v183, v183
  v_exp_f32 v184, v184
  v_exp_f32 v185, v185
  v_exp_f32 v186, v186
  v_exp_f32 v187, v187
  v_exp_f32 v188, v188
  v_exp_f32 v189, v189
  v_exp_f32 v190, v190
  v_exp_f32 v191, v191
  v_add_f32 v27, v176, v177
  v_add_f32 v27, v27, v178
  v_add_f32 v27, v27, v179
  v_add_f32 v27, v27, v180
  v_add_f32 v27, v27, v181
  v_add_f32 v27, v27, v182
  v_add_f32 v27, v27, v183
  v_add_f32 v27, v27, v184
  v_add_f32 v27, v27, v185
  v_add_f32 v27, v27, v186
  v_add_f32 v27, v27, v187
  v_add_f32 v27, v27, v188
  v_add_f32 v27, v27, v189
  v_add_f32 v27, v27, v190
  v_add_f32 v27, v27, v191
  v_cvt_pk_bf16_f32 v208, v176, v177
  v_cvt_pk_bf16_f32 v209, v178, v179
  v_cvt_pk_bf16_f32 v210, v180, v181
  v_cvt_pk_bf16_f32 v211, v182, v183
  v_cvt_pk_bf16_f32 v212, v184, v185
  v_cvt_pk_bf16_f32 v213, v186, v187
  v_cvt_pk_bf16_f32 v214, v188, v189
  v_cvt_pk_bf16_f32 v215, v190, v191
hmask_59:
  s_add_u32 s29, s18, 2
  s_lshl_b32 s30, s29, 5
  s_sub_i32 s30, s39, s30
  v_add_u32 v12, s30, v4
  v_mov_b32 v13, s32
  v_cmp_gt_i32 s[56:57], 0, v12
  v_cmp_gt_i32 s[58:59], 1, v12
  v_cmp_gt_i32 s[60:61], 2, v12
  v_cmp_gt_i32 s[62:63], 3, v12
  v_cndmask_b32 v32, v5, v13, s[56:57]
  v_cndmask_b32 v33, v5, v13, s[58:59]
  v_cndmask_b32 v34, v5, v13, s[60:61]
  v_cndmask_b32 v35, v5, v13, s[62:63]
  v_cmp_gt_i32 s[56:57], 8, v12
  v_cmp_gt_i32 s[58:59], 9, v12
  v_cmp_gt_i32 s[60:61], 10, v12
  v_cmp_gt_i32 s[62:63], 11, v12
  v_cndmask_b32 v36, v5, v13, s[56:57]
  v_cndmask_b32 v37, v5, v13, s[58:59]
  v_cndmask_b32 v38, v5, v13, s[60:61]
  v_cndmask_b32 v39, v5, v13, s[62:63]
  v_cmp_gt_i32 s[56:57], 16, v12
  v_cmp_gt_i32 s[58:59], 17, v12
  v_cmp_gt_i32 s[60:61], 18, v12
  v_cmp_gt_i32 s[62:63], 19, v12
  v_cndmask_b32 v40, v5, v13, s[56:57]
  v_cndmask_b32 v41, v5, v13, s[58:59]
  v_cndmask_b32 v42, v5, v13, s[60:61]
  v_cndmask_b32 v43, v5, v13, s[62:63]
  v_cmp_gt_i32 s[56:57], 24, v12
  v_cmp_gt_i32 s[58:59], 25, v12
  v_cmp_gt_i32 s[60:61], 26, v12
  v_cmp_gt_i32 s[62:63], 27, v12
  v_cndmask_b32 v44, v5, v13, s[56:57]
  v_cndmask_b32 v45, v5, v13, s[58:59]
  v_cndmask_b32 v46, v5, v13, s[60:61]
  v_cndmask_b32 v47, v5, v13, s[62:63]
  s_lshl_b32 s30, s29, 5
  s_sub_i32 s30, s40, s30
  v_add_u32 v12, s30, v4
  v_mov_b32 v13, s32
  v_cmp_gt_i32 s[56:57], 0, v12
  v_cmp_gt_i32 s[58:59], 1, v12
  v_cmp_gt_i32 s[60:61], 2, v12
  v_cmp_gt_i32 s[62:63], 3, v12
  v_cndmask_b32 v160, v6, v13, s[56:57]
  v_cndmask_b32 v161, v6, v13, s[58:59]
  v_cndmask_b32 v162, v6, v13, s[60:61]
  v_cndmask_b32 v163, v6, v13, s[62:63]
  v_cmp_gt_i32 s[56:57], 8, v12
  v_cmp_gt_i32 s[58:59], 9, v12
  v_cmp_gt_i32 s[60:61], 10, v12
  v_cmp_gt_i32 s[62:63], 11, v12
  v_cndmask_b32 v164, v6, v13, s[56:57]
  v_cndmask_b32 v165, v6, v13, s[58:59]
  v_cndmask_b32 v166, v6, v13, s[60:61]
  v_cndmask_b32 v167, v6, v13, s[62:63]
  v_cmp_gt_i32 s[56:57], 16, v12
  v_cmp_gt_i32 s[58:59], 17, v12
  v_cmp_gt_i32 s[60:61], 18, v12
  v_cmp_gt_i32 s[62:63], 19, v12
  v_cndmask_b32 v168, v6, v13, s[56:57]
  v_cndmask_b32 v169, v6, v13, s[58:59]
  v_cndmask_b32 v170, v6, v13, s[60:61]
  v_cndmask_b32 v171, v6, v13, s[62:63]
  v_cmp_gt_i32 s[56:57], 24, v12
  v_cmp_gt_i32 s[58:59], 25, v12
  v_cmp_gt_i32 s[60:61], 26, v12
  v_cmp_gt_i32 s[62:63], 27, v12
  v_cndmask_b32 v172, v6, v13, s[56:57]
  v_cndmask_b32 v173, v6, v13, s[58:59]
  v_cndmask_b32 v174, v6, v13, s[60:61]
  v_cndmask_b32 v175, v6, v13, s[62:63]
  s_branch aret_18
asp_22:
  s_cbranch_vccz hmask_60
asl_23:
  v_max3_f32 v10, v64, v65, v66
  v_max3_f32 v10, v10, v67, v68
  v_max3_f32 v10, v10, v69, v70
  v_max3_f32 v10, v10, v71, v72
  v_max3_f32 v10, v10, v73, v74
  v_max3_f32 v10, v10, v75, v76
  v_max3_f32 v10, v10, v77, v78
  v_max_f32 v10, v10, v79
  v_mov_b32 v11, v10
  s_nop 1
  v_permlane32_swap_b32 v10, v11
  s_nop 1
  v_max_f32 v10, v10, v11
  v_max_f32 v10, 0, v10
  v_exp_f32 v11, -v10
  v_sub_f32 v5, v5, v10
  v_mul_f32 v7, v7, v11
  v_mul_f32 v96, v96, v11
  v_mul_f32 v97, v97, v11
  v_mul_f32 v98, v98, v11
  v_mul_f32 v99, v99, v11
  v_mul_f32 v100, v100, v11
  v_mul_f32 v101, v101, v11
  v_mul_f32 v102, v102, v11
  v_mul_f32 v103, v103, v11
  v_mul_f32 v104, v104, v11
  v_mul_f32 v105, v105, v11
  v_mul_f32 v106, v106, v11
  v_mul_f32 v107, v107, v11
  v_mul_f32 v108, v108, v11
  v_mul_f32 v109, v109, v11
  v_mul_f32 v110, v110, v11
  v_mul_f32 v111, v111, v11
  v_mul_f32 v112, v112, v11
  v_mul_f32 v113, v113, v11
  v_mul_f32 v114, v114, v11
  v_mul_f32 v115, v115, v11
  v_mul_f32 v116, v116, v11
  v_mul_f32 v117, v117, v11
  v_mul_f32 v118, v118, v11
  v_mul_f32 v119, v119, v11
  v_mul_f32 v120, v120, v11
  v_mul_f32 v121, v121, v11
  v_mul_f32 v122, v122, v11
  v_mul_f32 v123, v123, v11
  v_mul_f32 v124, v124, v11
  v_mul_f32 v125, v125, v11
  v_mul_f32 v126, v126, v11
  v_mul_f32 v127, v127, v11
  v_mul_f32 v128, v128, v11
  v_mul_f32 v129, v129, v11
  v_mul_f32 v130, v130, v11
  v_mul_f32 v131, v131, v11
  v_mul_f32 v132, v132, v11
  v_mul_f32 v133, v133, v11
  v_mul_f32 v134, v134, v11
  v_mul_f32 v135, v135, v11
  v_mul_f32 v136, v136, v11
  v_mul_f32 v137, v137, v11
  v_mul_f32 v138, v138, v11
  v_mul_f32 v139, v139, v11
  v_mul_f32 v140, v140, v11
  v_mul_f32 v141, v141, v11
  v_mul_f32 v142, v142, v11
  v_mul_f32 v143, v143, v11
  v_mul_f32 v144, v144, v11
  v_mul_f32 v145, v145, v11
  v_mul_f32 v146, v146, v11
  v_mul_f32 v147, v147, v11
  v_mul_f32 v148, v148, v11
  v_mul_f32 v149, v149, v11
  v_mul_f32 v150, v150, v11
  v_mul_f32 v151, v151, v11
  v_mul_f32 v152, v152, v11
  v_mul_f32 v153, v153, v11
  v_mul_f32 v154, v154, v11
  v_mul_f32 v155, v155, v11
  v_mul_f32 v156, v156, v11
  v_mul_f32 v157, v157, v11
  v_mul_f32 v158, v158, v11
  v_mul_f32 v159, v159, v11
  v_sub_f32 v48, v48, v10
  v_sub_f32 v49, v49, v10
  v_sub_f32 v50, v50, v10
  v_sub_f32 v51, v51, v10
  v_sub_f32 v52, v52, v10
  v_sub_f32 v53, v53, v10
  v_sub_f32 v54, v54, v10
  v_sub_f32 v55, v55, v10
  v_sub_f32 v56, v56, v10
  v_sub_f32 v57, v57, v10
  v_sub_f32 v58, v58, v10
  v_sub_f32 v59, v59, v10
  v_sub_f32 v60, v60, v10
  v_sub_f32 v61, v61, v10
  v_sub_f32 v62, v62, v10
  v_sub_f32 v63, v63, v10
  v_sub_f32 v64, v64, v10
  v_sub_f32 v65, v65, v10
  v_sub_f32 v66, v66, v10
  v_sub_f32 v67, v67, v10
  v_sub_f32 v68, v68, v10
  v_sub_f32 v69, v69, v10
  v_sub_f32 v70, v70, v10
  v_sub_f32 v71, v71, v10
  v_sub_f32 v72, v72, v10
  v_sub_f32 v73, v73, v10
  v_sub_f32 v74, v74, v10
  v_sub_f32 v75, v75, v10
  v_sub_f32 v76, v76, v10
  v_sub_f32 v77, v77, v10
  v_sub_f32 v78, v78, v10
  v_sub_f32 v79, v79, v10
  v_exp_f32 v64, v64
  v_exp_f32 v65, v65
  v_exp_f32 v66, v66
  v_exp_f32 v67, v67
  v_exp_f32 v68, v68
  v_exp_f32 v69, v69
  v_exp_f32 v70, v70
  v_exp_f32 v71, v71
  v_exp_f32 v72, v72
  v_exp_f32 v73, v73
  v_exp_f32 v74, v74
  v_exp_f32 v75, v75
  v_exp_f32 v76, v76
  v_exp_f32 v77, v77
  v_exp_f32 v78, v78
  v_exp_f32 v79, v79
  v_add_f32 v26, v64, v65
  v_add_f32 v26, v26, v66
  v_add_f32 v26, v26, v67
  v_add_f32 v26, v26, v68
  v_add_f32 v26, v26, v69
  v_add_f32 v26, v26, v70
  v_add_f32 v26, v26, v71
  v_add_f32 v26, v26, v72
  v_add_f32 v26, v26, v73
  v_add_f32 v26, v26, v74
  v_add_f32 v26, v26, v75
  v_add_f32 v26, v26, v76
  v_add_f32 v26, v26, v77
  v_add_f32 v26, v26, v78
  v_add_f32 v26, v26, v79
  v_cvt_pk_bf16_f32 v88, v64, v65
  v_cvt_pk_bf16_f32 v89, v66, v67
  v_cvt_pk_bf16_f32 v90, v68, v69
  v_cvt_pk_bf16_f32 v91, v70, v71
  v_cvt_pk_bf16_f32 v92, v72, v73
  v_cvt_pk_bf16_f32 v93, v74, v75
  v_cvt_pk_bf16_f32 v94, v76, v77
  v_cvt_pk_bf16_f32 v95, v78, v79
  v_max3_f32 v10, v192, v193, v194
  v_max3_f32 v10, v10, v195, v196
  v_max3_f32 v10, v10, v197, v198
  v_max3_f32 v10, v10, v199, v200
  v_max3_f32 v10, v10, v201, v202
  v_max3_f32 v10, v10, v203, v204
  v_max3_f32 v10, v10, v205, v206
  v_max_f32 v10, v10, v207
  v_mov_b32 v11, v10
  s_nop 1
  v_permlane32_swap_b32 v10, v11
  s_nop 1
  v_max_f32 v10, v10, v11
  v_max_f32 v10, 0, v10
  v_exp_f32 v11, -v10
  v_sub_f32 v6, v6, v10
  v_mul_f32 v24, v24, v11
  v_accvgpr_read_b32 v12, a128
  v_mul_f32 v12, v12, v11
  v_accvgpr_write_b32 a128, v12
  v_accvgpr_read_b32 v12, a129
  v_mul_f32 v12, v12, v11
  v_accvgpr_write_b32 a129, v12
  v_accvgpr_read_b32 v12, a130
  v_mul_f32 v12, v12, v11
  v_accvgpr_write_b32 a130, v12
  v_accvgpr_read_b32 v12, a131
  v_mul_f32 v12, v12, v11
  v_accvgpr_write_b32 a131, v12
  v_accvgpr_read_b32 v12, a132
  v_mul_f32 v12, v12, v11
  v_accvgpr_write_b32 a132, v12
  v_accvgpr_read_b32 v12, a133
  v_mul_f32 v12, v12, v11
  v_accvgpr_write_b32 a133, v12
  v_accvgpr_read_b32 v12, a134
  v_mul_f32 v12, v12, v11
  v_accvgpr_write_b32 a134, v12
  v_accvgpr_read_b32 v12, a135
  v_mul_f32 v12, v12, v11
  v_accvgpr_write_b32 a135, v12
  v_accvgpr_read_b32 v12, a136
  v_mul_f32 v12, v12, v11
  v_accvgpr_write_b32 a136, v12
  v_accvgpr_read_b32 v12, a137
  v_mul_f32 v12, v12, v11
  v_accvgpr_write_b32 a137, v12
  v_accvgpr_read_b32 v12, a138
  v_mul_f32 v12, v12, v11
  v_accvgpr_write_b32 a138, v12
  v_accvgpr_read_b32 v12, a139
  v_mul_f32 v12, v12, v11
  v_accvgpr_write_b32 a139, v12
  v_accvgpr_read_b32 v12, a140
  v_mul_f32 v12, v12, v11
  v_accvgpr_write_b32 a140, v12
  v_accvgpr_read_b32 v12, a141
  v_mul_f32 v12, v12, v11
  v_accvgpr_write_b32 a141, v12
  v_accvgpr_read_b32 v12, a142
  v_mul_f32 v12, v12, v11
  v_accvgpr_write_b32 a142, v12
  v_accvgpr_read_b32 v12, a143
  v_mul_f32 v12, v12, v11
  v_accvgpr_write_b32 a143, v12
  v_accvgpr_read_b32 v12, a144
  v_mul_f32 v12, v12, v11
  v_accvgpr_write_b32 a144, v12
  v_accvgpr_read_b32 v12, a145
  v_mul_f32 v12, v12, v11
  v_accvgpr_write_b32 a145, v12
  v_accvgpr_read_b32 v12, a146
  v_mul_f32 v12, v12, v11
  v_accvgpr_write_b32 a146, v12
  v_accvgpr_read_b32 v12, a147
  v_mul_f32 v12, v12, v11
  v_accvgpr_write_b32 a147, v12
  v_accvgpr_read_b32 v12, a148
  v_mul_f32 v12, v12, v11
  v_accvgpr_write_b32 a148, v12
  v_accvgpr_read_b32 v12, a149
  v_mul_f32 v12, v12, v11
  v_accvgpr_write_b32 a149, v12
  v_accvgpr_read_b32 v12, a150
  v_mul_f32 v12, v12, v11
  v_accvgpr_write_b32 a150, v12
  v_accvgpr_read_b32 v12, a151
  v_mul_f32 v12, v12, v11
  v_accvgpr_write_b32 a151, v12
  v_accvgpr_read_b32 v12, a152
  v_mul_f32 v12, v12, v11
  v_accvgpr_write_b32 a152, v12
  v_accvgpr_read_b32 v12, a153
  v_mul_f32 v12, v12, v11
  v_accvgpr_write_b32 a153, v12
  v_accvgpr_read_b32 v12, a154
  v_mul_f32 v12, v12, v11
  v_accvgpr_write_b32 a154, v12
  v_accvgpr_read_b32 v12, a155
  v_mul_f32 v12, v12, v11
  v_accvgpr_write_b32 a155, v12
  v_accvgpr_read_b32 v12, a156
  v_mul_f32 v12, v12, v11
  v_accvgpr_write_b32 a156, v12
  v_accvgpr_read_b32 v12, a157
  v_mul_f32 v12, v12, v11
  v_accvgpr_write_b32 a157, v12
  v_accvgpr_read_b32 v12, a158
  v_mul_f32 v12, v12, v11
  v_accvgpr_write_b32 a158, v12
  v_accvgpr_read_b32 v12, a159
  v_mul_f32 v12, v12, v11
  v_accvgpr_write_b32 a159, v12
  v_accvgpr_read_b32 v12, a160
  v_mul_f32 v12, v12, v11
  v_accvgpr_write_b32 a160, v12
  v_accvgpr_read_b32 v12, a161
  v_mul_f32 v12, v12, v11
  v_accvgpr_write_b32 a161, v12
  v_accvgpr_read_b32 v12, a162
  v_mul_f32 v12, v12, v11
  v_accvgpr_write_b32 a162, v12
  v_accvgpr_read_b32 v12, a163
  v_mul_f32 v12, v12, v11
  v_accvgpr_write_b32 a163, v12
  v_accvgpr_read_b32 v12, a164
  v_mul_f32 v12, v12, v11
  v_accvgpr_write_b32 a164, v12
  v_accvgpr_read_b32 v12, a165
  v_mul_f32 v12, v12, v11
  v_accvgpr_write_b32 a165, v12
  v_accvgpr_read_b32 v12, a166
  v_mul_f32 v12, v12, v11
  v_accvgpr_write_b32 a166, v12
  v_accvgpr_read_b32 v12, a167
  v_mul_f32 v12, v12, v11
  v_accvgpr_write_b32 a167, v12
  v_accvgpr_read_b32 v12, a168
  v_mul_f32 v12, v12, v11
  v_accvgpr_write_b32 a168, v12
  v_accvgpr_read_b32 v12, a169
  v_mul_f32 v12, v12, v11
  v_accvgpr_write_b32 a169, v12
  v_accvgpr_read_b32 v12, a170
  v_mul_f32 v12, v12, v11
  v_accvgpr_write_b32 a170, v12
  v_accvgpr_read_b32 v12, a171
  v_mul_f32 v12, v12, v11
  v_accvgpr_write_b32 a171, v12
  v_accvgpr_read_b32 v12, a172
  v_mul_f32 v12, v12, v11
  v_accvgpr_write_b32 a172, v12
  v_accvgpr_read_b32 v12, a173
  v_mul_f32 v12, v12, v11
  v_accvgpr_write_b32 a173, v12
  v_accvgpr_read_b32 v12, a174
  v_mul_f32 v12, v12, v11
  v_accvgpr_write_b32 a174, v12
  v_accvgpr_read_b32 v12, a175
  v_mul_f32 v12, v12, v11
  v_accvgpr_write_b32 a175, v12
  v_accvgpr_read_b32 v12, a176
  v_mul_f32 v12, v12, v11
  v_accvgpr_write_b32 a176, v12
  v_accvgpr_read_b32 v12, a177
  v_mul_f32 v12, v12, v11
  v_accvgpr_write_b32 a177, v12
  v_accvgpr_read_b32 v12, a178
  v_mul_f32 v12, v12, v11
  v_accvgpr_write_b32 a178, v12
  v_accvgpr_read_b32 v12, a179
  v_mul_f32 v12, v12, v11
  v_accvgpr_write_b32 a179, v12
  v_accvgpr_read_b32 v12, a180
  v_mul_f32 v12, v12, v11
  v_accvgpr_write_b32 a180, v12
  v_accvgpr_read_b32 v12, a181
  v_mul_f32 v12, v12, v11
  v_accvgpr_write_b32 a181, v12
  v_accvgpr_read_b32 v12, a182
  v_mul_f32 v12, v12, v11
  v_accvgpr_write_b32 a182, v12
  v_accvgpr_read_b32 v12, a183
  v_mul_f32 v12, v12, v11
  v_accvgpr_write_b32 a183, v12
  v_accvgpr_read_b32 v12, a184
  v_mul_f32 v12, v12, v11
  v_accvgpr_write_b32 a184, v12
  v_accvgpr_read_b32 v12, a185
  v_mul_f32 v12, v12, v11
  v_accvgpr_write_b32 a185, v12
  v_accvgpr_read_b32 v12, a186
  v_mul_f32 v12, v12, v11
  v_accvgpr_write_b32 a186, v12
  v_accvgpr_read_b32 v12, a187
  v_mul_f32 v12, v12, v11
  v_accvgpr_write_b32 a187, v12
  v_accvgpr_read_b32 v12, a188
  v_mul_f32 v12, v12, v11
  v_accvgpr_write_b32 a188, v12
  v_accvgpr_read_b32 v12, a189
  v_mul_f32 v12, v12, v11
  v_accvgpr_write_b32 a189, v12
  v_accvgpr_read_b32 v12, a190
  v_mul_f32 v12, v12, v11
  v_accvgpr_write_b32 a190, v12
  v_accvgpr_read_b32 v12, a191
  v_mul_f32 v12, v12, v11
  v_accvgpr_write_b32 a191, v12
  v_sub_f32 v176, v176, v10
  v_sub_f32 v177, v177, v10
  v_sub_f32 v178, v178, v10
  v_sub_f32 v179, v179, v10
  v_sub_f32 v180, v180, v10
  v_sub_f32 v181, v181, v10
  v_sub_f32 v182, v182, v10
  v_sub_f32 v183, v183, v10
  v_sub_f32 v184, v184, v10
  v_sub_f32 v185, v185, v10
  v_sub_f32 v186, v186, v10
  v_sub_f32 v187, v187, v10
  v_sub_f32 v188, v188, v10
  v_sub_f32 v189, v189, v10
  v_sub_f32 v190, v190, v10
  v_sub_f32 v191, v191, v10
  v_sub_f32 v192, v192, v10
  v_sub_f32 v193, v193, v10
  v_sub_f32 v194, v194, v10
  v_sub_f32 v195, v195, v10
  v_sub_f32 v196, v196, v10
  v_sub_f32 v197, v197, v10
  v_sub_f32 v198, v198, v10
  v_sub_f32 v199, v199, v10
  v_sub_f32 v200, v200, v10
  v_sub_f32 v201, v201, v10
  v_sub_f32 v202, v202, v10
  v_sub_f32 v203, v203, v10
  v_sub_f32 v204, v204, v10
  v_sub_f32 v205, v205, v10
  v_sub_f32 v206, v206, v10
  v_sub_f32 v207, v207, v10
  v_exp_f32 v192, v192
  v_exp_f32 v193, v193
  v_exp_f32 v194, v194
  v_exp_f32 v195, v195
  v_exp_f32 v196, v196
  v_exp_f32 v197, v197
  v_exp_f32 v198, v198
  v_exp_f32 v199, v199
  v_exp_f32 v200, v200
  v_exp_f32 v201, v201
  v_exp_f32 v202, v202
  v_exp_f32 v203, v203
  v_exp_f32 v204, v204
  v_exp_f32 v205, v205
  v_exp_f32 v206, v206
  v_exp_f32 v207, v207
  v_add_f32 v27, v192, v193
  v_add_f32 v27, v27, v194
  v_add_f32 v27, v27, v195
  v_add_f32 v27, v27, v196
  v_add_f32 v27, v27, v197
  v_add_f32 v27, v27, v198
  v_add_f32 v27, v27, v199
  v_add_f32 v27, v27, v200
  v_add_f32 v27, v27, v201
  v_add_f32 v27, v27, v202
  v_add_f32 v27, v27, v203
  v_add_f32 v27, v27, v204
  v_add_f32 v27, v27, v205
  v_add_f32 v27, v27, v206
  v_add_f32 v27, v27, v207
  v_cvt_pk_bf16_f32 v216, v192, v193
  v_cvt_pk_bf16_f32 v217, v194, v195
  v_cvt_pk_bf16_f32 v218, v196, v197
  v_cvt_pk_bf16_f32 v219, v198, v199
  v_cvt_pk_bf16_f32 v220, v200, v201
  v_cvt_pk_bf16_f32 v221, v202, v203
  v_cvt_pk_bf16_f32 v222, v204, v205
  v_cvt_pk_bf16_f32 v223, v206, v207
hmask_60:
  s_add_u32 s29, s18, 2
  s_lshl_b32 s30, s29, 5
  s_sub_i32 s30, s39, s30
  v_add_u32 v12, s30, v4
  v_mov_b32 v13, s32
  v_cmp_gt_i32 s[56:57], 0, v12
  v_cmp_gt_i32 s[58:59], 1, v12
  v_cmp_gt_i32 s[60:61], 2, v12
  v_cmp_gt_i32 s[62:63], 3, v12
  v_cndmask_b32 v32, v5, v13, s[56:57]
  v_cndmask_b32 v33, v5, v13, s[58:59]
  v_cndmask_b32 v34, v5, v13, s[60:61]
  v_cndmask_b32 v35, v5, v13, s[62:63]
  v_cmp_gt_i32 s[56:57], 8, v12
  v_cmp_gt_i32 s[58:59], 9, v12
  v_cmp_gt_i32 s[60:61], 10, v12
  v_cmp_gt_i32 s[62:63], 11, v12
  v_cndmask_b32 v36, v5, v13, s[56:57]
  v_cndmask_b32 v37, v5, v13, s[58:59]
  v_cndmask_b32 v38, v5, v13, s[60:61]
  v_cndmask_b32 v39, v5, v13, s[62:63]
  v_cmp_gt_i32 s[56:57], 16, v12
  v_cmp_gt_i32 s[58:59], 17, v12
  v_cmp_gt_i32 s[60:61], 18, v12
  v_cmp_gt_i32 s[62:63], 19, v12
  v_cndmask_b32 v40, v5, v13, s[56:57]
  v_cndmask_b32 v41, v5, v13, s[58:59]
  v_cndmask_b32 v42, v5, v13, s[60:61]
  v_cndmask_b32 v43, v5, v13, s[62:63]
  v_cmp_gt_i32 s[56:57], 24, v12
  v_cmp_gt_i32 s[58:59], 25, v12
  v_cmp_gt_i32 s[60:61], 26, v12
  v_cmp_gt_i32 s[62:63], 27, v12
  v_cndmask_b32 v44, v5, v13, s[56:57]
  v_cndmask_b32 v45, v5, v13, s[58:59]
  v_cndmask_b32 v46, v5, v13, s[60:61]
  v_cndmask_b32 v47, v5, v13, s[62:63]
  s_lshl_b32 s30, s29, 5
  s_sub_i32 s30, s40, s30
  v_add_u32 v12, s30, v4
  v_mov_b32 v13, s32
  v_cmp_gt_i32 s[56:57], 0, v12
  v_cmp_gt_i32 s[58:59], 1, v12
  v_cmp_gt_i32 s[60:61], 2, v12
  v_cmp_gt_i32 s[62:63], 3, v12
  v_cndmask_b32 v160, v6, v13, s[56:57]
  v_cndmask_b32 v161, v6, v13, s[58:59]
  v_cndmask_b32 v162, v6, v13, s[60:61]
  v_cndmask_b32 v163, v6, v13, s[62:63]
  v_cmp_gt_i32 s[56:57], 8, v12
  v_cmp_gt_i32 s[58:59], 9, v12
  v_cmp_gt_i32 s[60:61], 10, v12
  v_cmp_gt_i32 s[62:63], 11, v12
  v_cndmask_b32 v164, v6, v13, s[56:57]
  v_cndmask_b32 v165, v6, v13, s[58:59]
  v_cndmask_b32 v166, v6, v13, s[60:61]
  v_cndmask_b32 v167, v6, v13, s[62:63]
  v_cmp_gt_i32 s[56:57], 16, v12
  v_cmp_gt_i32 s[58:59], 17, v12
  v_cmp_gt_i32 s[60:61], 18, v12
  v_cmp_gt_i32 s[62:63], 19, v12
  v_cndmask_b32 v168, v6, v13, s[56:57]
  v_cndmask_b32 v169, v6, v13, s[58:59]
  v_cndmask_b32 v170, v6, v13, s[60:61]
  v_cndmask_b32 v171, v6, v13, s[62:63]
  v_cmp_gt_i32 s[56:57], 24, v12
  v_cmp_gt_i32 s[58:59], 25, v12
  v_cmp_gt_i32 s[60:61], 26, v12
  v_cmp_gt_i32 s[62:63], 27, v12
  v_cndmask_b32 v172, v6, v13, s[56:57]
  v_cndmask_b32 v173, v6, v13, s[58:59]
  v_cndmask_b32 v174, v6, v13, s[60:61]
  v_cndmask_b32 v175, v6, v13, s[62:63]
  s_branch aret_21
asp_25:
  s_cbranch_vccz hmask_61
asl_26:
  v_max3_f32 v10, v48, v49, v50
  v_max3_f32 v10, v10, v51, v52
  v_max3_f32 v10, v10, v53, v54
  v_max3_f32 v10, v10, v55, v56
  v_max3_f32 v10, v10, v57, v58
  v_max3_f32 v10, v10, v59, v60
  v_max3_f32 v10, v10, v61, v62
  v_max_f32 v10, v10, v63
  v_mov_b32 v11, v10
  s_nop 1
  v_permlane32_swap_b32 v10, v11
  s_nop 1
  v_max_f32 v10, v10, v11
  v_max_f32 v10, 0, v10
  v_exp_f32 v11, -v10
  v_sub_f32 v5, v5, v10
  v_mul_f32 v7, v7, v11
  v_mul_f32 v96, v96, v11
  v_mul_f32 v97, v97, v11
  v_mul_f32 v98, v98, v11
  v_mul_f32 v99, v99, v11
  v_mul_f32 v100, v100, v11
  v_mul_f32 v101, v101, v11
  v_mul_f32 v102, v102, v11
  v_mul_f32 v103, v103, v11
  v_mul_f32 v104, v104, v11
  v_mul_f32 v105, v105, v11
  v_mul_f32 v106, v106, v11
  v_mul_f32 v107, v107, v11
  v_mul_f32 v108, v108, v11
  v_mul_f32 v109, v109, v11
  v_mul_f32 v110, v110, v11
  v_mul_f32 v111, v111, v11
  v_mul_f32 v112, v112, v11
  v_mul_f32 v113, v113, v11
  v_mul_f32 v114, v114, v11
  v_mul_f32 v115, v115, v11
  v_mul_f32 v116, v116, v11
  v_mul_f32 v117, v117, v11
  v_mul_f32 v118, v118, v11
  v_mul_f32 v119, v119, v11
  v_mul_f32 v120, v120, v11
  v_mul_f32 v121, v121, v11
  v_mul_f32 v122, v122, v11
  v_mul_f32 v123, v123, v11
  v_mul_f32 v124, v124, v11
  v_mul_f32 v125, v125, v11
  v_mul_f32 v126, v126, v11
  v_mul_f32 v127, v127, v11
  v_mul_f32 v128, v128, v11
  v_mul_f32 v129, v129, v11
  v_mul_f32 v130, v130, v11
  v_mul_f32 v131, v131, v11
  v_mul_f32 v132, v132, v11
  v_mul_f32 v133, v133, v11
  v_mul_f32 v134, v134, v11
  v_mul_f32 v135, v135, v11
  v_mul_f32 v136, v136, v11
  v_mul_f32 v137, v137, v11
  v_mul_f32 v138, v138, v11
  v_mul_f32 v139, v139, v11
  v_mul_f32 v140, v140, v11
  v_mul_f32 v141, v141, v11
  v_mul_f32 v142, v142, v11
  v_mul_f32 v143, v143, v11
  v_mul_f32 v144, v144, v11
  v_mul_f32 v145, v145, v11
  v_mul_f32 v146, v146, v11
  v_mul_f32 v147, v147, v11
  v_mul_f32 v148, v148, v11
  v_mul_f32 v149, v149, v11
  v_mul_f32 v150, v150, v11
  v_mul_f32 v151, v151, v11
  v_mul_f32 v152, v152, v11
  v_mul_f32 v153, v153, v11
  v_mul_f32 v154, v154, v11
  v_mul_f32 v155, v155, v11
  v_mul_f32 v156, v156, v11
  v_mul_f32 v157, v157, v11
  v_mul_f32 v158, v158, v11
  v_mul_f32 v159, v159, v11
  v_sub_f32 v64, v64, v10
  v_sub_f32 v65, v65, v10
  v_sub_f32 v66, v66, v10
  v_sub_f32 v67, v67, v10
  v_sub_f32 v68, v68, v10
  v_sub_f32 v69, v69, v10
  v_sub_f32 v70, v70, v10
  v_sub_f32 v71, v71, v10
  v_sub_f32 v72, v72, v10
  v_sub_f32 v73, v73, v10
  v_sub_f32 v74, v74, v10
  v_sub_f32 v75, v75, v10
  v_sub_f32 v76, v76, v10
  v_sub_f32 v77, v77, v10
  v_sub_f32 v78, v78, v10
  v_sub_f32 v79, v79, v10
  v_sub_f32 v48, v48, v10
  v_sub_f32 v49, v49, v10
  v_sub_f32 v50, v50, v10
  v_sub_f32 v51, v51, v10
  v_sub_f32 v52, v52, v10
  v_sub_f32 v53, v53, v10
  v_sub_f32 v54, v54, v10
  v_sub_f32 v55, v55, v10
  v_sub_f32 v56, v56, v10
  v_sub_f32 v57, v57, v10
  v_sub_f32 v58, v58, v10
  v_sub_f32 v59, v59, v10
  v_sub_f32 v60, v60, v10
  v_sub_f32 v61, v61, v10
  v_sub_f32 v62, v62, v10
  v_sub_f32 v63, v63, v10
  v_exp_f32 v48, v48
  v_exp_f32 v49, v49
  v_exp_f32 v50, v50
  v_exp_f32 v51, v51
  v_exp_f32 v52, v52
  v_exp_f32 v53, v53
  v_exp_f32 v54, v54
  v_exp_f32 v55, v55
  v_exp_f32 v56, v56
  v_exp_f32 v57, v57
  v_exp_f32 v58, v58
  v_exp_f32 v59, v59
  v_exp_f32 v60, v60
  v_exp_f32 v61, v61
  v_exp_f32 v62, v62
  v_exp_f32 v63, v63
  v_add_f32 v26, v48, v49
  v_add_f32 v26, v26, v50
  v_add_f32 v26, v26, v51
  v_add_f32 v26, v26, v52
  v_add_f32 v26, v26, v53
  v_add_f32 v26, v26, v54
  v_add_f32 v26, v26, v55
  v_add_f32 v26, v26, v56
  v_add_f32 v26, v26, v57
  v_add_f32 v26, v26, v58
  v_add_f32 v26, v26, v59
  v_add_f32 v26, v26, v60
  v_add_f32 v26, v26, v61
  v_add_f32 v26, v26, v62
  v_add_f32 v26, v26, v63
  v_cvt_pk_bf16_f32 v80, v48, v49
  v_cvt_pk_bf16_f32 v81, v50, v51
  v_cvt_pk_bf16_f32 v82, v52, v53
  v_cvt_pk_bf16_f32 v83, v54, v55
  v_cvt_pk_bf16_f32 v84, v56, v57
  v_cvt_pk_bf16_f32 v85, v58, v59
  v_cvt_pk_bf16_f32 v86, v60, v61
  v_cvt_pk_bf16_f32 v87, v62, v63
  v_max3_f32 v10, v176, v177, v178
  v_max3_f32 v10, v10, v179, v180
  v_max3_f32 v10, v10, v181, v182
  v_max3_f32 v10, v10, v183, v184
  v_max3_f32 v10, v10, v185, v186
  v_max3_f32 v10, v10, v187, v188
  v_max3_f32 v10, v10, v189, v190
  v_max_f32 v10, v10, v191
  v_mov_b32 v11, v10
  s_nop 1
  v_permlane32_swap_b32 v10, v11
  s_nop 1
  v_max_f32 v10, v10, v11
  v_max_f32 v10, 0, v10
  v_exp_f32 v11, -v10
  v_sub_f32 v6, v6, v10
  v_mul_f32 v24, v24, v11
  v_accvgpr_read_b32 v12, a128
  v_mul_f32 v12, v12, v11
  v_accvgpr_write_b32 a128, v12
  v_accvgpr_read_b32 v12, a129
  v_mul_f32 v12, v12, v11
  v_accvgpr_write_b32 a129, v12
  v_accvgpr_read_b32 v12, a130
  v_mul_f32 v12, v12, v11
  v_accvgpr_write_b32 a130, v12
  v_accvgpr_read_b32 v12, a131
  v_mul_f32 v12, v12, v11
  v_accvgpr_write_b32 a131, v12
  v_accvgpr_read_b32 v12, a132
  v_mul_f32 v12, v12, v11
  v_accvgpr_write_b32 a132, v12
  v_accvgpr_read_b32 v12, a133
  v_mul_f32 v12, v12, v11
  v_accvgpr_write_b32 a133, v12
  v_accvgpr_read_b32 v12, a134
  v_mul_f32 v12, v12, v11
  v_accvgpr_write_b32 a134, v12
  v_accvgpr_read_b32 v12, a135
  v_mul_f32 v12, v12, v11
  v_accvgpr_write_b32 a135, v12
  v_accvgpr_read_b32 v12, a136
  v_mul_f32 v12, v12, v11
  v_accvgpr_write_b32 a136, v12
  v_accvgpr_read_b32 v12, a137
  v_mul_f32 v12, v12, v11
  v_accvgpr_write_b32 a137, v12
  v_accvgpr_read_b32 v12, a138
  v_mul_f32 v12, v12, v11
  v_accvgpr_write_b32 a138, v12
  v_accvgpr_read_b32 v12, a139
  v_mul_f32 v12, v12, v11
  v_accvgpr_write_b32 a139, v12
  v_accvgpr_read_b32 v12, a140
  v_mul_f32 v12, v12, v11
  v_accvgpr_write_b32 a140, v12
  v_accvgpr_read_b32 v12, a141
  v_mul_f32 v12, v12, v11
  v_accvgpr_write_b32 a141, v12
  v_accvgpr_read_b32 v12, a142
  v_mul_f32 v12, v12, v11
  v_accvgpr_write_b32 a142, v12
  v_accvgpr_read_b32 v12, a143
  v_mul_f32 v12, v12, v11
  v_accvgpr_write_b32 a143, v12
  v_accvgpr_read_b32 v12, a144
  v_mul_f32 v12, v12, v11
  v_accvgpr_write_b32 a144, v12
  v_accvgpr_read_b32 v12, a145
  v_mul_f32 v12, v12, v11
  v_accvgpr_write_b32 a145, v12
  v_accvgpr_read_b32 v12, a146
  v_mul_f32 v12, v12, v11
  v_accvgpr_write_b32 a146, v12
  v_accvgpr_read_b32 v12, a147
  v_mul_f32 v12, v12, v11
  v_accvgpr_write_b32 a147, v12
  v_accvgpr_read_b32 v12, a148
  v_mul_f32 v12, v12, v11
  v_accvgpr_write_b32 a148, v12
  v_accvgpr_read_b32 v12, a149
  v_mul_f32 v12, v12, v11
  v_accvgpr_write_b32 a149, v12
  v_accvgpr_read_b32 v12, a150
  v_mul_f32 v12, v12, v11
  v_accvgpr_write_b32 a150, v12
  v_accvgpr_read_b32 v12, a151
  v_mul_f32 v12, v12, v11
  v_accvgpr_write_b32 a151, v12
  v_accvgpr_read_b32 v12, a152
  v_mul_f32 v12, v12, v11
  v_accvgpr_write_b32 a152, v12
  v_accvgpr_read_b32 v12, a153
  v_mul_f32 v12, v12, v11
  v_accvgpr_write_b32 a153, v12
  v_accvgpr_read_b32 v12, a154
  v_mul_f32 v12, v12, v11
  v_accvgpr_write_b32 a154, v12
  v_accvgpr_read_b32 v12, a155
  v_mul_f32 v12, v12, v11
  v_accvgpr_write_b32 a155, v12
  v_accvgpr_read_b32 v12, a156
  v_mul_f32 v12, v12, v11
  v_accvgpr_write_b32 a156, v12
  v_accvgpr_read_b32 v12, a157
  v_mul_f32 v12, v12, v11
  v_accvgpr_write_b32 a157, v12
  v_accvgpr_read_b32 v12, a158
  v_mul_f32 v12, v12, v11
  v_accvgpr_write_b32 a158, v12
  v_accvgpr_read_b32 v12, a159
  v_mul_f32 v12, v12, v11
  v_accvgpr_write_b32 a159, v12
  v_accvgpr_read_b32 v12, a160
  v_mul_f32 v12, v12, v11
  v_accvgpr_write_b32 a160, v12
  v_accvgpr_read_b32 v12, a161
  v_mul_f32 v12, v12, v11
  v_accvgpr_write_b32 a161, v12
  v_accvgpr_read_b32 v12, a162
  v_mul_f32 v12, v12, v11
  v_accvgpr_write_b32 a162, v12
  v_accvgpr_read_b32 v12, a163
  v_mul_f32 v12, v12, v11
  v_accvgpr_write_b32 a163, v12
  v_accvgpr_read_b32 v12, a164
  v_mul_f32 v12, v12, v11
  v_accvgpr_write_b32 a164, v12
  v_accvgpr_read_b32 v12, a165
  v_mul_f32 v12, v12, v11
  v_accvgpr_write_b32 a165, v12
  v_accvgpr_read_b32 v12, a166
  v_mul_f32 v12, v12, v11
  v_accvgpr_write_b32 a166, v12
  v_accvgpr_read_b32 v12, a167
  v_mul_f32 v12, v12, v11
  v_accvgpr_write_b32 a167, v12
  v_accvgpr_read_b32 v12, a168
  v_mul_f32 v12, v12, v11
  v_accvgpr_write_b32 a168, v12
  v_accvgpr_read_b32 v12, a169
  v_mul_f32 v12, v12, v11
  v_accvgpr_write_b32 a169, v12
  v_accvgpr_read_b32 v12, a170
  v_mul_f32 v12, v12, v11
  v_accvgpr_write_b32 a170, v12
  v_accvgpr_read_b32 v12, a171
  v_mul_f32 v12, v12, v11
  v_accvgpr_write_b32 a171, v12
  v_accvgpr_read_b32 v12, a172
  v_mul_f32 v12, v12, v11
  v_accvgpr_write_b32 a172, v12
  v_accvgpr_read_b32 v12, a173
  v_mul_f32 v12, v12, v11
  v_accvgpr_write_b32 a173, v12
  v_accvgpr_read_b32 v12, a174
  v_mul_f32 v12, v12, v11
  v_accvgpr_write_b32 a174, v12
  v_accvgpr_read_b32 v12, a175
  v_mul_f32 v12, v12, v11
  v_accvgpr_write_b32 a175, v12
  v_accvgpr_read_b32 v12, a176
  v_mul_f32 v12, v12, v11
  v_accvgpr_write_b32 a176, v12
  v_accvgpr_read_b32 v12, a177
  v_mul_f32 v12, v12, v11
  v_accvgpr_write_b32 a177, v12
  v_accvgpr_read_b32 v12, a178
  v_mul_f32 v12, v12, v11
  v_accvgpr_write_b32 a178, v12
  v_accvgpr_read_b32 v12, a179
  v_mul_f32 v12, v12, v11
  v_accvgpr_write_b32 a179, v12
  v_accvgpr_read_b32 v12, a180
  v_mul_f32 v12, v12, v11
  v_accvgpr_write_b32 a180, v12
  v_accvgpr_read_b32 v12, a181
  v_mul_f32 v12, v12, v11
  v_accvgpr_write_b32 a181, v12
  v_accvgpr_read_b32 v12, a182
  v_mul_f32 v12, v12, v11
  v_accvgpr_write_b32 a182, v12
  v_accvgpr_read_b32 v12, a183
  v_mul_f32 v12, v12, v11
  v_accvgpr_write_b32 a183, v12
  v_accvgpr_read_b32 v12, a184
  v_mul_f32 v12, v12, v11
  v_accvgpr_write_b32 a184, v12
  v_accvgpr_read_b32 v12, a185
  v_mul_f32 v12, v12, v11
  v_accvgpr_write_b32 a185, v12
  v_accvgpr_read_b32 v12, a186
  v_mul_f32 v12, v12, v11
  v_accvgpr_write_b32 a186, v12
  v_accvgpr_read_b32 v12, a187
  v_mul_f32 v12, v12, v11
  v_accvgpr_write_b32 a187, v12
  v_accvgpr_read_b32 v12, a188
  v_mul_f32 v12, v12, v11
  v_accvgpr_write_b32 a188, v12
  v_accvgpr_read_b32 v12, a189
  v_mul_f32 v12, v12, v11
  v_accvgpr_write_b32 a189, v12
  v_accvgpr_read_b32 v12, a190
  v_mul_f32 v12, v12, v11
  v_accvgpr_write_b32 a190, v12
  v_accvgpr_read_b32 v12, a191
  v_mul_f32 v12, v12, v11
  v_accvgpr_write_b32 a191, v12
  v_sub_f32 v192, v192, v10
  v_sub_f32 v193, v193, v10
  v_sub_f32 v194, v194, v10
  v_sub_f32 v195, v195, v10
  v_sub_f32 v196, v196, v10
  v_sub_f32 v197, v197, v10
  v_sub_f32 v198, v198, v10
  v_sub_f32 v199, v199, v10
  v_sub_f32 v200, v200, v10
  v_sub_f32 v201, v201, v10
  v_sub_f32 v202, v202, v10
  v_sub_f32 v203, v203, v10
  v_sub_f32 v204, v204, v10
  v_sub_f32 v205, v205, v10
  v_sub_f32 v206, v206, v10
  v_sub_f32 v207, v207, v10
  v_sub_f32 v176, v176, v10
  v_sub_f32 v177, v177, v10
  v_sub_f32 v178, v178, v10
  v_sub_f32 v179, v179, v10
  v_sub_f32 v180, v180, v10
  v_sub_f32 v181, v181, v10
  v_sub_f32 v182, v182, v10
  v_sub_f32 v183, v183, v10
  v_sub_f32 v184, v184, v10
  v_sub_f32 v185, v185, v10
  v_sub_f32 v186, v186, v10
  v_sub_f32 v187, v187, v10
  v_sub_f32 v188, v188, v10
  v_sub_f32 v189, v189, v10
  v_sub_f32 v190, v190, v10
  v_sub_f32 v191, v191, v10
  v_exp_f32 v176, v176
  v_exp_f32 v177, v177
  v_exp_f32 v178, v178
  v_exp_f32 v179, v179
  v_exp_f32 v180, v180
  v_exp_f32 v181, v181
  v_exp_f32 v182, v182
  v_exp_f32 v183, v183
  v_exp_f32 v184, v184
  v_exp_f32 v185, v185
  v_exp_f32 v186, v186
  v_exp_f32 v187, v187
  v_exp_f32 v188, v188
  v_exp_f32 v189, v189
  v_exp_f32 v190, v190
  v_exp_f32 v191, v191
  v_add_f32 v27, v176, v177
  v_add_f32 v27, v27, v178
  v_add_f32 v27, v27, v179
  v_add_f32 v27, v27, v180
  v_add_f32 v27, v27, v181
  v_add_f32 v27, v27, v182
  v_add_f32 v27, v27, v183
  v_add_f32 v27, v27, v184
  v_add_f32 v27, v27, v185
  v_add_f32 v27, v27, v186
  v_add_f32 v27, v27, v187
  v_add_f32 v27, v27, v188
  v_add_f32 v27, v27, v189
  v_add_f32 v27, v27, v190
  v_add_f32 v27, v27, v191
  v_cvt_pk_bf16_f32 v208, v176, v177
  v_cvt_pk_bf16_f32 v209, v178, v179
  v_cvt_pk_bf16_f32 v210, v180, v181
  v_cvt_pk_bf16_f32 v211, v182, v183
  v_cvt_pk_bf16_f32 v212, v184, v185
  v_cvt_pk_bf16_f32 v213, v186, v187
  v_cvt_pk_bf16_f32 v214, v188, v189
  v_cvt_pk_bf16_f32 v215, v190, v191
hmask_61:
  s_add_u32 s29, s18, 2
  s_lshl_b32 s30, s29, 5
  s_sub_i32 s30, s39, s30
  v_add_u32 v12, s30, v4
  v_mov_b32 v13, s32
  v_cmp_gt_i32 s[56:57], 0, v12
  v_cmp_gt_i32 s[58:59], 1, v12
  v_cmp_gt_i32 s[60:61], 2, v12
  v_cmp_gt_i32 s[62:63], 3, v12
  v_cndmask_b32 v32, v5, v13, s[56:57]
  v_cndmask_b32 v33, v5, v13, s[58:59]
  v_cndmask_b32 v34, v5, v13, s[60:61]
  v_cndmask_b32 v35, v5, v13, s[62:63]
  v_cmp_gt_i32 s[56:57], 8, v12
  v_cmp_gt_i32 s[58:59], 9, v12
  v_cmp_gt_i32 s[60:61], 10, v12
  v_cmp_gt_i32 s[62:63], 11, v12
  v_cndmask_b32 v36, v5, v13, s[56:57]
  v_cndmask_b32 v37, v5, v13, s[58:59]
  v_cndmask_b32 v38, v5, v13, s[60:61]
  v_cndmask_b32 v39, v5, v13, s[62:63]
  v_cmp_gt_i32 s[56:57], 16, v12
  v_cmp_gt_i32 s[58:59], 17, v12
  v_cmp_gt_i32 s[60:61], 18, v12
  v_cmp_gt_i32 s[62:63], 19, v12
  v_cndmask_b32 v40, v5, v13, s[56:57]
  v_cndmask_b32 v41, v5, v13, s[58:59]
  v_cndmask_b32 v42, v5, v13, s[60:61]
  v_cndmask_b32 v43, v5, v13, s[62:63]
  v_cmp_gt_i32 s[56:57], 24, v12
  v_cmp_gt_i32 s[58:59], 25, v12
  v_cmp_gt_i32 s[60:61], 26, v12
  v_cmp_gt_i32 s[62:63], 27, v12
  v_cndmask_b32 v44, v5, v13, s[56:57]
  v_cndmask_b32 v45, v5, v13, s[58:59]
  v_cndmask_b32 v46, v5, v13, s[60:61]
  v_cndmask_b32 v47, v5, v13, s[62:63]
  s_branch aret_24
asp_28:
  s_cbranch_vccz hmask_62
asl_29:
  v_max3_f32 v10, v64, v65, v66
  v_max3_f32 v10, v10, v67, v68
  v_max3_f32 v10, v10, v69, v70
  v_max3_f32 v10, v10, v71, v72
  v_max3_f32 v10, v10, v73, v74
  v_max3_f32 v10, v10, v75, v76
  v_max3_f32 v10, v10, v77, v78
  v_max_f32 v10, v10, v79
  v_mov_b32 v11, v10
  s_nop 1
  v_permlane32_swap_b32 v10, v11
  s_nop 1
  v_max_f32 v10, v10, v11
  v_max_f32 v10, 0, v10
  v_exp_f32 v11, -v10
  v_sub_f32 v5, v5, v10
  v_mul_f32 v7, v7, v11
  v_mul_f32 v96, v96, v11
  v_mul_f32 v97, v97, v11
  v_mul_f32 v98, v98, v11
  v_mul_f32 v99, v99, v11
  v_mul_f32 v100, v100, v11
  v_mul_f32 v101, v101, v11
  v_mul_f32 v102, v102, v11
  v_mul_f32 v103, v103, v11
  v_mul_f32 v104, v104, v11
  v_mul_f32 v105, v105, v11
  v_mul_f32 v106, v106, v11
  v_mul_f32 v107, v107, v11
  v_mul_f32 v108, v108, v11
  v_mul_f32 v109, v109, v11
  v_mul_f32 v110, v110, v11
  v_mul_f32 v111, v111, v11
  v_mul_f32 v112, v112, v11
  v_mul_f32 v113, v113, v11
  v_mul_f32 v114, v114, v11
  v_mul_f32 v115, v115, v11
  v_mul_f32 v116, v116, v11
  v_mul_f32 v117, v117, v11
  v_mul_f32 v118, v118, v11
  v_mul_f32 v119, v119, v11
  v_mul_f32 v120, v120, v11
  v_mul_f32 v121, v121, v11
  v_mul_f32 v122, v122, v11
  v_mul_f32 v123, v123, v11
  v_mul_f32 v124, v124, v11
  v_mul_f32 v125, v125, v11
  v_mul_f32 v126, v126, v11
  v_mul_f32 v127, v127, v11
  v_mul_f32 v128, v128, v11
  v_mul_f32 v129, v129, v11
  v_mul_f32 v130, v130, v11
  v_mul_f32 v131, v131, v11
  v_mul_f32 v132, v132, v11
  v_mul_f32 v133, v133, v11
  v_mul_f32 v134, v134, v11
  v_mul_f32 v135, v135, v11
  v_mul_f32 v136, v136, v11
  v_mul_f32 v137, v137, v11
  v_mul_f32 v138, v138, v11
  v_mul_f32 v139, v139, v11
  v_mul_f32 v140, v140, v11
  v_mul_f32 v141, v141, v11
  v_mul_f32 v142, v142, v11
  v_mul_f32 v143, v143, v11
  v_mul_f32 v144, v144, v11
  v_mul_f32 v145, v145, v11
  v_mul_f32 v146, v146, v11
  v_mul_f32 v147, v147, v11
  v_mul_f32 v148, v148, v11
  v_mul_f32 v149, v149, v11
  v_mul_f32 v150, v150, v11
  v_mul_f32 v151, v151, v11
  v_mul_f32 v152, v152, v11
  v_mul_f32 v153, v153, v11
  v_mul_f32 v154, v154, v11
  v_mul_f32 v155, v155, v11
  v_mul_f32 v156, v156, v11
  v_mul_f32 v157, v157, v11
  v_mul_f32 v158, v158, v11
  v_mul_f32 v159, v159, v11
  v_sub_f32 v48, v48, v10
  v_sub_f32 v49, v49, v10
  v_sub_f32 v50, v50, v10
  v_sub_f32 v51, v51, v10
  v_sub_f32 v52, v52, v10
  v_sub_f32 v53, v53, v10
  v_sub_f32 v54, v54, v10
  v_sub_f32 v55, v55, v10
  v_sub_f32 v56, v56, v10
  v_sub_f32 v57, v57, v10
  v_sub_f32 v58, v58, v10
  v_sub_f32 v59, v59, v10
  v_sub_f32 v60, v60, v10
  v_sub_f32 v61, v61, v10
  v_sub_f32 v62, v62, v10
  v_sub_f32 v63, v63, v10
  v_sub_f32 v64, v64, v10
  v_sub_f32 v65, v65, v10
  v_sub_f32 v66, v66, v10
  v_sub_f32 v67, v67, v10
  v_sub_f32 v68, v68, v10
  v_sub_f32 v69, v69, v10
  v_sub_f32 v70, v70, v10
  v_sub_f32 v71, v71, v10
  v_sub_f32 v72, v72, v10
  v_sub_f32 v73, v73, v10
  v_sub_f32 v74, v74, v10
  v_sub_f32 v75, v75, v10
  v_sub_f32 v76, v76, v10
  v_sub_f32 v77, v77, v10
  v_sub_f32 v78, v78, v10
  v_sub_f32 v79, v79, v10
  v_exp_f32 v64, v64
  v_exp_f32 v65, v65
  v_exp_f32 v66, v66
  v_exp_f32 v67, v67
  v_exp_f32 v68, v68
  v_exp_f32 v69, v69
  v_exp_f32 v70, v70
  v_exp_f32 v71, v71
  v_exp_f32 v72, v72
  v_exp_f32 v73, v73
  v_exp_f32 v74, v74
  v_exp_f32 v75, v75
  v_exp_f32 v76, v76
  v_exp_f32 v77, v77
  v_exp_f32 v78, v78
  v_exp_f32 v79, v79
  v_add_f32 v26, v64, v65
  v_add_f32 v26, v26, v66
  v_add_f32 v26, v26, v67
  v_add_f32 v26, v26, v68
  v_add_f32 v26, v26, v69
  v_add_f32 v26, v26, v70
  v_add_f32 v26, v26, v71
  v_add_f32 v26, v26, v72
  v_add_f32 v26, v26, v73
  v_add_f32 v26, v26, v74
  v_add_f32 v26, v26, v75
  v_add_f32 v26, v26, v76
  v_add_f32 v26, v26, v77
  v_add_f32 v26, v26, v78
  v_add_f32 v26, v26, v79
  v_cvt_pk_bf16_f32 v88, v64, v65
  v_cvt_pk_bf16_f32 v89, v66, v67
  v_cvt_pk_bf16_f32 v90, v68, v69
  v_cvt_pk_bf16_f32 v91, v70, v71
  v_cvt_pk_bf16_f32 v92, v72, v73
  v_cvt_pk_bf16_f32 v93, v74, v75
  v_cvt_pk_bf16_f32 v94, v76, v77
  v_cvt_pk_bf16_f32 v95, v78, v79
  v_max3_f32 v10, v192, v193, v194
  v_max3_f32 v10, v10, v195, v196
  v_max3_f32 v10, v10, v197, v198
  v_max3_f32 v10, v10, v199, v200
  v_max3_f32 v10, v10, v201, v202
  v_max3_f32 v10, v10, v203, v204
  v_max3_f32 v10, v10, v205, v206
  v_max_f32 v10, v10, v207
  v_mov_b32 v11, v10
  s_nop 1
  v_permlane32_swap_b32 v10, v11
  s_nop 1
  v_max_f32 v10, v10, v11
  v_max_f32 v10, 0, v10
  v_exp_f32 v11, -v10
  v_sub_f32 v6, v6, v10
  v_mul_f32 v24, v24, v11
  v_accvgpr_read_b32 v12, a128
  v_mul_f32 v12, v12, v11
  v_accvgpr_write_b32 a128, v12
  v_accvgpr_read_b32 v12, a129
  v_mul_f32 v12, v12, v11
  v_accvgpr_write_b32 a129, v12
  v_accvgpr_read_b32 v12, a130
  v_mul_f32 v12, v12, v11
  v_accvgpr_write_b32 a130, v12
  v_accvgpr_read_b32 v12, a131
  v_mul_f32 v12, v12, v11
  v_accvgpr_write_b32 a131, v12
  v_accvgpr_read_b32 v12, a132
  v_mul_f32 v12, v12, v11
  v_accvgpr_write_b32 a132, v12
  v_accvgpr_read_b32 v12, a133
  v_mul_f32 v12, v12, v11
  v_accvgpr_write_b32 a133, v12
  v_accvgpr_read_b32 v12, a134
  v_mul_f32 v12, v12, v11
  v_accvgpr_write_b32 a134, v12
  v_accvgpr_read_b32 v12, a135
  v_mul_f32 v12, v12, v11
  v_accvgpr_write_b32 a135, v12
  v_accvgpr_read_b32 v12, a136
  v_mul_f32 v12, v12, v11
  v_accvgpr_write_b32 a136, v12
  v_accvgpr_read_b32 v12, a137
  v_mul_f32 v12, v12, v11
  v_accvgpr_write_b32 a137, v12
  v_accvgpr_read_b32 v12, a138
  v_mul_f32 v12, v12, v11
  v_accvgpr_write_b32 a138, v12
  v_accvgpr_read_b32 v12, a139
  v_mul_f32 v12, v12, v11
  v_accvgpr_write_b32 a139, v12
  v_accvgpr_read_b32 v12, a140
  v_mul_f32 v12, v12, v11
  v_accvgpr_write_b32 a140, v12
  v_accvgpr_read_b32 v12, a141
  v_mul_f32 v12, v12, v11
  v_accvgpr_write_b32 a141, v12
  v_accvgpr_read_b32 v12, a142
  v_mul_f32 v12, v12, v11
  v_accvgpr_write_b32 a142, v12
  v_accvgpr_read_b32 v12, a143
  v_mul_f32 v12, v12, v11
  v_accvgpr_write_b32 a143, v12
  v_accvgpr_read_b32 v12, a144
  v_mul_f32 v12, v12, v11
  v_accvgpr_write_b32 a144, v12
  v_accvgpr_read_b32 v12, a145
  v_mul_f32 v12, v12, v11
  v_accvgpr_write_b32 a145, v12
  v_accvgpr_read_b32 v12, a146
  v_mul_f32 v12, v12, v11
  v_accvgpr_write_b32 a146, v12
  v_accvgpr_read_b32 v12, a147
  v_mul_f32 v12, v12, v11
  v_accvgpr_write_b32 a147, v12
  v_accvgpr_read_b32 v12, a148
  v_mul_f32 v12, v12, v11
  v_accvgpr_write_b32 a148, v12
  v_accvgpr_read_b32 v12, a149
  v_mul_f32 v12, v12, v11
  v_accvgpr_write_b32 a149, v12
  v_accvgpr_read_b32 v12, a150
  v_mul_f32 v12, v12, v11
  v_accvgpr_write_b32 a150, v12
  v_accvgpr_read_b32 v12, a151
  v_mul_f32 v12, v12, v11
  v_accvgpr_write_b32 a151, v12
  v_accvgpr_read_b32 v12, a152
  v_mul_f32 v12, v12, v11
  v_accvgpr_write_b32 a152, v12
  v_accvgpr_read_b32 v12, a153
  v_mul_f32 v12, v12, v11
  v_accvgpr_write_b32 a153, v12
  v_accvgpr_read_b32 v12, a154
  v_mul_f32 v12, v12, v11
  v_accvgpr_write_b32 a154, v12
  v_accvgpr_read_b32 v12, a155
  v_mul_f32 v12, v12, v11
  v_accvgpr_write_b32 a155, v12
  v_accvgpr_read_b32 v12, a156
  v_mul_f32 v12, v12, v11
  v_accvgpr_write_b32 a156, v12
  v_accvgpr_read_b32 v12, a157
  v_mul_f32 v12, v12, v11
  v_accvgpr_write_b32 a157, v12
  v_accvgpr_read_b32 v12, a158
  v_mul_f32 v12, v12, v11
  v_accvgpr_write_b32 a158, v12
  v_accvgpr_read_b32 v12, a159
  v_mul_f32 v12, v12, v11
  v_accvgpr_write_b32 a159, v12
  v_accvgpr_read_b32 v12, a160
  v_mul_f32 v12, v12, v11
  v_accvgpr_write_b32 a160, v12
  v_accvgpr_read_b32 v12, a161
  v_mul_f32 v12, v12, v11
  v_accvgpr_write_b32 a161, v12
  v_accvgpr_read_b32 v12, a162
  v_mul_f32 v12, v12, v11
  v_accvgpr_write_b32 a162, v12
  v_accvgpr_read_b32 v12, a163
  v_mul_f32 v12, v12, v11
  v_accvgpr_write_b32 a163, v12
  v_accvgpr_read_b32 v12, a164
  v_mul_f32 v12, v12, v11
  v_accvgpr_write_b32 a164, v12
  v_accvgpr_read_b32 v12, a165
  v_mul_f32 v12, v12, v11
  v_accvgpr_write_b32 a165, v12
  v_accvgpr_read_b32 v12, a166
  v_mul_f32 v12, v12, v11
  v_accvgpr_write_b32 a166, v12
  v_accvgpr_read_b32 v12, a167
  v_mul_f32 v12, v12, v11
  v_accvgpr_write_b32 a167, v12
  v_accvgpr_read_b32 v12, a168
  v_mul_f32 v12, v12, v11
  v_accvgpr_write_b32 a168, v12
  v_accvgpr_read_b32 v12, a169
  v_mul_f32 v12, v12, v11
  v_accvgpr_write_b32 a169, v12
  v_accvgpr_read_b32 v12, a170
  v_mul_f32 v12, v12, v11
  v_accvgpr_write_b32 a170, v12
  v_accvgpr_read_b32 v12, a171
  v_mul_f32 v12, v12, v11
  v_accvgpr_write_b32 a171, v12
  v_accvgpr_read_b32 v12, a172
  v_mul_f32 v12, v12, v11
  v_accvgpr_write_b32 a172, v12
  v_accvgpr_read_b32 v12, a173
  v_mul_f32 v12, v12, v11
  v_accvgpr_write_b32 a173, v12
  v_accvgpr_read_b32 v12, a174
  v_mul_f32 v12, v12, v11
  v_accvgpr_write_b32 a174, v12
  v_accvgpr_read_b32 v12, a175
  v_mul_f32 v12, v12, v11
  v_accvgpr_write_b32 a175, v12
  v_accvgpr_read_b32 v12, a176
  v_mul_f32 v12, v12, v11
  v_accvgpr_write_b32 a176, v12
  v_accvgpr_read_b32 v12, a177
  v_mul_f32 v12, v12, v11
  v_accvgpr_write_b32 a177, v12
  v_accvgpr_read_b32 v12, a178
  v_mul_f32 v12, v12, v11
  v_accvgpr_write_b32 a178, v12
  v_accvgpr_read_b32 v12, a179
  v_mul_f32 v12, v12, v11
  v_accvgpr_write_b32 a179, v12
  v_accvgpr_read_b32 v12, a180
  v_mul_f32 v12, v12, v11
  v_accvgpr_write_b32 a180, v12
  v_accvgpr_read_b32 v12, a181
  v_mul_f32 v12, v12, v11
  v_accvgpr_write_b32 a181, v12
  v_accvgpr_read_b32 v12, a182
  v_mul_f32 v12, v12, v11
  v_accvgpr_write_b32 a182, v12
  v_accvgpr_read_b32 v12, a183
  v_mul_f32 v12, v12, v11
  v_accvgpr_write_b32 a183, v12
  v_accvgpr_read_b32 v12, a184
  v_mul_f32 v12, v12, v11
  v_accvgpr_write_b32 a184, v12
  v_accvgpr_read_b32 v12, a185
  v_mul_f32 v12, v12, v11
  v_accvgpr_write_b32 a185, v12
  v_accvgpr_read_b32 v12, a186
  v_mul_f32 v12, v12, v11
  v_accvgpr_write_b32 a186, v12
  v_accvgpr_read_b32 v12, a187
  v_mul_f32 v12, v12, v11
  v_accvgpr_write_b32 a187, v12
  v_accvgpr_read_b32 v12, a188
  v_mul_f32 v12, v12, v11
  v_accvgpr_write_b32 a188, v12
  v_accvgpr_read_b32 v12, a189
  v_mul_f32 v12, v12, v11
  v_accvgpr_write_b32 a189, v12
  v_accvgpr_read_b32 v12, a190
  v_mul_f32 v12, v12, v11
  v_accvgpr_write_b32 a190, v12
  v_accvgpr_read_b32 v12, a191
  v_mul_f32 v12, v12, v11
  v_accvgpr_write_b32 a191, v12
  v_sub_f32 v176, v176, v10
  v_sub_f32 v177, v177, v10
  v_sub_f32 v178, v178, v10
  v_sub_f32 v179, v179, v10
  v_sub_f32 v180, v180, v10
  v_sub_f32 v181, v181, v10
  v_sub_f32 v182, v182, v10
  v_sub_f32 v183, v183, v10
  v_sub_f32 v184, v184, v10
  v_sub_f32 v185, v185, v10
  v_sub_f32 v186, v186, v10
  v_sub_f32 v187, v187, v10
  v_sub_f32 v188, v188, v10
  v_sub_f32 v189, v189, v10
  v_sub_f32 v190, v190, v10
  v_sub_f32 v191, v191, v10
  v_sub_f32 v192, v192, v10
  v_sub_f32 v193, v193, v10
  v_sub_f32 v194, v194, v10
  v_sub_f32 v195, v195, v10
  v_sub_f32 v196, v196, v10
  v_sub_f32 v197, v197, v10
  v_sub_f32 v198, v198, v10
  v_sub_f32 v199, v199, v10
  v_sub_f32 v200, v200, v10
  v_sub_f32 v201, v201, v10
  v_sub_f32 v202, v202, v10
  v_sub_f32 v203, v203, v10
  v_sub_f32 v204, v204, v10
  v_sub_f32 v205, v205, v10
  v_sub_f32 v206, v206, v10
  v_sub_f32 v207, v207, v10
  v_exp_f32 v192, v192
  v_exp_f32 v193, v193
  v_exp_f32 v194, v194
  v_exp_f32 v195, v195
  v_exp_f32 v196, v196
  v_exp_f32 v197, v197
  v_exp_f32 v198, v198
  v_exp_f32 v199, v199
  v_exp_f32 v200, v200
  v_exp_f32 v201, v201
  v_exp_f32 v202, v202
  v_exp_f32 v203, v203
  v_exp_f32 v204, v204
  v_exp_f32 v205, v205
  v_exp_f32 v206, v206
  v_exp_f32 v207, v207
  v_add_f32 v27, v192, v193
  v_add_f32 v27, v27, v194
  v_add_f32 v27, v27, v195
  v_add_f32 v27, v27, v196
  v_add_f32 v27, v27, v197
  v_add_f32 v27, v27, v198
  v_add_f32 v27, v27, v199
  v_add_f32 v27, v27, v200
  v_add_f32 v27, v27, v201
  v_add_f32 v27, v27, v202
  v_add_f32 v27, v27, v203
  v_add_f32 v27, v27, v204
  v_add_f32 v27, v27, v205
  v_add_f32 v27, v27, v206
  v_add_f32 v27, v27, v207
  v_cvt_pk_bf16_f32 v216, v192, v193
  v_cvt_pk_bf16_f32 v217, v194, v195
  v_cvt_pk_bf16_f32 v218, v196, v197
  v_cvt_pk_bf16_f32 v219, v198, v199
  v_cvt_pk_bf16_f32 v220, v200, v201
  v_cvt_pk_bf16_f32 v221, v202, v203
  v_cvt_pk_bf16_f32 v222, v204, v205
  v_cvt_pk_bf16_f32 v223, v206, v207
hmask_62:
  s_add_u32 s29, s18, 2
  s_lshl_b32 s30, s29, 5
  s_sub_i32 s30, s39, s30
  v_add_u32 v12, s30, v4
  v_mov_b32 v13, s32
  v_cmp_gt_i32 s[56:57], 0, v12
  v_cmp_gt_i32 s[58:59], 1, v12
  v_cmp_gt_i32 s[60:61], 2, v12
  v_cmp_gt_i32 s[62:63], 3, v12
  v_cndmask_b32 v32, v5, v13, s[56:57]
  v_cndmask_b32 v33, v5, v13, s[58:59]
  v_cndmask_b32 v34, v5, v13, s[60:61]
  v_cndmask_b32 v35, v5, v13, s[62:63]
  v_cmp_gt_i32 s[56:57], 8, v12
  v_cmp_gt_i32 s[58:59], 9, v12
  v_cmp_gt_i32 s[60:61], 10, v12
  v_cmp_gt_i32 s[62:63], 11, v12
  v_cndmask_b32 v36, v5, v13, s[56:57]
  v_cndmask_b32 v37, v5, v13, s[58:59]
  v_cndmask_b32 v38, v5, v13, s[60:61]
  v_cndmask_b32 v39, v5, v13, s[62:63]
  v_cmp_gt_i32 s[56:57], 16, v12
  v_cmp_gt_i32 s[58:59], 17, v12
  v_cmp_gt_i32 s[60:61], 18, v12
  v_cmp_gt_i32 s[62:63], 19, v12
  v_cndmask_b32 v40, v5, v13, s[56:57]
  v_cndmask_b32 v41, v5, v13, s[58:59]
  v_cndmask_b32 v42, v5, v13, s[60:61]
  v_cndmask_b32 v43, v5, v13, s[62:63]
  v_cmp_gt_i32 s[56:57], 24, v12
  v_cmp_gt_i32 s[58:59], 25, v12
  v_cmp_gt_i32 s[60:61], 26, v12
  v_cmp_gt_i32 s[62:63], 27, v12
  v_cndmask_b32 v44, v5, v13, s[56:57]
  v_cndmask_b32 v45, v5, v13, s[58:59]
  v_cndmask_b32 v46, v5, v13, s[60:61]
  v_cndmask_b32 v47, v5, v13, s[62:63]
  s_branch aret_27
asp_31:
  s_cbranch_vccz hmask_63
asl_32:
  v_max3_f32 v10, v48, v49, v50
  v_max3_f32 v10, v10, v51, v52
  v_max3_f32 v10, v10, v53, v54
  v_max3_f32 v10, v10, v55, v56
  v_max3_f32 v10, v10, v57, v58
  v_max3_f32 v10, v10, v59, v60
  v_max3_f32 v10, v10, v61, v62
  v_max_f32 v10, v10, v63
  v_mov_b32 v11, v10
  s_nop 1
  v_permlane32_swap_b32 v10, v11
  s_nop 1
  v_max_f32 v10, v10, v11
  v_max_f32 v10, 0, v10
  v_exp_f32 v11, -v10
  v_sub_f32 v5, v5, v10
  v_mul_f32 v7, v7, v11
  v_mul_f32 v96, v96, v11
  v_mul_f32 v97, v97, v11
  v_mul_f32 v98, v98, v11
  v_mul_f32 v99, v99, v11
  v_mul_f32 v100, v100, v11
  v_mul_f32 v101, v101, v11
  v_mul_f32 v102, v102, v11
  v_mul_f32 v103, v103, v11
  v_mul_f32 v104, v104, v11
  v_mul_f32 v105, v105, v11
  v_mul_f32 v106, v106, v11
  v_mul_f32 v107, v107, v11
  v_mul_f32 v108, v108, v11
  v_mul_f32 v109, v109, v11
  v_mul_f32 v110, v110, v11
  v_mul_f32 v111, v111, v11
  v_mul_f32 v112, v112, v11
  v_mul_f32 v113, v113, v11
  v_mul_f32 v114, v114, v11
  v_mul_f32 v115, v115, v11
  v_mul_f32 v116, v116, v11
  v_mul_f32 v117, v117, v11
  v_mul_f32 v118, v118, v11
  v_mul_f32 v119, v119, v11
  v_mul_f32 v120, v120, v11
  v_mul_f32 v121, v121, v11
  v_mul_f32 v122, v122, v11
  v_mul_f32 v123, v123, v11
  v_mul_f32 v124, v124, v11
  v_mul_f32 v125, v125, v11
  v_mul_f32 v126, v126, v11
  v_mul_f32 v127, v127, v11
  v_mul_f32 v128, v128, v11
  v_mul_f32 v129, v129, v11
  v_mul_f32 v130, v130, v11
  v_mul_f32 v131, v131, v11
  v_mul_f32 v132, v132, v11
  v_mul_f32 v133, v133, v11
  v_mul_f32 v134, v134, v11
  v_mul_f32 v135, v135, v11
  v_mul_f32 v136, v136, v11
  v_mul_f32 v137, v137, v11
  v_mul_f32 v138, v138, v11
  v_mul_f32 v139, v139, v11
  v_mul_f32 v140, v140, v11
  v_mul_f32 v141, v141, v11
  v_mul_f32 v142, v142, v11
  v_mul_f32 v143, v143, v11
  v_mul_f32 v144, v144, v11
  v_mul_f32 v145, v145, v11
  v_mul_f32 v146, v146, v11
  v_mul_f32 v147, v147, v11
  v_mul_f32 v148, v148, v11
  v_mul_f32 v149, v149, v11
  v_mul_f32 v150, v150, v11
  v_mul_f32 v151, v151, v11
  v_mul_f32 v152, v152, v11
  v_mul_f32 v153, v153, v11
  v_mul_f32 v154, v154, v11
  v_mul_f32 v155, v155, v11
  v_mul_f32 v156, v156, v11
  v_mul_f32 v157, v157, v11
  v_mul_f32 v158, v158, v11
  v_mul_f32 v159, v159, v11
  v_sub_f32 v64, v64, v10
  v_sub_f32 v65, v65, v10
  v_sub_f32 v66, v66, v10
  v_sub_f32 v67, v67, v10
  v_sub_f32 v68, v68, v10
  v_sub_f32 v69, v69, v10
  v_sub_f32 v70, v70, v10
  v_sub_f32 v71, v71, v10
  v_sub_f32 v72, v72, v10
  v_sub_f32 v73, v73, v10
  v_sub_f32 v74, v74, v10
  v_sub_f32 v75, v75, v10
  v_sub_f32 v76, v76, v10
  v_sub_f32 v77, v77, v10
  v_sub_f32 v78, v78, v10
  v_sub_f32 v79, v79, v10
  v_sub_f32 v48, v48, v10
  v_sub_f32 v49, v49, v10
  v_sub_f32 v50, v50, v10
  v_sub_f32 v51, v51, v10
  v_sub_f32 v52, v52, v10
  v_sub_f32 v53, v53, v10
  v_sub_f32 v54, v54, v10
  v_sub_f32 v55, v55, v10
  v_sub_f32 v56, v56, v10
  v_sub_f32 v57, v57, v10
  v_sub_f32 v58, v58, v10
  v_sub_f32 v59, v59, v10
  v_sub_f32 v60, v60, v10
  v_sub_f32 v61, v61, v10
  v_sub_f32 v62, v62, v10
  v_sub_f32 v63, v63, v10
  v_exp_f32 v48, v48
  v_exp_f32 v49, v49
  v_exp_f32 v50, v50
  v_exp_f32 v51, v51
  v_exp_f32 v52, v52
  v_exp_f32 v53, v53
  v_exp_f32 v54, v54
  v_exp_f32 v55, v55
  v_exp_f32 v56, v56
  v_exp_f32 v57, v57
  v_exp_f32 v58, v58
  v_exp_f32 v59, v59
  v_exp_f32 v60, v60
  v_exp_f32 v61, v61
  v_exp_f32 v62, v62
  v_exp_f32 v63, v63
  v_add_f32 v26, v48, v49
  v_add_f32 v26, v26, v50
  v_add_f32 v26, v26, v51
  v_add_f32 v26, v26, v52
  v_add_f32 v26, v26, v53
  v_add_f32 v26, v26, v54
  v_add_f32 v26, v26, v55
  v_add_f32 v26, v26, v56
  v_add_f32 v26, v26, v57
  v_add_f32 v26, v26, v58
  v_add_f32 v26, v26, v59
  v_add_f32 v26, v26, v60
  v_add_f32 v26, v26, v61
  v_add_f32 v26, v26, v62
  v_add_f32 v26, v26, v63
  v_cvt_pk_bf16_f32 v80, v48, v49
  v_cvt_pk_bf16_f32 v81, v50, v51
  v_cvt_pk_bf16_f32 v82, v52, v53
  v_cvt_pk_bf16_f32 v83, v54, v55
  v_cvt_pk_bf16_f32 v84, v56, v57
  v_cvt_pk_bf16_f32 v85, v58, v59
  v_cvt_pk_bf16_f32 v86, v60, v61
  v_cvt_pk_bf16_f32 v87, v62, v63
hmask_63:
  s_add_u32 s29, s18, 2
  s_lshl_b32 s30, s29, 5
  s_sub_i32 s30, s39, s30
  v_add_u32 v12, s30, v4
  v_mov_b32 v13, s32
  v_cmp_gt_i32 s[56:57], 0, v12
  v_cmp_gt_i32 s[58:59], 1, v12
  v_cmp_gt_i32 s[60:61], 2, v12
  v_cmp_gt_i32 s[62:63], 3, v12
  v_cndmask_b32 v32, v5, v13, s[56:57]
  v_cndmask_b32 v33, v5, v13, s[58:59]
  v_cndmask_b32 v34, v5, v13, s[60:61]
  v_cndmask_b32 v35, v5, v13, s[62:63]
  v_cmp_gt_i32 s[56:57], 8, v12
  v_cmp_gt_i32 s[58:59], 9, v12
  v_cmp_gt_i32 s[60:61], 10, v12
  v_cmp_gt_i32 s[62:63], 11, v12
  v_cndmask_b32 v36, v5, v13, s[56:57]
  v_cndmask_b32 v37, v5, v13, s[58:59]
  v_cndmask_b32 v38, v5, v13, s[60:61]
  v_cndmask_b32 v39, v5, v13, s[62:63]
  v_cmp_gt_i32 s[56:57], 16, v12
  v_cmp_gt_i32 s[58:59], 17, v12
  v_cmp_gt_i32 s[60:61], 18, v12
  v_cmp_gt_i32 s[62:63], 19, v12
  v_cndmask_b32 v40, v5, v13, s[56:57]
  v_cndmask_b32 v41, v5, v13, s[58:59]
  v_cndmask_b32 v42, v5, v13, s[60:61]
  v_cndmask_b32 v43, v5, v13, s[62:63]
  v_cmp_gt_i32 s[56:57], 24, v12
  v_cmp_gt_i32 s[58:59], 25, v12
  v_cmp_gt_i32 s[60:61], 26, v12
  v_cmp_gt_i32 s[62:63], 27, v12
  v_cndmask_b32 v44, v5, v13, s[56:57]
  v_cndmask_b32 v45, v5, v13, s[58:59]
  v_cndmask_b32 v46, v5, v13, s[60:61]
  v_cndmask_b32 v47, v5, v13, s[62:63]
  s_branch aret_30
asp_34:
  s_cbranch_vccz hmask_64
asl_35:
  v_max3_f32 v10, v48, v49, v50
  v_max3_f32 v10, v10, v51, v52
  v_max3_f32 v10, v10, v53, v54
  v_max3_f32 v10, v10, v55, v56
  v_max3_f32 v10, v10, v57, v58
  v_max3_f32 v10, v10, v59, v60
  v_max3_f32 v10, v10, v61, v62
  v_max_f32 v10, v10, v63
  v_mov_b32 v11, v10
  s_nop 1
  v_permlane32_swap_b32 v10, v11
  s_nop 1
  v_max_f32 v10, v10, v11
  v_max_f32 v10, 0, v10
  v_exp_f32 v11, -v10
  v_sub_f32 v5, v5, v10
  v_mul_f32 v7, v7, v11
  v_mul_f32 v96, v96, v11
  v_mul_f32 v97, v97, v11
  v_mul_f32 v98, v98, v11
  v_mul_f32 v99, v99, v11
  v_mul_f32 v100, v100, v11
  v_mul_f32 v101, v101, v11
  v_mul_f32 v102, v102, v11
  v_mul_f32 v103, v103, v11
  v_mul_f32 v104, v104, v11
  v_mul_f32 v105, v105, v11
  v_mul_f32 v106, v106, v11
  v_mul_f32 v107, v107, v11
  v_mul_f32 v108, v108, v11
  v_mul_f32 v109, v109, v11
  v_mul_f32 v110, v110, v11
  v_mul_f32 v111, v111, v11
  v_mul_f32 v112, v112, v11
  v_mul_f32 v113, v113, v11
  v_mul_f32 v114, v114, v11
  v_mul_f32 v115, v115, v11
  v_mul_f32 v116, v116, v11
  v_mul_f32 v117, v117, v11
  v_mul_f32 v118, v118, v11
  v_mul_f32 v119, v119, v11
  v_mul_f32 v120, v120, v11
  v_mul_f32 v121, v121, v11
  v_mul_f32 v122, v122, v11
  v_mul_f32 v123, v123, v11
  v_mul_f32 v124, v124, v11
  v_mul_f32 v125, v125, v11
  v_mul_f32 v126, v126, v11
  v_mul_f32 v127, v127, v11
  v_mul_f32 v128, v128, v11
  v_mul_f32 v129, v129, v11
  v_mul_f32 v130, v130, v11
  v_mul_f32 v131, v131, v11
  v_mul_f32 v132, v132, v11
  v_mul_f32 v133, v133, v11
  v_mul_f32 v134, v134, v11
  v_mul_f32 v135, v135, v11
  v_mul_f32 v136, v136, v11
  v_mul_f32 v137, v137, v11
  v_mul_f32 v138, v138, v11
  v_mul_f32 v139, v139, v11
  v_mul_f32 v140, v140, v11
  v_mul_f32 v141, v141, v11
  v_mul_f32 v142, v142, v11
  v_mul_f32 v143, v143, v11
  v_mul_f32 v144, v144, v11
  v_mul_f32 v145, v145, v11
  v_mul_f32 v146, v146, v11
  v_mul_f32 v147, v147, v11
  v_mul_f32 v148, v148, v11
  v_mul_f32 v149, v149, v11
  v_mul_f32 v150, v150, v11
  v_mul_f32 v151, v151, v11
  v_mul_f32 v152, v152, v11
  v_mul_f32 v153, v153, v11
  v_mul_f32 v154, v154, v11
  v_mul_f32 v155, v155, v11
  v_mul_f32 v156, v156, v11
  v_mul_f32 v157, v157, v11
  v_mul_f32 v158, v158, v11
  v_mul_f32 v159, v159, v11
  v_sub_f32 v64, v64, v10
  v_sub_f32 v65, v65, v10
  v_sub_f32 v66, v66, v10
  v_sub_f32 v67, v67, v10
  v_sub_f32 v68, v68, v10
  v_sub_f32 v69, v69, v10
  v_sub_f32 v70, v70, v10
  v_sub_f32 v71, v71, v10
  v_sub_f32 v72, v72, v10
  v_sub_f32 v73, v73, v10
  v_sub_f32 v74, v74, v10
  v_sub_f32 v75, v75, v10
  v_sub_f32 v76, v76, v10
  v_sub_f32 v77, v77, v10
  v_sub_f32 v78, v78, v10
  v_sub_f32 v79, v79, v10
  v_sub_f32 v48, v48, v10
  v_sub_f32 v49, v49, v10
  v_sub_f32 v50, v50, v10
  v_sub_f32 v51, v51, v10
  v_sub_f32 v52, v52, v10
  v_sub_f32 v53, v53, v10
  v_sub_f32 v54, v54, v10
  v_sub_f32 v55, v55, v10
  v_sub_f32 v56, v56, v10
  v_sub_f32 v57, v57, v10
  v_sub_f32 v58, v58, v10
  v_sub_f32 v59, v59, v10
  v_sub_f32 v60, v60, v10
  v_sub_f32 v61, v61, v10
  v_sub_f32 v62, v62, v10
  v_sub_f32 v63, v63, v10
  v_exp_f32 v48, v48
  v_exp_f32 v49, v49
  v_exp_f32 v50, v50
  v_exp_f32 v51, v51
  v_exp_f32 v52, v52
  v_exp_f32 v53, v53
  v_exp_f32 v54, v54
  v_exp_f32 v55, v55
  v_exp_f32 v56, v56
  v_exp_f32 v57, v57
  v_exp_f32 v58, v58
  v_exp_f32 v59, v59
  v_exp_f32 v60, v60
  v_exp_f32 v61, v61
  v_exp_f32 v62, v62
  v_exp_f32 v63, v63
  v_add_f32 v26, v48, v49
  v_add_f32 v26, v26, v50
  v_add_f32 v26, v26, v51
  v_add_f32 v26, v26, v52
  v_add_f32 v26, v26, v53
  v_add_f32 v26, v26, v54
  v_add_f32 v26, v26, v55
  v_add_f32 v26, v26, v56
  v_add_f32 v26, v26, v57
  v_add_f32 v26, v26, v58
  v_add_f32 v26, v26, v59
  v_add_f32 v26, v26, v60
  v_add_f32 v26, v26, v61
  v_add_f32 v26, v26, v62
  v_add_f32 v26, v26, v63
  v_cvt_pk_bf16_f32 v80, v48, v49
  v_cvt_pk_bf16_f32 v81, v50, v51
  v_cvt_pk_bf16_f32 v82, v52, v53
  v_cvt_pk_bf16_f32 v83, v54, v55
  v_cvt_pk_bf16_f32 v84, v56, v57
  v_cvt_pk_bf16_f32 v85, v58, v59
  v_cvt_pk_bf16_f32 v86, v60, v61
  v_cvt_pk_bf16_f32 v87, v62, v63
hmask_64:
  s_add_u32 s29, s18, 2
  s_lshl_b32 s30, s29, 5
  s_sub_i32 s30, s39, s30
  v_add_u32 v12, s30, v4
  v_mov_b32 v13, s32
  v_cmp_gt_i32 s[56:57], 0, v12
  v_cmp_gt_i32 s[58:59], 1, v12
  v_cmp_gt_i32 s[60:61], 2, v12
  v_cmp_gt_i32 s[62:63], 3, v12
  v_cndmask_b32 v32, v5, v13, s[56:57]
  v_cndmask_b32 v33, v5, v13, s[58:59]
  v_cndmask_b32 v34, v5, v13, s[60:61]
  v_cndmask_b32 v35, v5, v13, s[62:63]
  v_cmp_gt_i32 s[56:57], 8, v12
  v_cmp_gt_i32 s[58:59], 9, v12
  v_cmp_gt_i32 s[60:61], 10, v12
  v_cmp_gt_i32 s[62:63], 11, v12
  v_cndmask_b32 v36, v5, v13, s[56:57]
  v_cndmask_b32 v37, v5, v13, s[58:59]
  v_cndmask_b32 v38, v5, v13, s[60:61]
  v_cndmask_b32 v39, v5, v13, s[62:63]
  v_cmp_gt_i32 s[56:57], 16, v12
  v_cmp_gt_i32 s[58:59], 17, v12
  v_cmp_gt_i32 s[60:61], 18, v12
  v_cmp_gt_i32 s[62:63], 19, v12
  v_cndmask_b32 v40, v5, v13, s[56:57]
  v_cndmask_b32 v41, v5, v13, s[58:59]
  v_cndmask_b32 v42, v5, v13, s[60:61]
  v_cndmask_b32 v43, v5, v13, s[62:63]
  v_cmp_gt_i32 s[56:57], 24, v12
  v_cmp_gt_i32 s[58:59], 25, v12
  v_cmp_gt_i32 s[60:61], 26, v12
  v_cmp_gt_i32 s[62:63], 27, v12
  v_cndmask_b32 v44, v5, v13, s[56:57]
  v_cndmask_b32 v45, v5, v13, s[58:59]
  v_cndmask_b32 v46, v5, v13, s[60:61]
  v_cndmask_b32 v47, v5, v13, s[62:63]
  s_branch aret_33
asp_37:
  s_cbranch_vccz hmask_65
asl_38:
  v_max3_f32 v10, v64, v65, v66
  v_max3_f32 v10, v10, v67, v68
  v_max3_f32 v10, v10, v69, v70
  v_max3_f32 v10, v10, v71, v72
  v_max3_f32 v10, v10, v73, v74
  v_max3_f32 v10, v10, v75, v76
  v_max3_f32 v10, v10, v77, v78
  v_max_f32 v10, v10, v79
  v_mov_b32 v11, v10
  s_nop 1
  v_permlane32_swap_b32 v10, v11
  s_nop 1
  v_max_f32 v10, v10, v11
  v_max_f32 v10, 0, v10
  v_exp_f32 v11, -v10
  v_sub_f32 v5, v5, v10
  v_mul_f32 v7, v7, v11
  v_mul_f32 v96, v96, v11
  v_mul_f32 v97, v97, v11
  v_mul_f32 v98, v98, v11
  v_mul_f32 v99, v99, v11
  v_mul_f32 v100, v100, v11
  v_mul_f32 v101, v101, v11
  v_mul_f32 v102, v102, v11
  v_mul_f32 v103, v103, v11
  v_mul_f32 v104, v104, v11
  v_mul_f32 v105, v105, v11
  v_mul_f32 v106, v106, v11
  v_mul_f32 v107, v107, v11
  v_mul_f32 v108, v108, v11
  v_mul_f32 v109, v109, v11
  v_mul_f32 v110, v110, v11
  v_mul_f32 v111, v111, v11
  v_mul_f32 v112, v112, v11
  v_mul_f32 v113, v113, v11
  v_mul_f32 v114, v114, v11
  v_mul_f32 v115, v115, v11
  v_mul_f32 v116, v116, v11
  v_mul_f32 v117, v117, v11
  v_mul_f32 v118, v118, v11
  v_mul_f32 v119, v119, v11
  v_mul_f32 v120, v120, v11
  v_mul_f32 v121, v121, v11
  v_mul_f32 v122, v122, v11
  v_mul_f32 v123, v123, v11
  v_mul_f32 v124, v124, v11
  v_mul_f32 v125, v125, v11
  v_mul_f32 v126, v126, v11
  v_mul_f32 v127, v127, v11
  v_mul_f32 v128, v128, v11
  v_mul_f32 v129, v129, v11
  v_mul_f32 v130, v130, v11
  v_mul_f32 v131, v131, v11
  v_mul_f32 v132, v132, v11
  v_mul_f32 v133, v133, v11
  v_mul_f32 v134, v134, v11
  v_mul_f32 v135, v135, v11
  v_mul_f32 v136, v136, v11
  v_mul_f32 v137, v137, v11
  v_mul_f32 v138, v138, v11
  v_mul_f32 v139, v139, v11
  v_mul_f32 v140, v140, v11
  v_mul_f32 v141, v141, v11
  v_mul_f32 v142, v142, v11
  v_mul_f32 v143, v143, v11
  v_mul_f32 v144, v144, v11
  v_mul_f32 v145, v145, v11
  v_mul_f32 v146, v146, v11
  v_mul_f32 v147, v147, v11
  v_mul_f32 v148, v148, v11
  v_mul_f32 v149, v149, v11
  v_mul_f32 v150, v150, v11
  v_mul_f32 v151, v151, v11
  v_mul_f32 v152, v152, v11
  v_mul_f32 v153, v153, v11
  v_mul_f32 v154, v154, v11
  v_mul_f32 v155, v155, v11
  v_mul_f32 v156, v156, v11
  v_mul_f32 v157, v157, v11
  v_mul_f32 v158, v158, v11
  v_mul_f32 v159, v159, v11
  v_sub_f32 v48, v48, v10
  v_sub_f32 v49, v49, v10
  v_sub_f32 v50, v50, v10
  v_sub_f32 v51, v51, v10
  v_sub_f32 v52, v52, v10
  v_sub_f32 v53, v53, v10
  v_sub_f32 v54, v54, v10
  v_sub_f32 v55, v55, v10
  v_sub_f32 v56, v56, v10
  v_sub_f32 v57, v57, v10
  v_sub_f32 v58, v58, v10
  v_sub_f32 v59, v59, v10
  v_sub_f32 v60, v60, v10
  v_sub_f32 v61, v61, v10
  v_sub_f32 v62, v62, v10
  v_sub_f32 v63, v63, v10
  v_sub_f32 v64, v64, v10
  v_sub_f32 v65, v65, v10
  v_sub_f32 v66, v66, v10
  v_sub_f32 v67, v67, v10
  v_sub_f32 v68, v68, v10
  v_sub_f32 v69, v69, v10
  v_sub_f32 v70, v70, v10
  v_sub_f32 v71, v71, v10
  v_sub_f32 v72, v72, v10
  v_sub_f32 v73, v73, v10
  v_sub_f32 v74, v74, v10
  v_sub_f32 v75, v75, v10
  v_sub_f32 v76, v76, v10
  v_sub_f32 v77, v77, v10
  v_sub_f32 v78, v78, v10
  v_sub_f32 v79, v79, v10
  v_exp_f32 v64, v64
  v_exp_f32 v65, v65
  v_exp_f32 v66, v66
  v_exp_f32 v67, v67
  v_exp_f32 v68, v68
  v_exp_f32 v69, v69
  v_exp_f32 v70, v70
  v_exp_f32 v71, v71
  v_exp_f32 v72, v72
  v_exp_f32 v73, v73
  v_exp_f32 v74, v74
  v_exp_f32 v75, v75
  v_exp_f32 v76, v76
  v_exp_f32 v77, v77
  v_exp_f32 v78, v78
  v_exp_f32 v79, v79
  v_add_f32 v26, v64, v65
  v_add_f32 v26, v26, v66
  v_add_f32 v26, v26, v67
  v_add_f32 v26, v26, v68
  v_add_f32 v26, v26, v69
  v_add_f32 v26, v26, v70
  v_add_f32 v26, v26, v71
  v_add_f32 v26, v26, v72
  v_add_f32 v26, v26, v73
  v_add_f32 v26, v26, v74
  v_add_f32 v26, v26, v75
  v_add_f32 v26, v26, v76
  v_add_f32 v26, v26, v77
  v_add_f32 v26, v26, v78
  v_add_f32 v26, v26, v79
  v_cvt_pk_bf16_f32 v88, v64, v65
  v_cvt_pk_bf16_f32 v89, v66, v67
  v_cvt_pk_bf16_f32 v90, v68, v69
  v_cvt_pk_bf16_f32 v91, v70, v71
  v_cvt_pk_bf16_f32 v92, v72, v73
  v_cvt_pk_bf16_f32 v93, v74, v75
  v_cvt_pk_bf16_f32 v94, v76, v77
  v_cvt_pk_bf16_f32 v95, v78, v79
hmask_65:
  s_add_u32 s29, s18, 2
  s_lshl_b32 s30, s29, 5
  s_sub_i32 s30, s39, s30
  v_add_u32 v12, s30, v4
  v_mov_b32 v13, s32
  v_cmp_gt_i32 s[56:57], 0, v12
  v_cmp_gt_i32 s[58:59], 1, v12
  v_cmp_gt_i32 s[60:61], 2, v12
  v_cmp_gt_i32 s[62:63], 3, v12
  v_cndmask_b32 v32, v5, v13, s[56:57]
  v_cndmask_b32 v33, v5, v13, s[58:59]
  v_cndmask_b32 v34, v5, v13, s[60:61]
  v_cndmask_b32 v35, v5, v13, s[62:63]
  v_cmp_gt_i32 s[56:57], 8, v12
  v_cmp_gt_i32 s[58:59], 9, v12
  v_cmp_gt_i32 s[60:61], 10, v12
  v_cmp_gt_i32 s[62:63], 11, v12
  v_cndmask_b32 v36, v5, v13, s[56:57]
  v_cndmask_b32 v37, v5, v13, s[58:59]
  v_cndmask_b32 v38, v5, v13, s[60:61]
  v_cndmask_b32 v39, v5, v13, s[62:63]
  v_cmp_gt_i32 s[56:57], 16, v12
  v_cmp_gt_i32 s[58:59], 17, v12
  v_cmp_gt_i32 s[60:61], 18, v12
  v_cmp_gt_i32 s[62:63], 19, v12
  v_cndmask_b32 v40, v5, v13, s[56:57]
  v_cndmask_b32 v41, v5, v13, s[58:59]
  v_cndmask_b32 v42, v5, v13, s[60:61]
  v_cndmask_b32 v43, v5, v13, s[62:63]
  v_cmp_gt_i32 s[56:57], 24, v12
  v_cmp_gt_i32 s[58:59], 25, v12
  v_cmp_gt_i32 s[60:61], 26, v12
  v_cmp_gt_i32 s[62:63], 27, v12
  v_cndmask_b32 v44, v5, v13, s[56:57]
  v_cndmask_b32 v45, v5, v13, s[58:59]
  v_cndmask_b32 v46, v5, v13, s[60:61]
  v_cndmask_b32 v47, v5, v13, s[62:63]
  s_branch aret_36
asl_41:
  v_max3_f32 v10, v48, v49, v50
  v_max3_f32 v10, v10, v51, v52
  v_max3_f32 v10, v10, v53, v54
  v_max3_f32 v10, v10, v55, v56
  v_max3_f32 v10, v10, v57, v58
  v_max3_f32 v10, v10, v59, v60
  v_max3_f32 v10, v10, v61, v62
  v_max_f32 v10, v10, v63
  v_mov_b32 v11, v10
  s_nop 1
  v_permlane32_swap_b32 v10, v11
  s_nop 1
  v_max_f32 v10, v10, v11
  v_max_f32 v10, 0, v10
  v_exp_f32 v11, -v10
  v_sub_f32 v5, v5, v10
  v_mul_f32 v7, v7, v11
  v_mul_f32 v96, v96, v11
  v_mul_f32 v97, v97, v11
  v_mul_f32 v98, v98, v11
  v_mul_f32 v99, v99, v11
  v_mul_f32 v100, v100, v11
  v_mul_f32 v101, v101, v11
  v_mul_f32 v102, v102, v11
  v_mul_f32 v103, v103, v11
  v_mul_f32 v104, v104, v11
  v_mul_f32 v105, v105, v11
  v_mul_f32 v106, v106, v11
  v_mul_f32 v107, v107, v11
  v_mul_f32 v108, v108, v11
  v_mul_f32 v109, v109, v11
  v_mul_f32 v110, v110, v11
  v_mul_f32 v111, v111, v11
  v_mul_f32 v112, v112, v11
  v_mul_f32 v113, v113, v11
  v_mul_f32 v114, v114, v11
  v_mul_f32 v115, v115, v11
  v_mul_f32 v116, v116, v11
  v_mul_f32 v117, v117, v11
  v_mul_f32 v118, v118, v11
  v_mul_f32 v119, v119, v11
  v_mul_f32 v120, v120, v11
  v_mul_f32 v121, v121, v11
  v_mul_f32 v122, v122, v11
  v_mul_f32 v123, v123, v11
  v_mul_f32 v124, v124, v11
  v_mul_f32 v125, v125, v11
  v_mul_f32 v126, v126, v11
  v_mul_f32 v127, v127, v11
  v_mul_f32 v128, v128, v11
  v_mul_f32 v129, v129, v11
  v_mul_f32 v130, v130, v11
  v_mul_f32 v131, v131, v11
  v_mul_f32 v132, v132, v11
  v_mul_f32 v133, v133, v11
  v_mul_f32 v134, v134, v11
  v_mul_f32 v135, v135, v11
  v_mul_f32 v136, v136, v11
  v_mul_f32 v137, v137, v11
  v_mul_f32 v138, v138, v11
  v_mul_f32 v139, v139, v11
  v_mul_f32 v140, v140, v11
  v_mul_f32 v141, v141, v11
  v_mul_f32 v142, v142, v11
  v_mul_f32 v143, v143, v11
  v_mul_f32 v144, v144, v11
  v_mul_f32 v145, v145, v11
  v_mul_f32 v146, v146, v11
  v_mul_f32 v147, v147, v11
  v_mul_f32 v148, v148, v11
  v_mul_f32 v149, v149, v11
  v_mul_f32 v150, v150, v11
  v_mul_f32 v151, v151, v11
  v_mul_f32 v152, v152, v11
  v_mul_f32 v153, v153, v11
  v_mul_f32 v154, v154, v11
  v_mul_f32 v155, v155, v11
  v_mul_f32 v156, v156, v11
  v_mul_f32 v157, v157, v11
  v_mul_f32 v158, v158, v11
  v_mul_f32 v159, v159, v11
  v_sub_f32 v64, v64, v10
  v_sub_f32 v65, v65, v10
  v_sub_f32 v66, v66, v10
  v_sub_f32 v67, v67, v10
  v_sub_f32 v68, v68, v10
  v_sub_f32 v69, v69, v10
  v_sub_f32 v70, v70, v10
  v_sub_f32 v71, v71, v10
  v_sub_f32 v72, v72, v10
  v_sub_f32 v73, v73, v10
  v_sub_f32 v74, v74, v10
  v_sub_f32 v75, v75, v10
  v_sub_f32 v76, v76, v10
  v_sub_f32 v77, v77, v10
  v_sub_f32 v78, v78, v10
  v_sub_f32 v79, v79, v10
  v_sub_f32 v48, v48, v10
  v_sub_f32 v49, v49, v10
  v_sub_f32 v50, v50, v10
  v_sub_f32 v51, v51, v10
  v_sub_f32 v52, v52, v10
  v_sub_f32 v53, v53, v10
  v_sub_f32 v54, v54, v10
  v_sub_f32 v55, v55, v10
  v_sub_f32 v56, v56, v10
  v_sub_f32 v57, v57, v10
  v_sub_f32 v58, v58, v10
  v_sub_f32 v59, v59, v10
  v_sub_f32 v60, v60, v10
  v_sub_f32 v61, v61, v10
  v_sub_f32 v62, v62, v10
  v_sub_f32 v63, v63, v10
  v_exp_f32 v48, v48
  v_exp_f32 v49, v49
  v_exp_f32 v50, v50
  v_exp_f32 v51, v51
  v_exp_f32 v52, v52
  v_exp_f32 v53, v53
  v_exp_f32 v54, v54
  v_exp_f32 v55, v55
  v_exp_f32 v56, v56
  v_exp_f32 v57, v57
  v_exp_f32 v58, v58
  v_exp_f32 v59, v59
  v_exp_f32 v60, v60
  v_exp_f32 v61, v61
  v_exp_f32 v62, v62
  v_exp_f32 v63, v63
  v_add_f32 v26, v48, v49
  v_add_f32 v26, v26, v50
  v_add_f32 v26, v26, v51
  v_add_f32 v26, v26, v52
  v_add_f32 v26, v26, v53
  v_add_f32 v26, v26, v54
  v_add_f32 v26, v26, v55
  v_add_f32 v26, v26, v56
  v_add_f32 v26, v26, v57
  v_add_f32 v26, v26, v58
  v_add_f32 v26, v26, v59
  v_add_f32 v26, v26, v60
  v_add_f32 v26, v26, v61
  v_add_f32 v26, v26, v62
  v_add_f32 v26, v26, v63
  v_cvt_pk_bf16_f32 v80, v48, v49
  v_cvt_pk_bf16_f32 v81, v50, v51
  v_cvt_pk_bf16_f32 v82, v52, v53
  v_cvt_pk_bf16_f32 v83, v54, v55
  v_cvt_pk_bf16_f32 v84, v56, v57
  v_cvt_pk_bf16_f32 v85, v58, v59
  v_cvt_pk_bf16_f32 v86, v60, v61
  v_cvt_pk_bf16_f32 v87, v62, v63
hmask_66:
  s_add_u32 s29, s18, 2
  s_branch aret_39
asl_44:
  v_max3_f32 v10, v64, v65, v66
  v_max3_f32 v10, v10, v67, v68
  v_max3_f32 v10, v10, v69, v70
  v_max3_f32 v10, v10, v71, v72
  v_max3_f32 v10, v10, v73, v74
  v_max3_f32 v10, v10, v75, v76
  v_max3_f32 v10, v10, v77, v78
  v_max_f32 v10, v10, v79
  v_mov_b32 v11, v10
  s_nop 1
  v_permlane32_swap_b32 v10, v11
  s_nop 1
  v_max_f32 v10, v10, v11
  v_max_f32 v10, 0, v10
  v_exp_f32 v11, -v10
  v_sub_f32 v5, v5, v10
  v_mul_f32 v7, v7, v11
  v_mul_f32 v96, v96, v11
  v_mul_f32 v97, v97, v11
  v_mul_f32 v98, v98, v11
  v_mul_f32 v99, v99, v11
  v_mul_f32 v100, v100, v11
  v_mul_f32 v101, v101, v11
  v_mul_f32 v102, v102, v11
  v_mul_f32 v103, v103, v11
  v_mul_f32 v104, v104, v11
  v_mul_f32 v105, v105, v11
  v_mul_f32 v106, v106, v11
  v_mul_f32 v107, v107, v11
  v_mul_f32 v108, v108, v11
  v_mul_f32 v109, v109, v11
  v_mul_f32 v110, v110, v11
  v_mul_f32 v111, v111, v11
  v_mul_f32 v112, v112, v11
  v_mul_f32 v113, v113, v11
  v_mul_f32 v114, v114, v11
  v_mul_f32 v115, v115, v11
  v_mul_f32 v116, v116, v11
  v_mul_f32 v117, v117, v11
  v_mul_f32 v118, v118, v11
  v_mul_f32 v119, v119, v11
  v_mul_f32 v120, v120, v11
  v_mul_f32 v121, v121, v11
  v_mul_f32 v122, v122, v11
  v_mul_f32 v123, v123, v11
  v_mul_f32 v124, v124, v11
  v_mul_f32 v125, v125, v11
  v_mul_f32 v126, v126, v11
  v_mul_f32 v127, v127, v11
  v_mul_f32 v128, v128, v11
  v_mul_f32 v129, v129, v11
  v_mul_f32 v130, v130, v11
  v_mul_f32 v131, v131, v11
  v_mul_f32 v132, v132, v11
  v_mul_f32 v133, v133, v11
  v_mul_f32 v134, v134, v11
  v_mul_f32 v135, v135, v11
  v_mul_f32 v136, v136, v11
  v_mul_f32 v137, v137, v11
  v_mul_f32 v138, v138, v11
  v_mul_f32 v139, v139, v11
  v_mul_f32 v140, v140, v11
  v_mul_f32 v141, v141, v11
  v_mul_f32 v142, v142, v11
  v_mul_f32 v143, v143, v11
  v_mul_f32 v144, v144, v11
  v_mul_f32 v145, v145, v11
  v_mul_f32 v146, v146, v11
  v_mul_f32 v147, v147, v11
  v_mul_f32 v148, v148, v11
  v_mul_f32 v149, v149, v11
  v_mul_f32 v150, v150, v11
  v_mul_f32 v151, v151, v11
  v_mul_f32 v152, v152, v11
  v_mul_f32 v153, v153, v11
  v_mul_f32 v154, v154, v11
  v_mul_f32 v155, v155, v11
  v_mul_f32 v156, v156, v11
  v_mul_f32 v157, v157, v11
  v_mul_f32 v158, v158, v11
  v_mul_f32 v159, v159, v11
  v_sub_f32 v48, v48, v10
  v_sub_f32 v49, v49, v10
  v_sub_f32 v50, v50, v10
  v_sub_f32 v51, v51, v10
  v_sub_f32 v52, v52, v10
  v_sub_f32 v53, v53, v10
  v_sub_f32 v54, v54, v10
  v_sub_f32 v55, v55, v10
  v_sub_f32 v56, v56, v10
  v_sub_f32 v57, v57, v10
  v_sub_f32 v58, v58, v10
  v_sub_f32 v59, v59, v10
  v_sub_f32 v60, v60, v10
  v_sub_f32 v61, v61, v10
  v_sub_f32 v62, v62, v10
  v_sub_f32 v63, v63, v10
  v_sub_f32 v64, v64, v10
  v_sub_f32 v65, v65, v10
  v_sub_f32 v66, v66, v10
  v_sub_f32 v67, v67, v10
  v_sub_f32 v68, v68, v10
  v_sub_f32 v69, v69, v10
  v_sub_f32 v70, v70, v10
  v_sub_f32 v71, v71, v10
  v_sub_f32 v72, v72, v10
  v_sub_f32 v73, v73, v10
  v_sub_f32 v74, v74, v10
  v_sub_f32 v75, v75, v10
  v_sub_f32 v76, v76, v10
  v_sub_f32 v77, v77, v10
  v_sub_f32 v78, v78, v10
  v_sub_f32 v79, v79, v10
  v_exp_f32 v64, v64
  v_exp_f32 v65, v65
  v_exp_f32 v66, v66
  v_exp_f32 v67, v67
  v_exp_f32 v68, v68
  v_exp_f32 v69, v69
  v_exp_f32 v70, v70
  v_exp_f32 v71, v71
  v_exp_f32 v72, v72
  v_exp_f32 v73, v73
  v_exp_f32 v74, v74
  v_exp_f32 v75, v75
  v_exp_f32 v76, v76
  v_exp_f32 v77, v77
  v_exp_f32 v78, v78
  v_exp_f32 v79, v79
  v_add_f32 v26, v64, v65
  v_add_f32 v26, v26, v66
  v_add_f32 v26, v26, v67
  v_add_f32 v26, v26, v68
  v_add_f32 v26, v26, v69
  v_add_f32 v26, v26, v70
  v_add_f32 v26, v26, v71
  v_add_f32 v26, v26, v72
  v_add_f32 v26, v26, v73
  v_add_f32 v26, v26, v74
  v_add_f32 v26, v26, v75
  v_add_f32 v26, v26, v76
  v_add_f32 v26, v26, v77
  v_add_f32 v26, v26, v78
  v_add_f32 v26, v26, v79
  v_cvt_pk_bf16_f32 v88, v64, v65
  v_cvt_pk_bf16_f32 v89, v66, v67
  v_cvt_pk_bf16_f32 v90, v68, v69
  v_cvt_pk_bf16_f32 v91, v70, v71
  v_cvt_pk_bf16_f32 v92, v72, v73
  v_cvt_pk_bf16_f32 v93, v74, v75
  v_cvt_pk_bf16_f32 v94, v76, v77
  v_cvt_pk_bf16_f32 v95, v78, v79
hmask_67:
  s_add_u32 s29, s18, 2
  s_branch aret_42
.section .rodata,"a"
.p2align 6
.amdhsa_kernel gated_mix__compressed_kv_cla__geglu_ffn__prompt_kernel
  .amdhsa_next_free_vgpr 512
  .amdhsa_next_free_sgpr 102
  .amdhsa_accum_offset 256
  .amdhsa_group_segment_fixed_size 0
  .amdhsa_kernarg_size 112
  .amdhsa_user_sgpr_count 2
  .amdhsa_user_sgpr_kernarg_segment_ptr 1
  .amdhsa_system_sgpr_workgroup_id_x 1
.end_amdhsa_kernel
```
